```python
import torch

def _softmax(x, axis=-1):
    return torch.softmax(x, dim=axis)

def _gelu(x):
    return torch.nn.functional.gelu(x, approximate='tanh')

def _silu(x):
    return torch.nn.functional.silu(x)

def _sigmoid(x):
    return torch.sigmoid(x)

def _layernorm(x, axis=-1, eps=1e-05):
    m = x.mean(dim=axis, keepdim=True)
    v = x.var(dim=axis, keepdim=True, unbiased=False)
    return (x - m) / torch.sqrt(v + eps)

def _scatter_add(tgt, idx, src, axis=0):
    return tgt.clone().index_add_(axis, idx, src)

def _segment_sum(src, seg, n):
    out = torch.zeros((n,) + src.shape[1:], dtype=src.dtype)
    return out.index_add_(0, seg, src)

def _pad(x, pw):
    flat = tuple((v for pair in reversed(pw) for v in pair))
    return torch.nn.functional.pad(x, flat)
kernel_name = 'parallel_sum__compressed_kv_cla__mixer_gmlp__prompt'

def setup_inputs():

    _w = lambda a: (lambda t: t.to(torch.bfloat16) if t.is_floating_point() else t)(torch.as_tensor(a))

    def _A_setup():
        B, H, Sq, Sk, D, M = (1, 32, 2048, 2048, 128, 640)
        Dc = 4 * D
        return {'x': _w((lambda *s: torch.randn(*s, dtype=torch.bfloat16) * 0.05)(B, Sq, M)), 'c_kv': _w((lambda *s: torch.randn(*s, dtype=torch.bfloat16) * 1.6)(B, Sk, Dc)), 'w_q': _w((lambda *s: torch.randn(*s, dtype=torch.bfloat16) * 1.6)(M, H, D) * M ** (-0.5)), 'w_uk': _w((lambda *s: torch.randn(*s, dtype=torch.bfloat16) * 1.6)(Dc, H, D) * Dc ** (-0.5)), 'w_uv': _w((lambda *s: torch.randn(*s, dtype=torch.bfloat16) * 1.6)(Dc, H, D) * Dc ** (-0.5)), 'w_o': _w((lambda *s: torch.randn(*s, dtype=torch.bfloat16) * 1.6)(H, D, M) * (H * D) ** (-0.5))}
    _A_in = _A_setup()

    def _B_setup():
        B, S, D, F = (1, 2048, 640, 1728)
        Fh = F // 2
        return {'x': _w((lambda *s: torch.randn(*s, dtype=torch.bfloat16) * 0.05)(B, S, D)), 'w_in': _w((lambda *s: torch.randn(*s, dtype=torch.bfloat16) * 0.4)(D, 2 * Fh)), 'w_sp': _w(0.01 * (lambda *s: torch.randn(*s, dtype=torch.bfloat16) * 0.4)(S, S)), 'b_sp': _w(1.0 + 0.01 * (lambda *s: torch.randn(*s, dtype=torch.bfloat16) * 0.05)(S)), 'w_out': _w((lambda *s: torch.randn(*s, dtype=torch.bfloat16) * 0.05)(Fh, D))}
    _B_in = _B_setup()
    return {'A_x': _A_in['x'], 'A_c_kv': _A_in['c_kv'], 'A_w_q': _A_in['w_q'], 'A_w_uk': _A_in['w_uk'], 'A_w_uv': _A_in['w_uv'], 'A_w_o': _A_in['w_o'], 'B_x': _B_in['x'], 'B_w_in': _B_in['w_in'], 'B_w_sp': _B_in['w_sp'], 'B_b_sp': _B_in['b_sp'], 'B_w_out': _B_in['w_out']}

def reference(A_x, A_c_kv, A_w_q, A_w_uk, A_w_uv, A_w_o, B_x, B_w_in, B_w_sp, B_b_sp, B_w_out):

    def _A_ref(x, c_kv, w_q, w_uk, w_uv, w_o):
        B, Sq, M = (x.shape[0], x.shape[1], x.shape[2])
        Sk = c_kv.shape[1]
        H, D = (w_q.shape[1], w_q.shape[2])
        q = torch.einsum('bqm,mhd->bhqd', x, w_q)
        k = torch.einsum('bkc,chd->bhkd', c_kv, w_uk)
        v = torch.einsum('bkc,chd->bhkd', c_kv, w_uv)
        scores = torch.einsum('bhqd,bhkd->bhqk', q, k) * D ** (-0.5)
        off = Sk - Sq
        qi = torch.arange(Sq)[:, None]
        kj = torch.arange(Sk)[None, :]
        cmask = kj <= qi + off
        scores = torch.where(cmask[None, None], scores, -1000000000.0)
        p = _softmax(scores, axis=-1)
        ctx = torch.einsum('bhqk,bhkd->bhqd', p, v)
        return torch.einsum('bhqd,hdm->bqm', ctx, w_o)

    def _B_ref(x, w_in, w_sp, b_sp, w_out):
        B, S, D = x.shape
        F = w_in.shape[-1]
        Fh = F // 2
        z = _gelu(torch.einsum('bsd,df->bsf', x, w_in))
        z1 = z[..., :Fh].clone()
        z2 = _layernorm(z[..., Fh:], axis=-1)
        g = torch.einsum('ts,bsf->btf', w_sp, z2) + b_sp[None, :, None]
        return torch.einsum('bsf,fd->bsd', z1 * g, w_out)
    x = A_x
    xn = _layernorm(x, axis=-1)
    return x + _A_ref(xn, A_c_kv, A_w_q, A_w_uk, A_w_uv, A_w_o) + _B_ref(xn, B_w_in, B_w_sp, B_b_sp, B_w_out)
```

```asm
; @launch kernel=fk_kernel grid=(256,1,1) block=(256,1,1) lds=163840
.amdgcn_target "amdgcn-amd-amdhsa--gfx950"
.text
.globl fk_kernel
.p2align 8
.type fk_kernel,@function
fk_kernel:
    s_cmp_ge_u32 s2, 256
    s_cbranch_scc1 fk_end0
    s_load_dwordx8 s[16:23], s[0:1], 0
    s_load_dwordx4 s[24:27], s[0:1], 32
    s_load_dwordx8 s[32:39], s[0:1], 64
    s_load_dwordx4 s[40:43], s[0:1], 96
    s_load_dwordx2 s[76:77], s[0:1], 56
    v_and_b32 v1, 63, v0
    v_lshrrev_b32 v29, 6, v0
    s_nop 0
    v_readfirstlane_b32 s3, v29
    s_and_b32 s4, s2, 7
    s_lshr_b32 s5, s2, 3
    v_lshlrev_b32 v2, 4, v1
    s_getpc_b64 s[28:29]
fk_c0:
    s_lshl_b32 s11, s5, 2
    s_add_u32 s11, s11, s3
    s_lshl_b32 s11, s11, 10
    s_add_u32 s28, s28, s11
    s_addc_u32 s29, s29, 0
    s_sub_i32 s30, fk_last-fk_c0, s11
    s_max_i32 s30, s30, 0
    s_mov_b32 s31, 0x20000
    v_lshlrev_b32 v163, 4, v0
    buffer_load_dword v0, v2, s[28:31], 0 offen sc1
    s_and_b32 s6, s5, 3
    s_lshl_b32 s11, s4, 2
    s_add_u32 s6, s6, s11
    s_lshr_b32 s7, s5, 2
    v_lshrrev_b32 v29, 3, v1
    s_lshl_b32 s11, s3, 5
    s_and_b32 s12, s3, 1
    s_mul_i32 s12, s12, 992
    s_add_u32 s11, s11, s12
    v_add_lshl_u32 v29, v29, s11, 10
    v_lshrrev_b32 v30, 4, v1
    v_and_b32 v5, 7, v1
    v_xor_b32 v30, v30, v5
    v_lshl_add_u32 v4, v30, 4, v29
    v_xor_b32 v5, 64, v4
    v_add_u32 v5, 0x1c00, v5
    v_add_u32 v6, 0x3800, v4
    v_add_u32 v7, 0x3800, v5
    s_lshl_b32 s15, s3, 13
    s_lshl_b32 s14, s3, 12
    v_lshrrev_b32 v29, 3, v1
    s_and_b32 s99, s3, 1
    s_mul_i32 s99, s99, 262144
    s_lshr_b32 s98, s3, 1
    s_mul_i32 s98, s98, 128
    s_add_u32 s99, s99, s98
    v_mul_u32_u24 v8, 8192, v29
    v_and_b32 v29, 2, v29
    v_and_b32 v9, 7, v1
    v_xor_b32 v29, v29, v9
    v_lshl_add_u32 v8, v29, 4, v8
    v_xor_b32 v9, 64, v8
    v_add_u32 v8, s99, v8
    s_add_u32 s99, s99, 64512
    v_add_u32 v9, s99, v9
    v_add_u32 v10, 0x1f800, v8
    v_add_u32 v11, 0x1f800, v9
    s_lshl_b32 s13, s7, 17
    s_lshl_b32 s11, s6, 8
    s_sub_u32 s12, 0x400000, s11
    s_waitcnt lgkmcnt(0)
    s_add_u32 s44, s18, s13
    s_addc_u32 s45, s19, 0
    s_mov_b32 s46, 0x120000
    s_mov_b32 s47, 0x20000
    s_add_u32 s48, s22, s11
    s_addc_u32 s49, s23, 0
    s_mov_b32 s50, s12
    s_mov_b32 s51, 0x20000
    s_add_u32 s52, s24, s11
    s_addc_u32 s53, s25, 0
    s_mov_b32 s54, s12
    s_mov_b32 s55, 0x20000
    s_add_u32 m0, s15, 0x0
    s_mov_b32 s10, 0x0
    buffer_load_dwordx4 v4, s[44:47], s10 offen offset:0 lds
    buffer_load_dwordx4 v5, s[44:47], s10 offen offset:1024 lds
    buffer_load_dwordx4 v6, s[44:47], s10 offen offset:2048 lds
    buffer_load_dwordx4 v7, s[44:47], s10 offen offset:3072 lds
    s_add_u32 m0, s15, 0x1000
    s_mov_b32 s10, 0x8000
    buffer_load_dwordx4 v4, s[44:47], s10 offen offset:0 lds
    buffer_load_dwordx4 v5, s[44:47], s10 offen offset:1024 lds
    buffer_load_dwordx4 v6, s[44:47], s10 offen offset:2048 lds
    buffer_load_dwordx4 v7, s[44:47], s10 offen offset:3072 lds
    s_add_u32 m0, s14, 0x8000
    s_mov_b32 s10, 0x0
    buffer_load_dwordx4 v8, s[48:51], s10 offen offset:0 lds
    buffer_load_dwordx4 v9, s[48:51], s10 offen offset:1024 lds
    buffer_load_dwordx4 v10, s[48:51], s10 offen offset:2048 lds
    buffer_load_dwordx4 v11, s[48:51], s10 offen offset:3072 lds
    s_add_u32 m0, s14, 0xc000
    s_mov_b32 s10, 0x0
    buffer_load_dwordx4 v8, s[52:55], s10 offen offset:0 lds
    buffer_load_dwordx4 v9, s[52:55], s10 offen offset:1024 lds
    buffer_load_dwordx4 v10, s[52:55], s10 offen offset:2048 lds
    buffer_load_dwordx4 v11, s[52:55], s10 offen offset:3072 lds
    v_mov_b32 v164, 0
    v_mov_b32 v165, 0
    v_mov_b32 v166, 0
    v_mov_b32 v167, 0
    s_add_u32 s68, s42, 0x5000000
    s_addc_u32 s69, s43, 0
    s_mov_b32 s70, 0x10000
    s_mov_b32 s71, 0x20000
    s_lshl_b32 s11, s2, 12
    buffer_store_dwordx4 v[164:167], v163, s[68:71], s11 offen sc1
    s_and_b32 s11, s3, 1
    s_lshl_b32 s11, s11, 7
    v_and_b32 v29, 15, v1
    v_add_lshl_u32 v29, v29, s11, 7
    v_bfe_u32 v30, v1, 1, 3
    v_lshrrev_b32 v17, 4, v1
    v_xor_b32 v30, v30, v17
    v_lshl_add_u32 v16, v30, 4, v29
    v_xor_b32 v17, 64, v16
    s_lshr_b32 s11, s3, 1
    s_lshl_b32 s11, s11, 13
    s_add_u32 s11, s11, 0x8000
    v_and_b32 v18, 3, v1
    v_lshrrev_b32 v29, 1, v1
    v_and_b32 v29, 12, v29
    v_or_b32 v18, v18, v29
    v_lshlrev_b32 v18, 3, v18
    v_and_b32 v29, 12, v1
    v_lshl_add_u32 v18, v29, 5, v18
    v_and_b32 v29, 48, v1
    v_lshl_add_u32 v18, v29, 6, v18
    v_add_u32 v18, s11, v18
    v_xor_b32 v19, 32, v18
    v_xor_b32 v20, 64, v18
    v_xor_b32 v21, 96, v18
    s_add_u32 s56, s18, 0x0
    s_addc_u32 s57, s19, 0
    s_mov_b32 s58, 0x200000
    s_mov_b32 s59, 0x20000
    s_lshl_b32 s11, s2, 2
    s_add_u32 s11, s11, s3
    s_lshl_b32 s11, s11, 11
    v_lshl_add_u32 v174, v1, 5, s11
    buffer_load_dword v175, v174, s[56:59], 0 offen
    s_add_u32 m0, s14, 0x18000
    s_mov_b32 s10, 0x80000
    buffer_load_dwordx4 v8, s[48:51], s10 offen offset:0 lds
    buffer_load_dwordx4 v9, s[48:51], s10 offen offset:1024 lds
    buffer_load_dwordx4 v10, s[48:51], s10 offen offset:2048 lds
    buffer_load_dwordx4 v11, s[48:51], s10 offen offset:3072 lds
    s_add_u32 m0, s14, 0x1c000
    s_mov_b32 s10, 0x80000
    buffer_load_dwordx4 v8, s[52:55], s10 offen offset:0 lds
    buffer_load_dwordx4 v9, s[52:55], s10 offen offset:1024 lds
    buffer_load_dwordx4 v10, s[52:55], s10 offen offset:2048 lds
    buffer_load_dwordx4 v11, s[52:55], s10 offen offset:3072 lds
    s_waitcnt vmcnt(10)
    s_barrier
    ds_read_b64_tr_b16 v[96:97], v18 offset:16384
    ds_read_b64_tr_b16 v[98:99], v18 offset:16896
    ds_read_b64_tr_b16 v[100:101], v18 offset:20480
    ds_read_b64_tr_b16 v[102:103], v18 offset:20992
    ds_read_b128 v[32:35], v16 offset:0
    ds_read_b128 v[36:39], v17 offset:0
    ds_read_b64_tr_b16 v[104:105], v19 offset:16384
    ds_read_b64_tr_b16 v[106:107], v19 offset:16896
    ds_read_b64_tr_b16 v[108:109], v19 offset:20480
    ds_read_b64_tr_b16 v[110:111], v19 offset:20992
    ds_read_b64_tr_b16 v[112:113], v20 offset:16384
    ds_read_b64_tr_b16 v[114:115], v20 offset:16896
    ds_read_b64_tr_b16 v[116:117], v20 offset:20480
    ds_read_b64_tr_b16 v[118:119], v20 offset:20992
    ds_read_b64_tr_b16 v[120:121], v21 offset:16384
    ds_read_b64_tr_b16 v[122:123], v21 offset:16896
    ds_read_b64_tr_b16 v[124:125], v21 offset:20480
    ds_read_b64_tr_b16 v[126:127], v21 offset:20992
    ds_read_b128 v[40:43], v16 offset:2048
    ds_read_b128 v[44:47], v17 offset:2048
    s_waitcnt lgkmcnt(15)
    v_mfma_f32_16x16x32_bf16 a[128:131], v[32:35], v[96:99], 0
    ds_read_b128 v[48:51], v16 offset:4096
    s_waitcnt lgkmcnt(15)
    v_mfma_f32_16x16x32_bf16 a[128:131], v[36:39], v[100:103], a[128:131]
    s_mov_b32 s10, 0x80
    s_add_u32 m0, s15, 0x10000
    s_waitcnt lgkmcnt(13)
    v_mfma_f32_16x16x32_bf16 a[136:139], v[32:35], v[104:107], 0
    s_waitcnt lgkmcnt(11)
    buffer_load_dwordx4 v4, s[44:47], s10 offen offset:0 lds
    v_mfma_f32_16x16x32_bf16 a[136:139], v[36:39], v[108:111], a[136:139]
    s_add_u32 s72, s16, 0x0
    s_addc_u32 s73, s17, 0
    ds_read_b128 v[52:55], v17 offset:4096
    s_waitcnt lgkmcnt(10)
    v_mfma_f32_16x16x32_bf16 a[144:147], v[32:35], v[112:115], 0
    s_mov_b32 s74, 0x280000
    s_mov_b32 s75, 0x20000
    ds_read_b128 v[56:59], v16 offset:6144
    s_waitcnt lgkmcnt(9)
    v_mfma_f32_16x16x32_bf16 a[144:147], v[36:39], v[116:119], a[144:147]
    s_waitcnt lgkmcnt(7)
    buffer_load_dwordx4 v5, s[44:47], s10 offen offset:1024 lds
    v_mfma_f32_16x16x32_bf16 a[152:155], v[32:35], v[120:123], 0
    s_lshl_b32 s11, s2, 1
    s_add_u32 s11, s11, s3
    ds_read_b128 v[60:63], v17 offset:6144
    s_waitcnt lgkmcnt(6)
    v_mfma_f32_16x16x32_bf16 a[152:155], v[36:39], v[124:127], a[152:155]
    s_mul_i32 s11, s11, 5120
    s_cmp_lt_u32 s3, 2
    s_cselect_b32 s11, s11, 0x7f000000
    s_waitcnt lgkmcnt(4)
    v_mfma_f32_16x16x32_bf16 a[132:135], v[40:43], v[96:99], 0
    buffer_load_dwordx4 v6, s[44:47], s10 offen offset:2048 lds
    v_mfma_f32_16x16x32_bf16 a[132:135], v[44:47], v[100:103], a[132:135]
    ds_read_b128 v[64:67], v16 offset:8192
    v_and_b32 v29, 3, v1
    v_mfma_f32_16x16x32_bf16 a[140:143], v[40:43], v[104:107], 0
    ds_read_b128 v[68:71], v17 offset:8192
    v_mul_u32_u24 v30, 1280, v29
    v_mfma_f32_16x16x32_bf16 a[140:143], v[44:47], v[108:111], a[140:143]
    buffer_load_dwordx4 v7, s[44:47], s10 offen offset:3072 lds
    v_mfma_f32_16x16x32_bf16 a[148:151], v[40:43], v[112:115], 0
    ds_read_b128 v[72:75], v16 offset:10240
    v_and_b32 v244, 60, v1
    v_mfma_f32_16x16x32_bf16 a[148:151], v[44:47], v[116:119], a[148:151]
    s_mov_b32 s10, 0x8080
    s_add_u32 m0, s15, 0x11000
    v_lshl_add_u32 v30, v244, 2, v30
    v_mfma_f32_16x16x32_bf16 a[156:159], v[40:43], v[120:123], 0
    buffer_load_dwordx4 v4, s[44:47], s10 offen offset:0 lds
    v_mfma_f32_16x16x32_bf16 a[156:159], v[44:47], v[124:127], a[156:159]
    s_waitcnt lgkmcnt(3)
    ds_read_b128 v[76:79], v17 offset:10240
    v_add_u32 v173, s11, v30
    v_mfma_f32_16x16x32_bf16 a[160:163], v[48:51], v[96:99], 0
    ds_read_b128 v[80:83], v16 offset:12288
    v_lshlrev_b32 v28, 2, v1
    v_mfma_f32_16x16x32_bf16 a[160:163], v[52:55], v[100:103], a[160:163]
    buffer_load_dwordx4 v5, s[44:47], s10 offen offset:1024 lds
    v_mfma_f32_16x16x32_bf16 a[168:171], v[48:51], v[104:107], 0
    s_add_u32 s64, s42, 0x0
    s_addc_u32 s65, s43, 0
    ds_read_b128 v[84:87], v17 offset:12288
    v_mfma_f32_16x16x32_bf16 a[168:171], v[52:55], v[108:111], a[168:171]
    s_mov_b32 s66, 0x280000
    s_mov_b32 s67, 0x20000
    v_mfma_f32_16x16x32_bf16 a[176:179], v[48:51], v[112:115], 0
    buffer_load_dwordx4 v6, s[44:47], s10 offen offset:2048 lds
    v_mfma_f32_16x16x32_bf16 a[176:179], v[52:55], v[116:119], a[176:179]
    s_add_u32 s60, s40, 0x0
    s_addc_u32 s61, s41, 0
    ds_read_b128 v[88:91], v16 offset:14336
    v_mfma_f32_16x16x32_bf16 a[184:187], v[48:51], v[120:123], 0
    s_mov_b32 s62, 0x40
    s_mov_b32 s63, 0x20000
    ds_read_b128 v[92:95], v17 offset:14336
    v_mfma_f32_16x16x32_bf16 a[184:187], v[52:55], v[124:127], a[184:187]
    buffer_load_dwordx4 v7, s[44:47], s10 offen offset:3072 lds
    v_mfma_f32_16x16x32_bf16 a[164:167], v[56:59], v[96:99], 0
    s_lshr_b32 s11, s2, 2
    s_mul_i32 s11, s11, 40960
    s_and_b32 s12, s2, 3
    v_mfma_f32_16x16x32_bf16 a[164:167], v[60:63], v[100:103], a[164:167]
    s_mov_b32 s10, 0x100000
    s_add_u32 m0, s14, 0x20000
    s_lshl2_add_u32 s12, s3, s12
    v_mfma_f32_16x16x32_bf16 a[172:175], v[56:59], v[104:107], 0
    buffer_load_dwordx4 v8, s[48:51], s10 offen offset:0 lds
    v_mfma_f32_16x16x32_bf16 a[172:175], v[60:63], v[108:111], a[172:175]
    s_lshl_b32 s12, s12, 6
    s_add_u32 s11, s11, s12
    ds_read_b64_tr_b16 v[128:129], v18 offset:0
    v_mfma_f32_16x16x32_bf16 a[180:183], v[56:59], v[112:115], 0
    s_cmp_lt_u32 s3, 2
    s_cselect_b32 s11, s11, 0x7f000000
    ds_read_b64_tr_b16 v[130:131], v18 offset:512
    v_mfma_f32_16x16x32_bf16 a[180:183], v[60:63], v[116:119], a[180:183]
    buffer_load_dwordx4 v9, s[48:51], s10 offen offset:1024 lds
    v_mfma_f32_16x16x32_bf16 a[188:191], v[56:59], v[120:123], 0
    ds_read_b64_tr_b16 v[132:133], v18 offset:4096
    v_lshlrev_b32 v244, 7, v244
    v_mfma_f32_16x16x32_bf16 a[188:191], v[60:63], v[124:127], a[188:191]
    s_waitcnt lgkmcnt(7)
    v_lshl_add_u32 v244, v29, 4, v244
    v_add_u32 v244, s11, v244
    v_mfma_f32_16x16x32_bf16 a[192:195], v[64:67], v[96:99], 0
    buffer_load_dwordx4 v10, s[48:51], s10 offen offset:2048 lds
    v_mfma_f32_16x16x32_bf16 a[192:195], v[68:71], v[100:103], a[192:195]
    s_lshl_b32 s11, s2, 2
    s_add_u32 s11, s11, s3
    ds_read_b64_tr_b16 v[134:135], v18 offset:4608
    v_mfma_f32_16x16x32_bf16 a[200:203], v[64:67], v[104:107], 0
    s_mul_i32 s11, s11, 1280
    ds_read_b64_tr_b16 v[136:137], v19 offset:0
    v_mul_u32_u24 v171, 20, v1
    v_mfma_f32_16x16x32_bf16 a[200:203], v[68:71], v[108:111], a[200:203]
    buffer_load_dwordx4 v11, s[48:51], s10 offen offset:3072 lds
    v_mfma_f32_16x16x32_bf16 a[208:211], v[64:67], v[112:115], 0
    ds_read_b64_tr_b16 v[138:139], v19 offset:512
    v_add_u32 v171, s11, v171
    v_mfma_f32_16x16x32_bf16 a[208:211], v[68:71], v[116:119], a[208:211]
    s_mov_b32 s10, 0x100000
    s_add_u32 m0, s14, 0x24000
    s_mul_i32 s11, s5, 37
    v_mfma_f32_16x16x32_bf16 a[216:219], v[64:67], v[120:123], 0
    buffer_load_dwordx4 v8, s[52:55], s10 offen offset:0 lds
    v_mfma_f32_16x16x32_bf16 a[216:219], v[68:71], v[124:127], a[216:219]
    s_lshr_b32 s11, s11, 8
    s_mul_i32 s12, s11, 7
    ds_read_b64_tr_b16 v[140:141], v19 offset:4096
    v_mfma_f32_16x16x32_bf16 a[196:199], v[72:75], v[96:99], 0
    s_sub_u32 s9, s5, s12
    s_lshr_b32 s8, s4, 1
    ds_read_b64_tr_b16 v[142:143], v19 offset:4608
    v_mfma_f32_16x16x32_bf16 a[196:199], v[76:79], v[100:103], a[196:199]
    buffer_load_dwordx4 v9, s[52:55], s10 offen offset:1024 lds
    v_mfma_f32_16x16x32_bf16 a[204:207], v[72:75], v[104:107], 0
    s_lshl_b32 s8, s8, 2
    s_add_u32 s8, s8, s11
    ds_read_b64_tr_b16 v[144:145], v20 offset:0
    v_mfma_f32_16x16x32_bf16 a[204:207], v[76:79], v[108:111], a[204:207]
    s_and_b32 s8, s8, 15
    s_lshl_b32 s8, s8, 2
    s_and_b32 s95, s4, 1
    v_mfma_f32_16x16x32_bf16 a[212:215], v[72:75], v[112:115], 0
    buffer_load_dwordx4 v10, s[52:55], s10 offen offset:2048 lds
    v_mfma_f32_16x16x32_bf16 a[212:215], v[76:79], v[116:119], a[212:215]
    s_mul_i32 s95, s95, 7
    s_add_u32 s95, s95, s9
    ds_read_b64_tr_b16 v[146:147], v20 offset:512
    v_mfma_f32_16x16x32_bf16 a[220:223], v[72:75], v[120:123], 0
    s_lshl_b32 s11, s95, 7
    s_sub_u32 s12, 0x21c000, s11
    ds_read_b64_tr_b16 v[148:149], v20 offset:4096
    v_mfma_f32_16x16x32_bf16 a[220:223], v[76:79], v[124:127], a[220:223]
    s_waitcnt lgkmcnt(11)
    buffer_load_dwordx4 v11, s[52:55], s10 offen offset:3072 lds
    v_mfma_f32_16x16x32_bf16 a[224:227], v[80:83], v[96:99], 0
    s_cmp_lt_u32 s5, 28
    s_cselect_b32 s12, s12, 0
    ds_read_b64_tr_b16 v[150:151], v20 offset:4608
    v_mfma_f32_16x16x32_bf16 a[224:227], v[84:87], v[100:103], a[224:227]
    s_add_u32 s80, s76, s11
    s_addc_u32 s81, s77, 0
    s_mov_b32 s82, s12
    v_mfma_f32_16x16x32_bf16 a[232:235], v[80:83], v[104:107], 0
    s_mov_b32 s83, 0x20000
    ds_read_b64_tr_b16 v[152:153], v21 offset:0
    v_lshrrev_b32 v29, 3, v1
    v_mfma_f32_16x16x32_bf16 a[232:235], v[84:87], v[108:111], a[232:235]
    s_and_b32 s99, s3, 1
    s_mul_i32 s99, s99, 110592
    s_lshr_b32 s98, s3, 1
    v_mfma_f32_16x16x32_bf16 a[240:243], v[80:83], v[112:115], 0
    s_mul_i32 s98, s98, 1664
    s_add_u32 s99, s99, s98
    ds_read_b64_tr_b16 v[154:155], v21 offset:512
    v_mfma_f32_16x16x32_bf16 a[240:243], v[84:87], v[116:119], a[240:243]
    v_mul_u32_u24 v12, 3456, v29
    v_and_b32 v29, 2, v29
    v_mfma_f32_16x16x32_bf16 a[248:251], v[80:83], v[120:123], 0
    ds_read_b64_tr_b16 v[156:157], v21 offset:4096
    v_and_b32 v13, 7, v1
    v_mfma_f32_16x16x32_bf16 a[248:251], v[84:87], v[124:127], a[248:251]
    v_xor_b32 v29, v29, v13
    v_lshl_add_u32 v12, v29, 4, v12
    v_mfma_f32_16x16x32_bf16 a[228:231], v[88:91], v[96:99], 0
    ds_read_b64_tr_b16 v[158:159], v21 offset:4608
    v_xor_b32 v13, 64, v12
    v_mfma_f32_16x16x32_bf16 a[228:231], v[92:95], v[100:103], a[228:231]
    v_add_u32 v18, 0x10000, v18
    v_add_u32 v19, 0x10000, v19
    v_mfma_f32_16x16x32_bf16 a[236:239], v[88:91], v[104:107], 0
    v_add_u32 v20, 0x10000, v20
    v_add_u32 v21, 0x10000, v21
    v_mfma_f32_16x16x32_bf16 a[236:239], v[92:95], v[108:111], a[236:239]
    v_xor_b32 v16, 0x10000, v16
    v_xor_b32 v17, 0x10000, v17
    v_mfma_f32_16x16x32_bf16 a[244:247], v[88:91], v[112:115], 0
    v_add_u32 v12, s99, v12
    v_mfma_f32_16x16x32_bf16 a[244:247], v[92:95], v[116:119], a[244:247]
    s_add_u32 s99, s99, 26624
    v_add_u32 v13, s99, v13
    v_add_u32 v14, 0xd000, v12
    v_mfma_f32_16x16x32_bf16 a[252:255], v[88:91], v[120:123], 0
    v_add_u32 v15, 0xd000, v13
    v_lshrrev_b32 v29, 4, v1
    v_mfma_f32_16x16x32_bf16 a[252:255], v[92:95], v[124:127], a[252:255]
    s_waitcnt lgkmcnt(0)
    s_waitcnt vmcnt(8)
    s_barrier
    v_and_b32 v0, 0xf0, v2
    v_mfma_f32_16x16x32_bf16 a[0:3], v[128:131], v[32:35], 0
    ds_read_b64_tr_b16 v[96:97], v18 offset:16384
    v_lshl_add_u32 v0, v29, 9, v0
    v_mfma_f32_16x16x32_bf16 a[0:3], v[132:135], v[36:39], a[0:3]
    s_mov_b32 s10, 0x100
    s_add_u32 m0, s15, 0x0
    s_add_u32 s11, s8, s3
    v_mfma_f32_16x16x32_bf16 a[4:7], v[136:139], v[32:35], 0
    buffer_load_dwordx4 v4, s[44:47], s10 offen offset:0 lds
    v_mfma_f32_16x16x32_bf16 a[4:7], v[140:143], v[36:39], a[4:7]
    s_mul_i32 s11, s11, 40960
    v_add_u32 v24, s11, v0
    v_mfma_f32_16x16x32_bf16 a[8:11], v[144:147], v[32:35], 0
    s_lshl_b32 s11, s6, 4
    s_add_u32 s11, s11, s7
    ds_read_b64_tr_b16 v[98:99], v18 offset:16896
    v_mfma_f32_16x16x32_bf16 a[8:11], v[148:151], v[36:39], a[8:11]
    s_lshl_b32 s11, s11, 15
    s_add_u32 s12, s11, 0x300000
    v_mfma_f32_16x16x32_bf16 a[12:15], v[152:155], v[32:35], 0
    buffer_load_dwordx4 v5, s[44:47], s10 offen offset:1024 lds
    v_mfma_f32_16x16x32_bf16 a[12:15], v[156:159], v[36:39], a[12:15]
    ds_read_b128 v[32:35], v16 offset:0
    ds_read_b128 v[36:39], v17 offset:0
    v_mfma_f32_16x16x32_bf16 a[16:19], v[128:131], v[40:43], 0
    s_add_u32 s84, s42, s12
    s_addc_u32 s85, s43, 0
    ds_read_b64_tr_b16 v[100:101], v18 offset:20480
    v_mfma_f32_16x16x32_bf16 a[16:19], v[132:135], v[44:47], a[16:19]
    s_mov_b32 s86, 0x48000
    s_mov_b32 s87, 0x20000
    s_add_u32 s12, s11, 0x1300000
    v_mfma_f32_16x16x32_bf16 a[20:23], v[136:139], v[40:43], 0
    buffer_load_dwordx4 v6, s[44:47], s10 offen offset:2048 lds
    v_mfma_f32_16x16x32_bf16 a[20:23], v[140:143], v[44:47], a[20:23]
    s_add_u32 s88, s42, s12
    s_addc_u32 s89, s43, 0
    s_mov_b32 s90, 0x48000
    v_mfma_f32_16x16x32_bf16 a[24:27], v[144:147], v[40:43], 0
    s_mov_b32 s91, 0x20000
    s_and_b32 s11, s3, 1
    ds_read_b64_tr_b16 v[102:103], v18 offset:20992
    v_mfma_f32_16x16x32_bf16 a[24:27], v[148:151], v[44:47], a[24:27]
    s_lshl_b32 s11, s11, 14
    s_lshr_b32 s12, s3, 1
    s_lshl_b32 s12, s12, 11
    v_mfma_f32_16x16x32_bf16 a[28:31], v[152:155], v[40:43], 0
    buffer_load_dwordx4 v7, s[44:47], s10 offen offset:3072 lds
    v_mfma_f32_16x16x32_bf16 a[28:31], v[156:159], v[44:47], a[28:31]
    s_add_u32 s11, s11, s12
    ds_read_b128 v[40:43], v16 offset:2048
    ds_read_b128 v[44:47], v17 offset:2048
    v_mfma_f32_16x16x32_bf16 a[32:35], v[128:131], v[48:51], 0
    s_add_u32 s12, s11, s12
    ds_read_b64_tr_b16 v[104:105], v19 offset:16384
    v_add_u32 v25, s11, v2
    v_mfma_f32_16x16x32_bf16 a[32:35], v[132:135], v[52:55], a[32:35]
    s_mov_b32 s10, 0x8100
    s_add_u32 m0, s15, 0x1000
    v_add_u32 v26, s12, v2
    v_mfma_f32_16x16x32_bf16 a[36:39], v[136:139], v[48:51], 0
    buffer_load_dwordx4 v4, s[44:47], s10 offen offset:0 lds
    v_mfma_f32_16x16x32_bf16 a[36:39], v[140:143], v[52:55], a[36:39]
    v_and_b32 v22, 0xe30, v0
    v_and_b32 v29, 4, v1
    v_mfma_f32_16x16x32_bf16 a[40:43], v[144:147], v[48:51], 0
    ds_read_b64_tr_b16 v[106:107], v19 offset:16896
    v_lshl_add_u32 v22, v29, 6, v22
    v_mfma_f32_16x16x32_bf16 a[40:43], v[148:151], v[52:55], a[40:43]
    v_and_b32 v29, 8, v1
    v_lshl_add_u32 v22, v29, 3, v22
    v_mfma_f32_16x16x32_bf16 a[44:47], v[152:155], v[48:51], 0
    buffer_load_dwordx4 v5, s[44:47], s10 offen offset:1024 lds
    v_mfma_f32_16x16x32_bf16 a[44:47], v[156:159], v[52:55], a[44:47]
    s_lshr_b32 s12, s3, 1
    s_lshl2_add_u32 s12, s7, s12
    s_mul_i32 s12, s12, 320
    s_and_b32 s11, s3, 1
    s_add_u32 s12, s12, s11
    s_lshl_b32 s12, s12, 7
    s_lshl_b32 s11, s7, 2
    ds_read_b128 v[48:51], v16 offset:4096
    ds_read_b128 v[52:55], v17 offset:4096
    v_add_u32 v23, s12, v22
    v_mfma_f32_16x16x32_bf16 a[48:51], v[128:131], v[56:59], 0
    s_sub_u32 s12, 60, s11
    s_add_u32 s12, s12, s3
    s_mul_i32 s12, s12, 40960
    ds_read_b64_tr_b16 v[108:109], v19 offset:20480
    v_add_u32 v22, s12, v22
    v_mfma_f32_16x16x32_bf16 a[48:51], v[132:135], v[60:63], a[48:51]
    s_lshl_b32 s11, s8, 6
    s_lshl_b32 s12, s7, 8
    v_mov_b32 v170, s11
    v_mov_b32 v29, s12
    v_cmp_gt_u32 vcc, 16, v1
    s_nop 1
    v_cndmask_b32 v170, v29, v170, vcc
    v_sub_u32 v29, 0xf00, v29
    v_cmp_gt_u32 vcc, 32, v1
    s_nop 1
    v_cndmask_b32 v170, v29, v170, vcc
    v_and_b32 v29, 0x3c, v28
    v_mfma_f32_16x16x32_bf16 a[52:55], v[136:139], v[56:59], 0
    s_mov_b32 s98, 0x9000
    buffer_load_dwordx4 v6, s[44:47], s10 offen offset:2048 lds
    v_add_u32 v170, v170, v29
    v_mfma_f32_16x16x32_bf16 a[52:55], v[140:143], v[60:63], a[52:55]
    v_mfma_f32_16x16x32_bf16 a[56:59], v[144:147], v[56:59], 0
    s_lshl_b32 s97, s2, 2
    s_cmp_lg_u32 s3, 0
    s_cbranch_scc1 fk_pr
    v_mov_b32 v27, 1
    s_mov_b64 exec, 1
    buffer_store_dword v27, off, s[60:63], s97 sc1
    s_mov_b64 exec, -1
fk_pr:
    v_mfma_f32_16x16x32_bf16 a[56:59], v[148:151], v[60:63], a[56:59]
    ds_read_b64_tr_b16 v[110:111], v19 offset:20992
    v_mfma_f32_16x16x32_bf16 a[60:63], v[152:155], v[56:59], 0
    buffer_load_dwordx4 v7, s[44:47], s10 offen offset:3072 lds
    v_mfma_f32_16x16x32_bf16 a[60:63], v[156:159], v[60:63], a[60:63]
    ds_read_b128 v[56:59], v16 offset:6144
    ds_read_b128 v[60:63], v17 offset:6144
    v_mfma_f32_16x16x32_bf16 a[64:67], v[128:131], v[64:67], 0
    ds_read_b64_tr_b16 v[112:113], v20 offset:16384
    v_mfma_f32_16x16x32_bf16 a[64:67], v[132:135], v[68:71], a[64:67]
    s_mov_b32 s10, 0x180000
    s_add_u32 m0, s14, 0x8000
    v_mfma_f32_16x16x32_bf16 a[68:71], v[136:139], v[64:67], 0
    buffer_load_dwordx4 v8, s[48:51], s10 offen offset:0 lds
    v_mfma_f32_16x16x32_bf16 a[68:71], v[140:143], v[68:71], a[68:71]
    v_mfma_f32_16x16x32_bf16 a[72:75], v[144:147], v[64:67], 0
    buffer_load_dwordx4 v[176:179], v173, s[72:75], 0 offen
    v_mfma_f32_16x16x32_bf16 a[72:75], v[148:151], v[68:71], a[72:75]
    ds_read_b64_tr_b16 v[114:115], v20 offset:16896
    v_mfma_f32_16x16x32_bf16 a[76:79], v[152:155], v[64:67], 0
    buffer_load_dwordx4 v9, s[48:51], s10 offen offset:1024 lds
    v_mfma_f32_16x16x32_bf16 a[76:79], v[156:159], v[68:71], a[76:79]
    ds_read_b128 v[64:67], v16 offset:8192
    ds_read_b128 v[68:71], v17 offset:8192
    v_mfma_f32_16x16x32_bf16 a[80:83], v[128:131], v[72:75], 0
    buffer_load_dwordx4 v[180:183], v173, s[72:75], 0 offen offset:256
    v_mfma_f32_16x16x32_bf16 a[80:83], v[132:135], v[76:79], a[80:83]
    ds_read_b64_tr_b16 v[116:117], v20 offset:20480
    v_mfma_f32_16x16x32_bf16 a[84:87], v[136:139], v[72:75], 0
    buffer_load_dwordx4 v10, s[48:51], s10 offen offset:2048 lds
    v_mfma_f32_16x16x32_bf16 a[84:87], v[140:143], v[76:79], a[84:87]
    v_mfma_f32_16x16x32_bf16 a[88:91], v[144:147], v[72:75], 0
    buffer_load_dwordx4 v[184:187], v173, s[72:75], 0 offen offset:512
    v_mfma_f32_16x16x32_bf16 a[88:91], v[148:151], v[76:79], a[88:91]
    ds_read_b64_tr_b16 v[118:119], v20 offset:20992
    v_mfma_f32_16x16x32_bf16 a[92:95], v[152:155], v[72:75], 0
    buffer_load_dwordx4 v11, s[48:51], s10 offen offset:3072 lds
    v_mfma_f32_16x16x32_bf16 a[92:95], v[156:159], v[76:79], a[92:95]
    ds_read_b128 v[72:75], v16 offset:10240
    ds_read_b128 v[76:79], v17 offset:10240
    v_mfma_f32_16x16x32_bf16 a[96:99], v[128:131], v[80:83], 0
    buffer_load_dwordx4 v[188:191], v173, s[72:75], 0 offen offset:768
    v_mfma_f32_16x16x32_bf16 a[96:99], v[132:135], v[84:87], a[96:99]
    s_mov_b32 s10, 0x180000
    s_add_u32 m0, s14, 0xc000
    ds_read_b64_tr_b16 v[120:121], v21 offset:16384
    v_mfma_f32_16x16x32_bf16 a[100:103], v[136:139], v[80:83], 0
    buffer_load_dwordx4 v8, s[52:55], s10 offen offset:0 lds
    v_mfma_f32_16x16x32_bf16 a[100:103], v[140:143], v[84:87], a[100:103]
    v_mfma_f32_16x16x32_bf16 a[104:107], v[144:147], v[80:83], 0
    buffer_load_dwordx4 v[192:195], v173, s[72:75], 0 offen offset:1024
    v_mfma_f32_16x16x32_bf16 a[104:107], v[148:151], v[84:87], a[104:107]
    ds_read_b64_tr_b16 v[122:123], v21 offset:16896
    v_mfma_f32_16x16x32_bf16 a[108:111], v[152:155], v[80:83], 0
    buffer_load_dwordx4 v9, s[52:55], s10 offen offset:1024 lds
    v_mfma_f32_16x16x32_bf16 a[108:111], v[156:159], v[84:87], a[108:111]
    ds_read_b128 v[80:83], v16 offset:12288
    ds_read_b128 v[84:87], v17 offset:12288
    v_mfma_f32_16x16x32_bf16 a[112:115], v[128:131], v[88:91], 0
    ds_read_b64_tr_b16 v[124:125], v21 offset:20480
    v_mfma_f32_16x16x32_bf16 a[112:115], v[132:135], v[92:95], a[112:115]
    v_mfma_f32_16x16x32_bf16 a[116:119], v[136:139], v[88:91], 0
    buffer_load_dwordx4 v10, s[52:55], s10 offen offset:2048 lds
    v_mfma_f32_16x16x32_bf16 a[116:119], v[140:143], v[92:95], a[116:119]
    ds_read_b64_tr_b16 v[126:127], v21 offset:20992
    v_mfma_f32_16x16x32_bf16 a[120:123], v[144:147], v[88:91], 0
    v_mfma_f32_16x16x32_bf16 a[120:123], v[148:151], v[92:95], a[120:123]
    v_mfma_f32_16x16x32_bf16 a[124:127], v[152:155], v[88:91], 0
    buffer_load_dwordx4 v11, s[52:55], s10 offen offset:3072 lds
    v_mfma_f32_16x16x32_bf16 a[124:127], v[156:159], v[92:95], a[124:127]
    s_waitcnt lgkmcnt(4)
    ds_read_b128 v[88:91], v16 offset:14336
    ds_read_b128 v[92:95], v17 offset:14336
    v_mfma_f32_16x16x32_bf16 a[128:131], v[32:35], v[96:99], a[128:131]
    v_mfma_f32_16x16x32_bf16 a[128:131], v[36:39], v[100:103], a[128:131]
    v_mfma_f32_16x16x32_bf16 a[136:139], v[32:35], v[104:107], a[136:139]
    s_add_u32 s56, s76, 0x0
    s_addc_u32 s57, s77, 0
    v_mfma_f32_16x16x32_bf16 a[136:139], v[36:39], v[108:111], a[136:139]
    s_mov_b32 s58, 0x21c000
    s_mov_b32 s59, 0x20000
    s_mov_b32 s92, 0x0
    v_mfma_f32_16x16x32_bf16 a[144:147], v[32:35], v[112:115], a[144:147]
    buffer_load_dword v175, v171, s[56:59], s92 offen
    v_mfma_f32_16x16x32_bf16 a[144:147], v[36:39], v[116:119], a[144:147]
    v_mfma_f32_16x16x32_bf16 a[152:155], v[32:35], v[120:123], a[152:155]
    ds_read_b64_tr_b16 v[128:129], v18 offset:0
    s_waitcnt lgkmcnt(3)
    v_mfma_f32_16x16x32_bf16 a[152:155], v[36:39], v[124:127], a[152:155]
    v_mfma_f32_16x16x32_bf16 a[132:135], v[40:43], v[96:99], a[132:135]
    ds_read_b64_tr_b16 v[130:131], v18 offset:512
    v_mfma_f32_16x16x32_bf16 a[132:135], v[44:47], v[100:103], a[132:135]
    v_mfma_f32_16x16x32_bf16 a[140:143], v[40:43], v[104:107], a[140:143]
    ds_read_b64_tr_b16 v[132:133], v18 offset:4096
    v_mfma_f32_16x16x32_bf16 a[140:143], v[44:47], v[108:111], a[140:143]
    v_mfma_f32_16x16x32_bf16 a[148:151], v[40:43], v[112:115], a[148:151]
    ds_read_b64_tr_b16 v[134:135], v18 offset:4608
    v_mfma_f32_16x16x32_bf16 a[148:151], v[44:47], v[116:119], a[148:151]
    v_mfma_f32_16x16x32_bf16 a[156:159], v[40:43], v[120:123], a[156:159]
    ds_read_b64_tr_b16 v[136:137], v19 offset:0
    v_mfma_f32_16x16x32_bf16 a[156:159], v[44:47], v[124:127], a[156:159]
    v_mfma_f32_16x16x32_bf16 a[160:163], v[48:51], v[96:99], a[160:163]
    ds_read_b64_tr_b16 v[138:139], v19 offset:512
    v_mfma_f32_16x16x32_bf16 a[160:163], v[52:55], v[100:103], a[160:163]
    v_mfma_f32_16x16x32_bf16 a[168:171], v[48:51], v[104:107], a[168:171]
    ds_read_b64_tr_b16 v[140:141], v19 offset:4096
    v_mfma_f32_16x16x32_bf16 a[168:171], v[52:55], v[108:111], a[168:171]
    v_mfma_f32_16x16x32_bf16 a[176:179], v[48:51], v[112:115], a[176:179]
    ds_read_b64_tr_b16 v[142:143], v19 offset:4608
    v_mfma_f32_16x16x32_bf16 a[176:179], v[52:55], v[116:119], a[176:179]
    v_mfma_f32_16x16x32_bf16 a[184:187], v[48:51], v[120:123], a[184:187]
    ds_read_b64_tr_b16 v[144:145], v20 offset:0
    v_mfma_f32_16x16x32_bf16 a[184:187], v[52:55], v[124:127], a[184:187]
    v_mfma_f32_16x16x32_bf16 a[164:167], v[56:59], v[96:99], a[164:167]
    ds_read_b64_tr_b16 v[146:147], v20 offset:512
    v_mfma_f32_16x16x32_bf16 a[164:167], v[60:63], v[100:103], a[164:167]
    v_mfma_f32_16x16x32_bf16 a[172:175], v[56:59], v[104:107], a[172:175]
    ds_read_b64_tr_b16 v[148:149], v20 offset:4096
    v_mfma_f32_16x16x32_bf16 a[172:175], v[60:63], v[108:111], a[172:175]
    v_mfma_f32_16x16x32_bf16 a[180:183], v[56:59], v[112:115], a[180:183]
    ds_read_b64_tr_b16 v[150:151], v20 offset:4608
    v_mfma_f32_16x16x32_bf16 a[180:183], v[60:63], v[116:119], a[180:183]
    v_mfma_f32_16x16x32_bf16 a[188:191], v[56:59], v[120:123], a[188:191]
    ds_read_b64_tr_b16 v[152:153], v21 offset:0
    v_mfma_f32_16x16x32_bf16 a[188:191], v[60:63], v[124:127], a[188:191]
    v_mfma_f32_16x16x32_bf16 a[192:195], v[64:67], v[96:99], a[192:195]
    ds_read_b64_tr_b16 v[154:155], v21 offset:512
    v_mfma_f32_16x16x32_bf16 a[192:195], v[68:71], v[100:103], a[192:195]
    v_mfma_f32_16x16x32_bf16 a[200:203], v[64:67], v[104:107], a[200:203]
    ds_read_b64_tr_b16 v[156:157], v21 offset:4096
    v_mfma_f32_16x16x32_bf16 a[200:203], v[68:71], v[108:111], a[200:203]
    v_mfma_f32_16x16x32_bf16 a[208:211], v[64:67], v[112:115], a[208:211]
    ds_read_b64_tr_b16 v[158:159], v21 offset:4608
    v_mfma_f32_16x16x32_bf16 a[208:211], v[68:71], v[116:119], a[208:211]
    v_mfma_f32_16x16x32_bf16 a[216:219], v[64:67], v[120:123], a[216:219]
    v_mfma_f32_16x16x32_bf16 a[216:219], v[68:71], v[124:127], a[216:219]
    v_mfma_f32_16x16x32_bf16 a[196:199], v[72:75], v[96:99], a[196:199]
    v_mfma_f32_16x16x32_bf16 a[196:199], v[76:79], v[100:103], a[196:199]
    v_mfma_f32_16x16x32_bf16 a[204:207], v[72:75], v[104:107], a[204:207]
    v_mfma_f32_16x16x32_bf16 a[204:207], v[76:79], v[108:111], a[204:207]
    v_mfma_f32_16x16x32_bf16 a[212:215], v[72:75], v[112:115], a[212:215]
    v_mfma_f32_16x16x32_bf16 a[212:215], v[76:79], v[116:119], a[212:215]
    v_mfma_f32_16x16x32_bf16 a[220:223], v[72:75], v[120:123], a[220:223]
    v_mfma_f32_16x16x32_bf16 a[220:223], v[76:79], v[124:127], a[220:223]
    v_mfma_f32_16x16x32_bf16 a[224:227], v[80:83], v[96:99], a[224:227]
    v_mfma_f32_16x16x32_bf16 a[224:227], v[84:87], v[100:103], a[224:227]
    v_mfma_f32_16x16x32_bf16 a[232:235], v[80:83], v[104:107], a[232:235]
    v_mfma_f32_16x16x32_bf16 a[232:235], v[84:87], v[108:111], a[232:235]
    v_mfma_f32_16x16x32_bf16 a[240:243], v[80:83], v[112:115], a[240:243]
    v_mfma_f32_16x16x32_bf16 a[240:243], v[84:87], v[116:119], a[240:243]
    v_mfma_f32_16x16x32_bf16 a[248:251], v[80:83], v[120:123], a[248:251]
    v_mfma_f32_16x16x32_bf16 a[248:251], v[84:87], v[124:127], a[248:251]
    s_waitcnt lgkmcnt(15)
    v_mfma_f32_16x16x32_bf16 a[228:231], v[88:91], v[96:99], a[228:231]
    v_mfma_f32_16x16x32_bf16 a[228:231], v[92:95], v[100:103], a[228:231]
    v_add_u32 v18, 0x8000, v18
    v_add_u32 v19, 0x8000, v19
    v_mfma_f32_16x16x32_bf16 a[236:239], v[88:91], v[104:107], a[236:239]
    v_add_u32 v20, 0x8000, v20
    v_add_u32 v21, 0x8000, v21
    v_mfma_f32_16x16x32_bf16 a[236:239], v[92:95], v[108:111], a[236:239]
    v_xor_b32 v16, 0x10000, v16
    v_xor_b32 v17, 0x10000, v17
    v_mfma_f32_16x16x32_bf16 a[244:247], v[88:91], v[112:115], a[244:247]
    v_mfma_f32_16x16x32_bf16 a[244:247], v[92:95], v[116:119], a[244:247]
    v_mfma_f32_16x16x32_bf16 a[252:255], v[88:91], v[120:123], a[252:255]
    s_waitcnt vmcnt(12)
    v_lshlrev_b32 v196, 16, v176
    v_and_b32 v197, 0xffff0000, v176
    v_mfma_f32_16x16x32_bf16 a[252:255], v[92:95], v[124:127], a[252:255]
    s_waitcnt lgkmcnt(0)
    s_barrier
    v_lshlrev_b32 v198, 16, v177
    v_mfma_f32_16x16x32_bf16 a[0:3], v[128:131], v[32:35], a[0:3]
    ds_read_b64_tr_b16 v[96:97], v18 offset:16384
    v_and_b32 v199, 0xffff0000, v177
    v_mfma_f32_16x16x32_bf16 a[0:3], v[132:135], v[36:39], a[0:3]
    s_mov_b32 s10, 0x180
    s_add_u32 m0, s15, 0x10000
    v_lshlrev_b32 v200, 16, v178
    v_mfma_f32_16x16x32_bf16 a[4:7], v[136:139], v[32:35], a[4:7]
    buffer_load_dwordx4 v4, s[44:47], s10 offen offset:0 lds
    v_mfma_f32_16x16x32_bf16 a[4:7], v[140:143], v[36:39], a[4:7]
    v_and_b32 v201, 0xffff0000, v178
    v_lshlrev_b32 v202, 16, v179
    v_mfma_f32_16x16x32_bf16 a[8:11], v[144:147], v[32:35], a[8:11]
    ds_read_b64_tr_b16 v[98:99], v18 offset:16896
    v_and_b32 v203, 0xffff0000, v179
    v_mfma_f32_16x16x32_bf16 a[8:11], v[148:151], v[36:39], a[8:11]
    s_waitcnt vmcnt(11)
    v_lshlrev_b32 v204, 16, v180
    v_and_b32 v205, 0xffff0000, v180
    v_mfma_f32_16x16x32_bf16 a[12:15], v[152:155], v[32:35], a[12:15]
    buffer_load_dwordx4 v5, s[44:47], s10 offen offset:1024 lds
    v_mfma_f32_16x16x32_bf16 a[12:15], v[156:159], v[36:39], a[12:15]
    ds_read_b128 v[32:35], v16 offset:0
    ds_read_b128 v[36:39], v17 offset:0
    v_mfma_f32_16x16x32_bf16 a[16:19], v[128:131], v[40:43], a[16:19]
    ds_read_b64_tr_b16 v[100:101], v18 offset:20480
    v_lshlrev_b32 v206, 16, v181
    v_mfma_f32_16x16x32_bf16 a[16:19], v[132:135], v[44:47], a[16:19]
    v_and_b32 v207, 0xffff0000, v181
    v_lshlrev_b32 v208, 16, v182
    v_mfma_f32_16x16x32_bf16 a[20:23], v[136:139], v[40:43], a[20:23]
    buffer_load_dwordx4 v6, s[44:47], s10 offen offset:2048 lds
    v_mfma_f32_16x16x32_bf16 a[20:23], v[140:143], v[44:47], a[20:23]
    v_and_b32 v209, 0xffff0000, v182
    v_lshlrev_b32 v210, 16, v183
    v_mfma_f32_16x16x32_bf16 a[24:27], v[144:147], v[40:43], a[24:27]
    ds_read_b64_tr_b16 v[102:103], v18 offset:20992
    v_and_b32 v211, 0xffff0000, v183
    v_mfma_f32_16x16x32_bf16 a[24:27], v[148:151], v[44:47], a[24:27]
    s_waitcnt vmcnt(11)
    v_lshlrev_b32 v212, 16, v184
    v_and_b32 v213, 0xffff0000, v184
    v_mfma_f32_16x16x32_bf16 a[28:31], v[152:155], v[40:43], a[28:31]
    buffer_load_dwordx4 v7, s[44:47], s10 offen offset:3072 lds
    v_mfma_f32_16x16x32_bf16 a[28:31], v[156:159], v[44:47], a[28:31]
    ds_read_b128 v[40:43], v16 offset:2048
    ds_read_b128 v[44:47], v17 offset:2048
    v_mfma_f32_16x16x32_bf16 a[32:35], v[128:131], v[48:51], a[32:35]
    ds_read_b64_tr_b16 v[104:105], v19 offset:16384
    v_lshlrev_b32 v214, 16, v185
    v_mfma_f32_16x16x32_bf16 a[32:35], v[132:135], v[52:55], a[32:35]
    s_mov_b32 s10, 0x8180
    s_add_u32 m0, s15, 0x11000
    v_and_b32 v215, 0xffff0000, v185
    v_mfma_f32_16x16x32_bf16 a[36:39], v[136:139], v[48:51], a[36:39]
    buffer_load_dwordx4 v4, s[44:47], s10 offen offset:0 lds
    v_mfma_f32_16x16x32_bf16 a[36:39], v[140:143], v[52:55], a[36:39]
    v_lshlrev_b32 v216, 16, v186
    v_and_b32 v217, 0xffff0000, v186
    v_mfma_f32_16x16x32_bf16 a[40:43], v[144:147], v[48:51], a[40:43]
    ds_read_b64_tr_b16 v[106:107], v19 offset:16896
    v_lshlrev_b32 v218, 16, v187
    v_mfma_f32_16x16x32_bf16 a[40:43], v[148:151], v[52:55], a[40:43]
    v_and_b32 v219, 0xffff0000, v187
    s_waitcnt vmcnt(11)
    v_lshlrev_b32 v220, 16, v188
    v_mfma_f32_16x16x32_bf16 a[44:47], v[152:155], v[48:51], a[44:47]
    buffer_load_dwordx4 v5, s[44:47], s10 offen offset:1024 lds
    v_mfma_f32_16x16x32_bf16 a[44:47], v[156:159], v[52:55], a[44:47]
    ds_read_b128 v[48:51], v16 offset:4096
    ds_read_b128 v[52:55], v17 offset:4096
    v_mfma_f32_16x16x32_bf16 a[48:51], v[128:131], v[56:59], a[48:51]
    ds_read_b64_tr_b16 v[108:109], v19 offset:20480
    v_and_b32 v221, 0xffff0000, v188
    v_mfma_f32_16x16x32_bf16 a[48:51], v[132:135], v[60:63], a[48:51]
    v_lshlrev_b32 v222, 16, v189
    v_and_b32 v223, 0xffff0000, v189
    v_mfma_f32_16x16x32_bf16 a[52:55], v[136:139], v[56:59], a[52:55]
    buffer_load_dwordx4 v6, s[44:47], s10 offen offset:2048 lds
    v_mfma_f32_16x16x32_bf16 a[52:55], v[140:143], v[60:63], a[52:55]
    v_lshlrev_b32 v224, 16, v190
    v_and_b32 v225, 0xffff0000, v190
    v_mfma_f32_16x16x32_bf16 a[56:59], v[144:147], v[56:59], a[56:59]
    ds_read_b64_tr_b16 v[110:111], v19 offset:20992
    v_lshlrev_b32 v226, 16, v191
    v_mfma_f32_16x16x32_bf16 a[56:59], v[148:151], v[60:63], a[56:59]
    v_and_b32 v227, 0xffff0000, v191
    s_waitcnt vmcnt(11)
    v_lshlrev_b32 v228, 16, v192
    v_mfma_f32_16x16x32_bf16 a[60:63], v[152:155], v[56:59], a[60:63]
    buffer_load_dwordx4 v7, s[44:47], s10 offen offset:3072 lds
    v_mfma_f32_16x16x32_bf16 a[60:63], v[156:159], v[60:63], a[60:63]
    ds_read_b128 v[56:59], v16 offset:6144
    ds_read_b128 v[60:63], v17 offset:6144
    v_mfma_f32_16x16x32_bf16 a[64:67], v[128:131], v[64:67], a[64:67]
    ds_read_b64_tr_b16 v[112:113], v20 offset:16384
    v_and_b32 v229, 0xffff0000, v192
    v_mfma_f32_16x16x32_bf16 a[64:67], v[132:135], v[68:71], a[64:67]
    s_mov_b32 s10, 0x200000
    s_add_u32 m0, s14, 0x18000
    v_lshlrev_b32 v230, 16, v193
    v_mfma_f32_16x16x32_bf16 a[68:71], v[136:139], v[64:67], a[68:71]
    buffer_load_dwordx4 v8, s[48:51], s10 offen offset:0 lds
    v_mfma_f32_16x16x32_bf16 a[68:71], v[140:143], v[68:71], a[68:71]
    v_and_b32 v231, 0xffff0000, v193
    v_lshlrev_b32 v232, 16, v194
    v_mfma_f32_16x16x32_bf16 a[72:75], v[144:147], v[64:67], a[72:75]
    ds_read_b64_tr_b16 v[114:115], v20 offset:16896
    v_and_b32 v233, 0xffff0000, v194
    v_mfma_f32_16x16x32_bf16 a[72:75], v[148:151], v[68:71], a[72:75]
    v_lshlrev_b32 v234, 16, v195
    v_and_b32 v235, 0xffff0000, v195
    v_mfma_f32_16x16x32_bf16 a[76:79], v[152:155], v[64:67], a[76:79]
    buffer_load_dwordx4 v9, s[48:51], s10 offen offset:1024 lds
    v_mfma_f32_16x16x32_bf16 a[76:79], v[156:159], v[68:71], a[76:79]
    ds_read_b128 v[64:67], v16 offset:8192
    ds_read_b128 v[68:71], v17 offset:8192
    v_mfma_f32_16x16x32_bf16 a[80:83], v[128:131], v[72:75], a[80:83]
    ds_read_b64_tr_b16 v[116:117], v20 offset:20480
    v_add_f32 v245, v196, v197
    v_mfma_f32_16x16x32_bf16 a[80:83], v[132:135], v[76:79], a[80:83]
    v_add_f32 v246, v198, v199
    v_add_f32 v245, v245, v200
    v_mfma_f32_16x16x32_bf16 a[84:87], v[136:139], v[72:75], a[84:87]
    buffer_load_dwordx4 v10, s[48:51], s10 offen offset:2048 lds
    v_mfma_f32_16x16x32_bf16 a[84:87], v[140:143], v[76:79], a[84:87]
    v_add_f32 v246, v246, v201
    v_add_f32 v245, v245, v202
    v_mfma_f32_16x16x32_bf16 a[88:91], v[144:147], v[72:75], a[88:91]
    ds_read_b64_tr_b16 v[118:119], v20 offset:20992
    v_add_f32 v246, v246, v203
    v_mfma_f32_16x16x32_bf16 a[88:91], v[148:151], v[76:79], a[88:91]
    v_add_f32 v245, v245, v204
    v_add_f32 v246, v246, v205
    v_mfma_f32_16x16x32_bf16 a[92:95], v[152:155], v[72:75], a[92:95]
    buffer_load_dwordx4 v11, s[48:51], s10 offen offset:3072 lds
    v_mfma_f32_16x16x32_bf16 a[92:95], v[156:159], v[76:79], a[92:95]
    ds_read_b128 v[72:75], v16 offset:10240
    ds_read_b128 v[76:79], v17 offset:10240
    v_mfma_f32_16x16x32_bf16 a[96:99], v[128:131], v[80:83], a[96:99]
    ds_read_b64_tr_b16 v[120:121], v21 offset:16384
    v_add_f32 v245, v245, v206
    v_mfma_f32_16x16x32_bf16 a[96:99], v[132:135], v[84:87], a[96:99]
    s_mov_b32 s10, 0x200000
    s_add_u32 m0, s14, 0x1c000
    v_add_f32 v246, v246, v207
    v_mfma_f32_16x16x32_bf16 a[100:103], v[136:139], v[80:83], a[100:103]
    buffer_load_dwordx4 v8, s[52:55], s10 offen offset:0 lds
    v_mfma_f32_16x16x32_bf16 a[100:103], v[140:143], v[84:87], a[100:103]
    v_add_f32 v245, v245, v208
    v_add_f32 v246, v246, v209
    v_mfma_f32_16x16x32_bf16 a[104:107], v[144:147], v[80:83], a[104:107]
    ds_read_b64_tr_b16 v[122:123], v21 offset:16896
    v_add_f32 v245, v245, v210
    v_mfma_f32_16x16x32_bf16 a[104:107], v[148:151], v[84:87], a[104:107]
    v_add_f32 v246, v246, v211
    v_add_f32 v245, v245, v212
    v_mfma_f32_16x16x32_bf16 a[108:111], v[152:155], v[80:83], a[108:111]
    buffer_load_dwordx4 v9, s[52:55], s10 offen offset:1024 lds
    v_mfma_f32_16x16x32_bf16 a[108:111], v[156:159], v[84:87], a[108:111]
    ds_read_b128 v[80:83], v16 offset:12288
    ds_read_b128 v[84:87], v17 offset:12288
    v_mfma_f32_16x16x32_bf16 a[112:115], v[128:131], v[88:91], a[112:115]
    ds_read_b64_tr_b16 v[124:125], v21 offset:20480
    v_add_f32 v246, v246, v213
    v_mfma_f32_16x16x32_bf16 a[112:115], v[132:135], v[92:95], a[112:115]
    v_add_f32 v245, v245, v214
    v_add_f32 v246, v246, v215
    v_mfma_f32_16x16x32_bf16 a[116:119], v[136:139], v[88:91], a[116:119]
    buffer_load_dwordx4 v10, s[52:55], s10 offen offset:2048 lds
    v_mfma_f32_16x16x32_bf16 a[116:119], v[140:143], v[92:95], a[116:119]
    ds_read_b64_tr_b16 v[126:127], v21 offset:20992
    v_add_f32 v245, v245, v216
    v_mfma_f32_16x16x32_bf16 a[120:123], v[144:147], v[88:91], a[120:123]
    v_add_f32 v246, v246, v217
    v_add_f32 v245, v245, v218
    v_mfma_f32_16x16x32_bf16 a[120:123], v[148:151], v[92:95], a[120:123]
    v_add_f32 v246, v246, v219
    v_add_f32 v245, v245, v220
    v_mfma_f32_16x16x32_bf16 a[124:127], v[152:155], v[88:91], a[124:127]
    buffer_load_dwordx4 v11, s[52:55], s10 offen offset:3072 lds
    v_mfma_f32_16x16x32_bf16 a[124:127], v[156:159], v[92:95], a[124:127]
    s_waitcnt lgkmcnt(4)
    ds_read_b128 v[88:91], v16 offset:14336
    ds_read_b128 v[92:95], v17 offset:14336
    v_mfma_f32_16x16x32_bf16 a[128:131], v[32:35], v[96:99], a[128:131]
    v_add_f32 v246, v246, v221
    v_add_f32 v245, v245, v222
    v_mfma_f32_16x16x32_bf16 a[128:131], v[36:39], v[100:103], a[128:131]
    v_add_f32 v246, v246, v223
    v_add_f32 v245, v245, v224
    v_mfma_f32_16x16x32_bf16 a[136:139], v[32:35], v[104:107], a[136:139]
    v_add_f32 v246, v246, v225
    v_add_f32 v245, v245, v226
    v_mfma_f32_16x16x32_bf16 a[136:139], v[36:39], v[108:111], a[136:139]
    s_mov_b32 s92, 0x140000
    v_add_f32 v246, v246, v227
    v_add_f32 v245, v245, v228
    v_mfma_f32_16x16x32_bf16 a[144:147], v[32:35], v[112:115], a[144:147]
    buffer_load_dword v175, v171, s[56:59], s92 offen
    v_mfma_f32_16x16x32_bf16 a[144:147], v[36:39], v[116:119], a[144:147]
    v_add_f32 v246, v246, v229
    v_add_f32 v245, v245, v230
    v_mfma_f32_16x16x32_bf16 a[152:155], v[32:35], v[120:123], a[152:155]
    s_waitcnt lgkmcnt(2)
    ds_read_b64_tr_b16 v[128:129], v18 offset:0
    v_add_f32 v246, v246, v231
    v_mfma_f32_16x16x32_bf16 a[152:155], v[36:39], v[124:127], a[152:155]
    v_add_f32 v245, v245, v232
    v_add_f32 v246, v246, v233
    v_mfma_f32_16x16x32_bf16 a[132:135], v[40:43], v[96:99], a[132:135]
    ds_read_b64_tr_b16 v[130:131], v18 offset:512
    v_add_f32 v245, v245, v234
    v_mfma_f32_16x16x32_bf16 a[132:135], v[44:47], v[100:103], a[132:135]
    v_add_f32 v246, v246, v235
    v_add_f32 v245, v245, v246
    v_mfma_f32_16x16x32_bf16 a[140:143], v[40:43], v[104:107], a[140:143]
    ds_read_b64_tr_b16 v[132:133], v18 offset:4096
    v_add_f32_dpp v245, v245, v245 row_ror:4 row_mask:0xf bank_mask:0xf
    v_mfma_f32_16x16x32_bf16 a[140:143], v[44:47], v[108:111], a[140:143]
    s_nop 0
    v_add_f32_dpp v245, v245, v245 row_ror:8 row_mask:0xf bank_mask:0xf
    v_mov_b32 v248, v245
    v_mfma_f32_16x16x32_bf16 a[148:151], v[40:43], v[112:115], a[148:151]
    ds_read_b64_tr_b16 v[134:135], v18 offset:4608
    v_permlane16_swap_b32 v245, v248
    v_mfma_f32_16x16x32_bf16 a[148:151], v[44:47], v[116:119], a[148:151]
    v_add_f32 v245, v245, v248
    v_mov_b32 v248, v245
    v_mfma_f32_16x16x32_bf16 a[156:159], v[40:43], v[120:123], a[156:159]
    ds_read_b64_tr_b16 v[136:137], v19 offset:0
    v_permlane32_swap_b32 v245, v248
    v_mfma_f32_16x16x32_bf16 a[156:159], v[44:47], v[124:127], a[156:159]
    v_add_f32 v245, v245, v248
    v_mul_f32 v245, 0x3acccccd, v245
    v_mfma_f32_16x16x32_bf16 a[160:163], v[48:51], v[96:99], a[160:163]
    ds_read_b64_tr_b16 v[138:139], v19 offset:512
    v_cvt_pk_bf16_f32 v247, v245, v245
    v_mfma_f32_16x16x32_bf16 a[160:163], v[52:55], v[100:103], a[160:163]
    v_lshlrev_b32 v247, 16, v247
    v_sub_f32 v236, v196, v245
    v_mfma_f32_16x16x32_bf16 a[168:171], v[48:51], v[104:107], a[168:171]
    ds_read_b64_tr_b16 v[140:141], v19 offset:4096
    v_sub_f32 v237, v197, v245
    v_mfma_f32_16x16x32_bf16 a[168:171], v[52:55], v[108:111], a[168:171]
    v_sub_f32 v238, v198, v245
    v_sub_f32 v239, v199, v245
    v_mfma_f32_16x16x32_bf16 a[176:179], v[48:51], v[112:115], a[176:179]
    ds_read_b64_tr_b16 v[142:143], v19 offset:4608
    v_sub_f32 v240, v200, v245
    v_mfma_f32_16x16x32_bf16 a[176:179], v[52:55], v[116:119], a[176:179]
    v_mul_f32 v246, v236, v236
    v_sub_f32 v241, v201, v245
    v_mfma_f32_16x16x32_bf16 a[184:187], v[48:51], v[120:123], a[184:187]
    ds_read_b64_tr_b16 v[144:145], v20 offset:0
    v_mul_f32 v248, v237, v237
    v_mfma_f32_16x16x32_bf16 a[184:187], v[52:55], v[124:127], a[184:187]
    v_sub_f32 v242, v202, v245
    v_fmac_f32 v246, v238, v238
    v_mfma_f32_16x16x32_bf16 a[164:167], v[56:59], v[96:99], a[164:167]
    ds_read_b64_tr_b16 v[146:147], v20 offset:512
    v_sub_f32 v243, v203, v245
    v_mfma_f32_16x16x32_bf16 a[164:167], v[60:63], v[100:103], a[164:167]
    v_fmac_f32 v248, v239, v239
    v_sub_f32 v236, v204, v245
    v_mfma_f32_16x16x32_bf16 a[172:175], v[56:59], v[104:107], a[172:175]
    ds_read_b64_tr_b16 v[148:149], v20 offset:4096
    v_fmac_f32 v246, v240, v240
    v_mfma_f32_16x16x32_bf16 a[172:175], v[60:63], v[108:111], a[172:175]
    v_sub_f32 v237, v205, v245
    v_fmac_f32 v248, v241, v241
    v_mfma_f32_16x16x32_bf16 a[180:183], v[56:59], v[112:115], a[180:183]
    ds_read_b64_tr_b16 v[150:151], v20 offset:4608
    v_sub_f32 v238, v206, v245
    v_mfma_f32_16x16x32_bf16 a[180:183], v[60:63], v[116:119], a[180:183]
    v_fmac_f32 v246, v242, v242
    v_sub_f32 v239, v207, v245
    v_mfma_f32_16x16x32_bf16 a[188:191], v[56:59], v[120:123], a[188:191]
    ds_read_b64_tr_b16 v[152:153], v21 offset:0
    v_fmac_f32 v248, v243, v243
    v_mfma_f32_16x16x32_bf16 a[188:191], v[60:63], v[124:127], a[188:191]
    v_sub_f32 v240, v208, v245
    v_fmac_f32 v246, v236, v236
    v_mfma_f32_16x16x32_bf16 a[192:195], v[64:67], v[96:99], a[192:195]
    ds_read_b64_tr_b16 v[154:155], v21 offset:512
    v_sub_f32 v241, v209, v245
    v_mfma_f32_16x16x32_bf16 a[192:195], v[68:71], v[100:103], a[192:195]
    v_fmac_f32 v248, v237, v237
    v_sub_f32 v242, v210, v245
    v_mfma_f32_16x16x32_bf16 a[200:203], v[64:67], v[104:107], a[200:203]
    ds_read_b64_tr_b16 v[156:157], v21 offset:4096
    v_fmac_f32 v246, v238, v238
    v_mfma_f32_16x16x32_bf16 a[200:203], v[68:71], v[108:111], a[200:203]
    v_sub_f32 v243, v211, v245
    v_fmac_f32 v248, v239, v239
    v_mfma_f32_16x16x32_bf16 a[208:211], v[64:67], v[112:115], a[208:211]
    ds_read_b64_tr_b16 v[158:159], v21 offset:4608
    v_sub_f32 v236, v212, v245
    v_mfma_f32_16x16x32_bf16 a[208:211], v[68:71], v[116:119], a[208:211]
    v_fmac_f32 v246, v240, v240
    v_sub_f32 v237, v213, v245
    v_mfma_f32_16x16x32_bf16 a[216:219], v[64:67], v[120:123], a[216:219]
    v_fmac_f32 v248, v241, v241
    v_sub_f32 v238, v214, v245
    v_mfma_f32_16x16x32_bf16 a[216:219], v[68:71], v[124:127], a[216:219]
    v_fmac_f32 v246, v242, v242
    v_sub_f32 v239, v215, v245
    v_mfma_f32_16x16x32_bf16 a[196:199], v[72:75], v[96:99], a[196:199]
    v_fmac_f32 v248, v243, v243
    v_sub_f32 v240, v216, v245
    v_mfma_f32_16x16x32_bf16 a[196:199], v[76:79], v[100:103], a[196:199]
    v_fmac_f32 v246, v236, v236
    v_sub_f32 v241, v217, v245
    v_mfma_f32_16x16x32_bf16 a[204:207], v[72:75], v[104:107], a[204:207]
    v_fmac_f32 v248, v237, v237
    v_sub_f32 v242, v218, v245
    v_mfma_f32_16x16x32_bf16 a[204:207], v[76:79], v[108:111], a[204:207]
    v_fmac_f32 v246, v238, v238
    v_sub_f32 v243, v219, v245
    v_mfma_f32_16x16x32_bf16 a[212:215], v[72:75], v[112:115], a[212:215]
    v_fmac_f32 v248, v239, v239
    v_sub_f32 v236, v220, v245
    v_mfma_f32_16x16x32_bf16 a[212:215], v[76:79], v[116:119], a[212:215]
    v_fmac_f32 v246, v240, v240
    v_sub_f32 v237, v221, v245
    v_mfma_f32_16x16x32_bf16 a[220:223], v[72:75], v[120:123], a[220:223]
    v_fmac_f32 v248, v241, v241
    v_sub_f32 v238, v222, v245
    v_mfma_f32_16x16x32_bf16 a[220:223], v[76:79], v[124:127], a[220:223]
    v_fmac_f32 v246, v242, v242
    v_sub_f32 v239, v223, v245
    v_mfma_f32_16x16x32_bf16 a[224:227], v[80:83], v[96:99], a[224:227]
    v_fmac_f32 v248, v243, v243
    v_sub_f32 v240, v224, v245
    v_mfma_f32_16x16x32_bf16 a[224:227], v[84:87], v[100:103], a[224:227]
    v_fmac_f32 v246, v236, v236
    v_sub_f32 v241, v225, v245
    v_mfma_f32_16x16x32_bf16 a[232:235], v[80:83], v[104:107], a[232:235]
    v_fmac_f32 v248, v237, v237
    v_sub_f32 v242, v226, v245
    v_mfma_f32_16x16x32_bf16 a[232:235], v[84:87], v[108:111], a[232:235]
    v_fmac_f32 v246, v238, v238
    v_sub_f32 v243, v227, v245
    v_mfma_f32_16x16x32_bf16 a[240:243], v[80:83], v[112:115], a[240:243]
    v_fmac_f32 v248, v239, v239
    v_sub_f32 v236, v228, v245
    v_mfma_f32_16x16x32_bf16 a[240:243], v[84:87], v[116:119], a[240:243]
    v_fmac_f32 v246, v240, v240
    v_sub_f32 v237, v229, v245
    v_mfma_f32_16x16x32_bf16 a[248:251], v[80:83], v[120:123], a[248:251]
    v_fmac_f32 v248, v241, v241
    v_sub_f32 v238, v230, v245
    v_mfma_f32_16x16x32_bf16 a[248:251], v[84:87], v[124:127], a[248:251]
    s_waitcnt lgkmcnt(15)
    v_fmac_f32 v246, v242, v242
    v_sub_f32 v239, v231, v245
    v_mfma_f32_16x16x32_bf16 a[228:231], v[88:91], v[96:99], a[228:231]
    v_fmac_f32 v248, v243, v243
    v_sub_f32 v240, v232, v245
    v_mfma_f32_16x16x32_bf16 a[228:231], v[92:95], v[100:103], a[228:231]
    v_add_u32 v18, 0xfffe8000, v18
    v_add_u32 v19, 0xfffe8000, v19
    v_mfma_f32_16x16x32_bf16 a[236:239], v[88:91], v[104:107], a[236:239]
    v_add_u32 v20, 0xfffe8000, v20
    v_add_u32 v21, 0xfffe8000, v21
    v_mfma_f32_16x16x32_bf16 a[236:239], v[92:95], v[108:111], a[236:239]
    v_xor_b32 v16, 0x10000, v16
    v_xor_b32 v17, 0x10000, v17
    v_mfma_f32_16x16x32_bf16 a[244:247], v[88:91], v[112:115], a[244:247]
    v_fmac_f32 v246, v236, v236
    v_sub_f32 v241, v233, v245
    v_mfma_f32_16x16x32_bf16 a[244:247], v[92:95], v[116:119], a[244:247]
    v_fmac_f32 v248, v237, v237
    v_sub_f32 v242, v234, v245
    v_mfma_f32_16x16x32_bf16 a[252:255], v[88:91], v[120:123], a[252:255]
    v_fmac_f32 v246, v238, v238
    v_sub_f32 v243, v235, v245
    v_mfma_f32_16x16x32_bf16 a[252:255], v[92:95], v[124:127], a[252:255]
    s_waitcnt lgkmcnt(0)
    s_waitcnt vmcnt(9)
    s_barrier
    v_fmac_f32 v248, v239, v239
    v_mfma_f32_16x16x32_bf16 a[0:3], v[128:131], v[32:35], a[0:3]
    ds_read_b64_tr_b16 v[96:97], v18 offset:16384
    v_fmac_f32 v246, v240, v240
    v_mfma_f32_16x16x32_bf16 a[0:3], v[132:135], v[36:39], a[0:3]
    s_mov_b32 s10, 0x200
    s_add_u32 m0, s15, 0x0
    v_fmac_f32 v248, v241, v241
    v_mfma_f32_16x16x32_bf16 a[4:7], v[136:139], v[32:35], a[4:7]
    buffer_load_dwordx4 v4, s[44:47], s10 offen offset:0 lds
    v_mfma_f32_16x16x32_bf16 a[4:7], v[140:143], v[36:39], a[4:7]
    v_fmac_f32 v246, v242, v242
    v_fmac_f32 v248, v243, v243
    v_mfma_f32_16x16x32_bf16 a[8:11], v[144:147], v[32:35], a[8:11]
    ds_read_b64_tr_b16 v[98:99], v18 offset:16896
    v_add_f32 v246, v246, v248
    v_mfma_f32_16x16x32_bf16 a[8:11], v[148:151], v[36:39], a[8:11]
    s_nop 0
    v_add_f32_dpp v246, v246, v246 row_ror:4 row_mask:0xf bank_mask:0xf
    v_sub_f32 v196, v196, v247
    v_mfma_f32_16x16x32_bf16 a[12:15], v[152:155], v[32:35], a[12:15]
    buffer_load_dwordx4 v5, s[44:47], s10 offen offset:1024 lds
    v_mfma_f32_16x16x32_bf16 a[12:15], v[156:159], v[36:39], a[12:15]
    ds_read_b128 v[32:35], v16 offset:0
    ds_read_b128 v[36:39], v17 offset:0
    v_mfma_f32_16x16x32_bf16 a[16:19], v[128:131], v[40:43], a[16:19]
    s_cmp_lg_u32 s3, 0
    s_cbranch_scc1 fk_lr
    buffer_load_dword v27, v28, s[60:63], 0 offen sc1
fk_lr:
    v_mfma_f32_16x16x32_bf16 a[16:19], v[132:135], v[44:47], a[16:19]
    ds_read_b64_tr_b16 v[100:101], v18 offset:20480
    v_sub_f32 v197, v197, v247
    v_mfma_f32_16x16x32_bf16 a[20:23], v[136:139], v[40:43], a[20:23]
    buffer_load_dwordx4 v6, s[44:47], s10 offen offset:2048 lds
    v_mfma_f32_16x16x32_bf16 a[20:23], v[140:143], v[44:47], a[20:23]
    v_add_f32_dpp v246, v246, v246 row_ror:8 row_mask:0xf bank_mask:0xf
    v_sub_f32 v198, v198, v247
    v_mfma_f32_16x16x32_bf16 a[24:27], v[144:147], v[40:43], a[24:27]
    ds_read_b64_tr_b16 v[102:103], v18 offset:20992
    v_sub_f32 v199, v199, v247
    v_mfma_f32_16x16x32_bf16 a[24:27], v[148:151], v[44:47], a[24:27]
    v_mov_b32 v248, v246
    v_sub_f32 v200, v200, v247
    v_mfma_f32_16x16x32_bf16 a[28:31], v[152:155], v[40:43], a[28:31]
    buffer_load_dwordx4 v7, s[44:47], s10 offen offset:3072 lds
    v_mfma_f32_16x16x32_bf16 a[28:31], v[156:159], v[44:47], a[28:31]
    ds_read_b128 v[40:43], v16 offset:2048
    ds_read_b128 v[44:47], v17 offset:2048
    v_mfma_f32_16x16x32_bf16 a[32:35], v[128:131], v[48:51], a[32:35]
    ds_read_b64_tr_b16 v[104:105], v19 offset:16384
    v_sub_f32 v201, v201, v247
    v_mfma_f32_16x16x32_bf16 a[32:35], v[132:135], v[52:55], a[32:35]
    s_mov_b32 s10, 0x8200
    s_add_u32 m0, s15, 0x1000
    v_permlane16_swap_b32 v246, v248
    v_mfma_f32_16x16x32_bf16 a[36:39], v[136:139], v[48:51], a[36:39]
    buffer_load_dwordx4 v4, s[44:47], s10 offen offset:0 lds
    v_mfma_f32_16x16x32_bf16 a[36:39], v[140:143], v[52:55], a[36:39]
    v_sub_f32 v202, v202, v247
    v_sub_f32 v203, v203, v247
    v_mfma_f32_16x16x32_bf16 a[40:43], v[144:147], v[48:51], a[40:43]
    ds_read_b64_tr_b16 v[106:107], v19 offset:16896
    v_add_f32 v246, v246, v248
    v_mfma_f32_16x16x32_bf16 a[40:43], v[148:151], v[52:55], a[40:43]
    v_sub_f32 v204, v204, v247
    v_sub_f32 v205, v205, v247
    v_mfma_f32_16x16x32_bf16 a[44:47], v[152:155], v[48:51], a[44:47]
    buffer_load_dwordx4 v5, s[44:47], s10 offen offset:1024 lds
    v_mfma_f32_16x16x32_bf16 a[44:47], v[156:159], v[52:55], a[44:47]
    ds_read_b128 v[48:51], v16 offset:4096
    ds_read_b128 v[52:55], v17 offset:4096
    v_mfma_f32_16x16x32_bf16 a[48:51], v[128:131], v[56:59], a[48:51]
    ds_read_b64_tr_b16 v[108:109], v19 offset:20480
    v_mov_b32 v248, v246
    v_mfma_f32_16x16x32_bf16 a[48:51], v[132:135], v[60:63], a[48:51]
    v_sub_f32 v206, v206, v247
    v_sub_f32 v207, v207, v247
    v_mfma_f32_16x16x32_bf16 a[52:55], v[136:139], v[56:59], a[52:55]
    buffer_load_dwordx4 v6, s[44:47], s10 offen offset:2048 lds
    v_mfma_f32_16x16x32_bf16 a[52:55], v[140:143], v[60:63], a[52:55]
    v_permlane32_swap_b32 v246, v248
    v_sub_f32 v208, v208, v247
    v_mfma_f32_16x16x32_bf16 a[56:59], v[144:147], v[56:59], a[56:59]
    ds_read_b64_tr_b16 v[110:111], v19 offset:20992
    v_sub_f32 v209, v209, v247
    v_mfma_f32_16x16x32_bf16 a[56:59], v[148:151], v[60:63], a[56:59]
    v_add_f32 v246, v246, v248
    v_sub_f32 v210, v210, v247
    v_mfma_f32_16x16x32_bf16 a[60:63], v[152:155], v[56:59], a[60:63]
    buffer_load_dwordx4 v7, s[44:47], s10 offen offset:3072 lds
    v_mfma_f32_16x16x32_bf16 a[60:63], v[156:159], v[60:63], a[60:63]
    ds_read_b128 v[56:59], v16 offset:6144
    ds_read_b128 v[60:63], v17 offset:6144
    v_mfma_f32_16x16x32_bf16 a[64:67], v[128:131], v[64:67], a[64:67]
    ds_read_b64_tr_b16 v[112:113], v20 offset:16384
    v_sub_f32 v211, v211, v247
    v_mfma_f32_16x16x32_bf16 a[64:67], v[132:135], v[68:71], a[64:67]
    s_mov_b32 s10, 0x280000
    s_add_u32 m0, s14, 0x20000
    v_sub_f32 v212, v212, v247
    v_mfma_f32_16x16x32_bf16 a[68:71], v[136:139], v[64:67], a[68:71]
    buffer_load_dwordx4 v8, s[48:51], s10 offen offset:0 lds
    v_mfma_f32_16x16x32_bf16 a[68:71], v[140:143], v[68:71], a[68:71]
    v_sub_f32 v213, v213, v247
    v_sub_f32 v214, v214, v247
    v_mfma_f32_16x16x32_bf16 a[72:75], v[144:147], v[64:67], a[72:75]
    ds_read_b64_tr_b16 v[114:115], v20 offset:16896
    v_sub_f32 v215, v215, v247
    v_mfma_f32_16x16x32_bf16 a[72:75], v[148:151], v[68:71], a[72:75]
    v_sub_f32 v216, v216, v247
    v_sub_f32 v217, v217, v247
    v_mfma_f32_16x16x32_bf16 a[76:79], v[152:155], v[64:67], a[76:79]
    buffer_load_dwordx4 v9, s[48:51], s10 offen offset:1024 lds
    v_mfma_f32_16x16x32_bf16 a[76:79], v[156:159], v[68:71], a[76:79]
    ds_read_b128 v[64:67], v16 offset:8192
    ds_read_b128 v[68:71], v17 offset:8192
    v_mfma_f32_16x16x32_bf16 a[80:83], v[128:131], v[72:75], a[80:83]
    ds_read_b64_tr_b16 v[116:117], v20 offset:20480
    v_sub_f32 v218, v218, v247
    v_mfma_f32_16x16x32_bf16 a[80:83], v[132:135], v[76:79], a[80:83]
    v_sub_f32 v219, v219, v247
    v_sub_f32 v220, v220, v247
    v_mfma_f32_16x16x32_bf16 a[84:87], v[136:139], v[72:75], a[84:87]
    buffer_load_dwordx4 v10, s[48:51], s10 offen offset:2048 lds
    v_mfma_f32_16x16x32_bf16 a[84:87], v[140:143], v[76:79], a[84:87]
    v_sub_f32 v221, v221, v247
    v_sub_f32 v222, v222, v247
    v_mfma_f32_16x16x32_bf16 a[88:91], v[144:147], v[72:75], a[88:91]
    ds_read_b64_tr_b16 v[118:119], v20 offset:20992
    v_sub_f32 v223, v223, v247
    v_mfma_f32_16x16x32_bf16 a[88:91], v[148:151], v[76:79], a[88:91]
    v_sub_f32 v224, v224, v247
    v_sub_f32 v225, v225, v247
    v_mfma_f32_16x16x32_bf16 a[92:95], v[152:155], v[72:75], a[92:95]
    buffer_load_dwordx4 v11, s[48:51], s10 offen offset:3072 lds
    v_mfma_f32_16x16x32_bf16 a[92:95], v[156:159], v[76:79], a[92:95]
    ds_read_b128 v[72:75], v16 offset:10240
    ds_read_b128 v[76:79], v17 offset:10240
    v_mfma_f32_16x16x32_bf16 a[96:99], v[128:131], v[80:83], a[96:99]
    ds_read_b64_tr_b16 v[120:121], v21 offset:16384
    v_sub_f32 v226, v226, v247
    v_mfma_f32_16x16x32_bf16 a[96:99], v[132:135], v[84:87], a[96:99]
    s_mov_b32 s10, 0x280000
    s_add_u32 m0, s14, 0x24000
    v_sub_f32 v227, v227, v247
    v_mfma_f32_16x16x32_bf16 a[100:103], v[136:139], v[80:83], a[100:103]
    buffer_load_dwordx4 v8, s[52:55], s10 offen offset:0 lds
    v_mfma_f32_16x16x32_bf16 a[100:103], v[140:143], v[84:87], a[100:103]
    v_sub_f32 v228, v228, v247
    v_sub_f32 v229, v229, v247
    v_mfma_f32_16x16x32_bf16 a[104:107], v[144:147], v[80:83], a[104:107]
    ds_read_b64_tr_b16 v[122:123], v21 offset:16896
    v_sub_f32 v230, v230, v247
    v_mfma_f32_16x16x32_bf16 a[104:107], v[148:151], v[84:87], a[104:107]
    v_sub_f32 v231, v231, v247
    v_sub_f32 v232, v232, v247
    v_mfma_f32_16x16x32_bf16 a[108:111], v[152:155], v[80:83], a[108:111]
    buffer_load_dwordx4 v9, s[52:55], s10 offen offset:1024 lds
    v_mfma_f32_16x16x32_bf16 a[108:111], v[156:159], v[84:87], a[108:111]
    ds_read_b128 v[80:83], v16 offset:12288
    ds_read_b128 v[84:87], v17 offset:12288
    v_mfma_f32_16x16x32_bf16 a[112:115], v[128:131], v[88:91], a[112:115]
    ds_read_b64_tr_b16 v[124:125], v21 offset:20480
    v_sub_f32 v233, v233, v247
    v_mfma_f32_16x16x32_bf16 a[112:115], v[132:135], v[92:95], a[112:115]
    v_sub_f32 v234, v234, v247
    v_sub_f32 v235, v235, v247
    v_mfma_f32_16x16x32_bf16 a[116:119], v[136:139], v[88:91], a[116:119]
    buffer_load_dwordx4 v10, s[52:55], s10 offen offset:2048 lds
    v_mfma_f32_16x16x32_bf16 a[116:119], v[140:143], v[92:95], a[116:119]
    ds_read_b64_tr_b16 v[126:127], v21 offset:20992
    v_mul_f32 v246, 0x3acccccd, v246
    v_mfma_f32_16x16x32_bf16 a[120:123], v[144:147], v[88:91], a[120:123]
    v_cvt_pk_bf16_f32 v176, v196, v197
    v_cvt_pk_bf16_f32 v177, v198, v199
    v_mfma_f32_16x16x32_bf16 a[120:123], v[148:151], v[92:95], a[120:123]
    v_cvt_pk_bf16_f32 v246, v246, v246
    v_cvt_pk_bf16_f32 v178, v200, v201
    v_mfma_f32_16x16x32_bf16 a[124:127], v[152:155], v[88:91], a[124:127]
    buffer_load_dwordx4 v11, s[52:55], s10 offen offset:3072 lds
    v_mfma_f32_16x16x32_bf16 a[124:127], v[156:159], v[92:95], a[124:127]
    s_waitcnt lgkmcnt(4)
    ds_read_b128 v[88:91], v16 offset:14336
    ds_read_b128 v[92:95], v17 offset:14336
    v_mfma_f32_16x16x32_bf16 a[128:131], v[32:35], v[96:99], a[128:131]
    v_cvt_pk_bf16_f32 v179, v202, v203
    v_lshlrev_b32 v246, 16, v246
    v_mfma_f32_16x16x32_bf16 a[128:131], v[36:39], v[100:103], a[128:131]
    v_cvt_pk_bf16_f32 v180, v204, v205
    v_cvt_pk_bf16_f32 v181, v206, v207
    v_mfma_f32_16x16x32_bf16 a[136:139], v[32:35], v[104:107], a[136:139]
    s_add_u32 s56, s20, 0x0
    s_addc_u32 s57, s21, 0
    v_add_f32 v246, 0x3727c5ac, v246
    v_mfma_f32_16x16x32_bf16 a[136:139], v[36:39], v[108:111], a[136:139]
    s_mov_b32 s58, 0x500000
    s_mov_b32 s59, 0x20000
    s_mov_b32 s92, 0x0
    v_mfma_f32_16x16x32_bf16 a[144:147], v[32:35], v[112:115], a[144:147]
    buffer_load_dword v175, v171, s[56:59], s92 offen
    v_mfma_f32_16x16x32_bf16 a[144:147], v[36:39], v[116:119], a[144:147]
    v_cvt_pk_bf16_f32 v182, v208, v209
    v_cvt_pk_bf16_f32 v183, v210, v211
    v_mfma_f32_16x16x32_bf16 a[152:155], v[32:35], v[120:123], a[152:155]
    s_waitcnt lgkmcnt(2)
    ds_read_b64_tr_b16 v[128:129], v18 offset:0
    v_cvt_pk_bf16_f32 v246, v246, v246
    v_mfma_f32_16x16x32_bf16 a[152:155], v[36:39], v[124:127], a[152:155]
    v_cvt_pk_bf16_f32 v184, v212, v213
    v_cvt_pk_bf16_f32 v185, v214, v215
    v_mfma_f32_16x16x32_bf16 a[132:135], v[40:43], v[96:99], a[132:135]
    ds_read_b64_tr_b16 v[130:131], v18 offset:512
    v_lshlrev_b32 v246, 16, v246
    v_mfma_f32_16x16x32_bf16 a[132:135], v[44:47], v[100:103], a[132:135]
    v_cvt_pk_bf16_f32 v186, v216, v217
    v_cvt_pk_bf16_f32 v187, v218, v219
    v_mfma_f32_16x16x32_bf16 a[140:143], v[40:43], v[104:107], a[140:143]
    ds_read_b64_tr_b16 v[132:133], v18 offset:4096
    v_mfma_f32_16x16x32_bf16 a[140:143], v[44:47], v[108:111], a[140:143]
    v_sqrt_f32 v246, v246
    v_mfma_f32_16x16x32_bf16 a[148:151], v[40:43], v[112:115], a[148:151]
    ds_read_b64_tr_b16 v[134:135], v18 offset:4608
    v_cvt_pk_bf16_f32 v188, v220, v221
    v_mfma_f32_16x16x32_bf16 a[148:151], v[44:47], v[116:119], a[148:151]
    v_cvt_pk_bf16_f32 v189, v222, v223
    v_cvt_pk_bf16_f32 v246, v246, v246
    v_mfma_f32_16x16x32_bf16 a[156:159], v[40:43], v[120:123], a[156:159]
    ds_read_b64_tr_b16 v[136:137], v19 offset:0
    v_cvt_pk_bf16_f32 v190, v224, v225
    v_mfma_f32_16x16x32_bf16 a[156:159], v[44:47], v[124:127], a[156:159]
    v_cvt_pk_bf16_f32 v191, v226, v227
    v_lshlrev_b32 v246, 16, v246
    v_mfma_f32_16x16x32_bf16 a[160:163], v[48:51], v[96:99], a[160:163]
    ds_read_b64_tr_b16 v[138:139], v19 offset:512
    v_cvt_pk_bf16_f32 v192, v228, v229
    v_mfma_f32_16x16x32_bf16 a[160:163], v[52:55], v[100:103], a[160:163]
    v_cvt_pk_bf16_f32 v193, v230, v231
    v_mfma_f32_16x16x32_bf16 a[168:171], v[48:51], v[104:107], a[168:171]
    ds_read_b64_tr_b16 v[140:141], v19 offset:4096
    v_mfma_f32_16x16x32_bf16 a[168:171], v[52:55], v[108:111], a[168:171]
    v_rcp_f32 v246, v246
    v_mfma_f32_16x16x32_bf16 a[176:179], v[48:51], v[112:115], a[176:179]
    ds_read_b64_tr_b16 v[142:143], v19 offset:4608
    v_cvt_pk_bf16_f32 v194, v232, v233
    v_mfma_f32_16x16x32_bf16 a[176:179], v[52:55], v[116:119], a[176:179]
    v_cvt_pk_bf16_f32 v195, v234, v235
    v_lshlrev_b32 v196, 16, v176
    v_mfma_f32_16x16x32_bf16 a[184:187], v[48:51], v[120:123], a[184:187]
    ds_read_b64_tr_b16 v[144:145], v20 offset:0
    v_and_b32 v197, 0xffff0000, v176
    v_mfma_f32_16x16x32_bf16 a[184:187], v[52:55], v[124:127], a[184:187]
    v_lshlrev_b32 v198, 16, v177
    v_and_b32 v199, 0xffff0000, v177
    v_mfma_f32_16x16x32_bf16 a[164:167], v[56:59], v[96:99], a[164:167]
    ds_read_b64_tr_b16 v[146:147], v20 offset:512
    v_lshlrev_b32 v200, 16, v178
    v_mfma_f32_16x16x32_bf16 a[164:167], v[60:63], v[100:103], a[164:167]
    v_and_b32 v201, 0xffff0000, v178
    v_lshlrev_b32 v202, 16, v179
    v_mfma_f32_16x16x32_bf16 a[172:175], v[56:59], v[104:107], a[172:175]
    ds_read_b64_tr_b16 v[148:149], v20 offset:4096
    v_and_b32 v203, 0xffff0000, v179
    v_mfma_f32_16x16x32_bf16 a[172:175], v[60:63], v[108:111], a[172:175]
    v_mul_f32 v196, v196, v246
    v_mul_f32 v197, v197, v246
    v_mfma_f32_16x16x32_bf16 a[180:183], v[56:59], v[112:115], a[180:183]
    ds_read_b64_tr_b16 v[150:151], v20 offset:4608
    v_mul_f32 v198, v198, v246
    v_mfma_f32_16x16x32_bf16 a[180:183], v[60:63], v[116:119], a[180:183]
    v_mul_f32 v199, v199, v246
    v_mul_f32 v200, v200, v246
    v_mfma_f32_16x16x32_bf16 a[188:191], v[56:59], v[120:123], a[188:191]
    ds_read_b64_tr_b16 v[152:153], v21 offset:0
    v_mul_f32 v201, v201, v246
    v_mfma_f32_16x16x32_bf16 a[188:191], v[60:63], v[124:127], a[188:191]
    v_mul_f32 v202, v202, v246
    v_mul_f32 v203, v203, v246
    v_mfma_f32_16x16x32_bf16 a[192:195], v[64:67], v[96:99], a[192:195]
    ds_read_b64_tr_b16 v[154:155], v21 offset:512
    v_cvt_pk_bf16_f32 v176, v196, v197
    v_mfma_f32_16x16x32_bf16 a[192:195], v[68:71], v[100:103], a[192:195]
    v_cvt_pk_bf16_f32 v177, v198, v199
    v_cvt_pk_bf16_f32 v178, v200, v201
    v_cvt_pk_bf16_f32 v179, v202, v203
    v_lshlrev_b32 v204, 16, v180
    v_and_b32 v205, 0xffff0000, v180
    v_lshlrev_b32 v206, 16, v181
    v_and_b32 v207, 0xffff0000, v181
    v_lshlrev_b32 v208, 16, v182
    v_and_b32 v209, 0xffff0000, v182
    v_lshlrev_b32 v210, 16, v183
    v_and_b32 v211, 0xffff0000, v183
    v_mul_f32 v204, v204, v246
    v_mul_f32 v205, v205, v246
    v_mul_f32 v206, v206, v246
    v_mul_f32 v207, v207, v246
    v_mul_f32 v208, v208, v246
    v_mul_f32 v209, v209, v246
    v_mul_f32 v210, v210, v246
    v_mul_f32 v211, v211, v246
    v_cvt_pk_bf16_f32 v180, v204, v205
    v_cvt_pk_bf16_f32 v181, v206, v207
    v_cvt_pk_bf16_f32 v182, v208, v209
    v_cvt_pk_bf16_f32 v183, v210, v211
    v_lshlrev_b32 v212, 16, v184
    v_and_b32 v213, 0xffff0000, v184
    v_lshlrev_b32 v214, 16, v185
    v_and_b32 v215, 0xffff0000, v185
    v_lshlrev_b32 v216, 16, v186
    v_and_b32 v217, 0xffff0000, v186
    v_lshlrev_b32 v218, 16, v187
    v_and_b32 v219, 0xffff0000, v187
    v_mul_f32 v212, v212, v246
    v_mul_f32 v213, v213, v246
    v_mul_f32 v214, v214, v246
    v_mul_f32 v215, v215, v246
    v_mul_f32 v216, v216, v246
    v_mul_f32 v217, v217, v246
    v_mul_f32 v218, v218, v246
    v_mul_f32 v219, v219, v246
    v_cvt_pk_bf16_f32 v184, v212, v213
    v_cvt_pk_bf16_f32 v185, v214, v215
    v_cvt_pk_bf16_f32 v186, v216, v217
    v_cvt_pk_bf16_f32 v187, v218, v219
    v_lshlrev_b32 v220, 16, v188
    v_and_b32 v221, 0xffff0000, v188
    v_lshlrev_b32 v222, 16, v189
    v_and_b32 v223, 0xffff0000, v189
    v_lshlrev_b32 v224, 16, v190
    v_and_b32 v225, 0xffff0000, v190
    v_lshlrev_b32 v226, 16, v191
    v_and_b32 v227, 0xffff0000, v191
    v_mul_f32 v220, v220, v246
    v_mul_f32 v221, v221, v246
    v_mul_f32 v222, v222, v246
    v_mul_f32 v223, v223, v246
    v_mul_f32 v224, v224, v246
    v_mul_f32 v225, v225, v246
    v_mul_f32 v226, v226, v246
    v_mul_f32 v227, v227, v246
    v_cvt_pk_bf16_f32 v188, v220, v221
    v_cvt_pk_bf16_f32 v189, v222, v223
    v_cvt_pk_bf16_f32 v190, v224, v225
    v_cvt_pk_bf16_f32 v191, v226, v227
    v_lshlrev_b32 v228, 16, v192
    v_and_b32 v229, 0xffff0000, v192
    v_lshlrev_b32 v230, 16, v193
    v_and_b32 v231, 0xffff0000, v193
    v_lshlrev_b32 v232, 16, v194
    v_and_b32 v233, 0xffff0000, v194
    v_lshlrev_b32 v234, 16, v195
    v_and_b32 v235, 0xffff0000, v195
    v_mul_f32 v228, v228, v246
    v_mul_f32 v229, v229, v246
    v_mul_f32 v230, v230, v246
    v_mul_f32 v231, v231, v246
    v_mul_f32 v232, v232, v246
    v_mul_f32 v233, v233, v246
    v_mul_f32 v234, v234, v246
    v_mul_f32 v235, v235, v246
    v_cvt_pk_bf16_f32 v192, v228, v229
    v_cvt_pk_bf16_f32 v193, v230, v231
    v_cvt_pk_bf16_f32 v194, v232, v233
    v_cvt_pk_bf16_f32 v195, v234, v235
    v_mfma_f32_16x16x32_bf16 a[200:203], v[64:67], v[104:107], a[200:203]
    ds_read_b64_tr_b16 v[156:157], v21 offset:4096
    v_mfma_f32_16x16x32_bf16 a[200:203], v[68:71], v[108:111], a[200:203]
    s_mov_b32 s13, 0x0
    v_mfma_f32_16x16x32_bf16 a[208:211], v[64:67], v[112:115], a[208:211]
    buffer_store_dwordx4 v[176:179], v244, s[64:67], s13 offen sc1
    ds_read_b64_tr_b16 v[158:159], v21 offset:4608
    v_mfma_f32_16x16x32_bf16 a[208:211], v[68:71], v[116:119], a[208:211]
    v_mfma_f32_16x16x32_bf16 a[216:219], v[64:67], v[120:123], a[216:219]
    v_mfma_f32_16x16x32_bf16 a[216:219], v[68:71], v[124:127], a[216:219]
    s_mov_b32 s13, 0x2000
    v_mfma_f32_16x16x32_bf16 a[196:199], v[72:75], v[96:99], a[196:199]
    buffer_store_dwordx4 v[180:183], v244, s[64:67], s13 offen sc1
    v_mfma_f32_16x16x32_bf16 a[196:199], v[76:79], v[100:103], a[196:199]
    v_mfma_f32_16x16x32_bf16 a[204:207], v[72:75], v[104:107], a[204:207]
    v_mfma_f32_16x16x32_bf16 a[204:207], v[76:79], v[108:111], a[204:207]
    s_mov_b32 s13, 0x4000
    v_mfma_f32_16x16x32_bf16 a[212:215], v[72:75], v[112:115], a[212:215]
    buffer_store_dwordx4 v[184:187], v244, s[64:67], s13 offen sc1
    s_cmp_lg_u32 s3, 0
    s_cbranch_scc1 fk_p0
    s_waitcnt vmcnt(18)
    v_cmp_eq_u32 vcc, 1, v27
    s_nop 0
    s_bcnt1_i32_b64 s11, vcc
    s_cmp_ge_u32 s11, 16
    s_cbranch_scc0 fk_wr_slow
fk_wr_ok:
fk_p0:
    v_mfma_f32_16x16x32_bf16 a[212:215], v[76:79], v[116:119], a[212:215]
    v_mfma_f32_16x16x32_bf16 a[220:223], v[72:75], v[120:123], a[220:223]
    v_mfma_f32_16x16x32_bf16 a[220:223], v[76:79], v[124:127], a[220:223]
    s_mov_b32 s13, 0x6000
    v_mfma_f32_16x16x32_bf16 a[224:227], v[80:83], v[96:99], a[224:227]
    buffer_store_dwordx4 v[188:191], v244, s[64:67], s13 offen sc1
    v_mfma_f32_16x16x32_bf16 a[224:227], v[84:87], v[100:103], a[224:227]
    v_mfma_f32_16x16x32_bf16 a[232:235], v[80:83], v[104:107], a[232:235]
    v_mfma_f32_16x16x32_bf16 a[232:235], v[84:87], v[108:111], a[232:235]
    s_mov_b32 s13, 0x8000
    v_mfma_f32_16x16x32_bf16 a[240:243], v[80:83], v[112:115], a[240:243]
    buffer_store_dwordx4 v[192:195], v244, s[64:67], s13 offen sc1
    v_mfma_f32_16x16x32_bf16 a[240:243], v[84:87], v[116:119], a[240:243]
    v_mfma_f32_16x16x32_bf16 a[248:251], v[80:83], v[120:123], a[248:251]
    v_mfma_f32_16x16x32_bf16 a[248:251], v[84:87], v[124:127], a[248:251]
    s_waitcnt lgkmcnt(15)
    v_mfma_f32_16x16x32_bf16 a[228:231], v[88:91], v[96:99], a[228:231]
    v_mfma_f32_16x16x32_bf16 a[228:231], v[92:95], v[100:103], a[228:231]
    v_add_u32 v18, 0x10000, v18
    v_add_u32 v19, 0x10000, v19
    v_mfma_f32_16x16x32_bf16 a[236:239], v[88:91], v[104:107], a[236:239]
    v_add_u32 v20, 0x10000, v20
    v_add_u32 v21, 0x10000, v21
    v_mfma_f32_16x16x32_bf16 a[236:239], v[92:95], v[108:111], a[236:239]
    v_xor_b32 v16, 0x10000, v16
    v_xor_b32 v17, 0x10000, v17
    v_mfma_f32_16x16x32_bf16 a[244:247], v[88:91], v[112:115], a[244:247]
    v_mfma_f32_16x16x32_bf16 a[244:247], v[92:95], v[116:119], a[244:247]
    v_mfma_f32_16x16x32_bf16 a[252:255], v[88:91], v[120:123], a[252:255]
    v_mfma_f32_16x16x32_bf16 a[252:255], v[92:95], v[124:127], a[252:255]
    s_waitcnt lgkmcnt(0)
    s_waitcnt vmcnt(14)
    s_barrier
    v_mfma_f32_16x16x32_bf16 a[0:3], v[128:131], v[32:35], a[0:3]
    ds_read_b64_tr_b16 v[96:97], v18 offset:16384
    v_mfma_f32_16x16x32_bf16 a[0:3], v[132:135], v[36:39], a[0:3]
    s_mov_b32 s10, 0x280
    s_add_u32 m0, s15, 0x10000
    v_mfma_f32_16x16x32_bf16 a[4:7], v[136:139], v[32:35], a[4:7]
    buffer_load_dwordx4 v4, s[44:47], s10 offen offset:0 lds
    v_mfma_f32_16x16x32_bf16 a[4:7], v[140:143], v[36:39], a[4:7]
    v_mfma_f32_16x16x32_bf16 a[8:11], v[144:147], v[32:35], a[8:11]
    ds_read_b64_tr_b16 v[98:99], v18 offset:16896
    v_mfma_f32_16x16x32_bf16 a[8:11], v[148:151], v[36:39], a[8:11]
    v_mfma_f32_16x16x32_bf16 a[12:15], v[152:155], v[32:35], a[12:15]
    buffer_load_dwordx4 v5, s[44:47], s10 offen offset:1024 lds
    v_mfma_f32_16x16x32_bf16 a[12:15], v[156:159], v[36:39], a[12:15]
    ds_read_b128 v[32:35], v16 offset:0
    ds_read_b128 v[36:39], v17 offset:0
    v_mfma_f32_16x16x32_bf16 a[16:19], v[128:131], v[40:43], a[16:19]
    ds_read_b64_tr_b16 v[100:101], v18 offset:20480
    v_mfma_f32_16x16x32_bf16 a[16:19], v[132:135], v[44:47], a[16:19]
    v_mfma_f32_16x16x32_bf16 a[20:23], v[136:139], v[40:43], a[20:23]
    buffer_load_dwordx4 v6, s[44:47], s10 offen offset:2048 lds
    v_mfma_f32_16x16x32_bf16 a[20:23], v[140:143], v[44:47], a[20:23]
    v_mfma_f32_16x16x32_bf16 a[24:27], v[144:147], v[40:43], a[24:27]
    ds_read_b64_tr_b16 v[102:103], v18 offset:20992
    v_mfma_f32_16x16x32_bf16 a[24:27], v[148:151], v[44:47], a[24:27]
    v_mfma_f32_16x16x32_bf16 a[28:31], v[152:155], v[40:43], a[28:31]
    buffer_load_dwordx4 v7, s[44:47], s10 offen offset:3072 lds
    v_mfma_f32_16x16x32_bf16 a[28:31], v[156:159], v[44:47], a[28:31]
    ds_read_b128 v[40:43], v16 offset:2048
    ds_read_b128 v[44:47], v17 offset:2048
    v_mfma_f32_16x16x32_bf16 a[32:35], v[128:131], v[48:51], a[32:35]
    ds_read_b64_tr_b16 v[104:105], v19 offset:16384
    v_mfma_f32_16x16x32_bf16 a[32:35], v[132:135], v[52:55], a[32:35]
    s_mov_b32 s10, 0x8280
    s_add_u32 m0, s15, 0x11000
    v_mfma_f32_16x16x32_bf16 a[36:39], v[136:139], v[48:51], a[36:39]
    buffer_load_dwordx4 v4, s[44:47], s10 offen offset:0 lds
    v_mfma_f32_16x16x32_bf16 a[36:39], v[140:143], v[52:55], a[36:39]
    v_mfma_f32_16x16x32_bf16 a[40:43], v[144:147], v[48:51], a[40:43]
    ds_read_b64_tr_b16 v[106:107], v19 offset:16896
    v_mfma_f32_16x16x32_bf16 a[40:43], v[148:151], v[52:55], a[40:43]
    v_mfma_f32_16x16x32_bf16 a[44:47], v[152:155], v[48:51], a[44:47]
    buffer_load_dwordx4 v5, s[44:47], s10 offen offset:1024 lds
    v_mfma_f32_16x16x32_bf16 a[44:47], v[156:159], v[52:55], a[44:47]
    ds_read_b128 v[48:51], v16 offset:4096
    ds_read_b128 v[52:55], v17 offset:4096
    v_mfma_f32_16x16x32_bf16 a[48:51], v[128:131], v[56:59], a[48:51]
    ds_read_b64_tr_b16 v[108:109], v19 offset:20480
    v_mfma_f32_16x16x32_bf16 a[48:51], v[132:135], v[60:63], a[48:51]
    v_mfma_f32_16x16x32_bf16 a[52:55], v[136:139], v[56:59], a[52:55]
    buffer_load_dwordx4 v6, s[44:47], s10 offen offset:2048 lds
    v_mfma_f32_16x16x32_bf16 a[52:55], v[140:143], v[60:63], a[52:55]
    v_mfma_f32_16x16x32_bf16 a[56:59], v[144:147], v[56:59], a[56:59]
    ds_read_b64_tr_b16 v[110:111], v19 offset:20992
    v_mfma_f32_16x16x32_bf16 a[56:59], v[148:151], v[60:63], a[56:59]
    v_mfma_f32_16x16x32_bf16 a[60:63], v[152:155], v[56:59], a[60:63]
    buffer_load_dwordx4 v7, s[44:47], s10 offen offset:3072 lds
    v_mfma_f32_16x16x32_bf16 a[60:63], v[156:159], v[60:63], a[60:63]
    ds_read_b128 v[56:59], v16 offset:6144
    ds_read_b128 v[60:63], v17 offset:6144
    v_mfma_f32_16x16x32_bf16 a[64:67], v[128:131], v[64:67], a[64:67]
    ds_read_b64_tr_b16 v[112:113], v20 offset:16384
    v_mfma_f32_16x16x32_bf16 a[64:67], v[132:135], v[68:71], a[64:67]
    s_mov_b32 s10, 0x300000
    s_add_u32 m0, s14, 0x8000
    v_mfma_f32_16x16x32_bf16 a[68:71], v[136:139], v[64:67], a[68:71]
    buffer_load_dwordx4 v8, s[48:51], s10 offen offset:0 lds
    v_mfma_f32_16x16x32_bf16 a[68:71], v[140:143], v[68:71], a[68:71]
    v_mfma_f32_16x16x32_bf16 a[72:75], v[144:147], v[64:67], a[72:75]
    ds_read_b64_tr_b16 v[114:115], v20 offset:16896
    v_mfma_f32_16x16x32_bf16 a[72:75], v[148:151], v[68:71], a[72:75]
    v_mfma_f32_16x16x32_bf16 a[76:79], v[152:155], v[64:67], a[76:79]
    buffer_load_dwordx4 v9, s[48:51], s10 offen offset:1024 lds
    v_mfma_f32_16x16x32_bf16 a[76:79], v[156:159], v[68:71], a[76:79]
    ds_read_b128 v[64:67], v16 offset:8192
    ds_read_b128 v[68:71], v17 offset:8192
    v_mfma_f32_16x16x32_bf16 a[80:83], v[128:131], v[72:75], a[80:83]
    ds_read_b64_tr_b16 v[116:117], v20 offset:20480
    v_mfma_f32_16x16x32_bf16 a[80:83], v[132:135], v[76:79], a[80:83]
    v_mfma_f32_16x16x32_bf16 a[84:87], v[136:139], v[72:75], a[84:87]
    buffer_load_dwordx4 v10, s[48:51], s10 offen offset:2048 lds
    v_mfma_f32_16x16x32_bf16 a[84:87], v[140:143], v[76:79], a[84:87]
    v_mfma_f32_16x16x32_bf16 a[88:91], v[144:147], v[72:75], a[88:91]
    ds_read_b64_tr_b16 v[118:119], v20 offset:20992
    v_mfma_f32_16x16x32_bf16 a[88:91], v[148:151], v[76:79], a[88:91]
    v_mfma_f32_16x16x32_bf16 a[92:95], v[152:155], v[72:75], a[92:95]
    buffer_load_dwordx4 v11, s[48:51], s10 offen offset:3072 lds
    v_mfma_f32_16x16x32_bf16 a[92:95], v[156:159], v[76:79], a[92:95]
    ds_read_b128 v[72:75], v16 offset:10240
    ds_read_b128 v[76:79], v17 offset:10240
    v_mfma_f32_16x16x32_bf16 a[96:99], v[128:131], v[80:83], a[96:99]
    ds_read_b64_tr_b16 v[120:121], v21 offset:16384
    v_mfma_f32_16x16x32_bf16 a[96:99], v[132:135], v[84:87], a[96:99]
    s_mov_b32 s10, 0x300000
    s_add_u32 m0, s14, 0xc000
    v_mfma_f32_16x16x32_bf16 a[100:103], v[136:139], v[80:83], a[100:103]
    buffer_load_dwordx4 v8, s[52:55], s10 offen offset:0 lds
    v_mfma_f32_16x16x32_bf16 a[100:103], v[140:143], v[84:87], a[100:103]
    v_mfma_f32_16x16x32_bf16 a[104:107], v[144:147], v[80:83], a[104:107]
    ds_read_b64_tr_b16 v[122:123], v21 offset:16896
    v_mfma_f32_16x16x32_bf16 a[104:107], v[148:151], v[84:87], a[104:107]
    v_mfma_f32_16x16x32_bf16 a[108:111], v[152:155], v[80:83], a[108:111]
    buffer_load_dwordx4 v9, s[52:55], s10 offen offset:1024 lds
    v_mfma_f32_16x16x32_bf16 a[108:111], v[156:159], v[84:87], a[108:111]
    ds_read_b128 v[80:83], v16 offset:12288
    ds_read_b128 v[84:87], v17 offset:12288
    v_mfma_f32_16x16x32_bf16 a[112:115], v[128:131], v[88:91], a[112:115]
    ds_read_b64_tr_b16 v[124:125], v21 offset:20480
    v_mfma_f32_16x16x32_bf16 a[112:115], v[132:135], v[92:95], a[112:115]
    v_mfma_f32_16x16x32_bf16 a[116:119], v[136:139], v[88:91], a[116:119]
    buffer_load_dwordx4 v10, s[52:55], s10 offen offset:2048 lds
    v_mfma_f32_16x16x32_bf16 a[116:119], v[140:143], v[92:95], a[116:119]
    ds_read_b64_tr_b16 v[126:127], v21 offset:20992
    v_mfma_f32_16x16x32_bf16 a[120:123], v[144:147], v[88:91], a[120:123]
    v_mfma_f32_16x16x32_bf16 a[120:123], v[148:151], v[92:95], a[120:123]
    v_mfma_f32_16x16x32_bf16 a[124:127], v[152:155], v[88:91], a[124:127]
    buffer_load_dwordx4 v11, s[52:55], s10 offen offset:3072 lds
    v_mfma_f32_16x16x32_bf16 a[124:127], v[156:159], v[92:95], a[124:127]
    s_waitcnt lgkmcnt(4)
    ds_read_b128 v[88:91], v16 offset:14336
    ds_read_b128 v[92:95], v17 offset:14336
    v_mfma_f32_16x16x32_bf16 a[128:131], v[32:35], v[96:99], a[128:131]
    v_mfma_f32_16x16x32_bf16 a[128:131], v[36:39], v[100:103], a[128:131]
    v_mfma_f32_16x16x32_bf16 a[136:139], v[32:35], v[104:107], a[136:139]
    v_mfma_f32_16x16x32_bf16 a[136:139], v[36:39], v[108:111], a[136:139]
    s_mov_b32 s92, 0x140000
    v_mfma_f32_16x16x32_bf16 a[144:147], v[32:35], v[112:115], a[144:147]
    buffer_load_dword v175, v171, s[56:59], s92 offen
    v_mfma_f32_16x16x32_bf16 a[144:147], v[36:39], v[116:119], a[144:147]
    v_mfma_f32_16x16x32_bf16 a[152:155], v[32:35], v[120:123], a[152:155]
    ds_read_b64_tr_b16 v[128:129], v18 offset:0
    s_waitcnt lgkmcnt(3)
    v_mfma_f32_16x16x32_bf16 a[152:155], v[36:39], v[124:127], a[152:155]
    v_mfma_f32_16x16x32_bf16 a[132:135], v[40:43], v[96:99], a[132:135]
    s_cmp_ge_u32 s3, 2
    s_cbranch_scc1 fk_p0b
    s_lshr_b32 s11, s2, 4
    s_mul_i32 s11, s11, 192
    s_add_u32 s11, s11, s97
    s_add_u32 s11, s11, s3
    s_waitcnt vmcnt(17)
    s_add_u32 s11, s11, 0x9000
    v_mov_b32 v30, 1
    s_mov_b64 exec, 1
    buffer_store_byte v30, off, s[68:71], s11 sc1
    s_mov_b64 exec, -1
fk_p0b:
    v_mfma_f32_16x16x32_bf16 a[132:135], v[44:47], v[100:103], a[132:135]
    ds_read_b64_tr_b16 v[130:131], v18 offset:512
    v_mfma_f32_16x16x32_bf16 a[140:143], v[40:43], v[104:107], a[140:143]
    ds_read_b64_tr_b16 v[132:133], v18 offset:4096
    v_mfma_f32_16x16x32_bf16 a[140:143], v[44:47], v[108:111], a[140:143]
    v_mfma_f32_16x16x32_bf16 a[148:151], v[40:43], v[112:115], a[148:151]
    ds_read_b64_tr_b16 v[134:135], v18 offset:4608
    v_mfma_f32_16x16x32_bf16 a[148:151], v[44:47], v[116:119], a[148:151]
    v_mfma_f32_16x16x32_bf16 a[156:159], v[40:43], v[120:123], a[156:159]
    ds_read_b64_tr_b16 v[136:137], v19 offset:0
    v_mfma_f32_16x16x32_bf16 a[156:159], v[44:47], v[124:127], a[156:159]
    v_mfma_f32_16x16x32_bf16 a[160:163], v[48:51], v[96:99], a[160:163]
    ds_read_b64_tr_b16 v[138:139], v19 offset:512
    v_mfma_f32_16x16x32_bf16 a[160:163], v[52:55], v[100:103], a[160:163]
    v_mfma_f32_16x16x32_bf16 a[168:171], v[48:51], v[104:107], a[168:171]
    ds_read_b64_tr_b16 v[140:141], v19 offset:4096
    v_mfma_f32_16x16x32_bf16 a[168:171], v[52:55], v[108:111], a[168:171]
    v_mfma_f32_16x16x32_bf16 a[176:179], v[48:51], v[112:115], a[176:179]
    ds_read_b64_tr_b16 v[142:143], v19 offset:4608
    v_mfma_f32_16x16x32_bf16 a[176:179], v[52:55], v[116:119], a[176:179]
    v_mfma_f32_16x16x32_bf16 a[184:187], v[48:51], v[120:123], a[184:187]
    ds_read_b64_tr_b16 v[144:145], v20 offset:0
    v_mfma_f32_16x16x32_bf16 a[184:187], v[52:55], v[124:127], a[184:187]
    v_mfma_f32_16x16x32_bf16 a[164:167], v[56:59], v[96:99], a[164:167]
    ds_read_b64_tr_b16 v[146:147], v20 offset:512
    v_mfma_f32_16x16x32_bf16 a[164:167], v[60:63], v[100:103], a[164:167]
    v_mfma_f32_16x16x32_bf16 a[172:175], v[56:59], v[104:107], a[172:175]
    ds_read_b64_tr_b16 v[148:149], v20 offset:4096
    v_mfma_f32_16x16x32_bf16 a[172:175], v[60:63], v[108:111], a[172:175]
    v_mfma_f32_16x16x32_bf16 a[180:183], v[56:59], v[112:115], a[180:183]
    ds_read_b64_tr_b16 v[150:151], v20 offset:4608
    v_mfma_f32_16x16x32_bf16 a[180:183], v[60:63], v[116:119], a[180:183]
    v_mfma_f32_16x16x32_bf16 a[188:191], v[56:59], v[120:123], a[188:191]
    ds_read_b64_tr_b16 v[152:153], v21 offset:0
    v_mfma_f32_16x16x32_bf16 a[188:191], v[60:63], v[124:127], a[188:191]
    v_mfma_f32_16x16x32_bf16 a[192:195], v[64:67], v[96:99], a[192:195]
    ds_read_b64_tr_b16 v[154:155], v21 offset:512
    v_mfma_f32_16x16x32_bf16 a[192:195], v[68:71], v[100:103], a[192:195]
    v_mfma_f32_16x16x32_bf16 a[200:203], v[64:67], v[104:107], a[200:203]
    ds_read_b64_tr_b16 v[156:157], v21 offset:4096
    v_mfma_f32_16x16x32_bf16 a[200:203], v[68:71], v[108:111], a[200:203]
    v_mfma_f32_16x16x32_bf16 a[208:211], v[64:67], v[112:115], a[208:211]
    ds_read_b64_tr_b16 v[158:159], v21 offset:4608
    v_mfma_f32_16x16x32_bf16 a[208:211], v[68:71], v[116:119], a[208:211]
    v_mfma_f32_16x16x32_bf16 a[216:219], v[64:67], v[120:123], a[216:219]
    v_mfma_f32_16x16x32_bf16 a[216:219], v[68:71], v[124:127], a[216:219]
    v_mfma_f32_16x16x32_bf16 a[196:199], v[72:75], v[96:99], a[196:199]
    v_mfma_f32_16x16x32_bf16 a[196:199], v[76:79], v[100:103], a[196:199]
    v_mfma_f32_16x16x32_bf16 a[204:207], v[72:75], v[104:107], a[204:207]
    v_mfma_f32_16x16x32_bf16 a[204:207], v[76:79], v[108:111], a[204:207]
    v_mfma_f32_16x16x32_bf16 a[212:215], v[72:75], v[112:115], a[212:215]
    v_mfma_f32_16x16x32_bf16 a[212:215], v[76:79], v[116:119], a[212:215]
    v_mfma_f32_16x16x32_bf16 a[220:223], v[72:75], v[120:123], a[220:223]
    v_mfma_f32_16x16x32_bf16 a[220:223], v[76:79], v[124:127], a[220:223]
    v_mfma_f32_16x16x32_bf16 a[224:227], v[80:83], v[96:99], a[224:227]
    v_mfma_f32_16x16x32_bf16 a[224:227], v[84:87], v[100:103], a[224:227]
    v_mfma_f32_16x16x32_bf16 a[232:235], v[80:83], v[104:107], a[232:235]
    v_mfma_f32_16x16x32_bf16 a[232:235], v[84:87], v[108:111], a[232:235]
    v_mfma_f32_16x16x32_bf16 a[240:243], v[80:83], v[112:115], a[240:243]
    v_mfma_f32_16x16x32_bf16 a[240:243], v[84:87], v[116:119], a[240:243]
    v_mfma_f32_16x16x32_bf16 a[248:251], v[80:83], v[120:123], a[248:251]
    v_mfma_f32_16x16x32_bf16 a[248:251], v[84:87], v[124:127], a[248:251]
    s_waitcnt lgkmcnt(15)
    v_mfma_f32_16x16x32_bf16 a[228:231], v[88:91], v[96:99], a[228:231]
    v_mfma_f32_16x16x32_bf16 a[228:231], v[92:95], v[100:103], a[228:231]
    v_add_u32 v18, 0x8000, v18
    v_add_u32 v19, 0x8000, v19
    v_mfma_f32_16x16x32_bf16 a[236:239], v[88:91], v[104:107], a[236:239]
    v_add_u32 v20, 0x8000, v20
    v_add_u32 v21, 0x8000, v21
    v_mfma_f32_16x16x32_bf16 a[236:239], v[92:95], v[108:111], a[236:239]
    v_xor_b32 v16, 0x10000, v16
    v_xor_b32 v17, 0x10000, v17
    v_mfma_f32_16x16x32_bf16 a[244:247], v[88:91], v[112:115], a[244:247]
    v_mfma_f32_16x16x32_bf16 a[244:247], v[92:95], v[116:119], a[244:247]
    v_mfma_f32_16x16x32_bf16 a[252:255], v[88:91], v[120:123], a[252:255]
    v_mfma_f32_16x16x32_bf16 a[252:255], v[92:95], v[124:127], a[252:255]
    s_waitcnt lgkmcnt(0)
    s_waitcnt vmcnt(9)
    s_barrier
    v_mfma_f32_16x16x32_bf16 a[0:3], v[128:131], v[32:35], a[0:3]
    ds_read_b64_tr_b16 v[96:97], v18 offset:16384
    v_mfma_f32_16x16x32_bf16 a[0:3], v[132:135], v[36:39], a[0:3]
    s_mov_b32 s10, 0x300
    s_add_u32 m0, s15, 0x0
    v_mfma_f32_16x16x32_bf16 a[4:7], v[136:139], v[32:35], a[4:7]
    buffer_load_dwordx4 v4, s[44:47], s10 offen offset:0 lds
    v_mfma_f32_16x16x32_bf16 a[4:7], v[140:143], v[36:39], a[4:7]
    v_mfma_f32_16x16x32_bf16 a[8:11], v[144:147], v[32:35], a[8:11]
    ds_read_b64_tr_b16 v[98:99], v18 offset:16896
    v_mfma_f32_16x16x32_bf16 a[8:11], v[148:151], v[36:39], a[8:11]
    v_mfma_f32_16x16x32_bf16 a[12:15], v[152:155], v[32:35], a[12:15]
    buffer_load_dwordx4 v5, s[44:47], s10 offen offset:1024 lds
    v_mfma_f32_16x16x32_bf16 a[12:15], v[156:159], v[36:39], a[12:15]
    ds_read_b128 v[32:35], v16 offset:0
    ds_read_b128 v[36:39], v17 offset:0
    v_mfma_f32_16x16x32_bf16 a[16:19], v[128:131], v[40:43], a[16:19]
    ds_read_b64_tr_b16 v[100:101], v18 offset:20480
    v_mfma_f32_16x16x32_bf16 a[16:19], v[132:135], v[44:47], a[16:19]
    v_mfma_f32_16x16x32_bf16 a[20:23], v[136:139], v[40:43], a[20:23]
    buffer_load_dwordx4 v6, s[44:47], s10 offen offset:2048 lds
    v_mfma_f32_16x16x32_bf16 a[20:23], v[140:143], v[44:47], a[20:23]
    v_mfma_f32_16x16x32_bf16 a[24:27], v[144:147], v[40:43], a[24:27]
    ds_read_b64_tr_b16 v[102:103], v18 offset:20992
    v_mfma_f32_16x16x32_bf16 a[24:27], v[148:151], v[44:47], a[24:27]
    v_mfma_f32_16x16x32_bf16 a[28:31], v[152:155], v[40:43], a[28:31]
    buffer_load_dwordx4 v7, s[44:47], s10 offen offset:3072 lds
    v_mfma_f32_16x16x32_bf16 a[28:31], v[156:159], v[44:47], a[28:31]
    ds_read_b128 v[40:43], v16 offset:2048
    ds_read_b128 v[44:47], v17 offset:2048
    v_mfma_f32_16x16x32_bf16 a[32:35], v[128:131], v[48:51], a[32:35]
    ds_read_b64_tr_b16 v[104:105], v19 offset:16384
    v_mfma_f32_16x16x32_bf16 a[32:35], v[132:135], v[52:55], a[32:35]
    s_mov_b32 s10, 0x8300
    s_add_u32 m0, s15, 0x1000
    v_mfma_f32_16x16x32_bf16 a[36:39], v[136:139], v[48:51], a[36:39]
    buffer_load_dwordx4 v4, s[44:47], s10 offen offset:0 lds
    v_mfma_f32_16x16x32_bf16 a[36:39], v[140:143], v[52:55], a[36:39]
    v_mfma_f32_16x16x32_bf16 a[40:43], v[144:147], v[48:51], a[40:43]
    ds_read_b64_tr_b16 v[106:107], v19 offset:16896
    v_mfma_f32_16x16x32_bf16 a[40:43], v[148:151], v[52:55], a[40:43]
    v_mfma_f32_16x16x32_bf16 a[44:47], v[152:155], v[48:51], a[44:47]
    buffer_load_dwordx4 v5, s[44:47], s10 offen offset:1024 lds
    v_mfma_f32_16x16x32_bf16 a[44:47], v[156:159], v[52:55], a[44:47]
    ds_read_b128 v[48:51], v16 offset:4096
    ds_read_b128 v[52:55], v17 offset:4096
    v_mfma_f32_16x16x32_bf16 a[48:51], v[128:131], v[56:59], a[48:51]
    ds_read_b64_tr_b16 v[108:109], v19 offset:20480
    v_mfma_f32_16x16x32_bf16 a[48:51], v[132:135], v[60:63], a[48:51]
    v_mfma_f32_16x16x32_bf16 a[52:55], v[136:139], v[56:59], a[52:55]
    buffer_load_dwordx4 v6, s[44:47], s10 offen offset:2048 lds
    v_mfma_f32_16x16x32_bf16 a[52:55], v[140:143], v[60:63], a[52:55]
    v_mfma_f32_16x16x32_bf16 a[56:59], v[144:147], v[56:59], a[56:59]
    ds_read_b64_tr_b16 v[110:111], v19 offset:20992
    v_mfma_f32_16x16x32_bf16 a[56:59], v[148:151], v[60:63], a[56:59]
    v_mfma_f32_16x16x32_bf16 a[60:63], v[152:155], v[56:59], a[60:63]
    buffer_load_dwordx4 v7, s[44:47], s10 offen offset:3072 lds
    v_mfma_f32_16x16x32_bf16 a[60:63], v[156:159], v[60:63], a[60:63]
    ds_read_b128 v[56:59], v16 offset:6144
    ds_read_b128 v[60:63], v17 offset:6144
    v_mfma_f32_16x16x32_bf16 a[64:67], v[128:131], v[64:67], a[64:67]
    ds_read_b64_tr_b16 v[112:113], v20 offset:16384
    v_mfma_f32_16x16x32_bf16 a[64:67], v[132:135], v[68:71], a[64:67]
    s_mov_b32 s10, 0x380000
    s_add_u32 m0, s14, 0x18000
    v_mfma_f32_16x16x32_bf16 a[68:71], v[136:139], v[64:67], a[68:71]
    buffer_load_dwordx4 v8, s[48:51], s10 offen offset:0 lds
    v_mfma_f32_16x16x32_bf16 a[68:71], v[140:143], v[68:71], a[68:71]
    v_mfma_f32_16x16x32_bf16 a[72:75], v[144:147], v[64:67], a[72:75]
    ds_read_b64_tr_b16 v[114:115], v20 offset:16896
    v_mfma_f32_16x16x32_bf16 a[72:75], v[148:151], v[68:71], a[72:75]
    v_mfma_f32_16x16x32_bf16 a[76:79], v[152:155], v[64:67], a[76:79]
    buffer_load_dwordx4 v9, s[48:51], s10 offen offset:1024 lds
    v_mfma_f32_16x16x32_bf16 a[76:79], v[156:159], v[68:71], a[76:79]
    ds_read_b128 v[64:67], v16 offset:8192
    ds_read_b128 v[68:71], v17 offset:8192
    v_mfma_f32_16x16x32_bf16 a[80:83], v[128:131], v[72:75], a[80:83]
    ds_read_b64_tr_b16 v[116:117], v20 offset:20480
    v_mfma_f32_16x16x32_bf16 a[80:83], v[132:135], v[76:79], a[80:83]
    v_mfma_f32_16x16x32_bf16 a[84:87], v[136:139], v[72:75], a[84:87]
    buffer_load_dwordx4 v10, s[48:51], s10 offen offset:2048 lds
    v_mfma_f32_16x16x32_bf16 a[84:87], v[140:143], v[76:79], a[84:87]
    v_mfma_f32_16x16x32_bf16 a[88:91], v[144:147], v[72:75], a[88:91]
    ds_read_b64_tr_b16 v[118:119], v20 offset:20992
    v_mfma_f32_16x16x32_bf16 a[88:91], v[148:151], v[76:79], a[88:91]
    v_mfma_f32_16x16x32_bf16 a[92:95], v[152:155], v[72:75], a[92:95]
    buffer_load_dwordx4 v11, s[48:51], s10 offen offset:3072 lds
    v_mfma_f32_16x16x32_bf16 a[92:95], v[156:159], v[76:79], a[92:95]
    ds_read_b128 v[72:75], v16 offset:10240
    ds_read_b128 v[76:79], v17 offset:10240
    v_mfma_f32_16x16x32_bf16 a[96:99], v[128:131], v[80:83], a[96:99]
    ds_read_b64_tr_b16 v[120:121], v21 offset:16384
    v_mfma_f32_16x16x32_bf16 a[96:99], v[132:135], v[84:87], a[96:99]
    s_mov_b32 s10, 0x380000
    s_add_u32 m0, s14, 0x1c000
    v_mfma_f32_16x16x32_bf16 a[100:103], v[136:139], v[80:83], a[100:103]
    buffer_load_dwordx4 v8, s[52:55], s10 offen offset:0 lds
    v_mfma_f32_16x16x32_bf16 a[100:103], v[140:143], v[84:87], a[100:103]
    v_mfma_f32_16x16x32_bf16 a[104:107], v[144:147], v[80:83], a[104:107]
    ds_read_b64_tr_b16 v[122:123], v21 offset:16896
    v_mfma_f32_16x16x32_bf16 a[104:107], v[148:151], v[84:87], a[104:107]
    v_mfma_f32_16x16x32_bf16 a[108:111], v[152:155], v[80:83], a[108:111]
    buffer_load_dwordx4 v9, s[52:55], s10 offen offset:1024 lds
    v_mfma_f32_16x16x32_bf16 a[108:111], v[156:159], v[84:87], a[108:111]
    ds_read_b128 v[80:83], v16 offset:12288
    ds_read_b128 v[84:87], v17 offset:12288
    v_mfma_f32_16x16x32_bf16 a[112:115], v[128:131], v[88:91], a[112:115]
    ds_read_b64_tr_b16 v[124:125], v21 offset:20480
    v_mfma_f32_16x16x32_bf16 a[112:115], v[132:135], v[92:95], a[112:115]
    v_mfma_f32_16x16x32_bf16 a[116:119], v[136:139], v[88:91], a[116:119]
    buffer_load_dwordx4 v10, s[52:55], s10 offen offset:2048 lds
    v_mfma_f32_16x16x32_bf16 a[116:119], v[140:143], v[92:95], a[116:119]
    ds_read_b64_tr_b16 v[126:127], v21 offset:20992
    v_mfma_f32_16x16x32_bf16 a[120:123], v[144:147], v[88:91], a[120:123]
    v_mfma_f32_16x16x32_bf16 a[120:123], v[148:151], v[92:95], a[120:123]
    v_mfma_f32_16x16x32_bf16 a[124:127], v[152:155], v[88:91], a[124:127]
    buffer_load_dwordx4 v11, s[52:55], s10 offen offset:3072 lds
    v_mfma_f32_16x16x32_bf16 a[124:127], v[156:159], v[92:95], a[124:127]
    s_waitcnt lgkmcnt(4)
    ds_read_b128 v[88:91], v16 offset:14336
    ds_read_b128 v[92:95], v17 offset:14336
    v_mfma_f32_16x16x32_bf16 a[128:131], v[32:35], v[96:99], a[128:131]
    v_mfma_f32_16x16x32_bf16 a[128:131], v[36:39], v[100:103], a[128:131]
    v_mfma_f32_16x16x32_bf16 a[136:139], v[32:35], v[104:107], a[136:139]
    v_mfma_f32_16x16x32_bf16 a[136:139], v[36:39], v[108:111], a[136:139]
    s_mov_b32 s92, 0x280000
    v_mfma_f32_16x16x32_bf16 a[144:147], v[32:35], v[112:115], a[144:147]
    buffer_load_dword v175, v171, s[56:59], s92 offen
    v_mfma_f32_16x16x32_bf16 a[144:147], v[36:39], v[116:119], a[144:147]
    v_mfma_f32_16x16x32_bf16 a[152:155], v[32:35], v[120:123], a[152:155]
    s_waitcnt lgkmcnt(2)
    buffer_load_dword v175, v2, s[28:31], 0 offen sc1
    v_mfma_f32_16x16x32_bf16 a[152:155], v[36:39], v[124:127], a[152:155]
    ds_read_b64_tr_b16 v[128:129], v18 offset:0
    v_mfma_f32_16x16x32_bf16 a[132:135], v[40:43], v[96:99], a[132:135]
    ds_read_b64_tr_b16 v[130:131], v18 offset:512
    v_mfma_f32_16x16x32_bf16 a[132:135], v[44:47], v[100:103], a[132:135]
    v_mfma_f32_16x16x32_bf16 a[140:143], v[40:43], v[104:107], a[140:143]
    ds_read_b64_tr_b16 v[132:133], v18 offset:4096
    v_mfma_f32_16x16x32_bf16 a[140:143], v[44:47], v[108:111], a[140:143]
    v_mfma_f32_16x16x32_bf16 a[148:151], v[40:43], v[112:115], a[148:151]
    ds_read_b64_tr_b16 v[134:135], v18 offset:4608
    v_mfma_f32_16x16x32_bf16 a[148:151], v[44:47], v[116:119], a[148:151]
    v_mfma_f32_16x16x32_bf16 a[156:159], v[40:43], v[120:123], a[156:159]
    ds_read_b64_tr_b16 v[136:137], v19 offset:0
    v_mfma_f32_16x16x32_bf16 a[156:159], v[44:47], v[124:127], a[156:159]
    v_mfma_f32_16x16x32_bf16 a[160:163], v[48:51], v[96:99], a[160:163]
    ds_read_b64_tr_b16 v[138:139], v19 offset:512
    v_mfma_f32_16x16x32_bf16 a[160:163], v[52:55], v[100:103], a[160:163]
    v_mfma_f32_16x16x32_bf16 a[168:171], v[48:51], v[104:107], a[168:171]
    ds_read_b64_tr_b16 v[140:141], v19 offset:4096
    v_mfma_f32_16x16x32_bf16 a[168:171], v[52:55], v[108:111], a[168:171]
    v_mfma_f32_16x16x32_bf16 a[176:179], v[48:51], v[112:115], a[176:179]
    ds_read_b64_tr_b16 v[142:143], v19 offset:4608
    v_mfma_f32_16x16x32_bf16 a[176:179], v[52:55], v[116:119], a[176:179]
    v_mfma_f32_16x16x32_bf16 a[184:187], v[48:51], v[120:123], a[184:187]
    ds_read_b64_tr_b16 v[144:145], v20 offset:0
    v_mfma_f32_16x16x32_bf16 a[184:187], v[52:55], v[124:127], a[184:187]
    v_mfma_f32_16x16x32_bf16 a[164:167], v[56:59], v[96:99], a[164:167]
    ds_read_b64_tr_b16 v[146:147], v20 offset:512
    v_mfma_f32_16x16x32_bf16 a[164:167], v[60:63], v[100:103], a[164:167]
    v_mfma_f32_16x16x32_bf16 a[172:175], v[56:59], v[104:107], a[172:175]
    ds_read_b64_tr_b16 v[148:149], v20 offset:4096
    v_mfma_f32_16x16x32_bf16 a[172:175], v[60:63], v[108:111], a[172:175]
    v_mfma_f32_16x16x32_bf16 a[180:183], v[56:59], v[112:115], a[180:183]
    ds_read_b64_tr_b16 v[150:151], v20 offset:4608
    v_mfma_f32_16x16x32_bf16 a[180:183], v[60:63], v[116:119], a[180:183]
    v_mfma_f32_16x16x32_bf16 a[188:191], v[56:59], v[120:123], a[188:191]
    ds_read_b64_tr_b16 v[152:153], v21 offset:0
    v_mfma_f32_16x16x32_bf16 a[188:191], v[60:63], v[124:127], a[188:191]
    v_mfma_f32_16x16x32_bf16 a[192:195], v[64:67], v[96:99], a[192:195]
    ds_read_b64_tr_b16 v[154:155], v21 offset:512
    v_mfma_f32_16x16x32_bf16 a[192:195], v[68:71], v[100:103], a[192:195]
    v_mfma_f32_16x16x32_bf16 a[200:203], v[64:67], v[104:107], a[200:203]
    ds_read_b64_tr_b16 v[156:157], v21 offset:4096
    v_mfma_f32_16x16x32_bf16 a[200:203], v[68:71], v[108:111], a[200:203]
    v_mfma_f32_16x16x32_bf16 a[208:211], v[64:67], v[112:115], a[208:211]
    ds_read_b64_tr_b16 v[158:159], v21 offset:4608
    v_mfma_f32_16x16x32_bf16 a[208:211], v[68:71], v[116:119], a[208:211]
    v_mfma_f32_16x16x32_bf16 a[216:219], v[64:67], v[120:123], a[216:219]
    v_mfma_f32_16x16x32_bf16 a[216:219], v[68:71], v[124:127], a[216:219]
    v_mfma_f32_16x16x32_bf16 a[196:199], v[72:75], v[96:99], a[196:199]
    v_mfma_f32_16x16x32_bf16 a[196:199], v[76:79], v[100:103], a[196:199]
    v_mfma_f32_16x16x32_bf16 a[204:207], v[72:75], v[104:107], a[204:207]
    v_mfma_f32_16x16x32_bf16 a[204:207], v[76:79], v[108:111], a[204:207]
    v_mfma_f32_16x16x32_bf16 a[212:215], v[72:75], v[112:115], a[212:215]
    v_mfma_f32_16x16x32_bf16 a[212:215], v[76:79], v[116:119], a[212:215]
    v_mfma_f32_16x16x32_bf16 a[220:223], v[72:75], v[120:123], a[220:223]
    v_mfma_f32_16x16x32_bf16 a[220:223], v[76:79], v[124:127], a[220:223]
    v_mfma_f32_16x16x32_bf16 a[224:227], v[80:83], v[96:99], a[224:227]
    v_mfma_f32_16x16x32_bf16 a[224:227], v[84:87], v[100:103], a[224:227]
    v_mfma_f32_16x16x32_bf16 a[232:235], v[80:83], v[104:107], a[232:235]
    v_mfma_f32_16x16x32_bf16 a[232:235], v[84:87], v[108:111], a[232:235]
    v_mfma_f32_16x16x32_bf16 a[240:243], v[80:83], v[112:115], a[240:243]
    v_mfma_f32_16x16x32_bf16 a[240:243], v[84:87], v[116:119], a[240:243]
    v_mfma_f32_16x16x32_bf16 a[248:251], v[80:83], v[120:123], a[248:251]
    v_mfma_f32_16x16x32_bf16 a[248:251], v[84:87], v[124:127], a[248:251]
    s_waitcnt lgkmcnt(15)
    v_mfma_f32_16x16x32_bf16 a[228:231], v[88:91], v[96:99], a[228:231]
    v_mfma_f32_16x16x32_bf16 a[228:231], v[92:95], v[100:103], a[228:231]
    v_add_u32 v18, 0xfffe8000, v18
    v_add_u32 v19, 0xfffe8000, v19
    v_mfma_f32_16x16x32_bf16 a[236:239], v[88:91], v[104:107], a[236:239]
    v_add_u32 v20, 0xfffe8000, v20
    v_add_u32 v21, 0xfffe8000, v21
    v_mfma_f32_16x16x32_bf16 a[236:239], v[92:95], v[108:111], a[236:239]
    v_xor_b32 v16, 0x10000, v16
    v_xor_b32 v17, 0x10000, v17
    v_mfma_f32_16x16x32_bf16 a[244:247], v[88:91], v[112:115], a[244:247]
    v_mfma_f32_16x16x32_bf16 a[244:247], v[92:95], v[116:119], a[244:247]
    v_mfma_f32_16x16x32_bf16 a[252:255], v[88:91], v[120:123], a[252:255]
    v_mfma_f32_16x16x32_bf16 a[252:255], v[92:95], v[124:127], a[252:255]
    s_waitcnt lgkmcnt(0)
    s_waitcnt vmcnt(10)
    s_barrier
    v_mfma_f32_16x16x32_bf16 a[0:3], v[128:131], v[32:35], a[0:3]
    ds_read_b64_tr_b16 v[96:97], v18 offset:16384
    v_mfma_f32_16x16x32_bf16 a[0:3], v[132:135], v[36:39], a[0:3]
    s_mov_b32 s10, 0x380
    s_add_u32 m0, s15, 0x10000
    v_mfma_f32_16x16x32_bf16 a[4:7], v[136:139], v[32:35], a[4:7]
    buffer_load_dwordx4 v4, s[44:47], s10 offen offset:0 lds
    v_mfma_f32_16x16x32_bf16 a[4:7], v[140:143], v[36:39], a[4:7]
    v_mfma_f32_16x16x32_bf16 a[8:11], v[144:147], v[32:35], a[8:11]
    ds_read_b64_tr_b16 v[98:99], v18 offset:16896
    v_mfma_f32_16x16x32_bf16 a[8:11], v[148:151], v[36:39], a[8:11]
    v_mfma_f32_16x16x32_bf16 a[12:15], v[152:155], v[32:35], a[12:15]
    buffer_load_dwordx4 v5, s[44:47], s10 offen offset:1024 lds
    v_mfma_f32_16x16x32_bf16 a[12:15], v[156:159], v[36:39], a[12:15]
    ds_read_b128 v[32:35], v16 offset:0
    ds_read_b128 v[36:39], v17 offset:0
    v_mfma_f32_16x16x32_bf16 a[16:19], v[128:131], v[40:43], a[16:19]
    ds_read_b64_tr_b16 v[100:101], v18 offset:20480
    v_mfma_f32_16x16x32_bf16 a[16:19], v[132:135], v[44:47], a[16:19]
    v_mfma_f32_16x16x32_bf16 a[20:23], v[136:139], v[40:43], a[20:23]
    buffer_load_dwordx4 v6, s[44:47], s10 offen offset:2048 lds
    v_mfma_f32_16x16x32_bf16 a[20:23], v[140:143], v[44:47], a[20:23]
    v_mfma_f32_16x16x32_bf16 a[24:27], v[144:147], v[40:43], a[24:27]
    ds_read_b64_tr_b16 v[102:103], v18 offset:20992
    v_mfma_f32_16x16x32_bf16 a[24:27], v[148:151], v[44:47], a[24:27]
    v_mfma_f32_16x16x32_bf16 a[28:31], v[152:155], v[40:43], a[28:31]
    buffer_load_dwordx4 v7, s[44:47], s10 offen offset:3072 lds
    v_mfma_f32_16x16x32_bf16 a[28:31], v[156:159], v[44:47], a[28:31]
    ds_read_b128 v[40:43], v16 offset:2048
    ds_read_b128 v[44:47], v17 offset:2048
    v_mfma_f32_16x16x32_bf16 a[32:35], v[128:131], v[48:51], a[32:35]
    ds_read_b64_tr_b16 v[104:105], v19 offset:16384
    v_mfma_f32_16x16x32_bf16 a[32:35], v[132:135], v[52:55], a[32:35]
    s_mov_b32 s10, 0x8380
    s_add_u32 m0, s15, 0x11000
    v_mfma_f32_16x16x32_bf16 a[36:39], v[136:139], v[48:51], a[36:39]
    buffer_load_dwordx4 v4, s[44:47], s10 offen offset:0 lds
    v_mfma_f32_16x16x32_bf16 a[36:39], v[140:143], v[52:55], a[36:39]
    v_mfma_f32_16x16x32_bf16 a[40:43], v[144:147], v[48:51], a[40:43]
    ds_read_b64_tr_b16 v[106:107], v19 offset:16896
    v_mfma_f32_16x16x32_bf16 a[40:43], v[148:151], v[52:55], a[40:43]
    v_mfma_f32_16x16x32_bf16 a[44:47], v[152:155], v[48:51], a[44:47]
    buffer_load_dwordx4 v5, s[44:47], s10 offen offset:1024 lds
    v_mfma_f32_16x16x32_bf16 a[44:47], v[156:159], v[52:55], a[44:47]
    ds_read_b128 v[48:51], v16 offset:4096
    ds_read_b128 v[52:55], v17 offset:4096
    v_mfma_f32_16x16x32_bf16 a[48:51], v[128:131], v[56:59], a[48:51]
    ds_read_b64_tr_b16 v[108:109], v19 offset:20480
    v_mfma_f32_16x16x32_bf16 a[48:51], v[132:135], v[60:63], a[48:51]
    v_mfma_f32_16x16x32_bf16 a[52:55], v[136:139], v[56:59], a[52:55]
    buffer_load_dwordx4 v6, s[44:47], s10 offen offset:2048 lds
    v_mfma_f32_16x16x32_bf16 a[52:55], v[140:143], v[60:63], a[52:55]
    v_mfma_f32_16x16x32_bf16 a[56:59], v[144:147], v[56:59], a[56:59]
    ds_read_b64_tr_b16 v[110:111], v19 offset:20992
    v_mfma_f32_16x16x32_bf16 a[56:59], v[148:151], v[60:63], a[56:59]
    v_mfma_f32_16x16x32_bf16 a[60:63], v[152:155], v[56:59], a[60:63]
    buffer_load_dwordx4 v7, s[44:47], s10 offen offset:3072 lds
    v_mfma_f32_16x16x32_bf16 a[60:63], v[156:159], v[60:63], a[60:63]
    ds_read_b128 v[56:59], v16 offset:6144
    ds_read_b128 v[60:63], v17 offset:6144
    v_mfma_f32_16x16x32_bf16 a[64:67], v[128:131], v[64:67], a[64:67]
    ds_read_b64_tr_b16 v[112:113], v20 offset:16384
    v_mfma_f32_16x16x32_bf16 a[64:67], v[132:135], v[68:71], a[64:67]
    s_mov_b32 s10, 0x0
    s_add_u32 m0, s14, 0x20000
    v_mfma_f32_16x16x32_bf16 a[68:71], v[136:139], v[64:67], a[68:71]
    buffer_load_dwordx4 v12, s[80:83], s10 offen offset:0 lds
    v_mfma_f32_16x16x32_bf16 a[68:71], v[140:143], v[68:71], a[68:71]
    v_mfma_f32_16x16x32_bf16 a[72:75], v[144:147], v[64:67], a[72:75]
    ds_read_b64_tr_b16 v[114:115], v20 offset:16896
    v_mfma_f32_16x16x32_bf16 a[72:75], v[148:151], v[68:71], a[72:75]
    v_mfma_f32_16x16x32_bf16 a[76:79], v[152:155], v[64:67], a[76:79]
    buffer_load_dwordx4 v13, s[80:83], s10 offen offset:1024 lds
    v_mfma_f32_16x16x32_bf16 a[76:79], v[156:159], v[68:71], a[76:79]
    ds_read_b128 v[64:67], v16 offset:8192
    ds_read_b128 v[68:71], v17 offset:8192
    v_mfma_f32_16x16x32_bf16 a[80:83], v[128:131], v[72:75], a[80:83]
    ds_read_b64_tr_b16 v[116:117], v20 offset:20480
    v_and_b32 v4, 3, v1
    v_mfma_f32_16x16x32_bf16 a[80:83], v[132:135], v[76:79], a[80:83]
    v_lshrrev_b32 v29, 1, v1
    v_and_b32 v29, 12, v29
    v_mfma_f32_16x16x32_bf16 a[84:87], v[136:139], v[72:75], a[84:87]
    buffer_load_dwordx4 v14, s[80:83], s10 offen offset:2048 lds
    v_mfma_f32_16x16x32_bf16 a[84:87], v[140:143], v[76:79], a[84:87]
    v_or_b32 v4, v4, v29
    v_lshlrev_b32 v4, 3, v4
    v_mfma_f32_16x16x32_bf16 a[88:91], v[144:147], v[72:75], a[88:91]
    ds_read_b64_tr_b16 v[118:119], v20 offset:20992
    v_and_b32 v29, 12, v1
    v_mfma_f32_16x16x32_bf16 a[88:91], v[148:151], v[76:79], a[88:91]
    v_lshl_add_u32 v4, v29, 5, v4
    v_and_b32 v29, 48, v1
    v_mfma_f32_16x16x32_bf16 a[92:95], v[152:155], v[72:75], a[92:95]
    buffer_load_dwordx4 v15, s[80:83], s10 offen offset:3072 lds
    v_mfma_f32_16x16x32_bf16 a[92:95], v[156:159], v[76:79], a[92:95]
    ds_read_b128 v[72:75], v16 offset:10240
    ds_read_b128 v[76:79], v17 offset:10240
    v_mfma_f32_16x16x32_bf16 a[96:99], v[128:131], v[80:83], a[96:99]
    ds_read_b64_tr_b16 v[120:121], v21 offset:16384
    v_lshl_add_u32 v4, v29, 6, v4
    v_mfma_f32_16x16x32_bf16 a[96:99], v[132:135], v[84:87], a[96:99]
    s_mov_b32 s10, 0x36000
    s_add_u32 m0, s14, 0x24000
    v_add_u32 v4, 0x20000, v4
    v_mfma_f32_16x16x32_bf16 a[100:103], v[136:139], v[80:83], a[100:103]
    buffer_load_dwordx4 v12, s[80:83], s10 offen offset:0 lds
    v_mfma_f32_16x16x32_bf16 a[100:103], v[140:143], v[84:87], a[100:103]
    v_xor_b32 v5, 32, v4
    v_xor_b32 v6, 64, v4
    v_mfma_f32_16x16x32_bf16 a[104:107], v[144:147], v[80:83], a[104:107]
    ds_read_b64_tr_b16 v[122:123], v21 offset:16896
    v_xor_b32 v7, 96, v4
    v_mfma_f32_16x16x32_bf16 a[104:107], v[148:151], v[84:87], a[104:107]
    s_lshl_b32 s11, s6, 8
    s_sub_u32 s12, 0x500000, s11
    v_mfma_f32_16x16x32_bf16 a[108:111], v[152:155], v[80:83], a[108:111]
    buffer_load_dwordx4 v13, s[80:83], s10 offen offset:1024 lds
    v_mfma_f32_16x16x32_bf16 a[108:111], v[156:159], v[84:87], a[108:111]
    ds_read_b128 v[80:83], v16 offset:12288
    ds_read_b128 v[84:87], v17 offset:12288
    v_mfma_f32_16x16x32_bf16 a[112:115], v[128:131], v[88:91], a[112:115]
    s_add_u32 s48, s20, s11
    s_addc_u32 s49, s21, 0
    ds_read_b64_tr_b16 v[124:125], v21 offset:20480
    v_mfma_f32_16x16x32_bf16 a[112:115], v[132:135], v[92:95], a[112:115]
    s_mov_b32 s50, s12
    s_mov_b32 s51, 0x20000
    s_and_b32 s11, s7, 1
    v_mfma_f32_16x16x32_bf16 a[116:119], v[136:139], v[88:91], a[116:119]
    s_cmp_lg_u32 s3, 0
    s_cbranch_scc1 fk_l0
    buffer_load_dword v27, v170, s[68:71], s98 offen sc1
fk_l0:
    v_mfma_f32_16x16x32_bf16 a[116:119], v[140:143], v[92:95], a[116:119]
    buffer_load_dwordx4 v14, s[80:83], s10 offen offset:2048 lds
    v_mfma_f32_16x16x32_bf16 a[120:123], v[144:147], v[88:91], a[120:123]
    s_lshl_b32 s11, s11, 16
    s_or_b32 s15, s14, s11
    ds_read_b64_tr_b16 v[126:127], v21 offset:20992
    v_mfma_f32_16x16x32_bf16 a[120:123], v[148:151], v[92:95], a[120:123]
    v_mfma_f32_16x16x32_bf16 a[124:127], v[152:155], v[88:91], a[124:127]
    buffer_load_dwordx4 v15, s[80:83], s10 offen offset:3072 lds
    v_mfma_f32_16x16x32_bf16 a[124:127], v[156:159], v[92:95], a[124:127]
    s_waitcnt lgkmcnt(4)
    ds_read_b128 v[88:91], v16 offset:14336
    ds_read_b128 v[92:95], v17 offset:14336
    v_mfma_f32_16x16x32_bf16 a[128:131], v[32:35], v[96:99], a[128:131]
    v_mfma_f32_16x16x32_bf16 a[128:131], v[36:39], v[100:103], a[128:131]
    v_mfma_f32_16x16x32_bf16 a[136:139], v[32:35], v[104:107], a[136:139]
    v_mfma_f32_16x16x32_bf16 a[136:139], v[36:39], v[108:111], a[136:139]
    s_mov_b32 s92, 0x3c0000
    v_mfma_f32_16x16x32_bf16 a[144:147], v[32:35], v[112:115], a[144:147]
    buffer_load_dword v175, v171, s[56:59], s92 offen
    v_mfma_f32_16x16x32_bf16 a[144:147], v[36:39], v[116:119], a[144:147]
    v_mfma_f32_16x16x32_bf16 a[152:155], v[32:35], v[120:123], a[152:155]
    ds_read_b64_tr_b16 v[128:129], v18 offset:0
    s_waitcnt lgkmcnt(3)
    v_mfma_f32_16x16x32_bf16 a[152:155], v[36:39], v[124:127], a[152:155]
    v_mfma_f32_16x16x32_bf16 a[132:135], v[40:43], v[96:99], a[132:135]
    ds_read_b64_tr_b16 v[130:131], v18 offset:512
    v_mfma_f32_16x16x32_bf16 a[132:135], v[44:47], v[100:103], a[132:135]
    v_mfma_f32_16x16x32_bf16 a[140:143], v[40:43], v[104:107], a[140:143]
    ds_read_b64_tr_b16 v[132:133], v18 offset:4096
    v_mfma_f32_16x16x32_bf16 a[140:143], v[44:47], v[108:111], a[140:143]
    v_mfma_f32_16x16x32_bf16 a[148:151], v[40:43], v[112:115], a[148:151]
    ds_read_b64_tr_b16 v[134:135], v18 offset:4608
    v_mfma_f32_16x16x32_bf16 a[148:151], v[44:47], v[116:119], a[148:151]
    v_mfma_f32_16x16x32_bf16 a[156:159], v[40:43], v[120:123], a[156:159]
    ds_read_b64_tr_b16 v[136:137], v19 offset:0
    v_mfma_f32_16x16x32_bf16 a[156:159], v[44:47], v[124:127], a[156:159]
    v_mfma_f32_16x16x32_bf16 a[160:163], v[48:51], v[96:99], a[160:163]
    ds_read_b64_tr_b16 v[138:139], v19 offset:512
    v_mfma_f32_16x16x32_bf16 a[160:163], v[52:55], v[100:103], a[160:163]
    v_mfma_f32_16x16x32_bf16 a[168:171], v[48:51], v[104:107], a[168:171]
    ds_read_b64_tr_b16 v[140:141], v19 offset:4096
    v_mfma_f32_16x16x32_bf16 a[168:171], v[52:55], v[108:111], a[168:171]
    v_mfma_f32_16x16x32_bf16 a[176:179], v[48:51], v[112:115], a[176:179]
    ds_read_b64_tr_b16 v[142:143], v19 offset:4608
    v_mfma_f32_16x16x32_bf16 a[176:179], v[52:55], v[116:119], a[176:179]
    v_mfma_f32_16x16x32_bf16 a[184:187], v[48:51], v[120:123], a[184:187]
    ds_read_b64_tr_b16 v[144:145], v20 offset:0
    v_mfma_f32_16x16x32_bf16 a[184:187], v[52:55], v[124:127], a[184:187]
    v_mfma_f32_16x16x32_bf16 a[164:167], v[56:59], v[96:99], a[164:167]
    ds_read_b64_tr_b16 v[146:147], v20 offset:512
    v_mfma_f32_16x16x32_bf16 a[164:167], v[60:63], v[100:103], a[164:167]
    v_mfma_f32_16x16x32_bf16 a[172:175], v[56:59], v[104:107], a[172:175]
    ds_read_b64_tr_b16 v[148:149], v20 offset:4096
    v_mfma_f32_16x16x32_bf16 a[172:175], v[60:63], v[108:111], a[172:175]
    v_mfma_f32_16x16x32_bf16 a[180:183], v[56:59], v[112:115], a[180:183]
    ds_read_b64_tr_b16 v[150:151], v20 offset:4608
    v_mfma_f32_16x16x32_bf16 a[180:183], v[60:63], v[116:119], a[180:183]
    v_mfma_f32_16x16x32_bf16 a[188:191], v[56:59], v[120:123], a[188:191]
    ds_read_b64_tr_b16 v[152:153], v21 offset:0
    v_mfma_f32_16x16x32_bf16 a[188:191], v[60:63], v[124:127], a[188:191]
    v_mfma_f32_16x16x32_bf16 a[192:195], v[64:67], v[96:99], a[192:195]
    ds_read_b64_tr_b16 v[154:155], v21 offset:512
    v_mfma_f32_16x16x32_bf16 a[192:195], v[68:71], v[100:103], a[192:195]
    v_mfma_f32_16x16x32_bf16 a[200:203], v[64:67], v[104:107], a[200:203]
    ds_read_b64_tr_b16 v[156:157], v21 offset:4096
    v_mfma_f32_16x16x32_bf16 a[200:203], v[68:71], v[108:111], a[200:203]
    v_mfma_f32_16x16x32_bf16 a[208:211], v[64:67], v[112:115], a[208:211]
    ds_read_b64_tr_b16 v[158:159], v21 offset:4608
    v_mfma_f32_16x16x32_bf16 a[208:211], v[68:71], v[116:119], a[208:211]
    v_mfma_f32_16x16x32_bf16 a[216:219], v[64:67], v[120:123], a[216:219]
    v_mfma_f32_16x16x32_bf16 a[216:219], v[68:71], v[124:127], a[216:219]
    v_mfma_f32_16x16x32_bf16 a[196:199], v[72:75], v[96:99], a[196:199]
    v_mfma_f32_16x16x32_bf16 a[196:199], v[76:79], v[100:103], a[196:199]
    v_mfma_f32_16x16x32_bf16 a[204:207], v[72:75], v[104:107], a[204:207]
    v_mfma_f32_16x16x32_bf16 a[204:207], v[76:79], v[108:111], a[204:207]
    v_mfma_f32_16x16x32_bf16 a[212:215], v[72:75], v[112:115], a[212:215]
    v_mfma_f32_16x16x32_bf16 a[212:215], v[76:79], v[116:119], a[212:215]
    v_mfma_f32_16x16x32_bf16 a[220:223], v[72:75], v[120:123], a[220:223]
    v_mfma_f32_16x16x32_bf16 a[220:223], v[76:79], v[124:127], a[220:223]
    v_mfma_f32_16x16x32_bf16 a[224:227], v[80:83], v[96:99], a[224:227]
    v_mfma_f32_16x16x32_bf16 a[224:227], v[84:87], v[100:103], a[224:227]
    v_mfma_f32_16x16x32_bf16 a[232:235], v[80:83], v[104:107], a[232:235]
    v_mfma_f32_16x16x32_bf16 a[232:235], v[84:87], v[108:111], a[232:235]
    v_mfma_f32_16x16x32_bf16 a[240:243], v[80:83], v[112:115], a[240:243]
    v_mfma_f32_16x16x32_bf16 a[240:243], v[84:87], v[116:119], a[240:243]
    v_mfma_f32_16x16x32_bf16 a[248:251], v[80:83], v[120:123], a[248:251]
    v_mfma_f32_16x16x32_bf16 a[248:251], v[84:87], v[124:127], a[248:251]
    s_cmp_lg_u32 s3, 0
    s_cbranch_scc1 fk_c0w
    s_waitcnt vmcnt(3)
    v_cmp_eq_u32 vcc, 0x101, v27
    s_nop 0
    s_bcnt1_i32_b64 s11, vcc
    s_cmp_ge_u32 s11, 64
    s_cbranch_scc0 fk_w0_slow
fk_w0_ok:
fk_c0w:
    s_waitcnt lgkmcnt(15)
    v_mfma_f32_16x16x32_bf16 a[228:231], v[88:91], v[96:99], a[228:231]
    v_mfma_f32_16x16x32_bf16 a[228:231], v[92:95], v[100:103], a[228:231]
    v_add_u32 v18, 0x10000, v18
    v_add_u32 v19, 0x10000, v19
    v_mfma_f32_16x16x32_bf16 a[236:239], v[88:91], v[104:107], a[236:239]
    v_add_u32 v20, 0x10000, v20
    v_add_u32 v21, 0x10000, v21
    v_mfma_f32_16x16x32_bf16 a[236:239], v[92:95], v[108:111], a[236:239]
    v_xor_b32 v16, 0x10000, v16
    v_xor_b32 v17, 0x10000, v17
    v_mfma_f32_16x16x32_bf16 a[244:247], v[88:91], v[112:115], a[244:247]
    v_mfma_f32_16x16x32_bf16 a[244:247], v[92:95], v[116:119], a[244:247]
    v_mfma_f32_16x16x32_bf16 a[252:255], v[88:91], v[120:123], a[252:255]
    v_mfma_f32_16x16x32_bf16 a[252:255], v[92:95], v[124:127], a[252:255]
    s_waitcnt lgkmcnt(0)
    s_waitcnt vmcnt(9)
    s_barrier
    v_mfma_f32_16x16x32_bf16 a[0:3], v[128:131], v[32:35], a[0:3]
    ds_read_b64_tr_b16 v[96:97], v18 offset:16384
    v_mfma_f32_16x16x32_bf16 a[0:3], v[132:135], v[36:39], a[0:3]
    s_mov_b32 s10, 0x6c000
    s_add_u32 m0, s14, 0x0
    s_mov_b32 s97, 0x0
    v_mfma_f32_16x16x32_bf16 a[4:7], v[136:139], v[32:35], a[4:7]
    buffer_load_dwordx4 v12, s[80:83], s10 offen offset:0 lds
    v_mfma_f32_16x16x32_bf16 a[4:7], v[140:143], v[36:39], a[4:7]
    buffer_load_dwordx4 v[176:179], v24, s[64:67], s97 offen sc1
    v_mfma_f32_16x16x32_bf16 a[8:11], v[144:147], v[32:35], a[8:11]
    ds_read_b64_tr_b16 v[98:99], v18 offset:16896
    v_mfma_f32_16x16x32_bf16 a[8:11], v[148:151], v[36:39], a[8:11]
    v_mfma_f32_16x16x32_bf16 a[12:15], v[152:155], v[32:35], a[12:15]
    buffer_load_dwordx4 v13, s[80:83], s10 offen offset:1024 lds
    v_mfma_f32_16x16x32_bf16 a[12:15], v[156:159], v[36:39], a[12:15]
    ds_read_b128 v[32:35], v16 offset:0
    ds_read_b128 v[36:39], v17 offset:0
    v_mfma_f32_16x16x32_bf16 a[16:19], v[128:131], v[40:43], a[16:19]
    ds_read_b64_tr_b16 v[100:101], v18 offset:20480
    v_mfma_f32_16x16x32_bf16 a[16:19], v[132:135], v[44:47], a[16:19]
    v_mfma_f32_16x16x32_bf16 a[20:23], v[136:139], v[40:43], a[20:23]
    buffer_load_dwordx4 v14, s[80:83], s10 offen offset:2048 lds
    v_mfma_f32_16x16x32_bf16 a[20:23], v[140:143], v[44:47], a[20:23]
    v_mfma_f32_16x16x32_bf16 a[24:27], v[144:147], v[40:43], a[24:27]
    buffer_load_dwordx4 v[180:183], v24, s[64:67], s97 offen offset:256 sc1
    v_mfma_f32_16x16x32_bf16 a[24:27], v[148:151], v[44:47], a[24:27]
    ds_read_b64_tr_b16 v[102:103], v18 offset:20992
    v_mfma_f32_16x16x32_bf16 a[28:31], v[152:155], v[40:43], a[28:31]
    buffer_load_dwordx4 v15, s[80:83], s10 offen offset:3072 lds
    v_mfma_f32_16x16x32_bf16 a[28:31], v[156:159], v[44:47], a[28:31]
    ds_read_b128 v[40:43], v16 offset:2048
    ds_read_b128 v[44:47], v17 offset:2048
    v_mfma_f32_16x16x32_bf16 a[32:35], v[128:131], v[48:51], a[32:35]
    ds_read_b64_tr_b16 v[104:105], v19 offset:16384
    v_mfma_f32_16x16x32_bf16 a[32:35], v[132:135], v[52:55], a[32:35]
    s_mov_b32 s10, 0xa2000
    s_add_u32 m0, s14, 0x4000
    v_mfma_f32_16x16x32_bf16 a[36:39], v[136:139], v[48:51], a[36:39]
    buffer_load_dwordx4 v12, s[80:83], s10 offen offset:0 lds
    v_mfma_f32_16x16x32_bf16 a[36:39], v[140:143], v[52:55], a[36:39]
    v_mfma_f32_16x16x32_bf16 a[40:43], v[144:147], v[48:51], a[40:43]
    ds_read_b64_tr_b16 v[106:107], v19 offset:16896
    v_mfma_f32_16x16x32_bf16 a[40:43], v[148:151], v[52:55], a[40:43]
    buffer_load_dwordx4 v[184:187], v24, s[64:67], s97 offen offset:2048 sc1
    v_mfma_f32_16x16x32_bf16 a[44:47], v[152:155], v[48:51], a[44:47]
    buffer_load_dwordx4 v13, s[80:83], s10 offen offset:1024 lds
    v_mfma_f32_16x16x32_bf16 a[44:47], v[156:159], v[52:55], a[44:47]
    ds_read_b128 v[48:51], v16 offset:4096
    ds_read_b128 v[52:55], v17 offset:4096
    v_mfma_f32_16x16x32_bf16 a[48:51], v[128:131], v[56:59], a[48:51]
    ds_read_b64_tr_b16 v[108:109], v19 offset:20480
    v_mfma_f32_16x16x32_bf16 a[48:51], v[132:135], v[60:63], a[48:51]
    v_mfma_f32_16x16x32_bf16 a[52:55], v[136:139], v[56:59], a[52:55]
    buffer_load_dwordx4 v14, s[80:83], s10 offen offset:2048 lds
    v_mfma_f32_16x16x32_bf16 a[52:55], v[140:143], v[60:63], a[52:55]
    v_mfma_f32_16x16x32_bf16 a[56:59], v[144:147], v[56:59], a[56:59]
    ds_read_b64_tr_b16 v[110:111], v19 offset:20992
    v_mfma_f32_16x16x32_bf16 a[56:59], v[148:151], v[60:63], a[56:59]
    v_mfma_f32_16x16x32_bf16 a[60:63], v[152:155], v[56:59], a[60:63]
    buffer_load_dwordx4 v15, s[80:83], s10 offen offset:3072 lds
    v_mfma_f32_16x16x32_bf16 a[60:63], v[156:159], v[60:63], a[60:63]
    buffer_load_dwordx4 v[188:191], v24, s[64:67], s97 offen offset:2304 sc1
    v_mfma_f32_16x16x32_bf16 a[64:67], v[128:131], v[64:67], a[64:67]
    ds_read_b128 v[56:59], v16 offset:6144
    ds_read_b128 v[60:63], v17 offset:6144
    v_mfma_f32_16x16x32_bf16 a[64:67], v[132:135], v[68:71], a[64:67]
    s_mov_b32 s10, 0xd8000
    s_add_u32 m0, s14, 0x8000
    ds_read_b64_tr_b16 v[112:113], v20 offset:16384
    v_mfma_f32_16x16x32_bf16 a[68:71], v[136:139], v[64:67], a[68:71]
    buffer_load_dwordx4 v12, s[80:83], s10 offen offset:0 lds
    v_mfma_f32_16x16x32_bf16 a[68:71], v[140:143], v[68:71], a[68:71]
    v_mfma_f32_16x16x32_bf16 a[72:75], v[144:147], v[64:67], a[72:75]
    ds_read_b64_tr_b16 v[114:115], v20 offset:16896
    v_mfma_f32_16x16x32_bf16 a[72:75], v[148:151], v[68:71], a[72:75]
    s_mov_b32 s97, 0x1000
    v_mfma_f32_16x16x32_bf16 a[76:79], v[152:155], v[64:67], a[76:79]
    buffer_load_dwordx4 v13, s[80:83], s10 offen offset:1024 lds
    v_mfma_f32_16x16x32_bf16 a[76:79], v[156:159], v[68:71], a[76:79]
    buffer_load_dwordx4 v[192:195], v24, s[64:67], s97 offen sc1
    v_mfma_f32_16x16x32_bf16 a[80:83], v[128:131], v[72:75], a[80:83]
    ds_read_b128 v[64:67], v16 offset:8192
    ds_read_b128 v[68:71], v17 offset:8192
    v_mfma_f32_16x16x32_bf16 a[80:83], v[132:135], v[76:79], a[80:83]
    ds_read_b64_tr_b16 v[116:117], v20 offset:20480
    v_mfma_f32_16x16x32_bf16 a[84:87], v[136:139], v[72:75], a[84:87]
    buffer_load_dwordx4 v14, s[80:83], s10 offen offset:2048 lds
    v_mfma_f32_16x16x32_bf16 a[84:87], v[140:143], v[76:79], a[84:87]
    v_mfma_f32_16x16x32_bf16 a[88:91], v[144:147], v[72:75], a[88:91]
    ds_read_b64_tr_b16 v[118:119], v20 offset:20992
    v_mfma_f32_16x16x32_bf16 a[88:91], v[148:151], v[76:79], a[88:91]
    v_mfma_f32_16x16x32_bf16 a[92:95], v[152:155], v[72:75], a[92:95]
    buffer_load_dwordx4 v15, s[80:83], s10 offen offset:3072 lds
    v_mfma_f32_16x16x32_bf16 a[92:95], v[156:159], v[76:79], a[92:95]
    ds_read_b128 v[72:75], v16 offset:10240
    ds_read_b128 v[76:79], v17 offset:10240
    v_mfma_f32_16x16x32_bf16 a[96:99], v[128:131], v[80:83], a[96:99]
    buffer_load_dwordx4 v[196:199], v24, s[64:67], s97 offen offset:256 sc1
    v_mfma_f32_16x16x32_bf16 a[96:99], v[132:135], v[84:87], a[96:99]
    s_mov_b32 s10, 0x10e000
    s_add_u32 m0, s14, 0xc000
    ds_read_b64_tr_b16 v[120:121], v21 offset:16384
    v_mfma_f32_16x16x32_bf16 a[100:103], v[136:139], v[80:83], a[100:103]
    buffer_load_dwordx4 v12, s[80:83], s10 offen offset:0 lds
    v_mfma_f32_16x16x32_bf16 a[100:103], v[140:143], v[84:87], a[100:103]
    v_mfma_f32_16x16x32_bf16 a[104:107], v[144:147], v[80:83], a[104:107]
    ds_read_b64_tr_b16 v[122:123], v21 offset:16896
    v_mfma_f32_16x16x32_bf16 a[104:107], v[148:151], v[84:87], a[104:107]
    v_mfma_f32_16x16x32_bf16 a[108:111], v[152:155], v[80:83], a[108:111]
    buffer_load_dwordx4 v13, s[80:83], s10 offen offset:1024 lds
    v_mfma_f32_16x16x32_bf16 a[108:111], v[156:159], v[84:87], a[108:111]
    ds_read_b128 v[80:83], v16 offset:12288
    ds_read_b128 v[84:87], v17 offset:12288
    v_mfma_f32_16x16x32_bf16 a[112:115], v[128:131], v[88:91], a[112:115]
    ds_read_b64_tr_b16 v[124:125], v21 offset:20480
    v_mfma_f32_16x16x32_bf16 a[112:115], v[132:135], v[92:95], a[112:115]
    buffer_load_dwordx4 v[200:203], v24, s[64:67], s97 offen offset:2048 sc1
    v_mfma_f32_16x16x32_bf16 a[116:119], v[136:139], v[88:91], a[116:119]
    buffer_load_dwordx4 v14, s[80:83], s10 offen offset:2048 lds
    v_mfma_f32_16x16x32_bf16 a[116:119], v[140:143], v[92:95], a[116:119]
    ds_read_b64_tr_b16 v[126:127], v21 offset:20992
    v_mfma_f32_16x16x32_bf16 a[120:123], v[144:147], v[88:91], a[120:123]
    v_mfma_f32_16x16x32_bf16 a[120:123], v[148:151], v[92:95], a[120:123]
    v_mfma_f32_16x16x32_bf16 a[124:127], v[152:155], v[88:91], a[124:127]
    buffer_load_dwordx4 v15, s[80:83], s10 offen offset:3072 lds
    v_mfma_f32_16x16x32_bf16 a[124:127], v[156:159], v[92:95], a[124:127]
    s_waitcnt lgkmcnt(4)
    ds_read_b128 v[88:91], v16 offset:14336
    ds_read_b128 v[92:95], v17 offset:14336
    v_mfma_f32_16x16x32_bf16 a[128:131], v[32:35], v[96:99], a[128:131]
    v_mfma_f32_16x16x32_bf16 a[128:131], v[36:39], v[100:103], a[128:131]
    v_mfma_f32_16x16x32_bf16 a[136:139], v[32:35], v[104:107], a[136:139]
    buffer_load_dwordx4 v[204:207], v24, s[64:67], s97 offen offset:2304 sc1
    v_mfma_f32_16x16x32_bf16 a[136:139], v[36:39], v[108:111], a[136:139]
    v_mfma_f32_16x16x32_bf16 a[144:147], v[32:35], v[112:115], a[144:147]
    v_mfma_f32_16x16x32_bf16 a[144:147], v[36:39], v[116:119], a[144:147]
    v_mfma_f32_16x16x32_bf16 a[152:155], v[32:35], v[120:123], a[152:155]
    s_waitcnt lgkmcnt(2)
    buffer_load_dword v175, v2, s[28:31], 0 offen sc1
    v_mfma_f32_16x16x32_bf16 a[152:155], v[36:39], v[124:127], a[152:155]
    ds_read_b64_tr_b16 v[128:129], v18 offset:0
    v_mfma_f32_16x16x32_bf16 a[132:135], v[40:43], v[96:99], a[132:135]
    ds_read_b64_tr_b16 v[130:131], v18 offset:512
    v_mfma_f32_16x16x32_bf16 a[132:135], v[44:47], v[100:103], a[132:135]
    v_mfma_f32_16x16x32_bf16 a[140:143], v[40:43], v[104:107], a[140:143]
    s_mov_b32 s97, 0x2000
    ds_read_b64_tr_b16 v[132:133], v18 offset:4096
    v_mfma_f32_16x16x32_bf16 a[140:143], v[44:47], v[108:111], a[140:143]
    buffer_load_dwordx4 v[208:211], v24, s[64:67], s97 offen sc1
    v_mfma_f32_16x16x32_bf16 a[148:151], v[40:43], v[112:115], a[148:151]
    ds_read_b64_tr_b16 v[134:135], v18 offset:4608
    v_mfma_f32_16x16x32_bf16 a[148:151], v[44:47], v[116:119], a[148:151]
    v_mfma_f32_16x16x32_bf16 a[156:159], v[40:43], v[120:123], a[156:159]
    ds_read_b64_tr_b16 v[136:137], v19 offset:0
    v_mfma_f32_16x16x32_bf16 a[156:159], v[44:47], v[124:127], a[156:159]
    v_mfma_f32_16x16x32_bf16 a[160:163], v[48:51], v[96:99], a[160:163]
    ds_read_b64_tr_b16 v[138:139], v19 offset:512
    v_mfma_f32_16x16x32_bf16 a[160:163], v[52:55], v[100:103], a[160:163]
    v_mfma_f32_16x16x32_bf16 a[168:171], v[48:51], v[104:107], a[168:171]
    ds_read_b64_tr_b16 v[140:141], v19 offset:4096
    v_mfma_f32_16x16x32_bf16 a[168:171], v[52:55], v[108:111], a[168:171]
    v_mfma_f32_16x16x32_bf16 a[176:179], v[48:51], v[112:115], a[176:179]
    buffer_load_dwordx4 v[212:215], v24, s[64:67], s97 offen offset:256 sc1
    v_mfma_f32_16x16x32_bf16 a[176:179], v[52:55], v[116:119], a[176:179]
    ds_read_b64_tr_b16 v[142:143], v19 offset:4608
    v_mfma_f32_16x16x32_bf16 a[184:187], v[48:51], v[120:123], a[184:187]
    ds_read_b64_tr_b16 v[144:145], v20 offset:0
    v_mfma_f32_16x16x32_bf16 a[184:187], v[52:55], v[124:127], a[184:187]
    v_mfma_f32_16x16x32_bf16 a[164:167], v[56:59], v[96:99], a[164:167]
    ds_read_b64_tr_b16 v[146:147], v20 offset:512
    v_mfma_f32_16x16x32_bf16 a[164:167], v[60:63], v[100:103], a[164:167]
    v_mfma_f32_16x16x32_bf16 a[172:175], v[56:59], v[104:107], a[172:175]
    ds_read_b64_tr_b16 v[148:149], v20 offset:4096
    v_mfma_f32_16x16x32_bf16 a[172:175], v[60:63], v[108:111], a[172:175]
    v_mfma_f32_16x16x32_bf16 a[180:183], v[56:59], v[112:115], a[180:183]
    ds_read_b64_tr_b16 v[150:151], v20 offset:4608
    v_mfma_f32_16x16x32_bf16 a[180:183], v[60:63], v[116:119], a[180:183]
    buffer_load_dwordx4 v[216:219], v24, s[64:67], s97 offen offset:2048 sc1
    v_mfma_f32_16x16x32_bf16 a[188:191], v[56:59], v[120:123], a[188:191]
    ds_read_b64_tr_b16 v[152:153], v21 offset:0
    v_mfma_f32_16x16x32_bf16 a[188:191], v[60:63], v[124:127], a[188:191]
    v_mfma_f32_16x16x32_bf16 a[192:195], v[64:67], v[96:99], a[192:195]
    ds_read_b64_tr_b16 v[154:155], v21 offset:512
    v_mfma_f32_16x16x32_bf16 a[192:195], v[68:71], v[100:103], a[192:195]
    v_mfma_f32_16x16x32_bf16 a[200:203], v[64:67], v[104:107], a[200:203]
    ds_read_b64_tr_b16 v[156:157], v21 offset:4096
    v_mfma_f32_16x16x32_bf16 a[200:203], v[68:71], v[108:111], a[200:203]
    v_mfma_f32_16x16x32_bf16 a[208:211], v[64:67], v[112:115], a[208:211]
    ds_read_b64_tr_b16 v[158:159], v21 offset:4608
    v_mfma_f32_16x16x32_bf16 a[208:211], v[68:71], v[116:119], a[208:211]
    v_mfma_f32_16x16x32_bf16 a[216:219], v[64:67], v[120:123], a[216:219]
    buffer_load_dwordx4 v[220:223], v24, s[64:67], s97 offen offset:2304 sc1
    v_mfma_f32_16x16x32_bf16 a[216:219], v[68:71], v[124:127], a[216:219]
    v_mfma_f32_16x16x32_bf16 a[196:199], v[72:75], v[96:99], a[196:199]
    v_mfma_f32_16x16x32_bf16 a[196:199], v[76:79], v[100:103], a[196:199]
    v_mfma_f32_16x16x32_bf16 a[204:207], v[72:75], v[104:107], a[204:207]
    v_mfma_f32_16x16x32_bf16 a[204:207], v[76:79], v[108:111], a[204:207]
    v_mfma_f32_16x16x32_bf16 a[212:215], v[72:75], v[112:115], a[212:215]
    v_mfma_f32_16x16x32_bf16 a[212:215], v[76:79], v[116:119], a[212:215]
    v_mfma_f32_16x16x32_bf16 a[220:223], v[72:75], v[120:123], a[220:223]
    s_mov_b32 s97, 0x3000
    v_mfma_f32_16x16x32_bf16 a[220:223], v[76:79], v[124:127], a[220:223]
    buffer_load_dwordx4 v[224:227], v24, s[64:67], s97 offen sc1
    v_mfma_f32_16x16x32_bf16 a[224:227], v[80:83], v[96:99], a[224:227]
    v_mfma_f32_16x16x32_bf16 a[224:227], v[84:87], v[100:103], a[224:227]
    v_mfma_f32_16x16x32_bf16 a[232:235], v[80:83], v[104:107], a[232:235]
    v_mfma_f32_16x16x32_bf16 a[232:235], v[84:87], v[108:111], a[232:235]
    v_mfma_f32_16x16x32_bf16 a[240:243], v[80:83], v[112:115], a[240:243]
    v_mfma_f32_16x16x32_bf16 a[240:243], v[84:87], v[116:119], a[240:243]
    v_mfma_f32_16x16x32_bf16 a[248:251], v[80:83], v[120:123], a[248:251]
    v_mfma_f32_16x16x32_bf16 a[248:251], v[84:87], v[124:127], a[248:251]
    s_waitcnt lgkmcnt(15)
    v_mfma_f32_16x16x32_bf16 a[228:231], v[88:91], v[96:99], a[228:231]
    buffer_load_dwordx4 v[228:231], v24, s[64:67], s97 offen offset:256 sc1
    v_mfma_f32_16x16x32_bf16 a[228:231], v[92:95], v[100:103], a[228:231]
    v_mfma_f32_16x16x32_bf16 a[236:239], v[88:91], v[104:107], a[236:239]
    v_mfma_f32_16x16x32_bf16 a[236:239], v[92:95], v[108:111], a[236:239]
    v_mfma_f32_16x16x32_bf16 a[244:247], v[88:91], v[112:115], a[244:247]
    v_mfma_f32_16x16x32_bf16 a[244:247], v[92:95], v[116:119], a[244:247]
    v_mfma_f32_16x16x32_bf16 a[252:255], v[88:91], v[120:123], a[252:255]
    v_mfma_f32_16x16x32_bf16 a[252:255], v[92:95], v[124:127], a[252:255]
    s_waitcnt lgkmcnt(0)
    s_waitcnt vmcnt(8)
    s_barrier
    v_mfma_f32_16x16x32_bf16 a[0:3], v[128:131], v[32:35], a[0:3]
    s_mov_b32 s10, 0x144000
    s_add_u32 m0, s14, 0x18000
    v_mfma_f32_16x16x32_bf16 a[0:3], v[132:135], v[36:39], a[0:3]
    buffer_load_dwordx4 v[232:235], v24, s[64:67], s97 offen offset:2048 sc1
    v_mfma_f32_16x16x32_bf16 a[4:7], v[136:139], v[32:35], a[4:7]
    buffer_load_dwordx4 v12, s[80:83], s10 offen offset:0 lds
    v_mfma_f32_16x16x32_bf16 a[4:7], v[140:143], v[36:39], a[4:7]
    v_mfma_f32_16x16x32_bf16 a[8:11], v[144:147], v[32:35], a[8:11]
    v_mfma_f32_16x16x32_bf16 a[8:11], v[148:151], v[36:39], a[8:11]
    v_mfma_f32_16x16x32_bf16 a[12:15], v[152:155], v[32:35], a[12:15]
    buffer_load_dwordx4 v13, s[80:83], s10 offen offset:1024 lds
    v_mfma_f32_16x16x32_bf16 a[12:15], v[156:159], v[36:39], a[12:15]
    v_mfma_f32_16x16x32_bf16 a[16:19], v[128:131], v[40:43], a[16:19]
    v_mfma_f32_16x16x32_bf16 a[16:19], v[132:135], v[44:47], a[16:19]
    v_mfma_f32_16x16x32_bf16 a[20:23], v[136:139], v[40:43], a[20:23]
    buffer_load_dwordx4 v14, s[80:83], s10 offen offset:2048 lds
    v_mfma_f32_16x16x32_bf16 a[20:23], v[140:143], v[44:47], a[20:23]
    buffer_load_dwordx4 v[236:239], v24, s[64:67], s97 offen offset:2304 sc1
    v_mfma_f32_16x16x32_bf16 a[24:27], v[144:147], v[40:43], a[24:27]
    v_mfma_f32_16x16x32_bf16 a[24:27], v[148:151], v[44:47], a[24:27]
    v_mfma_f32_16x16x32_bf16 a[28:31], v[152:155], v[40:43], a[28:31]
    buffer_load_dwordx4 v15, s[80:83], s10 offen offset:3072 lds
    v_mfma_f32_16x16x32_bf16 a[28:31], v[156:159], v[44:47], a[28:31]
    v_mfma_f32_16x16x32_bf16 a[32:35], v[128:131], v[48:51], a[32:35]
    v_mfma_f32_16x16x32_bf16 a[32:35], v[132:135], v[52:55], a[32:35]
    s_mov_b32 s10, 0x17a000
    s_add_u32 m0, s14, 0x1c000
    s_mov_b32 s97, 0x4000
    v_mfma_f32_16x16x32_bf16 a[36:39], v[136:139], v[48:51], a[36:39]
    buffer_load_dwordx4 v12, s[80:83], s10 offen offset:0 lds
    v_mfma_f32_16x16x32_bf16 a[36:39], v[140:143], v[52:55], a[36:39]
    buffer_load_dwordx4 v[240:243], v24, s[64:67], s97 offen sc1
    v_mfma_f32_16x16x32_bf16 a[40:43], v[144:147], v[48:51], a[40:43]
    v_mfma_f32_16x16x32_bf16 a[40:43], v[148:151], v[52:55], a[40:43]
    v_mfma_f32_16x16x32_bf16 a[44:47], v[152:155], v[48:51], a[44:47]
    buffer_load_dwordx4 v13, s[80:83], s10 offen offset:1024 lds
    v_mfma_f32_16x16x32_bf16 a[44:47], v[156:159], v[52:55], a[44:47]
    v_mfma_f32_16x16x32_bf16 a[48:51], v[128:131], v[56:59], a[48:51]
    v_mfma_f32_16x16x32_bf16 a[48:51], v[132:135], v[60:63], a[48:51]
    v_mfma_f32_16x16x32_bf16 a[52:55], v[136:139], v[56:59], a[52:55]
    buffer_load_dwordx4 v14, s[80:83], s10 offen offset:2048 lds
    v_mfma_f32_16x16x32_bf16 a[52:55], v[140:143], v[60:63], a[52:55]
    v_mfma_f32_16x16x32_bf16 a[56:59], v[144:147], v[56:59], a[56:59]
    buffer_load_dwordx4 v[244:247], v24, s[64:67], s97 offen offset:256 sc1
    v_mfma_f32_16x16x32_bf16 a[56:59], v[148:151], v[60:63], a[56:59]
    v_mfma_f32_16x16x32_bf16 a[60:63], v[152:155], v[56:59], a[60:63]
    buffer_load_dwordx4 v15, s[80:83], s10 offen offset:3072 lds
    v_mfma_f32_16x16x32_bf16 a[60:63], v[156:159], v[60:63], a[60:63]
    v_mfma_f32_16x16x32_bf16 a[64:67], v[128:131], v[64:67], a[64:67]
    v_mfma_f32_16x16x32_bf16 a[64:67], v[132:135], v[68:71], a[64:67]
    v_mfma_f32_16x16x32_bf16 a[68:71], v[136:139], v[64:67], a[68:71]
    v_mfma_f32_16x16x32_bf16 a[68:71], v[140:143], v[68:71], a[68:71]
    v_mfma_f32_16x16x32_bf16 a[72:75], v[144:147], v[64:67], a[72:75]
    v_mfma_f32_16x16x32_bf16 a[72:75], v[148:151], v[68:71], a[72:75]
    buffer_load_dwordx4 v[248:251], v24, s[64:67], s97 offen offset:2048 sc1
    v_mfma_f32_16x16x32_bf16 a[76:79], v[152:155], v[64:67], a[76:79]
    v_mfma_f32_16x16x32_bf16 a[76:79], v[156:159], v[68:71], a[76:79]
    ds_read_b64_tr_b16 v[96:97], v4 offset:0
    v_mfma_f32_16x16x32_bf16 a[80:83], v[128:131], v[72:75], a[80:83]
    ds_read_b64_tr_b16 v[98:99], v4 offset:512
    v_mfma_f32_16x16x32_bf16 a[80:83], v[132:135], v[76:79], a[80:83]
    ds_read_b64_tr_b16 v[100:101], v4 offset:4096
    v_mfma_f32_16x16x32_bf16 a[84:87], v[136:139], v[72:75], a[84:87]
    ds_read_b64_tr_b16 v[102:103], v4 offset:4608
    v_mfma_f32_16x16x32_bf16 a[84:87], v[140:143], v[76:79], a[84:87]
    ds_read_b64_tr_b16 v[104:105], v5 offset:0
    v_mfma_f32_16x16x32_bf16 a[88:91], v[144:147], v[72:75], a[88:91]
    ds_read_b64_tr_b16 v[106:107], v5 offset:512
    v_mfma_f32_16x16x32_bf16 a[88:91], v[148:151], v[76:79], a[88:91]
    ds_read_b64_tr_b16 v[108:109], v5 offset:4096
    v_mfma_f32_16x16x32_bf16 a[92:95], v[152:155], v[72:75], a[92:95]
    buffer_load_dwordx4 v[252:255], v24, s[64:67], s97 offen offset:2304 sc1
    v_mfma_f32_16x16x32_bf16 a[92:95], v[156:159], v[76:79], a[92:95]
    ds_read_b64_tr_b16 v[110:111], v5 offset:4608
    ds_read_b64_tr_b16 v[112:113], v6 offset:0
    v_mfma_f32_16x16x32_bf16 a[96:99], v[128:131], v[80:83], a[96:99]
    ds_read_b64_tr_b16 v[114:115], v6 offset:512
    v_mfma_f32_16x16x32_bf16 a[96:99], v[132:135], v[84:87], a[96:99]
    ds_read_b64_tr_b16 v[116:117], v6 offset:4096
    v_mfma_f32_16x16x32_bf16 a[100:103], v[136:139], v[80:83], a[100:103]
    ds_read_b64_tr_b16 v[118:119], v6 offset:4608
    v_mfma_f32_16x16x32_bf16 a[100:103], v[140:143], v[84:87], a[100:103]
    ds_read_b64_tr_b16 v[120:121], v7 offset:0
    v_mfma_f32_16x16x32_bf16 a[104:107], v[144:147], v[80:83], a[104:107]
    ds_read_b64_tr_b16 v[122:123], v7 offset:512
    v_mfma_f32_16x16x32_bf16 a[104:107], v[148:151], v[84:87], a[104:107]
    ds_read_b64_tr_b16 v[124:125], v7 offset:4096
    v_mfma_f32_16x16x32_bf16 a[108:111], v[152:155], v[80:83], a[108:111]
    ds_read_b64_tr_b16 v[126:127], v7 offset:4608
    v_mfma_f32_16x16x32_bf16 a[108:111], v[156:159], v[84:87], a[108:111]
    v_mfma_f32_16x16x32_bf16 a[112:115], v[128:131], v[88:91], a[112:115]
    v_mfma_f32_16x16x32_bf16 a[112:115], v[132:135], v[92:95], a[112:115]
    v_mfma_f32_16x16x32_bf16 a[116:119], v[136:139], v[88:91], a[116:119]
    v_mfma_f32_16x16x32_bf16 a[116:119], v[140:143], v[92:95], a[116:119]
    v_mfma_f32_16x16x32_bf16 a[120:123], v[144:147], v[88:91], a[120:123]
    v_mfma_f32_16x16x32_bf16 a[120:123], v[148:151], v[92:95], a[120:123]
    v_mfma_f32_16x16x32_bf16 a[124:127], v[152:155], v[88:91], a[124:127]
    v_mfma_f32_16x16x32_bf16 a[124:127], v[156:159], v[92:95], a[124:127]
    s_cmp_ge_u32 s5, 28
    s_cbranch_scc1 fk_zs
    s_waitcnt lgkmcnt(4)
    v_mfma_f32_16x16x32_bf16 v[32:35], v[96:99], v[176:179], 0
    ds_read_b64_tr_b16 v[128:129], v4 offset:8192
    v_accvgpr_read_b32 v144, a128
    v_mfma_f32_16x16x32_bf16 v[32:35], v[100:103], v[184:187], v[32:35]
    ds_read_b64_tr_b16 v[130:131], v4 offset:8704
    v_accvgpr_read_b32 v145, a129
    v_mfma_f32_16x16x32_bf16 v[40:43], v[96:99], v[180:183], 0
    ds_read_b64_tr_b16 v[132:133], v4 offset:12288
    v_accvgpr_read_b32 v146, a130
    v_mfma_f32_16x16x32_bf16 v[40:43], v[100:103], v[188:191], v[40:43]
    ds_read_b64_tr_b16 v[134:135], v4 offset:12800
    v_accvgpr_read_b32 v147, a131
    v_mfma_f32_16x16x32_bf16 v[36:39], v[104:107], v[176:179], 0
    ds_read_b64_tr_b16 v[136:137], v5 offset:8192
    v_accvgpr_read_b32 v148, a132
    v_accvgpr_read_b32 v149, a133
    v_mfma_f32_16x16x32_bf16 v[36:39], v[108:111], v[184:187], v[36:39]
    s_mov_b32 s10, 0x1b0000
    s_add_u32 m0, s14, 0x10000
    ds_read_b64_tr_b16 v[138:139], v5 offset:8704
    v_accvgpr_read_b32 v150, a134
    v_accvgpr_read_b32 v151, a135
    v_accvgpr_read_b32 v152, a136
    v_mfma_f32_16x16x32_bf16 v[44:47], v[104:107], v[180:183], 0
    buffer_load_dwordx4 v12, s[80:83], s10 offen offset:0 lds
    v_mfma_f32_16x16x32_bf16 v[44:47], v[108:111], v[188:191], v[44:47]
    ds_read_b64_tr_b16 v[140:141], v5 offset:12288
    ds_read_b64_tr_b16 v[142:143], v5 offset:12800
    v_accvgpr_read_b32 v153, a137
    v_mfma_f32_16x16x32_bf16 v[48:51], v[112:115], v[176:179], 0
    ds_read_b64_tr_b16 v[96:97], v6 offset:8192
    v_accvgpr_read_b32 v154, a138
    v_accvgpr_read_b32 v155, a139
    v_mfma_f32_16x16x32_bf16 v[48:51], v[116:119], v[184:187], v[48:51]
    ds_read_b64_tr_b16 v[98:99], v6 offset:8704
    v_accvgpr_read_b32 v156, a140
    v_accvgpr_read_b32 v157, a141
    v_mfma_f32_16x16x32_bf16 v[56:59], v[112:115], v[180:183], 0
    ds_read_b64_tr_b16 v[100:101], v6 offset:12288
    v_accvgpr_read_b32 v158, a142
    v_mfma_f32_16x16x32_bf16 v[56:59], v[116:119], v[188:191], v[56:59]
    s_waitcnt lgkmcnt(7)
    ds_read_b64_tr_b16 v[102:103], v6 offset:12800
    v_accvgpr_read_b32 v159, a143
    v_cvt_pk_bf16_f32 v160, v144, v145
    v_mfma_f32_16x16x32_bf16 v[52:55], v[120:123], v[176:179], 0
    ds_read_b64_tr_b16 v[104:105], v7 offset:8192
    v_cvt_pk_bf16_f32 v161, v146, v147
    v_cvt_pk_bf16_f32 v162, v148, v149
    v_cvt_pk_bf16_f32 v163, v150, v151
    v_mfma_f32_16x16x32_bf16 v[52:55], v[124:127], v[184:187], v[52:55]
    s_mov_b32 s13, 0x0
    ds_read_b64_tr_b16 v[106:107], v7 offset:8704
    v_mfma_f32_16x16x32_bf16 v[60:63], v[120:123], v[180:183], 0
    buffer_store_dwordx4 v[160:163], v26, s[88:91], s13 offen sc1
    buffer_load_dwordx4 v13, s[80:83], s10 offen offset:1024 lds
    v_cvt_pk_bf16_f32 v164, v152, v153
    v_mfma_f32_16x16x32_bf16 v[60:63], v[124:127], v[188:191], v[60:63]
    ds_read_b64_tr_b16 v[108:109], v7 offset:12288
    ds_read_b64_tr_b16 v[110:111], v7 offset:12800
    v_cvt_pk_bf16_f32 v165, v154, v155
    v_mfma_f32_16x16x32_bf16 v[64:67], v[176:179], v[128:131], 0
    ds_read_b64_tr_b16 v[112:113], v4 offset:16384
    v_cvt_pk_bf16_f32 v166, v156, v157
    v_mfma_f32_16x16x32_bf16 v[64:67], v[184:187], v[132:135], v[64:67]
    ds_read_b64_tr_b16 v[114:115], v4 offset:16896
    v_cvt_pk_bf16_f32 v167, v158, v159
    v_accvgpr_read_b32 v144, a192
    v_mfma_f32_16x16x32_bf16 v[68:71], v[180:183], v[128:131], 0
    ds_read_b64_tr_b16 v[116:117], v4 offset:20480
    v_accvgpr_read_b32 v145, a193
    v_accvgpr_read_b32 v146, a194
    v_mfma_f32_16x16x32_bf16 v[68:71], v[188:191], v[132:135], v[68:71]
    s_waitcnt lgkmcnt(7)
    ds_read_b64_tr_b16 v[118:119], v4 offset:20992
    v_accvgpr_read_b32 v147, a195
    v_mfma_f32_16x16x32_bf16 v[72:75], v[176:179], v[136:139], 0
    ds_read_b64_tr_b16 v[120:121], v5 offset:16384
    v_accvgpr_read_b32 v148, a196
    v_accvgpr_read_b32 v149, a197
    v_mfma_f32_16x16x32_bf16 v[72:75], v[184:187], v[140:143], v[72:75]
    ds_read_b64_tr_b16 v[122:123], v5 offset:16896
    v_accvgpr_read_b32 v150, a198
    v_accvgpr_read_b32 v151, a199
    v_accvgpr_read_b32 v152, a200
    v_mfma_f32_16x16x32_bf16 v[76:79], v[180:183], v[136:139], 0
    buffer_load_dwordx4 v14, s[80:83], s10 offen offset:2048 lds
    v_mfma_f32_16x16x32_bf16 v[76:79], v[188:191], v[140:143], v[76:79]
    ds_read_b64_tr_b16 v[124:125], v5 offset:20480
    ds_read_b64_tr_b16 v[126:127], v5 offset:20992
    v_accvgpr_read_b32 v153, a201
    v_mfma_f32_16x16x32_bf16 v[80:83], v[176:179], v[96:99], 0
    ds_read_b64_tr_b16 v[128:129], v6 offset:16384
    v_accvgpr_read_b32 v154, a202
    v_accvgpr_read_b32 v155, a203
    v_mfma_f32_16x16x32_bf16 v[80:83], v[184:187], v[100:103], v[80:83]
    ds_read_b64_tr_b16 v[130:131], v6 offset:16896
    v_accvgpr_read_b32 v156, a204
    v_mfma_f32_16x16x32_bf16 v[84:87], v[180:183], v[96:99], 0
    ds_read_b64_tr_b16 v[132:133], v6 offset:20480
    v_accvgpr_read_b32 v157, a205
    v_accvgpr_read_b32 v158, a206
    v_mfma_f32_16x16x32_bf16 v[84:87], v[188:191], v[100:103], v[84:87]
    s_waitcnt lgkmcnt(7)
    ds_read_b64_tr_b16 v[134:135], v6 offset:20992
    v_accvgpr_read_b32 v159, a207
    v_cvt_pk_bf16_f32 v168, v144, v145
    v_mfma_f32_16x16x32_bf16 v[88:91], v[176:179], v[104:107], 0
    ds_read_b64_tr_b16 v[136:137], v7 offset:16384
    v_cvt_pk_bf16_f32 v169, v146, v147
    v_mfma_f32_16x16x32_bf16 v[88:91], v[184:187], v[108:111], v[88:91]
    ds_read_b64_tr_b16 v[138:139], v7 offset:16896
    v_cvt_pk_bf16_f32 v170, v148, v149
    v_cvt_pk_bf16_f32 v171, v150, v151
    v_cvt_pk_bf16_f32 v172, v152, v153
    v_mfma_f32_16x16x32_bf16 v[92:95], v[180:183], v[104:107], 0
    buffer_load_dwordx4 v15, s[80:83], s10 offen offset:3072 lds
    v_mfma_f32_16x16x32_bf16 v[92:95], v[188:191], v[108:111], v[92:95]
    ds_read_b64_tr_b16 v[140:141], v7 offset:20480
    ds_read_b64_tr_b16 v[142:143], v7 offset:20992
    v_cvt_pk_bf16_f32 v173, v154, v155
    v_cvt_pk_bf16_f32 v174, v156, v157
    v_mfma_f32_16x16x32_bf16 v[32:35], v[112:115], v[192:195], v[32:35]
    ds_read_b64_tr_b16 v[96:97], v4 offset:24576
    s_waitcnt vmcnt(25)
    v_cvt_pk_bf16_f32 v175, v158, v159
    v_mfma_f32_16x16x32_bf16 v[32:35], v[116:119], v[200:203], v[32:35]
    s_mov_b32 s97, 0x5000
    buffer_store_dwordx4 v[164:167], v26, s[88:91], s13 offen offset:1024 sc1
    ds_read_b64_tr_b16 v[98:99], v4 offset:25088
    v_accvgpr_write_b32 a192, v168
    v_accvgpr_write_b32 a193, v169
    v_mfma_f32_16x16x32_bf16 v[40:43], v[112:115], v[196:199], v[40:43]
    buffer_load_dwordx4 v[176:179], v24, s[64:67], s97 offen sc1
    v_mfma_f32_16x16x32_bf16 v[40:43], v[116:119], v[204:207], v[40:43]
    s_waitcnt lgkmcnt(6)
    ds_read_b64_tr_b16 v[100:101], v4 offset:28672
    ds_read_b64_tr_b16 v[102:103], v4 offset:29184
    v_accvgpr_write_b32 a194, v170
    v_accvgpr_write_b32 a195, v171
    v_mfma_f32_16x16x32_bf16 v[36:39], v[120:123], v[192:195], v[36:39]
    ds_read_b64_tr_b16 v[104:105], v5 offset:24576
    v_accvgpr_write_b32 a196, v172
    v_accvgpr_write_b32 a197, v173
    v_mfma_f32_16x16x32_bf16 v[36:39], v[124:127], v[200:203], v[36:39]
    s_mov_b32 s10, 0x1e6000
    s_add_u32 m0, s14, 0x14000
    ds_read_b64_tr_b16 v[106:107], v5 offset:25088
    v_accvgpr_write_b32 a198, v174
    v_accvgpr_write_b32 a199, v175
    v_accvgpr_read_b32 v144, a144
    v_mfma_f32_16x16x32_bf16 v[44:47], v[120:123], v[196:199], v[44:47]
    buffer_load_dwordx4 v12, s[80:83], s10 offen offset:0 lds
    v_mfma_f32_16x16x32_bf16 v[44:47], v[124:127], v[204:207], v[44:47]
    ds_read_b64_tr_b16 v[108:109], v5 offset:28672
    ds_read_b64_tr_b16 v[110:111], v5 offset:29184
    v_accvgpr_read_b32 v145, a145
    v_mfma_f32_16x16x32_bf16 v[48:51], v[128:131], v[192:195], v[48:51]
    ds_read_b64_tr_b16 v[112:113], v6 offset:24576
    v_add_u32 v21, 0x13f80, v23
    v_accvgpr_read_b32 v146, a146
    v_accvgpr_read_b32 v147, a147
    v_mfma_f32_16x16x32_bf16 v[48:51], v[132:135], v[200:203], v[48:51]
    ds_read_b64_tr_b16 v[114:115], v6 offset:25088
    v_accvgpr_read_b32 v148, a148
    v_accvgpr_read_b32 v149, a149
    v_accvgpr_read_b32 v150, a150
    v_mfma_f32_16x16x32_bf16 v[56:59], v[128:131], v[196:199], v[56:59]
    buffer_load_dwordx4 v[180:183], v24, s[64:67], s97 offen offset:256 sc1
    v_mfma_f32_16x16x32_bf16 v[56:59], v[132:135], v[204:207], v[56:59]
    s_waitcnt lgkmcnt(6)
    ds_read_b64_tr_b16 v[116:117], v6 offset:28672
    ds_read_b64_tr_b16 v[118:119], v6 offset:29184
    v_accvgpr_read_b32 v151, a151
    v_mfma_f32_16x16x32_bf16 v[52:55], v[136:139], v[192:195], v[52:55]
    ds_read_b64_tr_b16 v[120:121], v7 offset:24576
    v_accvgpr_read_b32 v152, a152
    v_accvgpr_read_b32 v153, a153
    v_mfma_f32_16x16x32_bf16 v[52:55], v[140:143], v[200:203], v[52:55]
    ds_read_b64_tr_b16 v[122:123], v7 offset:25088
    v_accvgpr_read_b32 v154, a154
    v_accvgpr_read_b32 v155, a155
    v_mfma_f32_16x16x32_bf16 v[60:63], v[136:139], v[196:199], v[60:63]
    buffer_load_dwordx4 v13, s[80:83], s10 offen offset:1024 lds
    v_accvgpr_read_b32 v156, a156
    v_mfma_f32_16x16x32_bf16 v[60:63], v[140:143], v[204:207], v[60:63]
    ds_read_b64_tr_b16 v[124:125], v7 offset:28672
    ds_read_b64_tr_b16 v[126:127], v7 offset:29184
    v_xor_b32 v4, 0x20000, v4
    v_xor_b32 v5, 0x20000, v5
    v_xor_b32 v6, 0x20000, v6
    v_xor_b32 v7, 0x20000, v7
    v_accvgpr_read_b32 v157, a157
    v_accvgpr_read_b32 v158, a158
    v_mfma_f32_16x16x32_bf16 v[64:67], v[192:195], v[96:99], v[64:67]
    ds_read_b64_tr_b16 v[128:129], v4 offset:0
    v_accvgpr_read_b32 v159, a159
    v_mfma_f32_16x16x32_bf16 v[64:67], v[200:203], v[100:103], v[64:67]
    ds_read_b64_tr_b16 v[130:131], v4 offset:512
    v_cvt_pk_bf16_f32 v160, v144, v145
    v_cvt_pk_bf16_f32 v161, v146, v147
    v_cvt_pk_bf16_f32 v162, v148, v149
    v_cvt_pk_bf16_f32 v163, v150, v151
    v_mfma_f32_16x16x32_bf16 v[68:71], v[196:199], v[96:99], v[68:71]
    buffer_load_dwordx4 v[184:187], v24, s[64:67], s97 offen offset:2048 sc1
    v_mfma_f32_16x16x32_bf16 v[68:71], v[204:207], v[100:103], v[68:71]
    s_waitcnt lgkmcnt(6)
    buffer_store_dwordx4 v[160:163], v26, s[88:91], s13 offen offset:2048 sc1
    ds_read_b64_tr_b16 v[132:133], v4 offset:4096
    ds_read_b64_tr_b16 v[134:135], v4 offset:4608
    v_cvt_pk_bf16_f32 v164, v152, v153
    v_mfma_f32_16x16x32_bf16 v[72:75], v[192:195], v[104:107], v[72:75]
    ds_read_b64_tr_b16 v[136:137], v5 offset:0
    v_cvt_pk_bf16_f32 v165, v154, v155
    v_mfma_f32_16x16x32_bf16 v[72:75], v[200:203], v[108:111], v[72:75]
    ds_read_b64_tr_b16 v[138:139], v5 offset:512
    v_cvt_pk_bf16_f32 v166, v156, v157
    v_cvt_pk_bf16_f32 v167, v158, v159
    v_accvgpr_read_b32 v144, a208
    v_mfma_f32_16x16x32_bf16 v[76:79], v[196:199], v[104:107], v[76:79]
    buffer_load_dwordx4 v14, s[80:83], s10 offen offset:2048 lds
    v_mfma_f32_16x16x32_bf16 v[76:79], v[204:207], v[108:111], v[76:79]
    ds_read_b64_tr_b16 v[140:141], v5 offset:4096
    ds_read_b64_tr_b16 v[142:143], v5 offset:4608
    v_accvgpr_read_b32 v145, a209
    v_mfma_f32_16x16x32_bf16 v[80:83], v[192:195], v[112:115], v[80:83]
    ds_read_b64_tr_b16 v[96:97], v6 offset:0
    v_accvgpr_read_b32 v146, a210
    v_accvgpr_read_b32 v147, a211
    v_mfma_f32_16x16x32_bf16 v[80:83], v[200:203], v[116:119], v[80:83]
    ds_read_b64_tr_b16 v[98:99], v6 offset:512
    v_accvgpr_read_b32 v148, a212
    v_accvgpr_read_b32 v149, a213
    v_accvgpr_read_b32 v150, a214
    v_mfma_f32_16x16x32_bf16 v[84:87], v[196:199], v[112:115], v[84:87]
    buffer_load_dwordx4 v[188:191], v24, s[64:67], s97 offen offset:2304 sc1
    v_mfma_f32_16x16x32_bf16 v[84:87], v[204:207], v[116:119], v[84:87]
    s_waitcnt lgkmcnt(6)
    ds_read_b64_tr_b16 v[100:101], v6 offset:4096
    ds_read_b64_tr_b16 v[102:103], v6 offset:4608
    v_accvgpr_read_b32 v151, a215
    v_mfma_f32_16x16x32_bf16 v[88:91], v[192:195], v[120:123], v[88:91]
    ds_read_b64_tr_b16 v[104:105], v7 offset:0
    v_accvgpr_read_b32 v152, a216
    v_accvgpr_read_b32 v153, a217
    v_mfma_f32_16x16x32_bf16 v[88:91], v[200:203], v[124:127], v[88:91]
    ds_read_b64_tr_b16 v[106:107], v7 offset:512
    v_accvgpr_read_b32 v154, a218
    v_accvgpr_read_b32 v155, a219
    v_accvgpr_read_b32 v156, a220
    v_mfma_f32_16x16x32_bf16 v[92:95], v[196:199], v[120:123], v[92:95]
    buffer_load_dwordx4 v15, s[80:83], s10 offen offset:3072 lds
    v_mfma_f32_16x16x32_bf16 v[92:95], v[204:207], v[124:127], v[92:95]
    ds_read_b64_tr_b16 v[108:109], v7 offset:4096
    ds_read_b64_tr_b16 v[110:111], v7 offset:4608
    v_accvgpr_read_b32 v157, a221
    v_accvgpr_read_b32 v158, a222
    s_waitcnt vmcnt(34)
    v_mfma_f32_16x16x32_bf16 v[32:35], v[128:131], v[208:211], v[32:35]
    ds_read_b64_tr_b16 v[112:113], v4 offset:8192
    v_accvgpr_read_b32 v159, a223
    s_waitcnt vmcnt(32)
    v_mfma_f32_16x16x32_bf16 v[32:35], v[132:135], v[216:219], v[32:35]
    s_mov_b32 s97, 0x6000
    ds_read_b64_tr_b16 v[114:115], v4 offset:8704
    v_cvt_pk_bf16_f32 v168, v144, v145
    v_cvt_pk_bf16_f32 v169, v146, v147
    v_cvt_pk_bf16_f32 v170, v148, v149
    v_mfma_f32_16x16x32_bf16 v[40:43], v[128:131], v[212:215], v[40:43]
    buffer_load_dwordx4 v[192:195], v24, s[64:67], s97 offen sc1
    s_waitcnt vmcnt(32)
    v_mfma_f32_16x16x32_bf16 v[40:43], v[132:135], v[220:223], v[40:43]
    s_waitcnt lgkmcnt(6)
    ds_read_b64_tr_b16 v[116:117], v4 offset:12288
    ds_read_b64_tr_b16 v[118:119], v4 offset:12800
    v_cvt_pk_bf16_f32 v171, v150, v151
    v_cvt_pk_bf16_f32 v172, v152, v153
    v_mfma_f32_16x16x32_bf16 v[36:39], v[136:139], v[208:211], v[36:39]
    ds_read_b64_tr_b16 v[120:121], v5 offset:8192
    v_cvt_pk_bf16_f32 v173, v154, v155
    v_mfma_f32_16x16x32_bf16 v[36:39], v[140:143], v[216:219], v[36:39]
    ds_read_b64_tr_b16 v[122:123], v5 offset:8704
    v_cvt_pk_bf16_f32 v174, v156, v157
    v_cvt_pk_bf16_f32 v175, v158, v159
    v_mfma_f32_16x16x32_bf16 v[44:47], v[136:139], v[212:215], v[44:47]
    buffer_store_dwordx4 v[164:167], v26, s[88:91], s13 offen offset:3072 sc1
    ds_read_b64_tr_b16 v[124:125], v5 offset:12288
    v_accvgpr_write_b32 a200, v168
    v_accvgpr_write_b32 a201, v169
    v_mfma_f32_16x16x32_bf16 v[44:47], v[140:143], v[220:223], v[44:47]
    ds_read_b64_tr_b16 v[126:127], v5 offset:12800
    v_accvgpr_write_b32 a202, v170
    v_mfma_f32_16x16x32_bf16 v[48:51], v[96:99], v[208:211], v[48:51]
    ds_read_b64_tr_b16 v[128:129], v6 offset:8192
    v_accvgpr_write_b32 a203, v171
    v_mfma_f32_16x16x32_bf16 v[48:51], v[100:103], v[216:219], v[48:51]
    ds_read_b64_tr_b16 v[130:131], v6 offset:8704
    v_accvgpr_write_b32 a204, v172
    v_accvgpr_write_b32 a205, v173
    v_accvgpr_write_b32 a206, v174
    v_mfma_f32_16x16x32_bf16 v[56:59], v[96:99], v[212:215], v[56:59]
    buffer_load_dwordx4 v[196:199], v24, s[64:67], s97 offen offset:256 sc1
    v_mfma_f32_16x16x32_bf16 v[56:59], v[100:103], v[220:223], v[56:59]
    s_waitcnt lgkmcnt(6)
    ds_read_b64_tr_b16 v[132:133], v6 offset:12288
    ds_read_b64_tr_b16 v[134:135], v6 offset:12800
    v_accvgpr_write_b32 a207, v175
    v_mfma_f32_16x16x32_bf16 v[52:55], v[104:107], v[208:211], v[52:55]
    ds_read_b64_tr_b16 v[136:137], v7 offset:8192
    v_accvgpr_read_b32 v144, a160
    v_accvgpr_read_b32 v145, a161
    v_mfma_f32_16x16x32_bf16 v[52:55], v[108:111], v[216:219], v[52:55]
    ds_read_b64_tr_b16 v[138:139], v7 offset:8704
    v_accvgpr_read_b32 v146, a162
    v_mfma_f32_16x16x32_bf16 v[60:63], v[104:107], v[212:215], v[60:63]
    ds_read_b64_tr_b16 v[140:141], v7 offset:12288
    v_accvgpr_read_b32 v147, a163
    v_accvgpr_read_b32 v148, a164
    v_mfma_f32_16x16x32_bf16 v[60:63], v[108:111], v[220:223], v[60:63]
    ds_read_b64_tr_b16 v[142:143], v7 offset:12800
    v_accvgpr_read_b32 v149, a165
    v_accvgpr_read_b32 v150, a166
    v_mfma_f32_16x16x32_bf16 v[64:67], v[208:211], v[112:115], v[64:67]
    ds_read_b64_tr_b16 v[96:97], v4 offset:16384
    v_accvgpr_read_b32 v151, a167
    v_mfma_f32_16x16x32_bf16 v[64:67], v[216:219], v[116:119], v[64:67]
    ds_read_b64_tr_b16 v[98:99], v4 offset:16896
    v_accvgpr_read_b32 v152, a168
    v_accvgpr_read_b32 v153, a169
    v_accvgpr_read_b32 v154, a170
    v_mfma_f32_16x16x32_bf16 v[68:71], v[212:215], v[112:115], v[68:71]
    buffer_load_dwordx4 v[200:203], v24, s[64:67], s97 offen offset:2048 sc1
    v_mfma_f32_16x16x32_bf16 v[68:71], v[220:223], v[116:119], v[68:71]
    s_waitcnt lgkmcnt(6)
    ds_read_b64_tr_b16 v[100:101], v4 offset:20480
    ds_read_b64_tr_b16 v[102:103], v4 offset:20992
    v_accvgpr_read_b32 v155, a171
    v_accvgpr_read_b32 v156, a172
    v_mfma_f32_16x16x32_bf16 v[72:75], v[208:211], v[120:123], v[72:75]
    ds_read_b64_tr_b16 v[104:105], v5 offset:16384
    v_accvgpr_read_b32 v157, a173
    v_mfma_f32_16x16x32_bf16 v[72:75], v[216:219], v[124:127], v[72:75]
    ds_read_b64_tr_b16 v[106:107], v5 offset:16896
    v_accvgpr_read_b32 v158, a174
    v_accvgpr_read_b32 v159, a175
    v_mfma_f32_16x16x32_bf16 v[76:79], v[212:215], v[120:123], v[76:79]
    ds_read_b64_tr_b16 v[108:109], v5 offset:20480
    v_cvt_pk_bf16_f32 v160, v144, v145
    v_cvt_pk_bf16_f32 v161, v146, v147
    v_cvt_pk_bf16_f32 v162, v148, v149
    v_cvt_pk_bf16_f32 v163, v150, v151
    v_mfma_f32_16x16x32_bf16 v[76:79], v[220:223], v[124:127], v[76:79]
    s_mov_b32 s13, 0x2000
    ds_read_b64_tr_b16 v[110:111], v5 offset:20992
    v_mfma_f32_16x16x32_bf16 v[80:83], v[208:211], v[128:131], v[80:83]
    buffer_store_dwordx4 v[160:163], v26, s[88:91], s13 offen sc1
    ds_read_b64_tr_b16 v[112:113], v6 offset:16384
    v_cvt_pk_bf16_f32 v164, v152, v153
    v_cvt_pk_bf16_f32 v165, v154, v155
    v_mfma_f32_16x16x32_bf16 v[80:83], v[216:219], v[132:135], v[80:83]
    ds_read_b64_tr_b16 v[114:115], v6 offset:16896
    v_cvt_pk_bf16_f32 v166, v156, v157
    v_mfma_f32_16x16x32_bf16 v[84:87], v[212:215], v[128:131], v[84:87]
    buffer_load_dword v3, v2, s[28:31], 0 offen sc1
    v_cvt_pk_bf16_f32 v167, v158, v159
    v_mfma_f32_16x16x32_bf16 v[84:87], v[220:223], v[132:135], v[84:87]
    s_waitcnt lgkmcnt(6)
    buffer_load_dwordx4 v[204:207], v24, s[64:67], s97 offen offset:2304 sc1
    v_mfma_f32_16x16x32_bf16 v[88:91], v[208:211], v[136:139], v[88:91]
    ds_read_b64_tr_b16 v[116:117], v6 offset:20480
    ds_read_b64_tr_b16 v[118:119], v6 offset:20992
    v_accvgpr_read_b32 v144, a224
    v_accvgpr_read_b32 v145, a225
    v_mfma_f32_16x16x32_bf16 v[88:91], v[216:219], v[140:143], v[88:91]
    ds_read_b64_tr_b16 v[120:121], v7 offset:16384
    v_accvgpr_read_b32 v146, a226
    v_mfma_f32_16x16x32_bf16 v[92:95], v[212:215], v[136:139], v[92:95]
    ds_read_b64_tr_b16 v[122:123], v7 offset:16896
    v_accvgpr_read_b32 v147, a227
    v_accvgpr_read_b32 v148, a228
    v_mfma_f32_16x16x32_bf16 v[92:95], v[220:223], v[140:143], v[92:95]
    ds_read_b64_tr_b16 v[124:125], v7 offset:20480
    v_accvgpr_read_b32 v149, a229
    s_waitcnt vmcnt(37)
    v_mfma_f32_16x16x32_bf16 v[32:35], v[96:99], v[224:227], v[32:35]
    ds_read_b64_tr_b16 v[126:127], v7 offset:20992
    v_accvgpr_read_b32 v150, a230
    v_accvgpr_read_b32 v151, a231
    s_waitcnt vmcnt(35)
    v_mfma_f32_16x16x32_bf16 v[32:35], v[100:103], v[232:235], v[32:35]
    s_mov_b32 s97, 0x7000
    ds_read_b64_tr_b16 v[128:129], v4 offset:24576
    v_accvgpr_read_b32 v152, a232
    v_accvgpr_read_b32 v153, a233
    v_accvgpr_read_b32 v154, a234
    v_mfma_f32_16x16x32_bf16 v[40:43], v[96:99], v[228:231], v[40:43]
    buffer_load_dwordx4 v[208:211], v24, s[64:67], s97 offen sc1
    s_waitcnt vmcnt(32)
    v_mfma_f32_16x16x32_bf16 v[40:43], v[100:103], v[236:239], v[40:43]
    s_waitcnt lgkmcnt(7)
    ds_read_b64_tr_b16 v[130:131], v4 offset:25088
    ds_read_b64_tr_b16 v[132:133], v4 offset:28672
    v_accvgpr_read_b32 v155, a235
    v_accvgpr_read_b32 v156, a236
    v_mfma_f32_16x16x32_bf16 v[36:39], v[104:107], v[224:227], v[36:39]
    ds_read_b64_tr_b16 v[134:135], v4 offset:29184
    v_accvgpr_read_b32 v157, a237
    v_mfma_f32_16x16x32_bf16 v[36:39], v[108:111], v[232:235], v[36:39]
    ds_read_b64_tr_b16 v[136:137], v5 offset:24576
    v_accvgpr_read_b32 v158, a238
    v_accvgpr_read_b32 v159, a239
    v_mfma_f32_16x16x32_bf16 v[44:47], v[104:107], v[228:231], v[44:47]
    ds_read_b64_tr_b16 v[138:139], v5 offset:25088
    v_cvt_pk_bf16_f32 v168, v144, v145
    v_mfma_f32_16x16x32_bf16 v[44:47], v[108:111], v[236:239], v[44:47]
    ds_read_b64_tr_b16 v[140:141], v5 offset:28672
    v_cvt_pk_bf16_f32 v169, v146, v147
    v_cvt_pk_bf16_f32 v170, v148, v149
    v_mfma_f32_16x16x32_bf16 v[48:51], v[112:115], v[224:227], v[48:51]
    s_waitcnt lgkmcnt(7)
    ds_read_b64_tr_b16 v[142:143], v5 offset:29184
    v_cvt_pk_bf16_f32 v171, v150, v151
    v_mfma_f32_16x16x32_bf16 v[48:51], v[116:119], v[232:235], v[48:51]
    ds_read_b64_tr_b16 v[96:97], v6 offset:24576
    v_cvt_pk_bf16_f32 v172, v152, v153
    v_cvt_pk_bf16_f32 v173, v154, v155
    v_cvt_pk_bf16_f32 v174, v156, v157
    v_cvt_pk_bf16_f32 v175, v158, v159
    v_mfma_f32_16x16x32_bf16 v[56:59], v[112:115], v[228:231], v[56:59]
    buffer_load_dwordx4 v[212:215], v24, s[64:67], s97 offen offset:256 sc1
    v_mfma_f32_16x16x32_bf16 v[56:59], v[116:119], v[236:239], v[56:59]
    buffer_store_dwordx4 v[164:167], v26, s[88:91], s13 offen offset:1024 sc1
    ds_read_b64_tr_b16 v[98:99], v6 offset:25088
    ds_read_b64_tr_b16 v[100:101], v6 offset:28672
    v_accvgpr_write_b32 a208, v168
    v_mfma_f32_16x16x32_bf16 v[52:55], v[120:123], v[224:227], v[52:55]
    ds_read_b64_tr_b16 v[102:103], v6 offset:29184
    v_accvgpr_write_b32 a209, v169
    v_mfma_f32_16x16x32_bf16 v[52:55], v[124:127], v[232:235], v[52:55]
    ds_read_b64_tr_b16 v[104:105], v7 offset:24576
    v_accvgpr_write_b32 a210, v170
    v_mfma_f32_16x16x32_bf16 v[60:63], v[120:123], v[228:231], v[60:63]
    s_barrier
    ds_read_b64_tr_b16 v[106:107], v7 offset:25088
    v_accvgpr_write_b32 a211, v171
    v_accvgpr_write_b32 a212, v172
    v_mfma_f32_16x16x32_bf16 v[60:63], v[124:127], v[236:239], v[60:63]
    s_waitcnt lgkmcnt(7)
    ds_read_b64_tr_b16 v[108:109], v7 offset:28672
    v_accvgpr_write_b32 a213, v173
    v_mfma_f32_16x16x32_bf16 v[64:67], v[224:227], v[128:131], v[64:67]
    ds_read_b64_tr_b16 v[110:111], v7 offset:29184
    v_accvgpr_write_b32 a214, v174
    v_accvgpr_write_b32 a215, v175
    v_mfma_f32_16x16x32_bf16 v[64:67], v[232:235], v[132:135], v[64:67]
    ds_read_b64_tr_b16 v[112:113], v4 offset:32768
    v_accvgpr_read_b32 v144, a176
    v_mfma_f32_16x16x32_bf16 v[68:71], v[228:231], v[128:131], v[68:71]
    buffer_load_dwordx4 v[216:219], v24, s[64:67], s97 offen offset:2048 sc1
    v_accvgpr_read_b32 v145, a177
    v_accvgpr_read_b32 v146, a178
    v_mfma_f32_16x16x32_bf16 v[68:71], v[236:239], v[132:135], v[68:71]
    s_mov_b32 s10, 0x0
    s_xor_b32 m0, s14, 0x20000
    ds_read_b64_tr_b16 v[114:115], v4 offset:33280
    v_accvgpr_read_b32 v147, a179
    v_accvgpr_read_b32 v148, a180
    v_accvgpr_read_b32 v149, a181
    v_mfma_f32_16x16x32_bf16 v[72:75], v[224:227], v[136:139], v[72:75]
    s_waitcnt lgkmcnt(6)
    buffer_load_dwordx4 v8, s[48:51], s10 offen offset:0 lds
    v_mfma_f32_16x16x32_bf16 v[72:75], v[232:235], v[140:143], v[72:75]
    ds_read_b64_tr_b16 v[116:117], v4 offset:36864
    ds_read_b64_tr_b16 v[118:119], v4 offset:37376
    v_accvgpr_read_b32 v150, a182
    v_accvgpr_read_b32 v151, a183
    v_mfma_f32_16x16x32_bf16 v[76:79], v[228:231], v[136:139], v[76:79]
    ds_read_b64_tr_b16 v[120:121], v5 offset:32768
    v_accvgpr_read_b32 v152, a184
    v_mfma_f32_16x16x32_bf16 v[76:79], v[236:239], v[140:143], v[76:79]
    ds_read_b64_tr_b16 v[122:123], v5 offset:33280
    v_accvgpr_read_b32 v153, a185
    v_accvgpr_read_b32 v154, a186
    v_mfma_f32_16x16x32_bf16 v[80:83], v[224:227], v[96:99], v[80:83]
    ds_read_b64_tr_b16 v[124:125], v5 offset:36864
    v_accvgpr_read_b32 v155, a187
    v_mfma_f32_16x16x32_bf16 v[80:83], v[232:235], v[100:103], v[80:83]
    ds_read_b64_tr_b16 v[126:127], v5 offset:37376
    v_accvgpr_read_b32 v156, a188
    v_accvgpr_read_b32 v157, a189
    v_accvgpr_read_b32 v158, a190
    v_mfma_f32_16x16x32_bf16 v[84:87], v[228:231], v[96:99], v[84:87]
    buffer_load_dwordx4 v[220:223], v24, s[64:67], s97 offen offset:2304 sc1
    v_mfma_f32_16x16x32_bf16 v[84:87], v[236:239], v[100:103], v[84:87]
    s_waitcnt lgkmcnt(6)
    ds_read_b64_tr_b16 v[128:129], v6 offset:32768
    ds_read_b64_tr_b16 v[130:131], v6 offset:33280
    v_accvgpr_read_b32 v159, a191
    v_cvt_pk_bf16_f32 v160, v144, v145
    v_cvt_pk_bf16_f32 v161, v146, v147
    v_cvt_pk_bf16_f32 v162, v148, v149
    v_mfma_f32_16x16x32_bf16 v[88:91], v[224:227], v[104:107], v[88:91]
    buffer_load_dwordx4 v9, s[48:51], s10 offen offset:1024 lds
    v_mfma_f32_16x16x32_bf16 v[88:91], v[232:235], v[108:111], v[88:91]
    ds_read_b64_tr_b16 v[132:133], v6 offset:36864
    ds_read_b64_tr_b16 v[134:135], v6 offset:37376
    v_cvt_pk_bf16_f32 v163, v150, v151
    v_mfma_f32_16x16x32_bf16 v[92:95], v[228:231], v[104:107], v[92:95]
    buffer_store_dwordx4 v[160:163], v26, s[88:91], s13 offen offset:2048 sc1
    ds_read_b64_tr_b16 v[136:137], v7 offset:32768
    v_cvt_pk_bf16_f32 v164, v152, v153
    v_cvt_pk_bf16_f32 v165, v154, v155
    v_mfma_f32_16x16x32_bf16 v[92:95], v[236:239], v[108:111], v[92:95]
    ds_read_b64_tr_b16 v[138:139], v7 offset:33280
    v_cvt_pk_bf16_f32 v166, v156, v157
    s_waitcnt vmcnt(36)
    v_mfma_f32_16x16x32_bf16 v[32:35], v[112:115], v[240:243], v[32:35]
    ds_read_b64_tr_b16 v[140:141], v7 offset:36864
    v_cvt_pk_bf16_f32 v167, v158, v159
    s_waitcnt vmcnt(31) lgkmcnt(8)
    v_mfma_f32_16x16x32_bf16 v[32:35], v[116:119], v[248:251], v[32:35]
    s_mov_b32 s97, 0x8000
    ds_read_b64_tr_b16 v[142:143], v7 offset:37376
    v_accvgpr_read_b32 v144, a240
    v_accvgpr_read_b32 v145, a241
    v_accvgpr_read_b32 v146, a242
    v_mfma_f32_16x16x32_bf16 v[40:43], v[112:115], v[244:247], v[40:43]
    buffer_load_dwordx4 v[224:227], v24, s[64:67], s97 offen sc1
    s_waitcnt vmcnt(31)
    v_mfma_f32_16x16x32_bf16 v[40:43], v[116:119], v[252:255], v[40:43]
    ds_read_b64_tr_b16 v[96:97], v4 offset:40960
    ds_read_b64_tr_b16 v[98:99], v4 offset:41472
    v_accvgpr_read_b32 v147, a243
    v_accvgpr_read_b32 v148, a244
    v_accvgpr_read_b32 v149, a245
    v_mfma_f32_16x16x32_bf16 v[36:39], v[120:123], v[240:243], v[36:39]
    s_waitcnt lgkmcnt(8)
    buffer_load_dwordx4 v10, s[48:51], s10 offen offset:2048 lds
    v_mfma_f32_16x16x32_bf16 v[36:39], v[124:127], v[248:251], v[36:39]
    ds_read_b64_tr_b16 v[100:101], v4 offset:45056
    ds_read_b64_tr_b16 v[102:103], v4 offset:45568
    v_accvgpr_read_b32 v150, a246
    v_accvgpr_read_b32 v151, a247
    v_mfma_f32_16x16x32_bf16 v[44:47], v[120:123], v[244:247], v[44:47]
    ds_read_b64_tr_b16 v[104:105], v5 offset:40960
    v_accvgpr_read_b32 v152, a248
    v_mfma_f32_16x16x32_bf16 v[44:47], v[124:127], v[252:255], v[44:47]
    ds_read_b64_tr_b16 v[106:107], v5 offset:41472
    v_accvgpr_read_b32 v153, a249
    v_accvgpr_read_b32 v154, a250
    v_mfma_f32_16x16x32_bf16 v[48:51], v[128:131], v[240:243], v[48:51]
    s_waitcnt lgkmcnt(7)
    ds_read_b64_tr_b16 v[108:109], v5 offset:45056
    v_accvgpr_read_b32 v155, a251
    v_mfma_f32_16x16x32_bf16 v[48:51], v[132:135], v[248:251], v[48:51]
    ds_read_b64_tr_b16 v[110:111], v5 offset:45568
    v_accvgpr_read_b32 v156, a252
    v_accvgpr_read_b32 v157, a253
    v_accvgpr_read_b32 v158, a254
    v_mfma_f32_16x16x32_bf16 v[56:59], v[128:131], v[244:247], v[56:59]
    buffer_load_dwordx4 v[228:231], v24, s[64:67], s97 offen offset:256 sc1
    v_mfma_f32_16x16x32_bf16 v[56:59], v[132:135], v[252:255], v[56:59]
    ds_read_b64_tr_b16 v[112:113], v6 offset:40960
    ds_read_b64_tr_b16 v[114:115], v6 offset:41472
    v_accvgpr_read_b32 v159, a255
    v_cvt_pk_bf16_f32 v168, v144, v145
    v_cvt_pk_bf16_f32 v169, v146, v147
    v_mfma_f32_16x16x32_bf16 v[52:55], v[136:139], v[240:243], v[52:55]
    s_waitcnt lgkmcnt(8)
    buffer_load_dwordx4 v11, s[48:51], s10 offen offset:3072 lds
    v_mfma_f32_16x16x32_bf16 v[52:55], v[140:143], v[248:251], v[52:55]
    ds_read_b64_tr_b16 v[116:117], v6 offset:45056
    ds_read_b64_tr_b16 v[118:119], v6 offset:45568
    v_cvt_pk_bf16_f32 v170, v148, v149
    v_cvt_pk_bf16_f32 v171, v150, v151
    v_mfma_f32_16x16x32_bf16 v[60:63], v[136:139], v[244:247], v[60:63]
    ds_read_b64_tr_b16 v[120:121], v7 offset:40960
    v_cvt_pk_bf16_f32 v172, v152, v153
    v_cvt_pk_bf16_f32 v173, v154, v155
    v_mfma_f32_16x16x32_bf16 v[60:63], v[140:143], v[252:255], v[60:63]
    ds_read_b64_tr_b16 v[122:123], v7 offset:41472
    v_cvt_pk_bf16_f32 v174, v156, v157
    v_cvt_pk_bf16_f32 v175, v158, v159
    v_mfma_f32_16x16x32_bf16 v[64:67], v[240:243], v[96:99], v[64:67]
    s_waitcnt lgkmcnt(7)
    buffer_store_dwordx4 v[164:167], v26, s[88:91], s13 offen offset:3072 sc1
    ds_read_b64_tr_b16 v[124:125], v7 offset:45056
    v_accvgpr_write_b32 a216, v168
    v_accvgpr_write_b32 a217, v169
    v_mfma_f32_16x16x32_bf16 v[64:67], v[248:251], v[100:103], v[64:67]
    ds_read_b64_tr_b16 v[126:127], v7 offset:45568
    v_accvgpr_write_b32 a218, v170
    v_mfma_f32_16x16x32_bf16 v[68:71], v[244:247], v[96:99], v[68:71]
    buffer_load_dwordx4 v[232:235], v24, s[64:67], s97 offen offset:2048 sc1
    v_mfma_f32_16x16x32_bf16 v[68:71], v[252:255], v[100:103], v[68:71]
    s_mov_b32 s10, 0x80000
    s_xor_b32 m0, s14, 0x24000
    ds_read_b64_tr_b16 v[128:129], v4 offset:49152
    v_accvgpr_write_b32 a219, v171
    v_accvgpr_write_b32 a220, v172
    v_accvgpr_write_b32 a221, v173
    v_mfma_f32_16x16x32_bf16 v[72:75], v[240:243], v[104:107], v[72:75]
    s_waitcnt lgkmcnt(7)
    buffer_load_dwordx4 v8, s[48:51], s10 offen offset:0 lds
    v_mfma_f32_16x16x32_bf16 v[72:75], v[248:251], v[108:111], v[72:75]
    ds_read_b64_tr_b16 v[130:131], v4 offset:49664
    ds_read_b64_tr_b16 v[132:133], v4 offset:53248
    v_accvgpr_write_b32 a222, v174
    v_mfma_f32_16x16x32_bf16 v[76:79], v[244:247], v[104:107], v[76:79]
    ds_read_b64_tr_b16 v[134:135], v4 offset:53760
    v_accvgpr_write_b32 a223, v175
    v_accvgpr_read_b32 v144, a0
    v_mfma_f32_16x16x32_bf16 v[76:79], v[252:255], v[108:111], v[76:79]
    ds_read_b64_tr_b16 v[136:137], v5 offset:49152
    v_accvgpr_read_b32 v145, a1
    v_accvgpr_read_b32 v146, a2
    v_mfma_f32_16x16x32_bf16 v[80:83], v[240:243], v[112:115], v[80:83]
    s_waitcnt lgkmcnt(6)
    ds_read_b64_tr_b16 v[138:139], v5 offset:49664
    v_accvgpr_read_b32 v147, a3
    v_mfma_f32_16x16x32_bf16 v[80:83], v[248:251], v[116:119], v[80:83]
    ds_read_b64_tr_b16 v[140:141], v5 offset:53248
    ds_read_b64_tr_b16 v[142:143], v5 offset:53760
    ds_read_b64_tr_b16 v[96:97], v6 offset:49152
    v_accvgpr_read_b32 v148, a4
    v_accvgpr_read_b32 v149, a5
    v_accvgpr_read_b32 v150, a6
    v_mfma_f32_16x16x32_bf16 v[84:87], v[244:247], v[112:115], v[84:87]
    buffer_load_dwordx4 v[236:239], v24, s[64:67], s97 offen offset:2304 sc1
    v_mfma_f32_16x16x32_bf16 v[84:87], v[252:255], v[116:119], v[84:87]
    ds_read_b64_tr_b16 v[98:99], v6 offset:49664
    ds_read_b64_tr_b16 v[100:101], v6 offset:53248
    v_accvgpr_read_b32 v151, a7
    v_accvgpr_read_b32 v152, a8
    v_accvgpr_read_b32 v153, a9
    v_mfma_f32_16x16x32_bf16 v[88:91], v[240:243], v[120:123], v[88:91]
    s_waitcnt lgkmcnt(10)
    buffer_load_dwordx4 v9, s[48:51], s10 offen offset:1024 lds
    v_mfma_f32_16x16x32_bf16 v[88:91], v[248:251], v[124:127], v[88:91]
    ds_read_b64_tr_b16 v[102:103], v6 offset:53760
    ds_read_b64_tr_b16 v[104:105], v7 offset:49152
    v_accvgpr_read_b32 v154, a10
    v_accvgpr_read_b32 v155, a11
    v_mfma_f32_16x16x32_bf16 v[92:95], v[244:247], v[120:123], v[92:95]
    ds_read_b64_tr_b16 v[106:107], v7 offset:49664
    v_accvgpr_read_b32 v156, a12
    v_mfma_f32_16x16x32_bf16 v[92:95], v[252:255], v[124:127], v[92:95]
    ds_read_b64_tr_b16 v[108:109], v7 offset:53248
    v_accvgpr_read_b32 v157, a13
    v_accvgpr_read_b32 v158, a14
    s_waitcnt vmcnt(32) lgkmcnt(10)
    v_mfma_f32_16x16x32_bf16 v[32:35], v[128:131], v[176:179], v[32:35]
    ds_read_b64_tr_b16 v[110:111], v7 offset:53760
    v_accvgpr_read_b32 v159, a15
    v_cvt_pk_bf16_f32 v160, v144, v145
    s_waitcnt vmcnt(28)
    v_mfma_f32_16x16x32_bf16 v[32:35], v[132:135], v[184:187], v[32:35]
    s_mov_b32 s97, 0x9000
    ds_read_b64_tr_b16 v[112:113], v4 offset:57344
    v_cvt_pk_bf16_f32 v161, v146, v147
    v_cvt_pk_bf16_f32 v162, v148, v149
    v_cvt_pk_bf16_f32 v163, v150, v151
    v_mfma_f32_16x16x32_bf16 v[40:43], v[128:131], v[180:183], v[40:43]
    s_mov_b32 s13, 0x0
    buffer_load_dwordx4 v[240:243], v24, s[64:67], s97 offen sc1
    s_waitcnt vmcnt(26)
    v_mfma_f32_16x16x32_bf16 v[40:43], v[132:135], v[188:191], v[40:43]
    s_waitcnt lgkmcnt(6)
    buffer_store_dwordx4 v[160:163], v25, s[84:87], s13 offen sc1
    ds_read_b64_tr_b16 v[114:115], v4 offset:57856
    ds_read_b64_tr_b16 v[116:117], v4 offset:61440
    v_cvt_pk_bf16_f32 v164, v152, v153
    v_cvt_pk_bf16_f32 v165, v154, v155
    v_mfma_f32_16x16x32_bf16 v[36:39], v[136:139], v[176:179], v[36:39]
    buffer_load_dwordx4 v10, s[48:51], s10 offen offset:2048 lds
    v_mfma_f32_16x16x32_bf16 v[36:39], v[140:143], v[184:187], v[36:39]
    ds_read_b64_tr_b16 v[118:119], v4 offset:61952
    ds_read_b64_tr_b16 v[120:121], v5 offset:57344
    v_cvt_pk_bf16_f32 v166, v156, v157
    v_mfma_f32_16x16x32_bf16 v[44:47], v[136:139], v[180:183], v[44:47]
    ds_read_b64_tr_b16 v[122:123], v5 offset:57856
    v_cvt_pk_bf16_f32 v167, v158, v159
    v_accvgpr_read_b32 v144, a64
    v_mfma_f32_16x16x32_bf16 v[44:47], v[140:143], v[188:191], v[44:47]
    s_mov_b32 s98, 0x0
    ds_read_b64_tr_b16 v[124:125], v5 offset:61440
    v_accvgpr_read_b32 v145, a65
    v_accvgpr_read_b32 v146, a66
    v_accvgpr_read_b32 v147, a67
    v_mfma_f32_16x16x32_bf16 v[48:51], v[96:99], v[176:179], v[48:51]
    s_waitcnt lgkmcnt(7)
    buffer_load_dwordx4 a[128:131], v22, s[64:67], s98 offen sc1
    v_mfma_f32_16x16x32_bf16 v[48:51], v[100:103], v[184:187], v[48:51]
    ds_read_b64_tr_b16 v[126:127], v5 offset:61952
    ds_read_b64_tr_b16 v[128:129], v6 offset:57344
    v_accvgpr_read_b32 v148, a68
    v_accvgpr_read_b32 v149, a69
    v_accvgpr_read_b32 v150, a70
    v_mfma_f32_16x16x32_bf16 v[56:59], v[96:99], v[180:183], v[56:59]
    buffer_load_dwordx4 v[244:247], v24, s[64:67], s97 offen offset:256 sc1
    v_mfma_f32_16x16x32_bf16 v[56:59], v[100:103], v[188:191], v[56:59]
    ds_read_b64_tr_b16 v[130:131], v6 offset:57856
    ds_read_b64_tr_b16 v[132:133], v6 offset:61440
    v_accvgpr_read_b32 v151, a71
    v_accvgpr_read_b32 v152, a72
    v_accvgpr_read_b32 v153, a73
    v_mfma_f32_16x16x32_bf16 v[52:55], v[104:107], v[176:179], v[52:55]
    buffer_load_dwordx4 v11, s[48:51], s10 offen offset:3072 lds
    v_mfma_f32_16x16x32_bf16 v[52:55], v[108:111], v[184:187], v[52:55]
    ds_read_b64_tr_b16 v[134:135], v6 offset:61952
    ds_read_b64_tr_b16 v[136:137], v7 offset:57344
    v_accvgpr_read_b32 v154, a74
    v_accvgpr_read_b32 v155, a75
    v_mfma_f32_16x16x32_bf16 v[60:63], v[104:107], v[180:183], v[60:63]
    s_waitcnt vmcnt(30)
    s_barrier
    ds_read_b64_tr_b16 v[138:139], v7 offset:57856
    v_accvgpr_read_b32 v156, a76
    v_mfma_f32_16x16x32_bf16 v[60:63], v[108:111], v[188:191], v[60:63]
    s_waitcnt lgkmcnt(7)
    ds_read_b64_tr_b16 v[140:141], v7 offset:61440
    ds_read_b64_tr_b16 v[142:143], v7 offset:61952
    v_xor_b32 v4, 0x10000, v4
    v_xor_b32 v5, 0x10000, v5
    v_xor_b32 v6, 0x10000, v6
    v_xor_b32 v7, 0x10000, v7
    v_accvgpr_read_b32 v157, a77
    v_accvgpr_read_b32 v158, a78
    v_accvgpr_read_b32 v159, a79
    v_mfma_f32_16x16x32_bf16 v[64:67], v[176:179], v[112:115], v[64:67]
    buffer_load_dwordx4 a[132:135], v23, s[64:67], s98 offen sc1
    v_mfma_f32_16x16x32_bf16 v[64:67], v[184:187], v[116:119], v[64:67]
    ds_read_b64_tr_b16 v[96:97], v4 offset:32768
    ds_read_b64_tr_b16 v[98:99], v4 offset:33280
    v_cvt_pk_bf16_f32 v168, v144, v145
    v_cvt_pk_bf16_f32 v169, v146, v147
    v_cvt_pk_bf16_f32 v170, v148, v149
    v_mfma_f32_16x16x32_bf16 v[68:71], v[180:183], v[112:115], v[68:71]
    buffer_load_dwordx4 v[248:251], v24, s[64:67], s97 offen offset:2048 sc1
    v_mfma_f32_16x16x32_bf16 v[68:71], v[188:191], v[116:119], v[68:71]
    ds_read_b64_tr_b16 v[100:101], v4 offset:36864
    ds_read_b64_tr_b16 v[102:103], v4 offset:37376
    v_cvt_pk_bf16_f32 v171, v150, v151
    v_cvt_pk_bf16_f32 v172, v152, v153
    v_mfma_f32_16x16x32_bf16 v[72:75], v[176:179], v[120:123], v[72:75]
    s_waitcnt lgkmcnt(9)
    ds_read_b64_tr_b16 v[104:105], v5 offset:32768
    v_cvt_pk_bf16_f32 v173, v154, v155
    v_mfma_f32_16x16x32_bf16 v[72:75], v[184:187], v[124:127], v[72:75]
    ds_read_b64_tr_b16 v[106:107], v5 offset:33280
    v_cvt_pk_bf16_f32 v174, v156, v157
    v_cvt_pk_bf16_f32 v175, v158, v159
    v_mfma_f32_16x16x32_bf16 v[76:79], v[180:183], v[120:123], v[76:79]
    buffer_store_dwordx4 v[164:167], v25, s[84:87], s13 offen offset:1024 sc1
    ds_read_b64_tr_b16 v[108:109], v5 offset:36864
    v_accvgpr_write_b32 a224, v168
    v_accvgpr_write_b32 a225, v169
    v_mfma_f32_16x16x32_bf16 v[76:79], v[188:191], v[124:127], v[76:79]
    ds_read_b64_tr_b16 v[110:111], v5 offset:37376
    v_accvgpr_write_b32 a226, v170
    v_accvgpr_write_b32 a227, v171
    v_mfma_f32_16x16x32_bf16 v[80:83], v[176:179], v[128:131], v[80:83]
    s_waitcnt lgkmcnt(8)
    buffer_load_dwordx4 a[136:139], v22, s[64:67], s98 offen offset:128 sc1
    v_mfma_f32_16x16x32_bf16 v[80:83], v[184:187], v[132:135], v[80:83]
    ds_read_b64_tr_b16 v[112:113], v6 offset:32768
    ds_read_b64_tr_b16 v[114:115], v6 offset:33280
    v_accvgpr_write_b32 a228, v172
    v_accvgpr_write_b32 a229, v173
    v_accvgpr_write_b32 a230, v174
    v_mfma_f32_16x16x32_bf16 v[84:87], v[180:183], v[128:131], v[84:87]
    buffer_load_dwordx4 v[252:255], v24, s[64:67], s97 offen offset:2304 sc1
    v_mfma_f32_16x16x32_bf16 v[84:87], v[188:191], v[132:135], v[84:87]
    ds_read_b64_tr_b16 v[116:117], v6 offset:36864
    ds_read_b64_tr_b16 v[118:119], v6 offset:37376
    v_accvgpr_write_b32 a231, v175
    v_mfma_f32_16x16x32_bf16 v[88:91], v[176:179], v[136:139], v[88:91]
    ds_read_b64_tr_b16 v[120:121], v7 offset:32768
    v_accvgpr_read_b32 v144, a16
    v_accvgpr_read_b32 v145, a17
    v_mfma_f32_16x16x32_bf16 v[88:91], v[184:187], v[140:143], v[88:91]
    ds_read_b64_tr_b16 v[122:123], v7 offset:33280
    v_accvgpr_read_b32 v146, a18
    v_mfma_f32_16x16x32_bf16 v[92:95], v[180:183], v[136:139], v[92:95]
    ds_read_b64_tr_b16 v[124:125], v7 offset:36864
    v_accvgpr_read_b32 v147, a19
    v_accvgpr_read_b32 v148, a20
    v_mfma_f32_16x16x32_bf16 v[92:95], v[188:191], v[140:143], v[92:95]
    ds_read_b64_tr_b16 v[126:127], v7 offset:37376
    v_accvgpr_read_b32 v149, a21
    v_accvgpr_read_b32 v150, a22
    v_accvgpr_read_b32 v151, a23
    s_waitcnt vmcnt(34) lgkmcnt(8)
    v_mfma_f32_16x16x32_bf16 v[32:35], v[96:99], v[192:195], v[32:35]
    buffer_load_dwordx4 a[140:143], v21, s[64:67], s98 offen offset:128 sc1
    s_waitcnt vmcnt(32)
    v_mfma_f32_16x16x32_bf16 v[32:35], v[100:103], v[200:203], v[32:35]
    ds_read_b64_tr_b16 v[128:129], v4 offset:40960
    ds_read_b64_tr_b16 v[130:131], v4 offset:41472
    v_accvgpr_read_b32 v152, a24
    v_accvgpr_read_b32 v153, a25
    v_mfma_f32_16x16x32_bf16 v[40:43], v[96:99], v[196:199], v[40:43]
    ds_read_b64_tr_b16 v[132:133], v4 offset:45056
    v_accvgpr_read_b32 v154, a26
    s_waitcnt vmcnt(29)
    v_mfma_f32_16x16x32_bf16 v[40:43], v[100:103], v[204:207], v[40:43]
    ds_read_b64_tr_b16 v[134:135], v4 offset:45568
    v_accvgpr_read_b32 v155, a27
    v_accvgpr_read_b32 v156, a28
    v_mfma_f32_16x16x32_bf16 v[36:39], v[104:107], v[192:195], v[36:39]
    ds_read_b64_tr_b16 v[136:137], v5 offset:40960
    v_accvgpr_read_b32 v157, a29
    v_mfma_f32_16x16x32_bf16 v[36:39], v[108:111], v[200:203], v[36:39]
    ds_read_b64_tr_b16 v[138:139], v5 offset:41472
    v_accvgpr_read_b32 v158, a30
    v_accvgpr_read_b32 v159, a31
    v_mfma_f32_16x16x32_bf16 v[44:47], v[104:107], v[196:199], v[44:47]
    ds_read_b64_tr_b16 v[140:141], v5 offset:45056
    v_cvt_pk_bf16_f32 v160, v144, v145
    v_mfma_f32_16x16x32_bf16 v[44:47], v[108:111], v[204:207], v[44:47]
    s_waitcnt lgkmcnt(7)
    ds_read_b64_tr_b16 v[142:143], v5 offset:45568
    v_cvt_pk_bf16_f32 v161, v146, v147
    v_cvt_pk_bf16_f32 v162, v148, v149
    v_cvt_pk_bf16_f32 v163, v150, v151
    v_mfma_f32_16x16x32_bf16 v[48:51], v[112:115], v[192:195], v[48:51]
    s_mov_b32 s13, 0x1000
    buffer_load_dwordx4 a[144:147], v22, s[64:67], s98 offen offset:2048 sc1
    v_mfma_f32_16x16x32_bf16 v[48:51], v[116:119], v[200:203], v[48:51]
    buffer_store_dwordx4 v[160:163], v25, s[84:87], s13 offen sc1
    ds_read_b64_tr_b16 v[96:97], v6 offset:40960
    ds_read_b64_tr_b16 v[98:99], v6 offset:41472
    v_cvt_pk_bf16_f32 v164, v152, v153
    v_mfma_f32_16x16x32_bf16 v[56:59], v[112:115], v[196:199], v[56:59]
    ds_read_b64_tr_b16 v[100:101], v6 offset:45056
    v_cvt_pk_bf16_f32 v165, v154, v155
    v_mfma_f32_16x16x32_bf16 v[56:59], v[116:119], v[204:207], v[56:59]
    ds_read_b64_tr_b16 v[102:103], v6 offset:45568
    v_cvt_pk_bf16_f32 v166, v156, v157
    v_cvt_pk_bf16_f32 v167, v158, v159
    v_mfma_f32_16x16x32_bf16 v[52:55], v[120:123], v[192:195], v[52:55]
    ds_read_b64_tr_b16 v[104:105], v7 offset:40960
    v_accvgpr_read_b32 v144, a80
    v_accvgpr_read_b32 v145, a81
    v_mfma_f32_16x16x32_bf16 v[52:55], v[124:127], v[200:203], v[52:55]
    ds_read_b64_tr_b16 v[106:107], v7 offset:41472
    v_accvgpr_read_b32 v146, a82
    v_mfma_f32_16x16x32_bf16 v[60:63], v[120:123], v[196:199], v[60:63]
    ds_read_b64_tr_b16 v[108:109], v7 offset:45056
    v_accvgpr_read_b32 v147, a83
    v_accvgpr_read_b32 v148, a84
    v_mfma_f32_16x16x32_bf16 v[60:63], v[124:127], v[204:207], v[60:63]
    s_waitcnt lgkmcnt(7)
    ds_read_b64_tr_b16 v[110:111], v7 offset:45568
    v_accvgpr_read_b32 v149, a85
    v_accvgpr_read_b32 v150, a86
    v_accvgpr_read_b32 v151, a87
    v_mfma_f32_16x16x32_bf16 v[64:67], v[192:195], v[128:131], v[64:67]
    buffer_load_dwordx4 a[148:151], v23, s[64:67], s98 offen offset:2048 sc1
    v_mfma_f32_16x16x32_bf16 v[64:67], v[200:203], v[132:135], v[64:67]
    ds_read_b64_tr_b16 v[112:113], v4 offset:49152
    ds_read_b64_tr_b16 v[114:115], v4 offset:49664
    v_accvgpr_read_b32 v152, a88
    v_mfma_f32_16x16x32_bf16 v[68:71], v[196:199], v[128:131], v[68:71]
    ds_read_b64_tr_b16 v[116:117], v4 offset:53248
    v_accvgpr_read_b32 v153, a89
    v_accvgpr_read_b32 v154, a90
    v_mfma_f32_16x16x32_bf16 v[68:71], v[204:207], v[132:135], v[68:71]
    ds_read_b64_tr_b16 v[118:119], v4 offset:53760
    v_accvgpr_read_b32 v155, a91
    v_mfma_f32_16x16x32_bf16 v[72:75], v[192:195], v[136:139], v[72:75]
    ds_read_b64_tr_b16 v[120:121], v5 offset:49152
    v_accvgpr_read_b32 v156, a92
    v_accvgpr_read_b32 v157, a93
    v_mfma_f32_16x16x32_bf16 v[72:75], v[200:203], v[140:143], v[72:75]
    ds_read_b64_tr_b16 v[122:123], v5 offset:49664
    v_accvgpr_read_b32 v158, a94
    v_mfma_f32_16x16x32_bf16 v[76:79], v[196:199], v[136:139], v[76:79]
    ds_read_b64_tr_b16 v[124:125], v5 offset:53248
    v_accvgpr_read_b32 v159, a95
    v_cvt_pk_bf16_f32 v168, v144, v145
    v_mfma_f32_16x16x32_bf16 v[76:79], v[204:207], v[140:143], v[76:79]
    s_waitcnt lgkmcnt(7)
    ds_read_b64_tr_b16 v[126:127], v5 offset:53760
    v_cvt_pk_bf16_f32 v169, v146, v147
    v_cvt_pk_bf16_f32 v170, v148, v149
    v_cvt_pk_bf16_f32 v171, v150, v151
    v_mfma_f32_16x16x32_bf16 v[80:83], v[192:195], v[96:99], v[80:83]
    buffer_load_dwordx4 a[152:155], v22, s[64:67], s98 offen offset:2176 sc1
    v_mfma_f32_16x16x32_bf16 v[80:83], v[200:203], v[100:103], v[80:83]
    ds_read_b64_tr_b16 v[128:129], v6 offset:49152
    ds_read_b64_tr_b16 v[130:131], v6 offset:49664
    v_cvt_pk_bf16_f32 v172, v152, v153
    v_cvt_pk_bf16_f32 v173, v154, v155
    v_mfma_f32_16x16x32_bf16 v[84:87], v[196:199], v[96:99], v[84:87]
    ds_read_b64_tr_b16 v[132:133], v6 offset:53248
    v_cvt_pk_bf16_f32 v174, v156, v157
    v_cvt_pk_bf16_f32 v175, v158, v159
    v_mfma_f32_16x16x32_bf16 v[84:87], v[204:207], v[100:103], v[84:87]
    buffer_store_dwordx4 v[164:167], v25, s[84:87], s13 offen offset:1024 sc1
    ds_read_b64_tr_b16 v[134:135], v6 offset:53760
    v_accvgpr_write_b32 a232, v168
    v_accvgpr_write_b32 a233, v169
    v_mfma_f32_16x16x32_bf16 v[88:91], v[192:195], v[104:107], v[88:91]
    ds_read_b64_tr_b16 v[136:137], v7 offset:49152
    v_accvgpr_write_b32 a234, v170
    v_mfma_f32_16x16x32_bf16 v[88:91], v[200:203], v[108:111], v[88:91]
    ds_read_b64_tr_b16 v[138:139], v7 offset:49664
    v_accvgpr_write_b32 a235, v171
    v_mfma_f32_16x16x32_bf16 v[92:95], v[196:199], v[104:107], v[92:95]
    ds_read_b64_tr_b16 v[140:141], v7 offset:53248
    v_accvgpr_write_b32 a236, v172
    v_mfma_f32_16x16x32_bf16 v[92:95], v[204:207], v[108:111], v[92:95]
    ds_read_b64_tr_b16 v[142:143], v7 offset:53760
    v_accvgpr_write_b32 a237, v173
    v_accvgpr_write_b32 a238, v174
    s_waitcnt vmcnt(33) lgkmcnt(8)
    v_mfma_f32_16x16x32_bf16 v[32:35], v[112:115], v[208:211], v[32:35]
    buffer_load_dwordx4 a[156:159], v21, s[64:67], s98 offen offset:2176 sc1
    s_waitcnt vmcnt(31)
    v_mfma_f32_16x16x32_bf16 v[32:35], v[116:119], v[216:219], v[32:35]
    ds_read_b64_tr_b16 v[96:97], v4 offset:57344
    ds_read_b64_tr_b16 v[98:99], v4 offset:57856
    v_accvgpr_write_b32 a239, v175
    v_accvgpr_read_b32 v144, a32
    v_mfma_f32_16x16x32_bf16 v[40:43], v[112:115], v[212:215], v[40:43]
    ds_read_b64_tr_b16 v[100:101], v4 offset:61440
    v_accvgpr_read_b32 v145, a33
    v_accvgpr_read_b32 v146, a34
    s_waitcnt vmcnt(29)
    v_mfma_f32_16x16x32_bf16 v[40:43], v[116:119], v[220:223], v[40:43]
    ds_read_b64_tr_b16 v[102:103], v4 offset:61952
    v_accvgpr_read_b32 v147, a35
    v_mfma_f32_16x16x32_bf16 v[36:39], v[120:123], v[208:211], v[36:39]
    ds_read_b64_tr_b16 v[104:105], v5 offset:57344
    v_accvgpr_read_b32 v148, a36
    v_accvgpr_read_b32 v149, a37
    v_mfma_f32_16x16x32_bf16 v[36:39], v[124:127], v[216:219], v[36:39]
    ds_read_b64_tr_b16 v[106:107], v5 offset:57856
    v_accvgpr_read_b32 v150, a38
    v_mfma_f32_16x16x32_bf16 v[44:47], v[120:123], v[212:215], v[44:47]
    s_waitcnt lgkmcnt(6)
    ds_read_b64_tr_b16 v[108:109], v5 offset:61440
    v_accvgpr_read_b32 v151, a39
    v_accvgpr_read_b32 v152, a40
    v_mfma_f32_16x16x32_bf16 v[44:47], v[124:127], v[220:223], v[44:47]
    s_mov_b32 s98, 0x1000
    ds_read_b64_tr_b16 v[110:111], v5 offset:61952
    v_accvgpr_read_b32 v153, a41
    v_accvgpr_read_b32 v154, a42
    v_accvgpr_read_b32 v155, a43
    v_mfma_f32_16x16x32_bf16 v[48:51], v[128:131], v[208:211], v[48:51]
    buffer_load_dwordx4 a[160:163], v22, s[64:67], s98 offen sc1
    v_mfma_f32_16x16x32_bf16 v[48:51], v[132:135], v[216:219], v[48:51]
    ds_read_b64_tr_b16 v[112:113], v6 offset:57344
    ds_read_b64_tr_b16 v[114:115], v6 offset:57856
    v_accvgpr_read_b32 v156, a44
    v_mfma_f32_16x16x32_bf16 v[56:59], v[128:131], v[212:215], v[56:59]
    ds_read_b64_tr_b16 v[116:117], v6 offset:61440
    v_accvgpr_read_b32 v157, a45
    v_accvgpr_read_b32 v158, a46
    v_mfma_f32_16x16x32_bf16 v[56:59], v[132:135], v[220:223], v[56:59]
    ds_read_b64_tr_b16 v[118:119], v6 offset:61952
    v_accvgpr_read_b32 v159, a47
    v_cvt_pk_bf16_f32 v160, v144, v145
    v_mfma_f32_16x16x32_bf16 v[52:55], v[136:139], v[208:211], v[52:55]
    ds_read_b64_tr_b16 v[120:121], v7 offset:57344
    v_cvt_pk_bf16_f32 v161, v146, v147
    v_cvt_pk_bf16_f32 v162, v148, v149
    v_cvt_pk_bf16_f32 v163, v150, v151
    v_mfma_f32_16x16x32_bf16 v[52:55], v[140:143], v[216:219], v[52:55]
    s_mov_b32 s13, 0x2000
    ds_read_b64_tr_b16 v[122:123], v7 offset:57856
    v_mfma_f32_16x16x32_bf16 v[60:63], v[136:139], v[212:215], v[60:63]
    s_barrier
    buffer_store_dwordx4 v[160:163], v25, s[84:87], s13 offen sc1
    ds_read_b64_tr_b16 v[124:125], v7 offset:61440
    v_cvt_pk_bf16_f32 v164, v152, v153
    v_cvt_pk_bf16_f32 v165, v154, v155
    v_mfma_f32_16x16x32_bf16 v[60:63], v[140:143], v[220:223], v[60:63]
    s_waitcnt lgkmcnt(7)
    ds_read_b64_tr_b16 v[126:127], v7 offset:61952
    v_cvt_pk_bf16_f32 v166, v156, v157
    v_mfma_f32_16x16x32_bf16 v[64:67], v[208:211], v[96:99], v[64:67]
    buffer_load_dwordx4 a[164:167], v23, s[64:67], s98 offen sc1
    v_mfma_f32_16x16x32_bf16 v[64:67], v[216:219], v[100:103], v[64:67]
    ds_read_b64_tr_b16 v[128:129], v4 offset:0
    ds_read_b64_tr_b16 v[130:131], v4 offset:512
    v_cvt_pk_bf16_f32 v167, v158, v159
    v_accvgpr_read_b32 v144, a96
    v_mfma_f32_16x16x32_bf16 v[68:71], v[212:215], v[96:99], v[68:71]
    ds_read_b64_tr_b16 v[132:133], v4 offset:4096
    v_accvgpr_read_b32 v145, a97
    v_mfma_f32_16x16x32_bf16 v[68:71], v[220:223], v[100:103], v[68:71]
    s_mov_b32 s10, 0x100000
    s_xor_b32 m0, s15, 0x18000
    ds_read_b64_tr_b16 v[134:135], v4 offset:4608
    v_accvgpr_read_b32 v146, a98
    v_accvgpr_read_b32 v147, a99
    v_accvgpr_read_b32 v148, a100
    v_mfma_f32_16x16x32_bf16 v[72:75], v[208:211], v[104:107], v[72:75]
    buffer_load_dwordx4 v8, s[48:51], s10 offen offset:0 lds
    v_mfma_f32_16x16x32_bf16 v[72:75], v[216:219], v[108:111], v[72:75]
    ds_read_b64_tr_b16 v[136:137], v5 offset:0
    ds_read_b64_tr_b16 v[138:139], v5 offset:512
    v_accvgpr_read_b32 v149, a101
    v_accvgpr_read_b32 v150, a102
    v_mfma_f32_16x16x32_bf16 v[76:79], v[212:215], v[104:107], v[76:79]
    ds_read_b64_tr_b16 v[140:141], v5 offset:4096
    v_accvgpr_read_b32 v151, a103
    v_accvgpr_read_b32 v152, a104
    v_mfma_f32_16x16x32_bf16 v[76:79], v[220:223], v[108:111], v[76:79]
    s_waitcnt lgkmcnt(7)
    ds_read_b64_tr_b16 v[142:143], v5 offset:4608
    v_accvgpr_read_b32 v153, a105
    v_accvgpr_read_b32 v154, a106
    v_accvgpr_read_b32 v155, a107
    v_mfma_f32_16x16x32_bf16 v[80:83], v[208:211], v[112:115], v[80:83]
    buffer_load_dwordx4 a[168:171], v22, s[64:67], s98 offen offset:128 sc1
    v_mfma_f32_16x16x32_bf16 v[80:83], v[216:219], v[116:119], v[80:83]
    ds_read_b64_tr_b16 v[96:97], v6 offset:0
    ds_read_b64_tr_b16 v[98:99], v6 offset:512
    v_accvgpr_read_b32 v156, a108
    v_mfma_f32_16x16x32_bf16 v[84:87], v[212:215], v[112:115], v[84:87]
    ds_read_b64_tr_b16 v[100:101], v6 offset:4096
    v_accvgpr_read_b32 v157, a109
    v_accvgpr_read_b32 v158, a110
    v_mfma_f32_16x16x32_bf16 v[84:87], v[220:223], v[116:119], v[84:87]
    ds_read_b64_tr_b16 v[102:103], v6 offset:4608
    v_accvgpr_read_b32 v159, a111
    v_cvt_pk_bf16_f32 v168, v144, v145
    v_cvt_pk_bf16_f32 v169, v146, v147
    v_mfma_f32_16x16x32_bf16 v[88:91], v[208:211], v[120:123], v[88:91]
    buffer_load_dwordx4 v9, s[48:51], s10 offen offset:1024 lds
    v_mfma_f32_16x16x32_bf16 v[88:91], v[216:219], v[124:127], v[88:91]
    ds_read_b64_tr_b16 v[104:105], v7 offset:0
    ds_read_b64_tr_b16 v[106:107], v7 offset:512
    v_cvt_pk_bf16_f32 v170, v148, v149
    v_mfma_f32_16x16x32_bf16 v[92:95], v[212:215], v[120:123], v[92:95]
    ds_read_b64_tr_b16 v[108:109], v7 offset:4096
    v_cvt_pk_bf16_f32 v171, v150, v151
    v_cvt_pk_bf16_f32 v172, v152, v153
    v_mfma_f32_16x16x32_bf16 v[92:95], v[220:223], v[124:127], v[92:95]
    ds_read_b64_tr_b16 v[110:111], v7 offset:4608
    v_cvt_pk_bf16_f32 v173, v154, v155
    v_cvt_pk_bf16_f32 v174, v156, v157
    v_cvt_pk_bf16_f32 v175, v158, v159
    s_waitcnt vmcnt(32) lgkmcnt(8)
    v_mfma_f32_16x16x32_bf16 v[32:35], v[128:131], v[224:227], v[32:35]
    buffer_load_dwordx4 a[172:175], v21, s[64:67], s98 offen offset:128 sc1
    s_waitcnt vmcnt(28)
    v_mfma_f32_16x16x32_bf16 v[32:35], v[132:135], v[232:235], v[32:35]
    buffer_store_dwordx4 v[164:167], v25, s[84:87], s13 offen offset:1024 sc1
    ds_read_b64_tr_b16 v[112:113], v4 offset:8192
    ds_read_b64_tr_b16 v[114:115], v4 offset:8704
    v_accvgpr_write_b32 a240, v168
    v_mfma_f32_16x16x32_bf16 v[40:43], v[128:131], v[228:231], v[40:43]
    ds_read_b64_tr_b16 v[116:117], v4 offset:12288
    v_accvgpr_write_b32 a241, v169
    s_waitcnt vmcnt(27)
    v_mfma_f32_16x16x32_bf16 v[40:43], v[132:135], v[236:239], v[40:43]
    ds_read_b64_tr_b16 v[118:119], v4 offset:12800
    v_accvgpr_write_b32 a242, v170
    v_accvgpr_write_b32 a243, v171
    v_accvgpr_write_b32 a244, v172
    v_mfma_f32_16x16x32_bf16 v[36:39], v[136:139], v[224:227], v[36:39]
    buffer_load_dwordx4 v10, s[48:51], s10 offen offset:2048 lds
    v_mfma_f32_16x16x32_bf16 v[36:39], v[140:143], v[232:235], v[36:39]
    ds_read_b64_tr_b16 v[120:121], v5 offset:8192
    ds_read_b64_tr_b16 v[122:123], v5 offset:8704
    v_accvgpr_write_b32 a245, v173
    v_accvgpr_write_b32 a246, v174
    v_mfma_f32_16x16x32_bf16 v[44:47], v[136:139], v[228:231], v[44:47]
    ds_read_b64_tr_b16 v[124:125], v5 offset:12288
    v_accvgpr_write_b32 a247, v175
    v_mfma_f32_16x16x32_bf16 v[44:47], v[140:143], v[236:239], v[44:47]
    s_waitcnt lgkmcnt(7)
    ds_read_b64_tr_b16 v[126:127], v5 offset:12800
    v_accvgpr_read_b32 v144, a48
    v_accvgpr_read_b32 v145, a49
    v_accvgpr_read_b32 v146, a50
    v_mfma_f32_16x16x32_bf16 v[48:51], v[96:99], v[224:227], v[48:51]
    buffer_load_dwordx4 a[176:179], v22, s[64:67], s98 offen offset:2048 sc1
    v_mfma_f32_16x16x32_bf16 v[48:51], v[100:103], v[232:235], v[48:51]
    ds_read_b64_tr_b16 v[128:129], v6 offset:8192
    ds_read_b64_tr_b16 v[130:131], v6 offset:8704
    v_accvgpr_read_b32 v147, a51
    v_accvgpr_read_b32 v148, a52
    v_mfma_f32_16x16x32_bf16 v[56:59], v[96:99], v[228:231], v[56:59]
    ds_read_b64_tr_b16 v[132:133], v6 offset:12288
    v_accvgpr_read_b32 v149, a53
    v_mfma_f32_16x16x32_bf16 v[56:59], v[100:103], v[236:239], v[56:59]
    ds_read_b64_tr_b16 v[134:135], v6 offset:12800
    v_accvgpr_read_b32 v150, a54
    v_accvgpr_read_b32 v151, a55
    v_accvgpr_read_b32 v152, a56
    v_accvgpr_read_b32 v153, a57
    v_mfma_f32_16x16x32_bf16 v[52:55], v[104:107], v[224:227], v[52:55]
    buffer_load_dwordx4 v11, s[48:51], s10 offen offset:3072 lds
    v_mfma_f32_16x16x32_bf16 v[52:55], v[108:111], v[232:235], v[52:55]
    ds_read_b64_tr_b16 v[136:137], v7 offset:8192
    ds_read_b64_tr_b16 v[138:139], v7 offset:8704
    v_accvgpr_read_b32 v154, a58
    v_mfma_f32_16x16x32_bf16 v[60:63], v[104:107], v[228:231], v[60:63]
    ds_read_b64_tr_b16 v[140:141], v7 offset:12288
    v_accvgpr_read_b32 v155, a59
    v_accvgpr_read_b32 v156, a60
    v_mfma_f32_16x16x32_bf16 v[60:63], v[108:111], v[236:239], v[60:63]
    s_waitcnt lgkmcnt(7)
    ds_read_b64_tr_b16 v[142:143], v7 offset:12800
    v_accvgpr_read_b32 v157, a61
    v_accvgpr_read_b32 v158, a62
    v_accvgpr_read_b32 v159, a63
    v_mfma_f32_16x16x32_bf16 v[64:67], v[224:227], v[112:115], v[64:67]
    buffer_load_dwordx4 a[180:183], v23, s[64:67], s98 offen offset:2048 sc1
    v_mfma_f32_16x16x32_bf16 v[64:67], v[232:235], v[116:119], v[64:67]
    ds_read_b64_tr_b16 v[96:97], v4 offset:16384
    ds_read_b64_tr_b16 v[98:99], v4 offset:16896
    v_cvt_pk_bf16_f32 v160, v144, v145
    v_mfma_f32_16x16x32_bf16 v[68:71], v[228:231], v[112:115], v[68:71]
    ds_read_b64_tr_b16 v[100:101], v4 offset:20480
    v_cvt_pk_bf16_f32 v161, v146, v147
    v_cvt_pk_bf16_f32 v162, v148, v149
    v_cvt_pk_bf16_f32 v163, v150, v151
    v_mfma_f32_16x16x32_bf16 v[68:71], v[236:239], v[116:119], v[68:71]
    s_mov_b32 s13, 0x3000
    ds_read_b64_tr_b16 v[102:103], v4 offset:20992
    v_mfma_f32_16x16x32_bf16 v[72:75], v[224:227], v[120:123], v[72:75]
    buffer_store_dwordx4 v[160:163], v25, s[84:87], s13 offen sc1
    ds_read_b64_tr_b16 v[104:105], v5 offset:16384
    v_cvt_pk_bf16_f32 v164, v152, v153
    v_cvt_pk_bf16_f32 v165, v154, v155
    v_mfma_f32_16x16x32_bf16 v[72:75], v[232:235], v[124:127], v[72:75]
    ds_read_b64_tr_b16 v[106:107], v5 offset:16896
    v_cvt_pk_bf16_f32 v166, v156, v157
    v_mfma_f32_16x16x32_bf16 v[76:79], v[228:231], v[120:123], v[76:79]
    ds_read_b64_tr_b16 v[108:109], v5 offset:20480
    v_cvt_pk_bf16_f32 v167, v158, v159
    v_mfma_f32_16x16x32_bf16 v[76:79], v[236:239], v[124:127], v[76:79]
    s_waitcnt lgkmcnt(7)
    ds_read_b64_tr_b16 v[110:111], v5 offset:20992
    v_accvgpr_read_b32 v144, a112
    v_accvgpr_read_b32 v145, a113
    v_accvgpr_read_b32 v146, a114
    v_mfma_f32_16x16x32_bf16 v[80:83], v[224:227], v[128:131], v[80:83]
    buffer_load_dwordx4 a[184:187], v22, s[64:67], s98 offen offset:2176 sc1
    v_mfma_f32_16x16x32_bf16 v[80:83], v[232:235], v[132:135], v[80:83]
    ds_read_b64_tr_b16 v[112:113], v6 offset:16384
    ds_read_b64_tr_b16 v[114:115], v6 offset:16896
    v_accvgpr_read_b32 v147, a115
    v_accvgpr_read_b32 v148, a116
    v_mfma_f32_16x16x32_bf16 v[84:87], v[228:231], v[128:131], v[84:87]
    ds_read_b64_tr_b16 v[116:117], v6 offset:20480
    v_accvgpr_read_b32 v149, a117
    v_mfma_f32_16x16x32_bf16 v[84:87], v[236:239], v[132:135], v[84:87]
    ds_read_b64_tr_b16 v[118:119], v6 offset:20992
    v_accvgpr_read_b32 v150, a118
    v_accvgpr_read_b32 v151, a119
    v_mfma_f32_16x16x32_bf16 v[88:91], v[224:227], v[136:139], v[88:91]
    ds_read_b64_tr_b16 v[120:121], v7 offset:16384
    v_accvgpr_read_b32 v152, a120
    v_mfma_f32_16x16x32_bf16 v[88:91], v[232:235], v[140:143], v[88:91]
    ds_read_b64_tr_b16 v[122:123], v7 offset:16896
    v_accvgpr_read_b32 v153, a121
    v_accvgpr_read_b32 v154, a122
    v_mfma_f32_16x16x32_bf16 v[92:95], v[228:231], v[136:139], v[92:95]
    ds_read_b64_tr_b16 v[124:125], v7 offset:20480
    v_accvgpr_read_b32 v155, a123
    v_mfma_f32_16x16x32_bf16 v[92:95], v[236:239], v[140:143], v[92:95]
    ds_read_b64_tr_b16 v[126:127], v7 offset:20992
    v_accvgpr_read_b32 v156, a124
    v_accvgpr_read_b32 v157, a125
    v_accvgpr_read_b32 v158, a126
    s_waitcnt vmcnt(31) lgkmcnt(8)
    v_mfma_f32_16x16x32_bf16 v[32:35], v[96:99], v[240:243], v[32:35]
    buffer_load_dwordx4 a[188:191], v21, s[64:67], s98 offen offset:2176 sc1
    s_waitcnt vmcnt(25)
    v_mfma_f32_16x16x32_bf16 v[32:35], v[100:103], v[248:251], v[32:35]
    ds_read_b64_tr_b16 v[128:129], v4 offset:24576
    ds_read_b64_tr_b16 v[130:131], v4 offset:25088
    v_accvgpr_read_b32 v159, a127
    v_cvt_pk_bf16_f32 v168, v144, v145
    v_mfma_f32_16x16x32_bf16 v[40:43], v[96:99], v[244:247], v[40:43]
    ds_read_b64_tr_b16 v[132:133], v4 offset:28672
    v_cvt_pk_bf16_f32 v169, v146, v147
    v_cvt_pk_bf16_f32 v170, v148, v149
    s_waitcnt vmcnt(22)
    v_mfma_f32_16x16x32_bf16 v[40:43], v[100:103], v[252:255], v[40:43]
    ds_read_b64_tr_b16 v[134:135], v4 offset:29184
    v_cvt_pk_bf16_f32 v171, v150, v151
    v_mfma_f32_16x16x32_bf16 v[36:39], v[104:107], v[240:243], v[36:39]
    ds_read_b64_tr_b16 v[136:137], v5 offset:24576
    v_cvt_pk_bf16_f32 v172, v152, v153
    v_cvt_pk_bf16_f32 v173, v154, v155
    v_mfma_f32_16x16x32_bf16 v[36:39], v[108:111], v[248:251], v[36:39]
    ds_read_b64_tr_b16 v[138:139], v5 offset:25088
    v_cvt_pk_bf16_f32 v174, v156, v157
    v_cvt_pk_bf16_f32 v175, v158, v159
    v_mfma_f32_16x16x32_bf16 v[44:47], v[104:107], v[244:247], v[44:47]
    buffer_store_dwordx4 v[164:167], v25, s[84:87], s13 offen offset:1024 sc1
    ds_read_b64_tr_b16 v[140:141], v5 offset:28672
    v_accvgpr_write_b32 a248, v168
    v_accvgpr_write_b32 a249, v169
    v_mfma_f32_16x16x32_bf16 v[44:47], v[108:111], v[252:255], v[44:47]
    s_waitcnt lgkmcnt(7)
    ds_read_b64_tr_b16 v[142:143], v5 offset:29184
    v_accvgpr_write_b32 a250, v170
    v_mfma_f32_16x16x32_bf16 v[48:51], v[112:115], v[240:243], v[48:51]
    ds_read_b64_tr_b16 v[96:97], v6 offset:24576
    v_accvgpr_write_b32 a251, v171
    v_mfma_f32_16x16x32_bf16 v[48:51], v[116:119], v[248:251], v[48:51]
    ds_read_b64_tr_b16 v[98:99], v6 offset:25088
    v_accvgpr_write_b32 a252, v172
    v_mfma_f32_16x16x32_bf16 v[56:59], v[112:115], v[244:247], v[56:59]
    ds_read_b64_tr_b16 v[100:101], v6 offset:28672
    v_accvgpr_write_b32 a253, v173
    v_mfma_f32_16x16x32_bf16 v[56:59], v[116:119], v[252:255], v[56:59]
    ds_read_b64_tr_b16 v[102:103], v6 offset:29184
    v_accvgpr_write_b32 a254, v174
    v_mfma_f32_16x16x32_bf16 v[52:55], v[120:123], v[240:243], v[52:55]
    ds_read_b64_tr_b16 v[104:105], v7 offset:24576
    v_accvgpr_write_b32 a255, v175
    v_mfma_f32_16x16x32_bf16 v[52:55], v[124:127], v[248:251], v[52:55]
    s_add_u32 s44, s42, 0x2300000
    s_addc_u32 s45, s43, 0
    ds_read_b64_tr_b16 v[106:107], v7 offset:25088
    v_mfma_f32_16x16x32_bf16 v[60:63], v[120:123], v[244:247], v[60:63]
    s_barrier
    s_mov_b32 s46, 0x760000
    ds_read_b64_tr_b16 v[108:109], v7 offset:28672
    v_mfma_f32_16x16x32_bf16 v[60:63], v[124:127], v[252:255], v[60:63]
    s_mov_b32 s47, 0x20000
    ds_read_b64_tr_b16 v[110:111], v7 offset:29184
    v_xor_b32 v4, 0x30000, v4
    v_xor_b32 v5, 0x30000, v5
    v_xor_b32 v6, 0x30000, v6
    v_xor_b32 v7, 0x30000, v7
    s_waitcnt lgkmcnt(8)
    v_mfma_f32_16x16x32_bf16 v[64:67], v[240:243], v[128:131], v[64:67]
    s_add_u32 s11, s8, s3
    s_mul_i32 s100, s11, 27
    ds_read_b64_tr_b16 a[0:1], v4 offset:0
    v_mfma_f32_16x16x32_bf16 v[64:67], v[248:251], v[132:135], v[64:67]
    s_lshl_b32 s12, s95, 1
    s_add_u32 s100, s100, s12
    ds_read_b64_tr_b16 a[2:3], v4 offset:512
    v_mfma_f32_16x16x32_bf16 v[68:71], v[244:247], v[128:131], v[68:71]
    s_lshl_b32 s100, s100, 11
    s_lshl_b32 s12, s12, 6
    ds_read_b64_tr_b16 a[4:5], v4 offset:4096
    v_mfma_f32_16x16x32_bf16 v[68:71], v[252:255], v[132:135], v[68:71]
    s_add_u32 s11, s11, s12
    s_lshl_b32 s11, s11, 11
    ds_read_b64_tr_b16 a[6:7], v4 offset:4608
    v_mfma_f32_16x16x32_bf16 v[72:75], v[240:243], v[136:139], v[72:75]
    s_add_u32 s96, s11, 0x400000
    ds_read_b64_tr_b16 a[8:9], v5 offset:0
    v_mfma_f32_16x16x32_bf16 v[72:75], v[248:251], v[140:143], v[72:75]
    ds_read_b64_tr_b16 a[10:11], v5 offset:512
    v_mfma_f32_16x16x32_bf16 v[76:79], v[244:247], v[136:139], v[76:79]
    ds_read_b64_tr_b16 a[12:13], v5 offset:4096
    v_mfma_f32_16x16x32_bf16 v[76:79], v[252:255], v[140:143], v[76:79]
    ds_read_b64_tr_b16 a[14:15], v5 offset:4608
    s_waitcnt lgkmcnt(8)
    v_mfma_f32_16x16x32_bf16 v[80:83], v[240:243], v[96:99], v[80:83]
    ds_read_b64_tr_b16 a[16:17], v6 offset:0
    v_mfma_f32_16x16x32_bf16 v[80:83], v[248:251], v[100:103], v[80:83]
    ds_read_b64_tr_b16 a[18:19], v6 offset:512
    v_mfma_f32_16x16x32_bf16 v[84:87], v[244:247], v[96:99], v[84:87]
    ds_read_b64_tr_b16 a[20:21], v6 offset:4096
    v_mfma_f32_16x16x32_bf16 v[84:87], v[252:255], v[100:103], v[84:87]
    ds_read_b64_tr_b16 a[22:23], v6 offset:4608
    v_mfma_f32_16x16x32_bf16 v[88:91], v[240:243], v[104:107], v[88:91]
    v_mfma_f32_16x16x32_bf16 v[88:91], v[248:251], v[108:111], v[88:91]
    v_mfma_f32_16x16x32_bf16 v[92:95], v[244:247], v[104:107], v[92:95]
    v_mfma_f32_16x16x32_bf16 v[92:95], v[252:255], v[108:111], v[92:95]
fk_q:
    s_waitcnt lgkmcnt(4)
    v_mfma_f32_16x16x32_bf16 v[128:131], a[0:3], a[132:135], 0
    ds_read_b64_tr_b16 a[24:25], v7 offset:0
    s_waitcnt vmcnt(19)
    v_mfma_f32_16x16x32_bf16 v[128:131], a[4:7], a[148:151], v[128:131]
    s_mov_b32 s98, 0x2000
    v_mfma_f32_16x16x32_bf16 v[136:139], a[0:3], a[140:143], 0
    buffer_load_dwordx4 a[48:51], v22, s[64:67], s98 offen sc1
    s_waitcnt vmcnt(17)
    v_mfma_f32_16x16x32_bf16 v[136:139], a[4:7], a[156:159], v[136:139]
    s_mov_b32 s101, 0xbdd2d3e8
    ds_read_b64_tr_b16 a[26:27], v7 offset:512
    v_mov_b32 v29, 0xc0135761
    v_mfma_f32_16x16x32_bf16 v[192:195], a[0:3], a[128:131], 0
    ds_read_b64_tr_b16 a[28:29], v7 offset:4096
    v_mul_f32 v96, v64, v64
    v_mfma_f32_16x16x32_bf16 v[192:195], a[4:7], a[144:147], v[192:195]
    v_mul_f32 v97, v65, v65
    v_mul_f32 v98, v66, v66
    v_mfma_f32_16x16x32_bf16 v[200:203], a[0:3], a[136:139], 0
    buffer_load_dwordx4 a[52:55], v23, s[64:67], s98 offen sc1
    v_mfma_f32_16x16x32_bf16 v[200:203], a[4:7], a[152:155], v[200:203]
    ds_read_b64_tr_b16 a[30:31], v7 offset:4608
    v_mul_f32 v99, v67, v67
    v_mfma_f32_16x16x32_bf16 v[132:135], a[8:11], a[132:135], 0
    ds_read_b64_tr_b16 a[0:1], v4 offset:8192
    v_mul_f32 v100, v68, v68
    v_mfma_f32_16x16x32_bf16 v[132:135], a[12:15], a[148:151], v[132:135]
    v_mul_f32 v101, v69, v69
    v_mul_f32 v102, v70, v70
    v_mfma_f32_16x16x32_bf16 v[140:143], a[8:11], a[140:143], 0
    ds_read_b64_tr_b16 a[2:3], v4 offset:8704
    v_mul_f32 v103, v71, v71
    v_mfma_f32_16x16x32_bf16 v[140:143], a[12:15], a[156:159], v[140:143]
    buffer_load_dwordx4 a[56:59], v22, s[64:67], s98 offen offset:128 sc1
    v_mfma_f32_16x16x32_bf16 v[196:199], a[8:11], a[128:131], 0
    ds_read_b64_tr_b16 a[4:5], v4 offset:12288
    v_fma_f32 v96, v96, s101, v29
    v_mfma_f32_16x16x32_bf16 v[196:199], a[12:15], a[144:147], v[196:199]
    v_fma_f32 v97, v97, s101, v29
    v_fma_f32 v98, v98, s101, v29
    v_mfma_f32_16x16x32_bf16 v[204:207], a[8:11], a[136:139], 0
    ds_read_b64_tr_b16 a[6:7], v4 offset:12800
    v_fma_f32 v99, v99, s101, v29
    v_mfma_f32_16x16x32_bf16 v[204:207], a[12:15], a[152:155], v[204:207]
    s_waitcnt lgkmcnt(4)
    buffer_load_dwordx4 a[60:63], v21, s[64:67], s98 offen offset:128 sc1
    v_mfma_f32_16x16x32_bf16 v[144:147], a[16:19], a[132:135], 0
    ds_read_b64_tr_b16 a[8:9], v5 offset:8192
    v_fma_f32 v100, v100, s101, v29
    v_mfma_f32_16x16x32_bf16 v[144:147], a[20:23], a[148:151], v[144:147]
    v_fma_f32 v101, v101, s101, v29
    v_fma_f32 v102, v102, s101, v29
    v_mfma_f32_16x16x32_bf16 v[152:155], a[16:19], a[140:143], 0
    ds_read_b64_tr_b16 a[10:11], v5 offset:8704
    v_fma_f32 v103, v103, s101, v29
    v_mfma_f32_16x16x32_bf16 v[152:155], a[20:23], a[156:159], v[152:155]
    v_mul_f32 v96, v96, v64
    v_mul_f32 v97, v97, v65
    v_mfma_f32_16x16x32_bf16 v[208:211], a[16:19], a[128:131], 0
    buffer_load_dwordx4 a[64:67], v22, s[64:67], s98 offen offset:2048 sc1
    v_mfma_f32_16x16x32_bf16 v[208:211], a[20:23], a[144:147], v[208:211]
    ds_read_b64_tr_b16 a[12:13], v5 offset:12288
    v_mul_f32 v98, v98, v66
    v_mfma_f32_16x16x32_bf16 v[216:219], a[16:19], a[136:139], 0
    ds_read_b64_tr_b16 a[14:15], v5 offset:12800
    v_mul_f32 v99, v99, v67
    v_mfma_f32_16x16x32_bf16 v[216:219], a[20:23], a[152:155], v[216:219]
    v_mul_f32 v100, v100, v68
    v_mul_f32 v101, v101, v69
    v_mfma_f32_16x16x32_bf16 v[148:151], a[24:27], a[132:135], 0
    ds_read_b64_tr_b16 a[16:17], v6 offset:8192
    v_mul_f32 v102, v102, v70
    v_mfma_f32_16x16x32_bf16 v[148:151], a[28:31], a[148:151], v[148:151]
    buffer_load_dwordx4 a[68:71], v23, s[64:67], s98 offen offset:2048 sc1
    v_mfma_f32_16x16x32_bf16 v[156:159], a[24:27], a[140:143], 0
    ds_read_b64_tr_b16 a[18:19], v6 offset:8704
    v_mul_f32 v103, v103, v71
    v_mfma_f32_16x16x32_bf16 v[156:159], a[28:31], a[156:159], v[156:159]
    v_exp_f32 v96, v96
    v_mfma_f32_16x16x32_bf16 v[212:215], a[24:27], a[128:131], 0
    ds_read_b64_tr_b16 a[20:21], v6 offset:12288
    v_mul_f32 v104, v72, v72
    v_mfma_f32_16x16x32_bf16 v[212:215], a[28:31], a[144:147], v[212:215]
    buffer_load_dwordx4 a[72:75], v22, s[64:67], s98 offen offset:2176 sc1
    v_mfma_f32_16x16x32_bf16 v[220:223], a[24:27], a[136:139], 0
    ds_read_b64_tr_b16 a[22:23], v6 offset:12800
    v_mfma_f32_16x16x32_bf16 v[220:223], a[28:31], a[152:155], v[220:223]
    s_waitcnt lgkmcnt(8)
    v_exp_f32 v97, v97
    v_mfma_f32_16x16x32_bf16 v[160:163], a[0:3], a[132:135], 0
    ds_read_b64_tr_b16 a[24:25], v7 offset:8192
    v_mul_f32 v105, v73, v73
    v_mfma_f32_16x16x32_bf16 v[160:163], a[4:7], a[148:151], v[160:163]
    v_exp_f32 v98, v98
    v_mfma_f32_16x16x32_bf16 v[168:171], a[0:3], a[140:143], 0
    s_barrier
    buffer_load_dwordx4 a[76:79], v21, s[64:67], s98 offen offset:2176 sc1
    v_mfma_f32_16x16x32_bf16 v[168:171], a[4:7], a[156:159], v[168:171]
    ds_read_b64_tr_b16 a[26:27], v7 offset:8704
    v_mfma_f32_16x16x32_bf16 v[224:227], a[0:3], a[128:131], 0
    ds_read_b64_tr_b16 a[28:29], v7 offset:12288
    v_mfma_f32_16x16x32_bf16 v[224:227], a[4:7], a[144:147], v[224:227]
    s_mov_b32 s10, 0x180000
    s_xor_b32 m0, s15, 0x1c000
    v_mfma_f32_16x16x32_bf16 v[232:235], a[0:3], a[136:139], 0
    buffer_load_dwordx4 v8, s[48:51], s10 offen offset:0 lds
    v_mfma_f32_16x16x32_bf16 v[232:235], a[4:7], a[152:155], v[232:235]
    s_waitcnt lgkmcnt(3)
    ds_read_b64_tr_b16 a[30:31], v7 offset:12800
    v_exp_f32 v99, v99
    v_mfma_f32_16x16x32_bf16 v[164:167], a[8:11], a[132:135], 0
    ds_read_b64_tr_b16 a[0:1], v4 offset:16384
    v_mul_f32 v106, v74, v74
    v_mfma_f32_16x16x32_bf16 v[164:167], a[12:15], a[148:151], v[164:167]
    v_exp_f32 v100, v100
    v_mfma_f32_16x16x32_bf16 v[172:175], a[8:11], a[140:143], 0
    ds_read_b64_tr_b16 a[2:3], v4 offset:16896
    v_exp_f32 v101, v101
    v_mfma_f32_16x16x32_bf16 v[172:175], a[12:15], a[156:159], v[172:175]
    buffer_load_dwordx4 v9, s[48:51], s10 offen offset:1024 lds
    v_mul_f32 v107, v75, v75
    v_mfma_f32_16x16x32_bf16 v[228:231], a[8:11], a[128:131], 0
    ds_read_b64_tr_b16 a[4:5], v4 offset:20480
    v_mfma_f32_16x16x32_bf16 v[228:231], a[12:15], a[144:147], v[228:231]
    v_exp_f32 v102, v102
    v_mfma_f32_16x16x32_bf16 v[236:239], a[8:11], a[136:139], 0
    ds_read_b64_tr_b16 a[6:7], v4 offset:20992
    v_exp_f32 v103, v103
    v_mfma_f32_16x16x32_bf16 v[236:239], a[12:15], a[152:155], v[236:239]
    v_mul_f32 v108, v76, v76
    v_add_f32 v96, 1.0, v96
    v_mfma_f32_16x16x32_bf16 v[176:179], a[16:19], a[132:135], 0
    buffer_load_dwordx4 v10, s[48:51], s10 offen offset:2048 lds
    v_mfma_f32_16x16x32_bf16 v[176:179], a[20:23], a[148:151], v[176:179]
    ds_read_b64_tr_b16 a[8:9], v5 offset:16384
    v_mul_f32 v109, v77, v77
    v_mfma_f32_16x16x32_bf16 v[184:187], a[16:19], a[140:143], 0
    ds_read_b64_tr_b16 a[10:11], v5 offset:16896
    v_add_f32 v97, 1.0, v97
    v_mfma_f32_16x16x32_bf16 v[184:187], a[20:23], a[156:159], v[184:187]
    v_add_f32 v98, 1.0, v98
    v_mul_f32 v110, v78, v78
    v_mfma_f32_16x16x32_bf16 v[240:243], a[16:19], a[128:131], 0
    buffer_load_dwordx4 v11, s[48:51], s10 offen offset:3072 lds
    v_mfma_f32_16x16x32_bf16 v[240:243], a[20:23], a[144:147], v[240:243]
    ds_read_b64_tr_b16 a[12:13], v5 offset:20480
    v_add_f32 v99, 1.0, v99
    v_mfma_f32_16x16x32_bf16 v[248:251], a[16:19], a[136:139], 0
    ds_read_b64_tr_b16 a[14:15], v5 offset:20992
    v_add_f32 v100, 1.0, v100
    v_mfma_f32_16x16x32_bf16 v[248:251], a[20:23], a[152:155], v[248:251]
    s_waitcnt lgkmcnt(4)
    v_mul_f32 v111, v79, v79
    v_add_f32 v101, 1.0, v101
    v_mfma_f32_16x16x32_bf16 v[180:183], a[24:27], a[132:135], 0
    s_mov_b32 s98, 0x3000
    ds_read_b64_tr_b16 a[16:17], v6 offset:16384
    v_add_f32 v102, 1.0, v102
    v_mfma_f32_16x16x32_bf16 v[180:183], a[28:31], a[148:151], v[180:183]
    buffer_load_dwordx4 a[80:83], v22, s[64:67], s98 offen sc1
    v_mfma_f32_16x16x32_bf16 v[188:191], a[24:27], a[140:143], 0
    ds_read_b64_tr_b16 a[18:19], v6 offset:16896
    v_fma_f32 v104, v104, s101, v29
    v_mfma_f32_16x16x32_bf16 v[188:191], a[28:31], a[156:159], v[188:191]
    v_add_f32 v103, 1.0, v103
    v_mfma_f32_16x16x32_bf16 v[244:247], a[24:27], a[128:131], 0
    ds_read_b64_tr_b16 a[20:21], v6 offset:20480
    v_mfma_f32_16x16x32_bf16 v[244:247], a[28:31], a[144:147], v[244:247]
    buffer_load_dwordx4 a[84:87], v23, s[64:67], s98 offen sc1
    v_mfma_f32_16x16x32_bf16 v[252:255], a[24:27], a[136:139], 0
    ds_read_b64_tr_b16 a[22:23], v6 offset:20992
    v_rcp_f32 v96, v96
    v_mfma_f32_16x16x32_bf16 v[252:255], a[28:31], a[152:155], v[252:255]
    v_fma_f32 v105, v105, s101, v29
    s_waitcnt vmcnt(27)
    v_mfma_f32_16x16x32_bf16 v[128:131], a[0:3], a[164:167], v[128:131]
    ds_read_b64_tr_b16 a[24:25], v7 offset:16384
    v_rcp_f32 v97, v97
    s_waitcnt vmcnt(18)
    v_mfma_f32_16x16x32_bf16 v[128:131], a[4:7], a[180:183], v[128:131]
    v_fma_f32 v106, v106, s101, v29
    v_mfma_f32_16x16x32_bf16 v[136:139], a[0:3], a[172:175], v[136:139]
    buffer_load_dwordx4 a[88:91], v22, s[64:67], s98 offen offset:128 sc1
    s_waitcnt vmcnt(16)
    v_mfma_f32_16x16x32_bf16 v[136:139], a[4:7], a[188:191], v[136:139]
    ds_read_b64_tr_b16 a[26:27], v7 offset:16896
    v_rcp_f32 v98, v98
    v_mfma_f32_16x16x32_bf16 v[192:195], a[0:3], a[160:163], v[192:195]
    ds_read_b64_tr_b16 a[28:29], v7 offset:20480
    v_rcp_f32 v99, v99
    v_mfma_f32_16x16x32_bf16 v[192:195], a[4:7], a[176:179], v[192:195]
    v_fma_f32 v107, v107, s101, v29
    v_mfma_f32_16x16x32_bf16 v[200:203], a[0:3], a[168:171], v[200:203]
    ds_read_b64_tr_b16 a[30:31], v7 offset:20992
    v_rcp_f32 v100, v100
    v_mfma_f32_16x16x32_bf16 v[200:203], a[4:7], a[184:187], v[200:203]
    s_waitcnt lgkmcnt(4)
    buffer_load_dwordx4 a[92:95], v21, s[64:67], s98 offen offset:128 sc1
    v_rcp_f32 v101, v101
    v_mfma_f32_16x16x32_bf16 v[132:135], a[8:11], a[164:167], v[132:135]
    ds_read_b64_tr_b16 a[0:1], v4 offset:24576
    v_fma_f32 v108, v108, s101, v29
    v_mfma_f32_16x16x32_bf16 v[132:135], a[12:15], a[180:183], v[132:135]
    v_rcp_f32 v102, v102
    v_mfma_f32_16x16x32_bf16 v[140:143], a[8:11], a[172:175], v[140:143]
    ds_read_b64_tr_b16 a[2:3], v4 offset:25088
    v_rcp_f32 v103, v103
    v_mfma_f32_16x16x32_bf16 v[140:143], a[12:15], a[188:191], v[140:143]
    buffer_load_dwordx4 a[96:99], v22, s[64:67], s98 offen offset:2048 sc1
    v_mfma_f32_16x16x32_bf16 v[196:199], a[8:11], a[160:163], v[196:199]
    ds_read_b64_tr_b16 a[4:5], v4 offset:28672
    v_fma_f32 v109, v109, s101, v29
    v_mfma_f32_16x16x32_bf16 v[196:199], a[12:15], a[176:179], v[196:199]
    v_mul_f32 v64, v96, v64
    v_mul_f32 v65, v97, v65
    v_mfma_f32_16x16x32_bf16 v[204:207], a[8:11], a[168:171], v[204:207]
    ds_read_b64_tr_b16 a[6:7], v4 offset:29184
    v_fma_f32 v110, v110, s101, v29
    v_mfma_f32_16x16x32_bf16 v[204:207], a[12:15], a[184:187], v[204:207]
    v_mul_f32 v66, v98, v66
    v_fma_f32 v111, v111, s101, v29
    v_mfma_f32_16x16x32_bf16 v[144:147], a[16:19], a[164:167], v[144:147]
    buffer_load_dwordx4 a[100:103], v23, s[64:67], s98 offen offset:2048 sc1
    v_mfma_f32_16x16x32_bf16 v[144:147], a[20:23], a[180:183], v[144:147]
    ds_read_b64_tr_b16 a[8:9], v5 offset:24576
    v_mul_f32 v67, v99, v67
    v_mfma_f32_16x16x32_bf16 v[152:155], a[16:19], a[172:175], v[152:155]
    ds_read_b64_tr_b16 a[10:11], v5 offset:25088
    v_mul_f32 v68, v100, v68
    v_mfma_f32_16x16x32_bf16 v[152:155], a[20:23], a[188:191], v[152:155]
    v_mul_f32 v104, v104, v72
    v_mul_f32 v69, v101, v69
    v_mfma_f32_16x16x32_bf16 v[208:211], a[16:19], a[160:163], v[208:211]
    buffer_load_dwordx4 a[104:107], v22, s[64:67], s98 offen offset:2176 sc1
    v_mfma_f32_16x16x32_bf16 v[208:211], a[20:23], a[176:179], v[208:211]
    ds_read_b64_tr_b16 a[12:13], v5 offset:28672
    v_mul_f32 v70, v102, v70
    v_mfma_f32_16x16x32_bf16 v[216:219], a[16:19], a[168:171], v[216:219]
    ds_read_b64_tr_b16 a[14:15], v5 offset:29184
    v_mul_f32 v105, v105, v73
    v_mfma_f32_16x16x32_bf16 v[216:219], a[20:23], a[184:187], v[216:219]
    s_waitcnt lgkmcnt(4)
    v_mul_f32 v71, v103, v71
    v_cvt_pk_bf16_f32 v64, v64, v65
    v_mfma_f32_16x16x32_bf16 v[148:151], a[24:27], a[164:167], v[148:151]
    ds_read_b64_tr_b16 a[16:17], v6 offset:24576
    v_mul_f32 v106, v106, v74
    v_mfma_f32_16x16x32_bf16 v[148:151], a[28:31], a[180:183], v[148:151]
    buffer_load_dwordx4 a[108:111], v21, s[64:67], s98 offen offset:2176 sc1
    v_mfma_f32_16x16x32_bf16 v[156:159], a[24:27], a[172:175], v[156:159]
    ds_read_b64_tr_b16 a[18:19], v6 offset:25088
    v_cvt_pk_bf16_f32 v65, v66, v67
    v_mfma_f32_16x16x32_bf16 v[156:159], a[28:31], a[188:191], v[156:159]
    v_cvt_pk_bf16_f32 v66, v68, v69
    v_mul_f32 v107, v107, v75
    v_mfma_f32_16x16x32_bf16 v[212:215], a[24:27], a[160:163], v[212:215]
    s_mov_b32 s10, 0x200000
    s_xor_b32 m0, s15, 0x0
    ds_read_b64_tr_b16 a[20:21], v6 offset:28672
    v_mfma_f32_16x16x32_bf16 v[212:215], a[28:31], a[176:179], v[212:215]
    buffer_load_dwordx4 v8, s[48:51], s10 offen offset:0 lds
    v_mfma_f32_16x16x32_bf16 v[220:223], a[24:27], a[168:171], v[220:223]
    ds_read_b64_tr_b16 a[22:23], v6 offset:29184
    v_cvt_pk_bf16_f32 v67, v70, v71
    v_mfma_f32_16x16x32_bf16 v[220:223], a[28:31], a[184:187], v[220:223]
    v_mul_f32 v108, v108, v76
    v_mfma_f32_16x16x32_bf16 v[160:163], a[0:3], a[164:167], v[160:163]
    ds_read_b64_tr_b16 a[24:25], v7 offset:24576
    v_mfma_f32_16x16x32_bf16 v[160:163], a[4:7], a[180:183], v[160:163]
    s_sub_u32 s13, s96, 0x20000
    s_cmp_eq_u32 s95, 0
    s_cselect_b32 s13, 0x7f000000, s13
    v_mfma_f32_16x16x32_bf16 v[168:171], a[0:3], a[172:175], v[168:171]
    s_waitcnt vmcnt(21)
    s_barrier
    buffer_store_dwordx4 v[64:67], v0, s[44:47], s13 offen sc1
    buffer_load_dwordx4 v9, s[48:51], s10 offen offset:1024 lds
    v_mul_f32 v109, v109, v77
    v_mfma_f32_16x16x32_bf16 v[168:171], a[4:7], a[188:191], v[168:171]
    ds_read_b64_tr_b16 a[26:27], v7 offset:25088
    v_cvt_pk_bf16_f32 v32, v32, v33
    v_mfma_f32_16x16x32_bf16 v[224:227], a[0:3], a[160:163], v[224:227]
    buffer_load_dword v3, v2, s[28:31], 0 offen sc1
    v_mfma_f32_16x16x32_bf16 v[224:227], a[4:7], a[176:179], v[224:227]
    ds_read_b64_tr_b16 a[28:29], v7 offset:28672
    v_cvt_pk_bf16_f32 v33, v34, v35
    v_mfma_f32_16x16x32_bf16 v[232:235], a[0:3], a[168:171], v[232:235]
    s_lshl_b32 s97, s6, 8
    s_lshl_b32 s11, s7, 2
    s_add_u32 s11, s11, s97
    s_cmp_lg_u32 s3, 0
    s_cbranch_scc1 fk_p1
    s_cmp_ge_u32 s5, 28
    v_mov_b32 v30, 1
    s_cselect_b64 exec, 1, 1
    buffer_store_dword v30, v28, s[68:71], s11 offen sc1
    s_mov_b64 exec, -1
fk_p1:
    ds_read_b64_tr_b16 a[30:31], v7 offset:29184
    v_mfma_f32_16x16x32_bf16 v[232:235], a[4:7], a[184:187], v[232:235]
    s_and_b32 s92, s15, 0x10000
    s_xor_b32 s92, s92, 0x30000
    buffer_load_dwordx4 v10, s[48:51], s10 offen offset:2048 lds
    v_xor_b32 v4, s92, v4
    v_xor_b32 v5, s92, v5
    v_xor_b32 v6, s92, v6
    v_xor_b32 v7, s92, v7
    s_waitcnt lgkmcnt(4)
    v_mfma_f32_16x16x32_bf16 v[164:167], a[8:11], a[164:167], v[164:167]
    ds_read_b64_tr_b16 a[0:1], v4 offset:32768
    v_mul_f32 v110, v110, v78
    v_mfma_f32_16x16x32_bf16 v[164:167], a[12:15], a[180:183], v[164:167]
    v_cvt_pk_bf16_f32 v34, v36, v37
    v_cvt_pk_bf16_f32 v35, v38, v39
    v_mfma_f32_16x16x32_bf16 v[172:175], a[8:11], a[172:175], v[172:175]
    ds_read_b64_tr_b16 a[2:3], v4 offset:33280
    v_mul_f32 v111, v111, v79
    v_mfma_f32_16x16x32_bf16 v[172:175], a[12:15], a[188:191], v[172:175]
    buffer_store_dwordx4 v[32:35], v0, s[44:47], s100 offen sc1
    buffer_load_dwordx4 v11, s[48:51], s10 offen offset:3072 lds
    v_mfma_f32_16x16x32_bf16 v[228:231], a[8:11], a[160:163], v[228:231]
    ds_read_b64_tr_b16 a[4:5], v4 offset:36864
    v_mfma_f32_16x16x32_bf16 v[228:231], a[12:15], a[176:179], v[228:231]
    v_exp_f32 v104, v104
    v_mfma_f32_16x16x32_bf16 v[236:239], a[8:11], a[168:171], v[236:239]
    ds_read_b64_tr_b16 a[6:7], v4 offset:37376
    v_mul_f32 v96, v80, v80
    v_mfma_f32_16x16x32_bf16 v[236:239], a[12:15], a[184:187], v[236:239]
    s_mov_b32 s98, 0x4000
    v_exp_f32 v105, v105
    v_mfma_f32_16x16x32_bf16 v[176:179], a[16:19], a[164:167], v[176:179]
    buffer_load_dwordx4 a[112:115], v22, s[64:67], s98 offen sc1
    v_mfma_f32_16x16x32_bf16 v[176:179], a[20:23], a[180:183], v[176:179]
    ds_read_b64_tr_b16 a[8:9], v5 offset:32768
    v_mul_f32 v97, v81, v81
    v_mfma_f32_16x16x32_bf16 v[184:187], a[16:19], a[172:175], v[184:187]
    ds_read_b64_tr_b16 a[10:11], v5 offset:33280
    v_mfma_f32_16x16x32_bf16 v[184:187], a[20:23], a[188:191], v[184:187]
    v_exp_f32 v106, v106
    v_mfma_f32_16x16x32_bf16 v[240:243], a[16:19], a[160:163], v[240:243]
    buffer_load_dwordx4 a[116:119], v23, s[64:67], s98 offen sc1
    v_mfma_f32_16x16x32_bf16 v[240:243], a[20:23], a[176:179], v[240:243]
    ds_read_b64_tr_b16 a[12:13], v5 offset:36864
    v_exp_f32 v107, v107
    v_mfma_f32_16x16x32_bf16 v[248:251], a[16:19], a[168:171], v[248:251]
    ds_read_b64_tr_b16 a[14:15], v5 offset:37376
    v_mul_f32 v98, v82, v82
    v_mfma_f32_16x16x32_bf16 v[248:251], a[20:23], a[184:187], v[248:251]
    s_waitcnt lgkmcnt(4)
    v_exp_f32 v108, v108
    v_mfma_f32_16x16x32_bf16 v[180:183], a[24:27], a[164:167], v[180:183]
    ds_read_b64_tr_b16 a[16:17], v6 offset:32768
    v_exp_f32 v109, v109
    v_mfma_f32_16x16x32_bf16 v[180:183], a[28:31], a[180:183], v[180:183]
    buffer_load_dwordx4 a[120:123], v22, s[64:67], s98 offen offset:128 sc1
    v_mul_f32 v99, v83, v83
    v_mfma_f32_16x16x32_bf16 v[188:191], a[24:27], a[172:175], v[188:191]
    ds_read_b64_tr_b16 a[18:19], v6 offset:33280
    v_mfma_f32_16x16x32_bf16 v[188:191], a[28:31], a[188:191], v[188:191]
    v_exp_f32 v110, v110
    v_mfma_f32_16x16x32_bf16 v[244:247], a[24:27], a[160:163], v[244:247]
    ds_read_b64_tr_b16 a[20:21], v6 offset:36864
    v_exp_f32 v111, v111
    v_mfma_f32_16x16x32_bf16 v[244:247], a[28:31], a[176:179], v[244:247]
    v_mul_f32 v100, v84, v84
    v_add_f32 v104, 1.0, v104
    v_mfma_f32_16x16x32_bf16 v[252:255], a[24:27], a[168:171], v[252:255]
    buffer_load_dwordx4 a[124:127], v21, s[64:67], s98 offen offset:128 sc1
    v_mfma_f32_16x16x32_bf16 v[252:255], a[28:31], a[184:187], v[252:255]
    ds_read_b64_tr_b16 a[22:23], v6 offset:37376
    v_mul_f32 v101, v85, v85
    s_waitcnt vmcnt(29)
    v_mfma_f32_16x16x32_bf16 v[128:131], a[0:3], a[52:55], v[128:131]
    ds_read_b64_tr_b16 a[24:25], v7 offset:32768
    v_add_f32 v105, 1.0, v105
    s_waitcnt vmcnt(25)
    v_mfma_f32_16x16x32_bf16 v[128:131], a[4:7], a[68:71], v[128:131]
    v_add_f32 v106, 1.0, v106
    v_mul_f32 v102, v86, v86
    v_mfma_f32_16x16x32_bf16 v[136:139], a[0:3], a[60:63], v[136:139]
    buffer_load_dwordx4 a[128:131], v22, s[64:67], s98 offen offset:2048 sc1
    s_waitcnt vmcnt(24)
    v_mfma_f32_16x16x32_bf16 v[136:139], a[4:7], a[76:79], v[136:139]
    ds_read_b64_tr_b16 a[26:27], v7 offset:33280
    v_add_f32 v107, 1.0, v107
    v_mfma_f32_16x16x32_bf16 v[192:195], a[0:3], a[48:51], v[192:195]
    ds_read_b64_tr_b16 a[28:29], v7 offset:36864
    v_add_f32 v108, 1.0, v108
    v_mfma_f32_16x16x32_bf16 v[192:195], a[4:7], a[64:67], v[192:195]
    v_mul_f32 v103, v87, v87
    v_add_f32 v109, 1.0, v109
    v_mfma_f32_16x16x32_bf16 v[200:203], a[0:3], a[56:59], v[200:203]
    ds_read_b64_tr_b16 a[30:31], v7 offset:37376
    v_add_f32 v110, 1.0, v110
    v_mfma_f32_16x16x32_bf16 v[200:203], a[4:7], a[72:75], v[200:203]
    s_waitcnt lgkmcnt(4)
    buffer_load_dwordx4 a[132:135], v23, s[64:67], s98 offen offset:2048 sc1
    v_mfma_f32_16x16x32_bf16 v[132:135], a[8:11], a[52:55], v[132:135]
    ds_read_b64_tr_b16 a[0:1], v4 offset:40960
    v_fma_f32 v96, v96, s101, v29
    v_mfma_f32_16x16x32_bf16 v[132:135], a[12:15], a[68:71], v[132:135]
    v_add_f32 v111, 1.0, v111
    v_fma_f32 v97, v97, s101, v29
    v_mfma_f32_16x16x32_bf16 v[140:143], a[8:11], a[60:63], v[140:143]
    ds_read_b64_tr_b16 a[2:3], v4 offset:41472
    v_mfma_f32_16x16x32_bf16 v[140:143], a[12:15], a[76:79], v[140:143]
    buffer_load_dwordx4 a[136:139], v22, s[64:67], s98 offen offset:2176 sc1
    v_mfma_f32_16x16x32_bf16 v[196:199], a[8:11], a[48:51], v[196:199]
    ds_read_b64_tr_b16 a[4:5], v4 offset:45056
    v_mfma_f32_16x16x32_bf16 v[196:199], a[12:15], a[64:67], v[196:199]
    v_rcp_f32 v104, v104
    v_mfma_f32_16x16x32_bf16 v[204:207], a[8:11], a[56:59], v[204:207]
    ds_read_b64_tr_b16 a[6:7], v4 offset:45568
    v_rcp_f32 v105, v105
    v_mfma_f32_16x16x32_bf16 v[204:207], a[12:15], a[72:75], v[204:207]
    v_fma_f32 v98, v98, s101, v29
    v_mfma_f32_16x16x32_bf16 v[144:147], a[16:19], a[52:55], v[144:147]
    buffer_load_dwordx4 a[140:143], v21, s[64:67], s98 offen offset:2176 sc1
    v_mfma_f32_16x16x32_bf16 v[144:147], a[20:23], a[68:71], v[144:147]
    ds_read_b64_tr_b16 a[8:9], v5 offset:40960
    v_rcp_f32 v106, v106
    v_mfma_f32_16x16x32_bf16 v[152:155], a[16:19], a[60:63], v[152:155]
    ds_read_b64_tr_b16 a[10:11], v5 offset:41472
    v_rcp_f32 v107, v107
    v_mfma_f32_16x16x32_bf16 v[152:155], a[20:23], a[76:79], v[152:155]
    v_fma_f32 v99, v99, s101, v29
    v_rcp_f32 v108, v108
    v_mfma_f32_16x16x32_bf16 v[208:211], a[16:19], a[48:51], v[208:211]
    s_mov_b32 s10, 0x280000
    s_xor_b32 m0, s15, 0x4000
    ds_read_b64_tr_b16 a[12:13], v5 offset:45056
    v_mfma_f32_16x16x32_bf16 v[208:211], a[20:23], a[64:67], v[208:211]
    buffer_load_dwordx4 v8, s[48:51], s10 offen offset:0 lds
    v_rcp_f32 v109, v109
    v_mfma_f32_16x16x32_bf16 v[216:219], a[16:19], a[56:59], v[216:219]
    ds_read_b64_tr_b16 a[14:15], v5 offset:45568
    v_fma_f32 v100, v100, s101, v29
    v_mfma_f32_16x16x32_bf16 v[216:219], a[20:23], a[72:75], v[216:219]
    s_waitcnt lgkmcnt(4)
    v_rcp_f32 v110, v110
    v_mfma_f32_16x16x32_bf16 v[148:151], a[24:27], a[52:55], v[148:151]
    ds_read_b64_tr_b16 a[16:17], v6 offset:40960
    v_fma_f32 v101, v101, s101, v29
    v_mfma_f32_16x16x32_bf16 v[148:151], a[28:31], a[68:71], v[148:151]
    buffer_load_dwordx4 v9, s[48:51], s10 offen offset:1024 lds
    v_mfma_f32_16x16x32_bf16 v[156:159], a[24:27], a[60:63], v[156:159]
    ds_read_b64_tr_b16 a[18:19], v6 offset:41472
    v_rcp_f32 v111, v111
    v_mfma_f32_16x16x32_bf16 v[156:159], a[28:31], a[76:79], v[156:159]
    v_mul_f32 v72, v104, v72
    v_fma_f32 v102, v102, s101, v29
    v_mfma_f32_16x16x32_bf16 v[212:215], a[24:27], a[48:51], v[212:215]
    ds_read_b64_tr_b16 a[20:21], v6 offset:45056
    v_mul_f32 v73, v105, v73
    v_mfma_f32_16x16x32_bf16 v[212:215], a[28:31], a[64:67], v[212:215]
    v_mul_f32 v74, v106, v74
    v_fma_f32 v103, v103, s101, v29
    v_mfma_f32_16x16x32_bf16 v[220:223], a[24:27], a[56:59], v[220:223]
    buffer_load_dwordx4 v10, s[48:51], s10 offen offset:2048 lds
    v_mfma_f32_16x16x32_bf16 v[220:223], a[28:31], a[72:75], v[220:223]
    ds_read_b64_tr_b16 a[22:23], v6 offset:45568
    v_mul_f32 v75, v107, v75
    v_mfma_f32_16x16x32_bf16 v[160:163], a[0:3], a[52:55], v[160:163]
    ds_read_b64_tr_b16 a[24:25], v7 offset:40960
    v_mul_f32 v76, v108, v76
    v_mfma_f32_16x16x32_bf16 v[160:163], a[4:7], a[68:71], v[160:163]
    v_mul_f32 v96, v96, v80
    v_mul_f32 v77, v109, v77
    v_mfma_f32_16x16x32_bf16 v[168:171], a[0:3], a[60:63], v[168:171]
    s_waitcnt vmcnt(26)
    s_barrier
    buffer_load_dwordx4 v11, s[48:51], s10 offen offset:3072 lds
    v_mfma_f32_16x16x32_bf16 v[168:171], a[4:7], a[76:79], v[168:171]
    ds_read_b64_tr_b16 a[26:27], v7 offset:41472
    v_mul_f32 v97, v97, v81
    v_mfma_f32_16x16x32_bf16 v[224:227], a[0:3], a[48:51], v[224:227]
    ds_read_b64_tr_b16 a[28:29], v7 offset:45056
    v_mul_f32 v78, v110, v78
    v_mfma_f32_16x16x32_bf16 v[224:227], a[4:7], a[64:67], v[224:227]
    v_mul_f32 v79, v111, v79
    v_mul_f32 v98, v98, v82
    v_mfma_f32_16x16x32_bf16 v[232:235], a[0:3], a[56:59], v[232:235]
    s_mov_b32 s98, 0x5000
    ds_read_b64_tr_b16 a[30:31], v7 offset:45568
    v_cvt_pk_bf16_f32 v72, v72, v73
    v_mfma_f32_16x16x32_bf16 v[232:235], a[4:7], a[72:75], v[232:235]
    s_waitcnt lgkmcnt(4)
    buffer_load_dwordx4 a[144:147], v22, s[64:67], s98 offen sc1
    v_mfma_f32_16x16x32_bf16 v[164:167], a[8:11], a[52:55], v[164:167]
    ds_read_b64_tr_b16 a[0:1], v4 offset:49152
    v_cvt_pk_bf16_f32 v73, v74, v75
    v_mfma_f32_16x16x32_bf16 v[164:167], a[12:15], a[68:71], v[164:167]
    v_mul_f32 v99, v99, v83
    v_cvt_pk_bf16_f32 v74, v76, v77
    v_mfma_f32_16x16x32_bf16 v[172:175], a[8:11], a[60:63], v[172:175]
    ds_read_b64_tr_b16 a[2:3], v4 offset:49664
    v_cvt_pk_bf16_f32 v75, v78, v79
    v_mfma_f32_16x16x32_bf16 v[172:175], a[12:15], a[76:79], v[172:175]
    v_mul_f32 v100, v100, v84
    v_mfma_f32_16x16x32_bf16 v[228:231], a[8:11], a[48:51], v[228:231]
    buffer_store_dwordx4 v[72:75], v0, s[44:47], s13 offen offset:256 sc1
    buffer_load_dwordx4 a[148:151], v23, s[64:67], s98 offen sc1
    v_mul_f32 v101, v101, v85
    v_mfma_f32_16x16x32_bf16 v[228:231], a[12:15], a[64:67], v[228:231]
    ds_read_b64_tr_b16 a[4:5], v4 offset:53248
    v_cvt_pk_bf16_f32 v40, v40, v41
    v_mfma_f32_16x16x32_bf16 v[236:239], a[8:11], a[56:59], v[236:239]
    ds_read_b64_tr_b16 a[6:7], v4 offset:53760
    v_cvt_pk_bf16_f32 v41, v42, v43
    v_mfma_f32_16x16x32_bf16 v[236:239], a[12:15], a[72:75], v[236:239]
    v_mul_f32 v102, v102, v86
    v_cvt_pk_bf16_f32 v42, v44, v45
    v_mfma_f32_16x16x32_bf16 v[176:179], a[16:19], a[52:55], v[176:179]
    buffer_load_dwordx4 a[152:155], v22, s[64:67], s98 offen offset:128 sc1
    v_mfma_f32_16x16x32_bf16 v[176:179], a[20:23], a[68:71], v[176:179]
    ds_read_b64_tr_b16 a[8:9], v5 offset:49152
    v_cvt_pk_bf16_f32 v43, v46, v47
    v_mfma_f32_16x16x32_bf16 v[184:187], a[16:19], a[60:63], v[184:187]
    ds_read_b64_tr_b16 a[10:11], v5 offset:49664
    v_mul_f32 v103, v103, v87
    v_mfma_f32_16x16x32_bf16 v[184:187], a[20:23], a[76:79], v[184:187]
    buffer_store_dwordx4 v[40:43], v0, s[44:47], s100 offen offset:256 sc1
    v_exp_f32 v96, v96
    v_mul_f32 v104, v88, v88
    v_mfma_f32_16x16x32_bf16 v[240:243], a[16:19], a[48:51], v[240:243]
    ds_read_b64_tr_b16 a[12:13], v5 offset:53248
    v_mfma_f32_16x16x32_bf16 v[240:243], a[20:23], a[64:67], v[240:243]
    buffer_load_dwordx4 a[156:159], v21, s[64:67], s98 offen offset:128 sc1
    v_mfma_f32_16x16x32_bf16 v[248:251], a[16:19], a[56:59], v[248:251]
    ds_read_b64_tr_b16 a[14:15], v5 offset:53760
    v_mfma_f32_16x16x32_bf16 v[248:251], a[20:23], a[72:75], v[248:251]
    s_waitcnt lgkmcnt(4)
    v_exp_f32 v97, v97
    v_mfma_f32_16x16x32_bf16 v[180:183], a[24:27], a[52:55], v[180:183]
    ds_read_b64_tr_b16 a[16:17], v6 offset:49152
    v_mul_f32 v105, v89, v89
    v_mfma_f32_16x16x32_bf16 v[180:183], a[28:31], a[68:71], v[180:183]
    buffer_load_dwordx4 a[160:163], v22, s[64:67], s98 offen offset:2048 sc1
    v_mfma_f32_16x16x32_bf16 v[188:191], a[24:27], a[60:63], v[188:191]
    ds_read_b64_tr_b16 a[18:19], v6 offset:49664
    v_mfma_f32_16x16x32_bf16 v[188:191], a[28:31], a[76:79], v[188:191]
    v_exp_f32 v98, v98
    v_mfma_f32_16x16x32_bf16 v[244:247], a[24:27], a[48:51], v[244:247]
    ds_read_b64_tr_b16 a[20:21], v6 offset:53248
    v_mfma_f32_16x16x32_bf16 v[244:247], a[28:31], a[64:67], v[244:247]
    v_exp_f32 v99, v99
    v_mfma_f32_16x16x32_bf16 v[252:255], a[24:27], a[56:59], v[252:255]
    buffer_load_dwordx4 a[164:167], v23, s[64:67], s98 offen offset:2048 sc1
    v_mfma_f32_16x16x32_bf16 v[252:255], a[28:31], a[72:75], v[252:255]
    ds_read_b64_tr_b16 a[22:23], v6 offset:53760
    v_mul_f32 v106, v90, v90
    s_waitcnt vmcnt(33)
    v_mfma_f32_16x16x32_bf16 v[128:131], a[0:3], a[84:87], v[128:131]
    ds_read_b64_tr_b16 a[24:25], v7 offset:49152
    s_waitcnt vmcnt(29)
    v_mfma_f32_16x16x32_bf16 v[128:131], a[4:7], a[100:103], v[128:131]
    v_exp_f32 v100, v100
    v_mfma_f32_16x16x32_bf16 v[136:139], a[0:3], a[92:95], v[136:139]
    ds_read_b64_tr_b16 a[26:27], v7 offset:49664
    s_waitcnt vmcnt(27)
    v_mfma_f32_16x16x32_bf16 v[136:139], a[4:7], a[108:111], v[136:139]
    buffer_load_dwordx4 a[168:171], v22, s[64:67], s98 offen offset:2176 sc1
    v_mfma_f32_16x16x32_bf16 v[192:195], a[0:3], a[80:83], v[192:195]
    ds_read_b64_tr_b16 a[28:29], v7 offset:53248
    v_mfma_f32_16x16x32_bf16 v[192:195], a[4:7], a[96:99], v[192:195]
    v_exp_f32 v101, v101
    v_mfma_f32_16x16x32_bf16 v[200:203], a[0:3], a[88:91], v[200:203]
    ds_read_b64_tr_b16 a[30:31], v7 offset:53760
    v_mul_f32 v107, v91, v91
    v_mfma_f32_16x16x32_bf16 v[200:203], a[4:7], a[104:107], v[200:203]
    s_waitcnt lgkmcnt(4)
    buffer_load_dwordx4 a[172:175], v21, s[64:67], s98 offen offset:2176 sc1
    v_exp_f32 v102, v102
    v_mfma_f32_16x16x32_bf16 v[132:135], a[8:11], a[84:87], v[132:135]
    ds_read_b64_tr_b16 a[0:1], v4 offset:57344
    v_mfma_f32_16x16x32_bf16 v[132:135], a[12:15], a[100:103], v[132:135]
    v_exp_f32 v103, v103
    v_mfma_f32_16x16x32_bf16 v[140:143], a[8:11], a[92:95], v[140:143]
    ds_read_b64_tr_b16 a[2:3], v4 offset:57856
    v_mul_f32 v108, v92, v92
    v_mfma_f32_16x16x32_bf16 v[140:143], a[12:15], a[108:111], v[140:143]
    s_mov_b32 s10, 0x300000
    s_xor_b32 m0, s15, 0x8000
    v_add_f32 v96, 1.0, v96
    v_mfma_f32_16x16x32_bf16 v[196:199], a[8:11], a[80:83], v[196:199]
    buffer_load_dwordx4 v8, s[48:51], s10 offen offset:0 lds
    v_mul_f32 v109, v93, v93
    v_mfma_f32_16x16x32_bf16 v[196:199], a[12:15], a[96:99], v[196:199]
    ds_read_b64_tr_b16 a[4:5], v4 offset:61440
    v_add_f32 v97, 1.0, v97
    v_mfma_f32_16x16x32_bf16 v[204:207], a[8:11], a[88:91], v[204:207]
    ds_read_b64_tr_b16 a[6:7], v4 offset:61952
    v_add_f32 v98, 1.0, v98
    v_mfma_f32_16x16x32_bf16 v[204:207], a[12:15], a[104:107], v[204:207]
    v_mul_f32 v110, v94, v94
    v_add_f32 v99, 1.0, v99
    v_mfma_f32_16x16x32_bf16 v[144:147], a[16:19], a[84:87], v[144:147]
    buffer_load_dwordx4 v9, s[48:51], s10 offen offset:1024 lds
    v_mfma_f32_16x16x32_bf16 v[144:147], a[20:23], a[100:103], v[144:147]
    ds_read_b64_tr_b16 a[8:9], v5 offset:57344
    v_add_f32 v100, 1.0, v100
    v_mfma_f32_16x16x32_bf16 v[152:155], a[16:19], a[92:95], v[152:155]
    ds_read_b64_tr_b16 a[10:11], v5 offset:57856
    v_mul_f32 v111, v95, v95
    v_mfma_f32_16x16x32_bf16 v[152:155], a[20:23], a[108:111], v[152:155]
    v_add_f32 v101, 1.0, v101
    v_add_f32 v102, 1.0, v102
    v_mfma_f32_16x16x32_bf16 v[208:211], a[16:19], a[80:83], v[208:211]
    ds_read_b64_tr_b16 a[12:13], v5 offset:61440
    v_fma_f32 v104, v104, s101, v29
    v_mfma_f32_16x16x32_bf16 v[208:211], a[20:23], a[96:99], v[208:211]
    buffer_load_dwordx4 v10, s[48:51], s10 offen offset:2048 lds
    v_mfma_f32_16x16x32_bf16 v[216:219], a[16:19], a[88:91], v[216:219]
    ds_read_b64_tr_b16 a[14:15], v5 offset:61952
    v_add_f32 v103, 1.0, v103
    v_mfma_f32_16x16x32_bf16 v[216:219], a[20:23], a[104:107], v[216:219]
    s_waitcnt lgkmcnt(4)
    v_rcp_f32 v96, v96
    v_mfma_f32_16x16x32_bf16 v[148:151], a[24:27], a[84:87], v[148:151]
    ds_read_b64_tr_b16 a[16:17], v6 offset:57344
    v_fma_f32 v105, v105, s101, v29
    v_mfma_f32_16x16x32_bf16 v[148:151], a[28:31], a[100:103], v[148:151]
    v_rcp_f32 v97, v97
    v_mfma_f32_16x16x32_bf16 v[156:159], a[24:27], a[92:95], v[156:159]
    buffer_load_dwordx4 v11, s[48:51], s10 offen offset:3072 lds
    v_mfma_f32_16x16x32_bf16 v[156:159], a[28:31], a[108:111], v[156:159]
    ds_read_b64_tr_b16 a[18:19], v6 offset:57856
    v_fma_f32 v106, v106, s101, v29
    v_mfma_f32_16x16x32_bf16 v[212:215], a[24:27], a[80:83], v[212:215]
    ds_read_b64_tr_b16 a[20:21], v6 offset:61440
    v_mfma_f32_16x16x32_bf16 v[212:215], a[28:31], a[96:99], v[212:215]
    s_mov_b32 s98, 0x6000
    v_rcp_f32 v98, v98
    v_mfma_f32_16x16x32_bf16 v[220:223], a[24:27], a[88:91], v[220:223]
    buffer_load_dwordx4 a[176:179], v22, s[64:67], s98 offen sc1
    v_mfma_f32_16x16x32_bf16 v[220:223], a[28:31], a[104:107], v[220:223]
    ds_read_b64_tr_b16 a[22:23], v6 offset:61952
    v_rcp_f32 v99, v99
    v_mfma_f32_16x16x32_bf16 v[160:163], a[0:3], a[84:87], v[160:163]
    ds_read_b64_tr_b16 a[24:25], v7 offset:57344
    v_fma_f32 v107, v107, s101, v29
    v_mfma_f32_16x16x32_bf16 v[160:163], a[4:7], a[100:103], v[160:163]
    v_rcp_f32 v100, v100
    v_mfma_f32_16x16x32_bf16 v[168:171], a[0:3], a[92:95], v[168:171]
    s_waitcnt vmcnt(27)
    s_barrier
    ds_read_b64_tr_b16 a[26:27], v7 offset:57856
    v_rcp_f32 v101, v101
    v_mfma_f32_16x16x32_bf16 v[168:171], a[4:7], a[108:111], v[168:171]
    buffer_load_dwordx4 a[180:183], v23, s[64:67], s98 offen sc1
    v_fma_f32 v108, v108, s101, v29
    v_mfma_f32_16x16x32_bf16 v[224:227], a[0:3], a[80:83], v[224:227]
    ds_read_b64_tr_b16 a[28:29], v7 offset:61440
    v_mfma_f32_16x16x32_bf16 v[224:227], a[4:7], a[96:99], v[224:227]
    v_rcp_f32 v102, v102
    v_mfma_f32_16x16x32_bf16 v[232:235], a[0:3], a[88:91], v[232:235]
    ds_read_b64_tr_b16 a[30:31], v7 offset:61952
    v_xor_b32 v4, 0x10000, v4
    v_rcp_f32 v103, v103
    v_mfma_f32_16x16x32_bf16 v[232:235], a[4:7], a[104:107], v[232:235]
    s_waitcnt lgkmcnt(4)
    buffer_load_dwordx4 a[184:187], v22, s[64:67], s98 offen offset:128 sc1
    v_xor_b32 v5, 0x10000, v5
    v_xor_b32 v6, 0x10000, v6
    v_xor_b32 v7, 0x10000, v7
    v_fma_f32 v109, v109, s101, v29
    v_mfma_f32_16x16x32_bf16 v[164:167], a[8:11], a[84:87], v[164:167]
    ds_read_b64_tr_b16 a[0:1], v4 offset:0
    v_mul_f32 v80, v96, v80
    v_mfma_f32_16x16x32_bf16 v[164:167], a[12:15], a[100:103], v[164:167]
    v_mul_f32 v81, v97, v81
    v_fma_f32 v110, v110, s101, v29
    v_mfma_f32_16x16x32_bf16 v[172:175], a[8:11], a[92:95], v[172:175]
    ds_read_b64_tr_b16 a[2:3], v4 offset:512
    v_mul_f32 v82, v98, v82
    v_mfma_f32_16x16x32_bf16 v[172:175], a[12:15], a[108:111], v[172:175]
    v_fma_f32 v111, v111, s101, v29
    v_mul_f32 v83, v99, v83
    v_mfma_f32_16x16x32_bf16 v[228:231], a[8:11], a[80:83], v[228:231]
    buffer_load_dwordx4 a[188:191], v21, s[64:67], s98 offen offset:128 sc1
    v_mfma_f32_16x16x32_bf16 v[228:231], a[12:15], a[96:99], v[228:231]
    ds_read_b64_tr_b16 a[4:5], v4 offset:4096
    v_mul_f32 v84, v100, v84
    v_mfma_f32_16x16x32_bf16 v[236:239], a[8:11], a[88:91], v[236:239]
    ds_read_b64_tr_b16 a[6:7], v4 offset:4608
    v_mul_f32 v104, v104, v88
    v_mfma_f32_16x16x32_bf16 v[236:239], a[12:15], a[104:107], v[236:239]
    v_mul_f32 v85, v101, v85
    v_mul_f32 v86, v102, v86
    v_mfma_f32_16x16x32_bf16 v[176:179], a[16:19], a[84:87], v[176:179]
    ds_read_b64_tr_b16 a[8:9], v5 offset:0
    v_mul_f32 v105, v105, v89
    v_mfma_f32_16x16x32_bf16 v[176:179], a[20:23], a[100:103], v[176:179]
    buffer_load_dwordx4 a[48:51], v22, s[64:67], s98 offen offset:2048 sc1
    v_mfma_f32_16x16x32_bf16 v[184:187], a[16:19], a[92:95], v[184:187]
    ds_read_b64_tr_b16 a[10:11], v5 offset:512
    v_mul_f32 v87, v103, v87
    v_mfma_f32_16x16x32_bf16 v[184:187], a[20:23], a[108:111], v[184:187]
    v_cvt_pk_bf16_f32 v80, v80, v81
    v_mul_f32 v106, v106, v90
    v_mfma_f32_16x16x32_bf16 v[240:243], a[16:19], a[80:83], v[240:243]
    ds_read_b64_tr_b16 a[12:13], v5 offset:4096
    v_cvt_pk_bf16_f32 v81, v82, v83
    v_mfma_f32_16x16x32_bf16 v[240:243], a[20:23], a[96:99], v[240:243]
    buffer_load_dwordx4 a[52:55], v23, s[64:67], s98 offen offset:2048 sc1
    v_mfma_f32_16x16x32_bf16 v[248:251], a[16:19], a[88:91], v[248:251]
    ds_read_b64_tr_b16 a[14:15], v5 offset:4608
    v_cvt_pk_bf16_f32 v82, v84, v85
    v_mfma_f32_16x16x32_bf16 v[248:251], a[20:23], a[104:107], v[248:251]
    s_waitcnt lgkmcnt(4)
    v_mul_f32 v107, v107, v91
    v_cvt_pk_bf16_f32 v83, v86, v87
    v_mfma_f32_16x16x32_bf16 v[180:183], a[24:27], a[84:87], v[180:183]
    ds_read_b64_tr_b16 a[16:17], v6 offset:0
    v_mul_f32 v108, v108, v92
    v_mfma_f32_16x16x32_bf16 v[180:183], a[28:31], a[100:103], v[180:183]
    buffer_store_dwordx4 v[80:83], v0, s[44:47], s96 offen sc1
    v_cvt_pk_bf16_f32 v48, v48, v49
    v_mul_f32 v109, v109, v93
    v_cvt_pk_bf16_f32 v49, v50, v51
    v_mfma_f32_16x16x32_bf16 v[188:191], a[24:27], a[92:95], v[188:191]
    buffer_load_dwordx4 a[56:59], v22, s[64:67], s98 offen offset:2176 sc1
    v_mfma_f32_16x16x32_bf16 v[188:191], a[28:31], a[108:111], v[188:191]
    ds_read_b64_tr_b16 a[18:19], v6 offset:512
    v_cvt_pk_bf16_f32 v50, v52, v53
    v_mfma_f32_16x16x32_bf16 v[244:247], a[24:27], a[80:83], v[244:247]
    ds_read_b64_tr_b16 a[20:21], v6 offset:4096
    v_mul_f32 v110, v110, v94
    v_mfma_f32_16x16x32_bf16 v[244:247], a[28:31], a[96:99], v[244:247]
    v_cvt_pk_bf16_f32 v51, v54, v55
    v_mfma_f32_16x16x32_bf16 v[252:255], a[24:27], a[88:91], v[252:255]
    buffer_load_dwordx4 a[60:63], v21, s[64:67], s98 offen offset:2176 sc1
    v_mfma_f32_16x16x32_bf16 v[252:255], a[28:31], a[104:107], v[252:255]
    ds_read_b64_tr_b16 a[22:23], v6 offset:4608
    s_waitcnt vmcnt(33)
    v_mfma_f32_16x16x32_bf16 v[128:131], a[0:3], a[116:119], v[128:131]
    ds_read_b64_tr_b16 a[24:25], v7 offset:0
    s_waitcnt vmcnt(29)
    v_mfma_f32_16x16x32_bf16 v[128:131], a[4:7], a[132:135], v[128:131]
    s_add_u32 s100, s100, 0x800
    s_cmp_eq_u32 s95, 13
    s_cselect_b32 s100, 0x7f000000, s100
    v_mfma_f32_16x16x32_bf16 v[136:139], a[0:3], a[124:127], v[136:139]
    s_mov_b32 s10, 0x380000
    s_xor_b32 m0, s15, 0xc000
    ds_read_b64_tr_b16 a[26:27], v7 offset:512
    s_waitcnt vmcnt(27)
    v_mfma_f32_16x16x32_bf16 v[136:139], a[4:7], a[140:143], v[136:139]
    buffer_load_dwordx4 v8, s[48:51], s10 offen offset:0 lds
    v_mfma_f32_16x16x32_bf16 v[192:195], a[0:3], a[112:115], v[192:195]
    ds_read_b64_tr_b16 a[28:29], v7 offset:4096
    v_mul_f32 v111, v111, v95
    v_mfma_f32_16x16x32_bf16 v[192:195], a[4:7], a[128:131], v[192:195]
    buffer_store_dwordx4 v[48:51], v0, s[44:47], s100 offen sc1
    v_exp_f32 v104, v104
    v_mfma_f32_16x16x32_bf16 v[200:203], a[0:3], a[120:123], v[200:203]
    ds_read_b64_tr_b16 a[30:31], v7 offset:4608
    v_mfma_f32_16x16x32_bf16 v[200:203], a[4:7], a[136:139], v[200:203]
    s_waitcnt lgkmcnt(4)
    v_exp_f32 v105, v105
    v_mfma_f32_16x16x32_bf16 v[132:135], a[8:11], a[116:119], v[132:135]
    buffer_load_dwordx4 v9, s[48:51], s10 offen offset:1024 lds
    v_mfma_f32_16x16x32_bf16 v[132:135], a[12:15], a[132:135], v[132:135]
    ds_read_b64_tr_b16 a[0:1], v4 offset:8192
    v_mfma_f32_16x16x32_bf16 v[140:143], a[8:11], a[124:127], v[140:143]
    ds_read_b64_tr_b16 a[2:3], v4 offset:8704
    v_mfma_f32_16x16x32_bf16 v[140:143], a[12:15], a[140:143], v[140:143]
    v_exp_f32 v106, v106
    v_mfma_f32_16x16x32_bf16 v[196:199], a[8:11], a[112:115], v[196:199]
    buffer_load_dwordx4 v10, s[48:51], s10 offen offset:2048 lds
    v_mfma_f32_16x16x32_bf16 v[196:199], a[12:15], a[128:131], v[196:199]
    ds_read_b64_tr_b16 a[4:5], v4 offset:12288
    v_exp_f32 v107, v107
    v_mfma_f32_16x16x32_bf16 v[204:207], a[8:11], a[120:123], v[204:207]
    ds_read_b64_tr_b16 a[6:7], v4 offset:12800
    v_exp_f32 v108, v108
    v_mfma_f32_16x16x32_bf16 v[204:207], a[12:15], a[136:139], v[204:207]
    v_exp_f32 v109, v109
    v_mfma_f32_16x16x32_bf16 v[144:147], a[16:19], a[116:119], v[144:147]
    ds_read_b64_tr_b16 a[8:9], v5 offset:8192
    v_exp_f32 v110, v110
    v_mfma_f32_16x16x32_bf16 v[144:147], a[20:23], a[132:135], v[144:147]
    buffer_load_dwordx4 v11, s[48:51], s10 offen offset:3072 lds
    v_mfma_f32_16x16x32_bf16 v[152:155], a[16:19], a[124:127], v[152:155]
    ds_read_b64_tr_b16 a[10:11], v5 offset:8704
    v_exp_f32 v111, v111
    v_mfma_f32_16x16x32_bf16 v[152:155], a[20:23], a[140:143], v[152:155]
    v_add_f32 v104, 1.0, v104
    v_add_f32 v105, 1.0, v105
    v_mfma_f32_16x16x32_bf16 v[208:211], a[16:19], a[112:115], v[208:211]
    s_mov_b32 s98, 0x7000
    ds_read_b64_tr_b16 a[12:13], v5 offset:12288
    v_add_f32 v106, 1.0, v106
    v_mfma_f32_16x16x32_bf16 v[208:211], a[20:23], a[128:131], v[208:211]
    buffer_load_dwordx4 a[64:67], v22, s[64:67], s98 offen sc1
    v_mfma_f32_16x16x32_bf16 v[216:219], a[16:19], a[120:123], v[216:219]
    ds_read_b64_tr_b16 a[14:15], v5 offset:12800
    v_add_f32 v107, 1.0, v107
    v_mfma_f32_16x16x32_bf16 v[216:219], a[20:23], a[136:139], v[216:219]
    s_waitcnt lgkmcnt(4)
    v_add_f32 v108, 1.0, v108
    v_add_f32 v109, 1.0, v109
    v_mfma_f32_16x16x32_bf16 v[148:151], a[24:27], a[116:119], v[148:151]
    ds_read_b64_tr_b16 a[16:17], v6 offset:8192
    v_add_f32 v110, 1.0, v110
    v_mfma_f32_16x16x32_bf16 v[148:151], a[28:31], a[132:135], v[148:151]
    v_add_f32 v111, 1.0, v111
    v_mfma_f32_16x16x32_bf16 v[156:159], a[24:27], a[124:127], v[156:159]
    buffer_load_dwordx4 a[68:71], v23, s[64:67], s98 offen sc1
    v_mfma_f32_16x16x32_bf16 v[156:159], a[28:31], a[140:143], v[156:159]
    ds_read_b64_tr_b16 a[18:19], v6 offset:8704
    v_mfma_f32_16x16x32_bf16 v[212:215], a[24:27], a[112:115], v[212:215]
    ds_read_b64_tr_b16 a[20:21], v6 offset:12288
    v_rcp_f32 v104, v104
    v_mfma_f32_16x16x32_bf16 v[212:215], a[28:31], a[128:131], v[212:215]
    v_rcp_f32 v105, v105
    v_mfma_f32_16x16x32_bf16 v[220:223], a[24:27], a[120:123], v[220:223]
    ds_read_b64_tr_b16 a[22:23], v6 offset:12800
    v_rcp_f32 v106, v106
    v_mfma_f32_16x16x32_bf16 v[220:223], a[28:31], a[136:139], v[220:223]
    buffer_load_dwordx4 a[72:75], v22, s[64:67], s98 offen offset:128 sc1
    v_mfma_f32_16x16x32_bf16 v[160:163], a[0:3], a[116:119], v[160:163]
    ds_read_b64_tr_b16 a[24:25], v7 offset:8192
    v_rcp_f32 v107, v107
    v_mfma_f32_16x16x32_bf16 v[160:163], a[4:7], a[132:135], v[160:163]
    v_rcp_f32 v108, v108
    v_mfma_f32_16x16x32_bf16 v[168:171], a[0:3], a[124:127], v[168:171]
    s_waitcnt vmcnt(31)
    s_barrier
    ds_read_b64_tr_b16 a[26:27], v7 offset:8704
    v_rcp_f32 v109, v109
    v_mfma_f32_16x16x32_bf16 v[168:171], a[4:7], a[140:143], v[168:171]
    buffer_load_dwordx4 a[76:79], v21, s[64:67], s98 offen offset:128 sc1
    v_rcp_f32 v110, v110
    v_mfma_f32_16x16x32_bf16 v[224:227], a[0:3], a[112:115], v[224:227]
    ds_read_b64_tr_b16 a[28:29], v7 offset:12288
    v_mfma_f32_16x16x32_bf16 v[224:227], a[4:7], a[128:131], v[224:227]
    v_rcp_f32 v111, v111
    v_mfma_f32_16x16x32_bf16 v[232:235], a[0:3], a[120:123], v[232:235]
    ds_read_b64_tr_b16 a[30:31], v7 offset:12800
    v_mul_f32 v88, v104, v88
    v_mfma_f32_16x16x32_bf16 v[232:235], a[4:7], a[136:139], v[232:235]
    s_waitcnt lgkmcnt(4)
    v_mul_f32 v89, v105, v89
    v_mul_f32 v90, v106, v90
    v_mfma_f32_16x16x32_bf16 v[164:167], a[8:11], a[116:119], v[164:167]
    buffer_load_dwordx4 a[80:83], v22, s[64:67], s98 offen offset:2048 sc1
    v_mfma_f32_16x16x32_bf16 v[164:167], a[12:15], a[132:135], v[164:167]
    ds_read_b64_tr_b16 a[0:1], v4 offset:16384
    v_mul_f32 v91, v107, v91
    v_mfma_f32_16x16x32_bf16 v[172:175], a[8:11], a[124:127], v[172:175]
    ds_read_b64_tr_b16 a[2:3], v4 offset:16896
    v_mul_f32 v92, v108, v92
    v_mfma_f32_16x16x32_bf16 v[172:175], a[12:15], a[140:143], v[172:175]
    v_mul_f32 v93, v109, v93
    v_mul_f32 v94, v110, v94
    v_mfma_f32_16x16x32_bf16 v[228:231], a[8:11], a[112:115], v[228:231]
    ds_read_b64_tr_b16 a[4:5], v4 offset:20480
    v_mul_f32 v95, v111, v95
    v_mfma_f32_16x16x32_bf16 v[228:231], a[12:15], a[128:131], v[228:231]
    buffer_load_dwordx4 a[84:87], v23, s[64:67], s98 offen offset:2048 sc1
    v_mfma_f32_16x16x32_bf16 v[236:239], a[8:11], a[120:123], v[236:239]
    ds_read_b64_tr_b16 a[6:7], v4 offset:20992
    v_cvt_pk_bf16_f32 v88, v88, v89
    v_mfma_f32_16x16x32_bf16 v[236:239], a[12:15], a[136:139], v[236:239]
    v_cvt_pk_bf16_f32 v89, v90, v91
    v_cvt_pk_bf16_f32 v90, v92, v93
    v_mfma_f32_16x16x32_bf16 v[176:179], a[16:19], a[116:119], v[176:179]
    ds_read_b64_tr_b16 a[8:9], v5 offset:16384
    v_cvt_pk_bf16_f32 v91, v94, v95
    v_mfma_f32_16x16x32_bf16 v[176:179], a[20:23], a[132:135], v[176:179]
    buffer_store_dwordx4 v[88:91], v0, s[44:47], s96 offen offset:256 sc1
    buffer_load_dwordx4 a[88:91], v22, s[64:67], s98 offen offset:2176 sc1
    v_cvt_pk_bf16_f32 v56, v56, v57
    v_mfma_f32_16x16x32_bf16 v[184:187], a[16:19], a[124:127], v[184:187]
    ds_read_b64_tr_b16 a[10:11], v5 offset:16896
    v_cvt_pk_bf16_f32 v57, v58, v59
    v_mfma_f32_16x16x32_bf16 v[184:187], a[20:23], a[140:143], v[184:187]
    v_cvt_pk_bf16_f32 v58, v60, v61
    v_cvt_pk_bf16_f32 v59, v62, v63
    v_mfma_f32_16x16x32_bf16 v[240:243], a[16:19], a[112:115], v[240:243]
    buffer_store_dwordx4 v[56:59], v0, s[44:47], s100 offen offset:256 sc1
    ds_read_b64_tr_b16 a[12:13], v5 offset:20480
    v_mfma_f32_16x16x32_bf16 v[240:243], a[20:23], a[128:131], v[240:243]
    v_mfma_f32_16x16x32_bf16 v[248:251], a[16:19], a[120:123], v[248:251]
    buffer_load_dwordx4 a[92:95], v21, s[64:67], s98 offen offset:2176 sc1
    v_mfma_f32_16x16x32_bf16 v[248:251], a[20:23], a[136:139], v[248:251]
    ds_read_b64_tr_b16 a[14:15], v5 offset:20992
    s_waitcnt lgkmcnt(4)
    v_mfma_f32_16x16x32_bf16 v[180:183], a[24:27], a[116:119], v[180:183]
    ds_read_b64_tr_b16 a[16:17], v6 offset:16384
    v_mfma_f32_16x16x32_bf16 v[180:183], a[28:31], a[132:135], v[180:183]
    s_mov_b32 s10, 0x400000
    s_xor_b32 m0, s15, 0x10000
    v_mfma_f32_16x16x32_bf16 v[188:191], a[24:27], a[124:127], v[188:191]
    buffer_load_dwordx4 v8, s[48:51], s10 offen offset:0 lds
    v_mfma_f32_16x16x32_bf16 v[188:191], a[28:31], a[140:143], v[188:191]
    ds_read_b64_tr_b16 a[18:19], v6 offset:16896
    v_mfma_f32_16x16x32_bf16 v[244:247], a[24:27], a[112:115], v[244:247]
    ds_read_b64_tr_b16 a[20:21], v6 offset:20480
    v_mfma_f32_16x16x32_bf16 v[244:247], a[28:31], a[128:131], v[244:247]
    v_mfma_f32_16x16x32_bf16 v[252:255], a[24:27], a[120:123], v[252:255]
    ds_read_b64_tr_b16 a[22:23], v6 offset:20992
    v_mfma_f32_16x16x32_bf16 v[252:255], a[28:31], a[136:139], v[252:255]
    buffer_load_dwordx4 v9, s[48:51], s10 offen offset:1024 lds
    s_waitcnt vmcnt(37)
    v_mfma_f32_16x16x32_bf16 v[128:131], a[0:3], a[148:151], v[128:131]
    ds_read_b64_tr_b16 a[24:25], v7 offset:16384
    s_waitcnt vmcnt(32)
    v_mfma_f32_16x16x32_bf16 v[128:131], a[4:7], a[164:167], v[128:131]
    v_mfma_f32_16x16x32_bf16 v[136:139], a[0:3], a[156:159], v[136:139]
    ds_read_b64_tr_b16 a[26:27], v7 offset:16896
    s_waitcnt vmcnt(30)
    v_mfma_f32_16x16x32_bf16 v[136:139], a[4:7], a[172:175], v[136:139]
    v_mfma_f32_16x16x32_bf16 v[192:195], a[0:3], a[144:147], v[192:195]
    buffer_load_dwordx4 v10, s[48:51], s10 offen offset:2048 lds
    v_mfma_f32_16x16x32_bf16 v[192:195], a[4:7], a[160:163], v[192:195]
    ds_read_b64_tr_b16 a[28:29], v7 offset:20480
    v_mfma_f32_16x16x32_bf16 v[200:203], a[0:3], a[152:155], v[200:203]
    ds_read_b64_tr_b16 a[30:31], v7 offset:20992
    v_mfma_f32_16x16x32_bf16 v[200:203], a[4:7], a[168:171], v[200:203]
    s_waitcnt lgkmcnt(4)
    v_mfma_f32_16x16x32_bf16 v[132:135], a[8:11], a[148:151], v[132:135]
    buffer_load_dwordx4 v11, s[48:51], s10 offen offset:3072 lds
    v_mfma_f32_16x16x32_bf16 v[132:135], a[12:15], a[164:167], v[132:135]
    ds_read_b64_tr_b16 a[0:1], v4 offset:24576
    v_mfma_f32_16x16x32_bf16 v[140:143], a[8:11], a[156:159], v[140:143]
    ds_read_b64_tr_b16 a[2:3], v4 offset:25088
    v_mfma_f32_16x16x32_bf16 v[140:143], a[12:15], a[172:175], v[140:143]
    v_mfma_f32_16x16x32_bf16 v[196:199], a[8:11], a[144:147], v[196:199]
    s_mov_b32 s10, 0x480000
    s_xor_b32 m0, s15, 0x14000
    ds_read_b64_tr_b16 a[4:5], v4 offset:28672
    v_mfma_f32_16x16x32_bf16 v[196:199], a[12:15], a[160:163], v[196:199]
    buffer_load_dwordx4 v8, s[48:51], s10 offen offset:0 lds
    v_mfma_f32_16x16x32_bf16 v[204:207], a[8:11], a[152:155], v[204:207]
    ds_read_b64_tr_b16 a[6:7], v4 offset:29184
    v_mfma_f32_16x16x32_bf16 v[204:207], a[12:15], a[168:171], v[204:207]
    v_mfma_f32_16x16x32_bf16 v[144:147], a[16:19], a[148:151], v[144:147]
    ds_read_b64_tr_b16 a[8:9], v5 offset:24576
    v_mfma_f32_16x16x32_bf16 v[144:147], a[20:23], a[164:167], v[144:147]
    buffer_load_dwordx4 v9, s[48:51], s10 offen offset:1024 lds
    v_mfma_f32_16x16x32_bf16 v[152:155], a[16:19], a[156:159], v[152:155]
    ds_read_b64_tr_b16 a[10:11], v5 offset:25088
    v_mfma_f32_16x16x32_bf16 v[152:155], a[20:23], a[172:175], v[152:155]
    v_mfma_f32_16x16x32_bf16 v[208:211], a[16:19], a[144:147], v[208:211]
    ds_read_b64_tr_b16 a[12:13], v5 offset:28672
    v_mfma_f32_16x16x32_bf16 v[208:211], a[20:23], a[160:163], v[208:211]
    v_mfma_f32_16x16x32_bf16 v[216:219], a[16:19], a[152:155], v[216:219]
    buffer_load_dwordx4 v10, s[48:51], s10 offen offset:2048 lds
    v_mfma_f32_16x16x32_bf16 v[216:219], a[20:23], a[168:171], v[216:219]
    ds_read_b64_tr_b16 a[14:15], v5 offset:29184
    s_waitcnt lgkmcnt(8)
    v_mfma_f32_16x16x32_bf16 v[148:151], a[24:27], a[148:151], v[148:151]
    ds_read_b64_tr_b16 a[16:17], v6 offset:24576
    v_mfma_f32_16x16x32_bf16 v[148:151], a[28:31], a[164:167], v[148:151]
    v_mfma_f32_16x16x32_bf16 v[156:159], a[24:27], a[156:159], v[156:159]
    ds_read_b64_tr_b16 a[18:19], v6 offset:25088
    v_mfma_f32_16x16x32_bf16 v[156:159], a[28:31], a[172:175], v[156:159]
    buffer_load_dwordx4 v11, s[48:51], s10 offen offset:3072 lds
    v_mfma_f32_16x16x32_bf16 v[212:215], a[24:27], a[144:147], v[212:215]
    s_cmp_lg_u32 s3, 0
    s_cbranch_scc1 fk_l1
    buffer_load_dword v27, v28, s[68:71], s97 offen sc1
fk_l1:
    v_mfma_f32_16x16x32_bf16 v[212:215], a[28:31], a[160:163], v[212:215]
    ds_read_b64_tr_b16 a[20:21], v6 offset:28672
    v_mfma_f32_16x16x32_bf16 v[220:223], a[24:27], a[152:155], v[220:223]
    s_mov_b32 s98, 0x8000
    ds_read_b64_tr_b16 a[22:23], v6 offset:29184
    v_mfma_f32_16x16x32_bf16 v[220:223], a[28:31], a[168:171], v[220:223]
    s_waitcnt lgkmcnt(8)
    buffer_load_dwordx4 a[96:99], v22, s[64:67], s98 offen sc1
    v_mfma_f32_16x16x32_bf16 v[160:163], a[0:3], a[148:151], v[160:163]
    ds_read_b64_tr_b16 a[24:25], v7 offset:24576
    v_mfma_f32_16x16x32_bf16 v[160:163], a[4:7], a[164:167], v[160:163]
    v_mfma_f32_16x16x32_bf16 v[168:171], a[0:3], a[156:159], v[168:171]
    s_waitcnt vmcnt(10)
    s_barrier
    ds_read_b64_tr_b16 a[26:27], v7 offset:25088
    v_mfma_f32_16x16x32_bf16 v[168:171], a[4:7], a[172:175], v[168:171]
    v_mfma_f32_16x16x32_bf16 v[224:227], a[0:3], a[144:147], v[224:227]
    buffer_load_dwordx4 a[100:103], v23, s[64:67], s98 offen sc1
    v_mfma_f32_16x16x32_bf16 v[224:227], a[4:7], a[160:163], v[224:227]
    ds_read_b64_tr_b16 a[28:29], v7 offset:28672
    v_mfma_f32_16x16x32_bf16 v[232:235], a[0:3], a[152:155], v[232:235]
    s_cmp_lg_u32 s3, 0
    s_cbranch_scc1 fk_p2c
    s_cmp_ge_u32 s5, 28
    s_cbranch_scc1 fk_p2c
    s_lshl_b32 s12, s8, 4
    s_add_u32 s11, s95, s12
    s_lshl_b32 s11, s11, 2
    s_add_u32 s11, s11, 0x2000
    v_mov_b32 v30, 1
    s_mov_b64 exec, 1
    buffer_store_dword v30, off, s[68:71], s11 sc1
    s_mov_b64 exec, -1
fk_p2c:
    v_mfma_f32_16x16x32_bf16 v[232:235], a[4:7], a[168:171], v[232:235]
    s_mov_b32 s11, 0x1300000
    ds_read_b64_tr_b16 a[30:31], v7 offset:29184
    s_waitcnt lgkmcnt(4)
    v_mfma_f32_16x16x32_bf16 v[164:167], a[8:11], a[148:151], v[164:167]
    buffer_load_dwordx4 a[104:107], v22, s[64:67], s98 offen offset:128 sc1
    v_mfma_f32_16x16x32_bf16 v[164:167], a[12:15], a[164:167], v[164:167]
    ds_read_b64_tr_b16 a[0:1], v4 offset:32768
    v_mfma_f32_16x16x32_bf16 v[172:175], a[8:11], a[156:159], v[172:175]
    ds_read_b64_tr_b16 a[2:3], v4 offset:33280
    v_mfma_f32_16x16x32_bf16 v[172:175], a[12:15], a[172:175], v[172:175]
    s_cmp_lt_u32 s3, 2
    s_cselect_b32 s11, 0x300000, s11
    s_cselect_b32 s91, 0, 0xffffa000
    v_mfma_f32_16x16x32_bf16 v[228:231], a[8:11], a[144:147], v[228:231]
    s_lshl_b32 s12, s6, 19
    s_add_u32 s11, s11, s12
    ds_read_b64_tr_b16 a[4:5], v4 offset:36864
    v_mfma_f32_16x16x32_bf16 v[228:231], a[12:15], a[160:163], v[228:231]
    buffer_load_dwordx4 a[108:111], v21, s[64:67], s98 offen offset:128 sc1
    v_mfma_f32_16x16x32_bf16 v[236:239], a[8:11], a[152:155], v[236:239]
    s_and_b32 s12, s3, 1
    s_lshl_b32 s12, s12, 12
    ds_read_b64_tr_b16 a[6:7], v4 offset:37376
    v_mfma_f32_16x16x32_bf16 v[236:239], a[12:15], a[168:171], v[236:239]
    s_add_u32 s11, s11, s12
    s_add_u32 s52, s42, s11
    s_addc_u32 s53, s43, 0
    v_mfma_f32_16x16x32_bf16 v[176:179], a[16:19], a[148:151], v[176:179]
    s_mov_b32 s54, 0x7f000
    s_mov_b32 s55, 0x20000
    ds_read_b64_tr_b16 a[8:9], v5 offset:32768
    v_mfma_f32_16x16x32_bf16 v[176:179], a[20:23], a[164:167], v[176:179]
    s_lshl_b32 s11, s7, 15
    s_cselect_b32 s92, 0, 0x8000
    s_add_u32 s91, s91, s11
    v_mfma_f32_16x16x32_bf16 v[184:187], a[16:19], a[156:159], v[184:187]
    buffer_load_dwordx4 a[112:115], v22, s[64:67], s98 offen offset:2048 sc1
    v_mfma_f32_16x16x32_bf16 v[184:187], a[20:23], a[172:175], v[184:187]
    s_add_u32 s90, s11, 0x8000
    ds_read_b64_tr_b16 a[10:11], v5 offset:33280
    v_mfma_f32_16x16x32_bf16 v[240:243], a[16:19], a[144:147], v[240:243]
    ds_read_b64_tr_b16 a[12:13], v5 offset:36864
    v_mfma_f32_16x16x32_bf16 v[240:243], a[20:23], a[160:163], v[240:243]
    v_mfma_f32_16x16x32_bf16 v[248:251], a[16:19], a[152:155], v[248:251]
    buffer_load_dwordx4 a[116:119], v23, s[64:67], s98 offen offset:2048 sc1
    v_mfma_f32_16x16x32_bf16 v[248:251], a[20:23], a[168:171], v[248:251]
    ds_read_b64_tr_b16 a[14:15], v5 offset:37376
    s_waitcnt lgkmcnt(4)
    v_mfma_f32_16x16x32_bf16 v[180:183], a[24:27], a[148:151], v[180:183]
    ds_read_b64_tr_b16 a[16:17], v6 offset:32768
    v_mfma_f32_16x16x32_bf16 v[180:183], a[28:31], a[164:167], v[180:183]
    v_mfma_f32_16x16x32_bf16 v[188:191], a[24:27], a[156:159], v[188:191]
    ds_read_b64_tr_b16 a[18:19], v6 offset:33280
    v_mfma_f32_16x16x32_bf16 v[188:191], a[28:31], a[172:175], v[188:191]
    buffer_load_dwordx4 a[120:123], v22, s[64:67], s98 offen offset:2176 sc1
    v_mfma_f32_16x16x32_bf16 v[244:247], a[24:27], a[144:147], v[244:247]
    ds_read_b64_tr_b16 a[20:21], v6 offset:36864
    v_mfma_f32_16x16x32_bf16 v[244:247], a[28:31], a[160:163], v[244:247]
    v_mfma_f32_16x16x32_bf16 v[252:255], a[24:27], a[152:155], v[252:255]
    ds_read_b64_tr_b16 a[22:23], v6 offset:37376
    v_mfma_f32_16x16x32_bf16 v[252:255], a[28:31], a[168:171], v[252:255]
    buffer_load_dwordx4 a[124:127], v21, s[64:67], s98 offen offset:2176 sc1
    v_mfma_f32_16x16x32_bf16 v[128:131], a[0:3], a[180:183], v[128:131]
    ds_read_b64_tr_b16 a[24:25], v7 offset:32768
    v_mfma_f32_16x16x32_bf16 v[128:131], a[4:7], a[52:55], v[128:131]
    v_mfma_f32_16x16x32_bf16 v[136:139], a[0:3], a[188:191], v[136:139]
    ds_read_b64_tr_b16 a[26:27], v7 offset:33280
    v_mfma_f32_16x16x32_bf16 v[136:139], a[4:7], a[60:63], v[136:139]
    s_mov_b32 s98, 0x9000
    v_mfma_f32_16x16x32_bf16 v[192:195], a[0:3], a[176:179], v[192:195]
    buffer_load_dwordx4 a[128:131], v22, s[64:67], s98 offen sc1
    v_mfma_f32_16x16x32_bf16 v[192:195], a[4:7], a[48:51], v[192:195]
    ds_read_b64_tr_b16 a[28:29], v7 offset:36864
    v_mfma_f32_16x16x32_bf16 v[200:203], a[0:3], a[184:187], v[200:203]
    ds_read_b64_tr_b16 a[30:31], v7 offset:37376
    v_mfma_f32_16x16x32_bf16 v[200:203], a[4:7], a[56:59], v[200:203]
    s_waitcnt lgkmcnt(4)
    v_mfma_f32_16x16x32_bf16 v[132:135], a[8:11], a[180:183], v[132:135]
    ds_read_b64_tr_b16 a[0:1], v4 offset:40960
    v_mfma_f32_16x16x32_bf16 v[132:135], a[12:15], a[52:55], v[132:135]
    buffer_load_dwordx4 a[132:135], v23, s[64:67], s98 offen sc1
    v_mfma_f32_16x16x32_bf16 v[140:143], a[8:11], a[188:191], v[140:143]
    ds_read_b64_tr_b16 a[2:3], v4 offset:41472
    v_mfma_f32_16x16x32_bf16 v[140:143], a[12:15], a[60:63], v[140:143]
    v_mfma_f32_16x16x32_bf16 v[196:199], a[8:11], a[176:179], v[196:199]
    ds_read_b64_tr_b16 a[4:5], v4 offset:45056
    v_mfma_f32_16x16x32_bf16 v[196:199], a[12:15], a[48:51], v[196:199]
    buffer_load_dwordx4 a[136:139], v22, s[64:67], s98 offen offset:128 sc1
    v_mfma_f32_16x16x32_bf16 v[204:207], a[8:11], a[184:187], v[204:207]
    ds_read_b64_tr_b16 a[6:7], v4 offset:45568
    v_mfma_f32_16x16x32_bf16 v[204:207], a[12:15], a[56:59], v[204:207]
    v_mfma_f32_16x16x32_bf16 v[144:147], a[16:19], a[180:183], v[144:147]
    buffer_load_dword v3, v2, s[28:31], 0 offen sc1
    v_mfma_f32_16x16x32_bf16 v[144:147], a[20:23], a[52:55], v[144:147]
    ds_read_b64_tr_b16 a[8:9], v5 offset:40960
    v_mfma_f32_16x16x32_bf16 v[152:155], a[16:19], a[188:191], v[152:155]
    buffer_load_dwordx4 a[140:143], v21, s[64:67], s98 offen offset:128 sc1
    v_mfma_f32_16x16x32_bf16 v[152:155], a[20:23], a[60:63], v[152:155]
    ds_read_b64_tr_b16 a[10:11], v5 offset:41472
    v_mfma_f32_16x16x32_bf16 v[208:211], a[16:19], a[176:179], v[208:211]
    ds_read_b64_tr_b16 a[12:13], v5 offset:45056
    v_mfma_f32_16x16x32_bf16 v[208:211], a[20:23], a[48:51], v[208:211]
    v_mfma_f32_16x16x32_bf16 v[216:219], a[16:19], a[184:187], v[216:219]
    buffer_load_dwordx4 a[144:147], v22, s[64:67], s98 offen offset:2048 sc1
    v_mfma_f32_16x16x32_bf16 v[216:219], a[20:23], a[56:59], v[216:219]
    ds_read_b64_tr_b16 a[14:15], v5 offset:45568
    s_waitcnt lgkmcnt(8)
    v_mfma_f32_16x16x32_bf16 v[148:151], a[24:27], a[180:183], v[148:151]
    ds_read_b64_tr_b16 a[16:17], v6 offset:40960
    v_mfma_f32_16x16x32_bf16 v[148:151], a[28:31], a[52:55], v[148:151]
    v_mfma_f32_16x16x32_bf16 v[156:159], a[24:27], a[188:191], v[156:159]
    ds_read_b64_tr_b16 a[18:19], v6 offset:41472
    v_mfma_f32_16x16x32_bf16 v[156:159], a[28:31], a[60:63], v[156:159]
    buffer_load_dwordx4 a[148:151], v23, s[64:67], s98 offen offset:2048 sc1
    v_mfma_f32_16x16x32_bf16 v[212:215], a[24:27], a[176:179], v[212:215]
    s_cmp_lg_u32 s3, 0
    s_cbranch_scc1 fk_p2d
    s_waitcnt vmcnt(15)
    v_cmp_eq_u32 vcc, 1, v27
    s_nop 0
    s_bfe_u32 s11, vcc_lo, 0x80000
    s_cmp_ge_u32 s11, 255
    s_cbranch_scc0 fk_w1_slow
fk_w1_ok:
fk_p2d:
    v_mfma_f32_16x16x32_bf16 v[212:215], a[28:31], a[48:51], v[212:215]
    s_add_u32 s56, s42, 0x3000000
    s_addc_u32 s57, s43, 0
    ds_read_b64_tr_b16 a[20:21], v6 offset:45056
    v_mfma_f32_16x16x32_bf16 v[220:223], a[24:27], a[184:187], v[220:223]
    s_mov_b32 s58, 0x1360000
    s_mov_b32 s59, 0x20000
    ds_read_b64_tr_b16 a[22:23], v6 offset:45568
    v_mfma_f32_16x16x32_bf16 v[220:223], a[28:31], a[56:59], v[220:223]
    s_xor_b32 s93, s15, 0x10000
    s_mov_b32 s95, 0
    s_mov_b32 s97, 0x3e0293ee
    s_waitcnt lgkmcnt(8)
    v_mfma_f32_16x16x32_bf16 v[160:163], a[0:3], a[180:183], v[160:163]
    buffer_load_dwordx4 a[152:155], v22, s[64:67], s98 offen offset:2176 sc1
    v_mfma_f32_16x16x32_bf16 v[160:163], a[4:7], a[52:55], v[160:163]
    s_lshr_b32 s94, s3, 1
    s_lshl2_add_u32 s94, s7, s94
    ds_read_b64_tr_b16 a[24:25], v7 offset:40960
    v_mfma_f32_16x16x32_bf16 v[168:171], a[0:3], a[188:191], v[168:171]
    s_barrier
    s_mul_i32 s94, s94, 155
    ds_read_b64_tr_b16 a[26:27], v7 offset:41472
    v_mfma_f32_16x16x32_bf16 v[168:171], a[4:7], a[60:63], v[168:171]
    s_lshl_b32 s12, s6, 2
    s_add_u32 s94, s94, s12
    s_lshl_b32 s94, s94, 11
    v_mfma_f32_16x16x32_bf16 v[224:227], a[0:3], a[176:179], v[224:227]
    s_waitcnt lgkmcnt(2)
    buffer_load_dwordx4 a[156:159], v21, s[64:67], s98 offen offset:2176 sc1
    v_mfma_f32_16x16x32_bf16 v[224:227], a[4:7], a[48:51], v[224:227]
    s_and_b32 s12, s3, 1
    s_lshl_b32 s12, s12, 8
    ds_read_b64_tr_b16 a[28:29], v7 offset:45056
    v_mfma_f32_16x16x32_bf16 v[232:235], a[0:3], a[184:187], v[232:235]
    s_add_u32 s94, s94, s12
    s_lshl_b32 s11, s6, 4
    ds_read_b64_tr_b16 a[30:31], v7 offset:45568
    v_mfma_f32_16x16x32_bf16 v[232:235], a[4:7], a[56:59], v[232:235]
    s_add_u32 s10, s91, 0x0
    s_add_u32 s11, s11, s7
    s_lshl_b32 s11, s11, 15
    v_mfma_f32_16x16x32_bf16 v[164:167], a[8:11], a[180:183], v[164:167]
    s_cmp_ge_u32 s3, 2
    s_cselect_b32 s10, 0x7f000000, s10
    s_xor_b32 m0, s15, 0x18000
    v_mfma_f32_16x16x32_bf16 v[164:167], a[12:15], a[52:55], v[164:167]
    buffer_load_dwordx4 v2, s[52:55], s10 offen offset:0 sc1 lds
    v_mfma_f32_16x16x32_bf16 v[172:175], a[8:11], a[188:191], v[172:175]
    s_add_u32 s11, s11, 0x340000
    ds_read_b64_tr_b16 a[0:1], v4 offset:49152
    ds_read_b64_tr_b16 a[2:3], v4 offset:49664
    v_mfma_f32_16x16x32_bf16 v[172:175], a[12:15], a[60:63], v[172:175]
    s_mov_b32 s12, 0x1008000
    s_add_u32 s84, s42, s11
    s_addc_u32 s85, s43, 0
    v_mfma_f32_16x16x32_bf16 v[228:231], a[8:11], a[176:179], v[228:231]
    s_mov_b32 s86, s12
    s_mov_b32 s87, 0x20000
    ds_read_b64_tr_b16 a[4:5], v4 offset:53248
    v_mfma_f32_16x16x32_bf16 v[228:231], a[12:15], a[48:51], v[228:231]
    buffer_load_dwordx4 v2, s[52:55], s10 offen offset:1024 sc1 lds
    v_mfma_f32_16x16x32_bf16 v[236:239], a[8:11], a[184:187], v[236:239]
    s_and_b32 s11, s15, 0x10000
    ds_read_b64_tr_b16 a[6:7], v4 offset:53760
    v_add_u32 v16, s11, v2
    v_mfma_f32_16x16x32_bf16 v[236:239], a[12:15], a[56:59], v[236:239]
    v_xor_b32 v17, 0x10000, v16
    v_and_b32 v124, 1, v1
    v_mfma_f32_16x16x32_bf16 v[176:179], a[16:19], a[180:183], v[176:179]
    ds_read_b64_tr_b16 a[8:9], v5 offset:49152
    v_mul_u32_u24 v124, 0xaaaa, v124
    v_mfma_f32_16x16x32_bf16 v[176:179], a[20:23], a[52:55], v[176:179]
    v_add_u32 v124, 0x4444, v124
    v_mov_b32 v112, 0
    v_mfma_f32_16x16x32_bf16 v[184:187], a[16:19], a[188:191], v[184:187]
    buffer_load_dwordx4 v2, s[52:55], s10 offen offset:2048 sc1 lds
    v_mfma_f32_16x16x32_bf16 v[184:187], a[20:23], a[60:63], v[184:187]
    ds_read_b64_tr_b16 a[10:11], v5 offset:49664
    v_mov_b32 v113, 0
    v_mfma_f32_16x16x32_bf16 v[240:243], a[16:19], a[176:179], v[240:243]
    ds_read_b64_tr_b16 a[12:13], v5 offset:53248
    v_mov_b32 v114, 0
    v_mfma_f32_16x16x32_bf16 v[240:243], a[20:23], a[48:51], v[240:243]
    v_mov_b32 v115, 0
    v_mov_b32 v116, 0
    v_mfma_f32_16x16x32_bf16 v[248:251], a[16:19], a[184:187], v[248:251]
    ds_read_b64_tr_b16 a[14:15], v5 offset:53760
    v_mov_b32 v117, 0
    v_mfma_f32_16x16x32_bf16 v[248:251], a[20:23], a[56:59], v[248:251]
    s_waitcnt lgkmcnt(4)
    buffer_load_dwordx4 v2, s[52:55], s10 offen offset:3072 sc1 lds
    v_mfma_f32_16x16x32_bf16 v[180:183], a[24:27], a[180:183], v[180:183]
    ds_read_b64_tr_b16 a[16:17], v6 offset:49152
    v_mov_b32 v118, 0
    v_mfma_f32_16x16x32_bf16 v[180:183], a[28:31], a[52:55], v[180:183]
    v_mov_b32 v119, 0
    v_mov_b32 v120, 0
    v_mfma_f32_16x16x32_bf16 v[188:191], a[24:27], a[188:191], v[188:191]
    ds_read_b64_tr_b16 a[18:19], v6 offset:49664
    v_mov_b32 v121, 0
    v_mfma_f32_16x16x32_bf16 v[188:191], a[28:31], a[60:63], v[188:191]
    v_mov_b32 v122, 0
    v_mov_b32 v123, 0
    v_mfma_f32_16x16x32_bf16 v[244:247], a[24:27], a[176:179], v[244:247]
    ds_read_b64_tr_b16 a[20:21], v6 offset:53248
    v_lshrrev_b32 v29, 4, v1
    v_mfma_f32_16x16x32_bf16 v[244:247], a[28:31], a[48:51], v[244:247]
    v_xor_b32 v29, v29, v1
    v_and_b32 v29, 2, v29
    v_mfma_f32_16x16x32_bf16 v[252:255], a[24:27], a[184:187], v[252:255]
    ds_read_b64_tr_b16 a[22:23], v6 offset:53760
    v_mov_b32 v30, 0x3f803f80
    v_mfma_f32_16x16x32_bf16 v[252:255], a[28:31], a[56:59], v[252:255]
    v_cmp_eq_u32 vcc, 0, v29
    s_nop 1
    v_cndmask_b32 v12, 0, v30, vcc
    v_mfma_f32_16x16x32_bf16 v[128:131], a[0:3], a[68:71], v[128:131]
    ds_read_b64_tr_b16 a[24:25], v7 offset:49152
    v_cndmask_b32 v13, 0, v30, vcc
    v_mfma_f32_16x16x32_bf16 v[128:131], a[4:7], a[84:87], v[128:131]
    v_cndmask_b32 v14, 0, v30, vcc
    v_cndmask_b32 v15, 0, v30, vcc
    v_mfma_f32_16x16x32_bf16 v[136:139], a[0:3], a[76:79], v[136:139]
    s_lshl_b32 s11, s3, 13
    s_add_u32 s11, s11, 0x20000
    ds_read_b64_tr_b16 a[26:27], v7 offset:49664
    s_waitcnt vmcnt(29)
    v_mfma_f32_16x16x32_bf16 v[136:139], a[4:7], a[92:95], v[136:139]
    v_add_u32 v18, s11, v2
    v_xor_b32 v19, 0x6000, v18
    v_mfma_f32_16x16x32_bf16 v[192:195], a[0:3], a[64:67], v[192:195]
    ds_read_b64_tr_b16 a[28:29], v7 offset:53248
    v_and_b32 v29, 15, v1
    v_mfma_f32_16x16x32_bf16 v[192:195], a[4:7], a[80:83], v[192:195]
    v_lshrrev_b32 v30, 2, v1
    v_and_b32 v30, 12, v30
    v_mfma_f32_16x16x32_bf16 v[200:203], a[0:3], a[72:75], v[200:203]
    ds_read_b64_tr_b16 a[30:31], v7 offset:53760
    v_sub_u32 v29, v29, v30
    v_mfma_f32_16x16x32_bf16 v[200:203], a[4:7], a[88:91], v[200:203]
    v_mov_b32 v30, 0xf1800000
    s_waitcnt lgkmcnt(4)
    v_mfma_f32_16x16x32_bf16 v[132:135], a[8:11], a[68:71], v[132:135]
    s_cmp_eq_u32 s3, 0
    s_cselect_b32 s96, 1.0, 0
    ds_read_b64_tr_b16 a[0:1], v4 offset:57344
    v_mfma_f32_16x16x32_bf16 v[132:135], a[12:15], a[84:87], v[132:135]
    v_cmp_le_i32 s[72:73], 0, v29
    v_cmp_le_i32 s[74:75], 1, v29
    v_mfma_f32_16x16x32_bf16 v[140:143], a[8:11], a[76:79], v[140:143]
    ds_read_b64_tr_b16 a[2:3], v4 offset:57856
    v_cmp_le_i32 s[76:77], 2, v29
    v_mfma_f32_16x16x32_bf16 v[140:143], a[12:15], a[92:95], v[140:143]
    v_cmp_le_i32 s[78:79], 3, v29
    v_cndmask_b32 v96, v30, 0, s[72:73]
    v_mfma_f32_16x16x32_bf16 v[196:199], a[8:11], a[64:67], v[196:199]
    ds_read_b64_tr_b16 a[4:5], v4 offset:61440
    v_cndmask_b32 v97, v30, 0, s[74:75]
    v_mfma_f32_16x16x32_bf16 v[196:199], a[12:15], a[80:83], v[196:199]
    v_cndmask_b32 v98, v30, 0, s[76:77]
    v_cndmask_b32 v99, v30, 0, s[78:79]
    v_mfma_f32_16x16x32_bf16 v[204:207], a[8:11], a[72:75], v[204:207]
    s_add_u32 s10, s91, 0x4000
    ds_read_b64_tr_b16 a[6:7], v4 offset:61952
    v_cmp_le_i32 s[72:73], 16, v29
    v_mfma_f32_16x16x32_bf16 v[204:207], a[12:15], a[88:91], v[204:207]
    s_cmp_ge_u32 s3, 2
    s_cselect_b32 s10, 0x7f000000, s10
    s_xor_b32 m0, s15, 0x1c000
    v_mfma_f32_16x16x32_bf16 v[144:147], a[16:19], a[68:71], v[144:147]
    buffer_load_dwordx4 v2, s[52:55], s10 offen offset:0 sc1 lds
    v_mfma_f32_16x16x32_bf16 v[144:147], a[20:23], a[84:87], v[144:147]
    ds_read_b64_tr_b16 a[8:9], v5 offset:57344
    v_cmp_le_i32 s[74:75], 17, v29
    v_mfma_f32_16x16x32_bf16 v[152:155], a[16:19], a[76:79], v[152:155]
    ds_read_b64_tr_b16 a[10:11], v5 offset:57856
    v_cmp_le_i32 s[76:77], 18, v29
    v_mfma_f32_16x16x32_bf16 v[152:155], a[20:23], a[92:95], v[152:155]
    v_cmp_le_i32 s[78:79], 19, v29
    v_cndmask_b32 v100, v30, 0, s[72:73]
    v_mfma_f32_16x16x32_bf16 v[208:211], a[16:19], a[64:67], v[208:211]
    buffer_load_dwordx4 v2, s[52:55], s10 offen offset:1024 sc1 lds
    v_mfma_f32_16x16x32_bf16 v[208:211], a[20:23], a[80:83], v[208:211]
    ds_read_b64_tr_b16 a[12:13], v5 offset:61440
    v_cndmask_b32 v101, v30, 0, s[74:75]
    v_mfma_f32_16x16x32_bf16 v[216:219], a[16:19], a[72:75], v[216:219]
    ds_read_b64_tr_b16 a[14:15], v5 offset:61952
    v_cndmask_b32 v102, v30, 0, s[76:77]
    v_mfma_f32_16x16x32_bf16 v[216:219], a[20:23], a[88:91], v[216:219]
    s_waitcnt lgkmcnt(4)
    v_cndmask_b32 v103, v30, 0, s[78:79]
    v_cmp_le_i32 s[72:73], -16, v29
    v_mfma_f32_16x16x32_bf16 v[148:151], a[24:27], a[68:71], v[148:151]
    ds_read_b64_tr_b16 a[16:17], v6 offset:57344
    v_cmp_le_i32 s[74:75], -15, v29
    v_mfma_f32_16x16x32_bf16 v[148:151], a[28:31], a[84:87], v[148:151]
    buffer_load_dwordx4 v2, s[52:55], s10 offen offset:2048 sc1 lds
    v_mfma_f32_16x16x32_bf16 v[156:159], a[24:27], a[76:79], v[156:159]
    ds_read_b64_tr_b16 a[18:19], v6 offset:57856
    v_cmp_le_i32 s[76:77], -14, v29
    v_mfma_f32_16x16x32_bf16 v[156:159], a[28:31], a[92:95], v[156:159]
    v_cmp_le_i32 s[78:79], -13, v29
    v_cndmask_b32 v104, v30, 0, s[72:73]
    v_mfma_f32_16x16x32_bf16 v[212:215], a[24:27], a[64:67], v[212:215]
    ds_read_b64_tr_b16 a[20:21], v6 offset:61440
    v_cndmask_b32 v105, v30, 0, s[74:75]
    v_mfma_f32_16x16x32_bf16 v[212:215], a[28:31], a[80:83], v[212:215]
    buffer_load_dwordx4 v2, s[52:55], s10 offen offset:3072 sc1 lds
    v_mfma_f32_16x16x32_bf16 v[220:223], a[24:27], a[72:75], v[220:223]
    ds_read_b64_tr_b16 a[22:23], v6 offset:61952
    v_cndmask_b32 v106, v30, 0, s[76:77]
    v_mfma_f32_16x16x32_bf16 v[220:223], a[28:31], a[88:91], v[220:223]
    v_cndmask_b32 v107, v30, 0, s[78:79]
    v_cmp_le_i32 s[72:73], 0, v29
    v_mfma_f32_16x16x32_bf16 v[160:163], a[0:3], a[68:71], v[160:163]
    ds_read_b64_tr_b16 a[24:25], v7 offset:57344
    v_cmp_le_i32 s[74:75], 1, v29
    v_mfma_f32_16x16x32_bf16 v[160:163], a[4:7], a[84:87], v[160:163]
    v_cmp_le_i32 s[76:77], 2, v29
    v_cmp_le_i32 s[78:79], 3, v29
    v_mfma_f32_16x16x32_bf16 v[168:171], a[0:3], a[76:79], v[168:171]
    s_waitcnt vmcnt(25)
    s_barrier
    ds_read_b64_tr_b16 a[26:27], v7 offset:57856
    v_cndmask_b32 v108, v30, 0, s[72:73]
    v_mfma_f32_16x16x32_bf16 v[168:171], a[4:7], a[92:95], v[168:171]
    v_cndmask_b32 v109, v30, 0, s[74:75]
    v_cndmask_b32 v110, v30, 0, s[76:77]
    v_mfma_f32_16x16x32_bf16 v[224:227], a[0:3], a[64:67], v[224:227]
    ds_read_b64_tr_b16 a[28:29], v7 offset:61440
    v_cndmask_b32 v111, v30, 0, s[78:79]
    v_mfma_f32_16x16x32_bf16 v[224:227], a[4:7], a[80:83], v[224:227]
    v_mul_f32 v48, s96, v96
    v_mul_f32 v49, s96, v97
    v_mfma_f32_16x16x32_bf16 v[232:235], a[0:3], a[72:75], v[232:235]
    ds_read_b64_tr_b16 a[30:31], v7 offset:61952
    v_xor_b32 v4, 0x10000, v4
    v_mfma_f32_16x16x32_bf16 v[232:235], a[4:7], a[88:91], v[232:235]
    s_waitcnt lgkmcnt(4)
    v_xor_b32 v5, 0x10000, v5
    v_xor_b32 v6, 0x10000, v6
    v_xor_b32 v7, 0x10000, v7
    v_mfma_f32_16x16x32_bf16 v[164:167], a[8:11], a[68:71], v[164:167]
    ds_read_b64_tr_b16 a[32:33], v4 offset:0
    v_mul_f32 v50, s96, v98
    v_mfma_f32_16x16x32_bf16 v[164:167], a[12:15], a[84:87], v[164:167]
    ds_read_b64_tr_b16 a[34:35], v4 offset:512
    v_mul_f32 v51, s96, v99
    v_mfma_f32_16x16x32_bf16 v[172:175], a[8:11], a[76:79], v[172:175]
    ds_read_b64_tr_b16 a[36:37], v4 offset:4096
    v_mul_f32 v52, s96, v100
    v_mfma_f32_16x16x32_bf16 v[172:175], a[12:15], a[92:95], v[172:175]
    ds_read_b64_tr_b16 a[38:39], v4 offset:4608
    v_mul_f32 v53, s96, v101
    v_mfma_f32_16x16x32_bf16 v[228:231], a[8:11], a[64:67], v[228:231]
    ds_read_b64_tr_b16 a[40:41], v4 offset:16384
    v_mul_f32 v54, s96, v102
    v_mfma_f32_16x16x32_bf16 v[228:231], a[12:15], a[80:83], v[228:231]
    ds_read_b64_tr_b16 a[42:43], v4 offset:16896
    v_mul_f32 v55, s96, v103
    v_mfma_f32_16x16x32_bf16 v[236:239], a[8:11], a[72:75], v[236:239]
    s_cmp_eq_u32 s3, 1
    s_cselect_b32 s96, 1.0, 0
    ds_read_b64_tr_b16 a[44:45], v4 offset:20480
    v_mfma_f32_16x16x32_bf16 v[236:239], a[12:15], a[88:91], v[236:239]
    ds_read_b64_tr_b16 a[46:47], v4 offset:20992
    v_fma_f32 v52, v96, s96, v52
    v_mfma_f32_16x16x32_bf16 v[176:179], a[16:19], a[68:71], v[176:179]
    ds_read_b64_tr_b16 a[0:1], v5 offset:0
    v_fma_f32 v53, v97, s96, v53
    v_mfma_f32_16x16x32_bf16 v[176:179], a[20:23], a[84:87], v[176:179]
    ds_read_b64_tr_b16 a[2:3], v5 offset:512
    v_fma_f32 v54, v98, s96, v54
    v_mfma_f32_16x16x32_bf16 v[184:187], a[16:19], a[76:79], v[184:187]
    v_fma_f32 v55, v99, s96, v55
    v_mfma_f32_16x16x32_bf16 v[184:187], a[20:23], a[92:95], v[184:187]
    s_and_b32 s12, s4, 1
    s_lshl_b32 s11, s12, 1
    ds_read_b64_tr_b16 a[4:5], v5 offset:4096
    v_mfma_f32_16x16x32_bf16 v[240:243], a[16:19], a[64:67], v[240:243]
    s_xor_b32 s11, s11, s3
    s_add_u32 s11, s11, s8
    ds_read_b64_tr_b16 a[6:7], v5 offset:4608
    v_mfma_f32_16x16x32_bf16 v[240:243], a[20:23], a[80:83], v[240:243]
    s_lshl_b32 s11, s11, 17
    s_mul_i32 s12, s12, 2048
    s_add_u32 s11, s11, s12
    v_mfma_f32_16x16x32_bf16 v[248:251], a[16:19], a[72:75], v[248:251]
    s_sub_u32 s13, 0x20000, s12
    s_lshl_b32 s12, s12, 5
    ds_read_b64_tr_b16 a[8:9], v5 offset:16384
    v_mfma_f32_16x16x32_bf16 v[248:251], a[20:23], a[88:91], v[248:251]
    s_add_u32 s10, s91, 0x6000
    s_xor_b32 m0, s15, 0x0
    ds_read_b64_tr_b16 a[10:11], v5 offset:16896
    s_waitcnt lgkmcnt(10)
    v_mfma_f32_16x16x32_bf16 v[180:183], a[24:27], a[68:71], v[180:183]
    buffer_load_dwordx4 v2, s[52:55], s10 offen offset:0 sc1 lds
    v_mfma_f32_16x16x32_bf16 v[180:183], a[28:31], a[84:87], v[180:183]
    s_sub_u32 s101, 0x20000, s12
    ds_read_b64_tr_b16 a[12:13], v5 offset:20480
    v_mfma_f32_16x16x32_bf16 v[188:191], a[24:27], a[76:79], v[188:191]
    ds_read_b64_tr_b16 a[14:15], v5 offset:20992
    v_mfma_f32_16x16x32_bf16 v[188:191], a[28:31], a[92:95], v[188:191]
    s_cmp_lt_u32 s5, 28
    s_cselect_b32 s13, s13, 0
    s_cselect_b32 s101, s101, 0
    v_mfma_f32_16x16x32_bf16 v[244:247], a[24:27], a[64:67], v[244:247]
    buffer_load_dwordx4 v2, s[52:55], s10 offen offset:1024 sc1 lds
    v_mfma_f32_16x16x32_bf16 v[244:247], a[28:31], a[80:83], v[244:247]
    s_add_u32 s76, s32, s11
    s_addc_u32 s77, s33, 0
    s_mov_b32 s78, s13
    v_mfma_f32_16x16x32_bf16 v[252:255], a[24:27], a[72:75], v[252:255]
    s_mov_b32 s79, 0x20000
    s_lshl_b32 s11, s9, 2
    s_add_u32 s11, s11, s3
    v_mfma_f32_16x16x32_bf16 v[252:255], a[28:31], a[88:91], v[252:255]
    s_cmp_lt_u32 s11, 27
    s_cselect_b32 s101, s101, 0
    s_lshl_b32 s11, s11, 17
    s_waitcnt vmcnt(25)
    v_mfma_f32_16x16x32_bf16 v[128:131], a[32:35], a[100:103], v[128:131]
    s_add_u32 s11, s11, s12
    s_add_u32 s11, s11, 0x2b00000
    ds_read_b64_tr_b16 a[16:17], v6 offset:0
    s_waitcnt vmcnt(21)
    v_mfma_f32_16x16x32_bf16 v[128:131], a[36:39], a[116:119], v[128:131]
    buffer_load_dwordx4 v2, s[52:55], s10 offen offset:2048 sc1 lds
    s_waitcnt vmcnt(18) lgkmcnt(9)
    v_mfma_f32_16x16x32_bf16 v[128:131], a[40:43], a[132:135], v[128:131]
    s_add_u32 s72, s42, s11
    s_addc_u32 s73, s43, 0
    ds_read_b64_tr_b16 a[18:19], v6 offset:512
    s_waitcnt vmcnt(13)
    v_mfma_f32_16x16x32_bf16 v[128:131], a[44:47], a[148:151], v[128:131]
    s_mov_b32 s74, s101
    s_mov_b32 s75, 0x20000
    ds_read_b64_tr_b16 a[20:21], v6 offset:4096
    v_mfma_f32_16x16x32_bf16 v[136:139], a[32:35], a[108:111], v[136:139]
    ds_read_b64_tr_b16 a[22:23], v6 offset:4608
    v_and_b32 v29, 15, v1
    v_mfma_f32_16x16x32_bf16 v[136:139], a[36:39], a[124:127], v[136:139]
    buffer_load_dwordx4 v2, s[52:55], s10 offen offset:3072 sc1 lds
    v_mfma_f32_16x16x32_bf16 v[136:139], a[40:43], a[140:143], v[136:139]
    s_cmp_lt_u32 s3, 2
    s_cselect_b32 m0, -2, 2
    s_lshl_b32 m0, m0, 13
    s_waitcnt vmcnt(12)
    v_mfma_f32_16x16x32_bf16 v[136:139], a[44:47], a[156:159], v[136:139]
    s_add_u32 s10, s10, m0
    s_cmp_eq_u32 s10, s90
    s_cselect_b32 s10, s92, s10
    v_mfma_f32_16x16x32_bf16 v[192:195], a[32:35], a[96:99], v[192:195]
    ds_read_b64_tr_b16 a[24:25], v6 offset:16384
    v_lshlrev_b32 v29, 7, v29
    v_mfma_f32_16x16x32_bf16 v[192:195], a[36:39], a[112:115], v[192:195]
    ds_read_b64_tr_b16 a[26:27], v6 offset:16896
    v_bfe_u32 v30, v1, 1, 3
    v_mfma_f32_16x16x32_bf16 v[192:195], a[40:43], a[128:131], v[192:195]
    ds_read_b64_tr_b16 a[28:29], v6 offset:20480
    v_lshrrev_b32 v24, 4, v1
    v_mfma_f32_16x16x32_bf16 v[192:195], a[44:47], a[144:147], v[192:195]
    ds_read_b64_tr_b16 a[30:31], v6 offset:20992
    v_xor_b32 v30, v30, v24
    v_mfma_f32_16x16x32_bf16 v[200:203], a[32:35], a[104:107], v[200:203]
    s_waitcnt lgkmcnt(8)
    v_lshl_add_u32 v24, v30, 4, v29
    v_mfma_f32_16x16x32_bf16 v[200:203], a[36:39], a[120:123], v[200:203]
    s_lshl_b32 s24, s6, 6
    s_add_u32 s24, s24, s7
    s_lshl_b32 s24, s24, 2
    v_mfma_f32_16x16x32_bf16 v[200:203], a[40:43], a[136:139], v[200:203]
    s_add_u32 s24, s24, 32
    s_lshl_b32 s11, s3, 16
    ds_read_b64_tr_b16 a[64:65], v7 offset:0
    v_mfma_f32_16x16x32_bf16 v[200:203], a[44:47], a[152:155], v[200:203]
    s_add_u32 s24, s24, s11
    ds_read_b64_tr_b16 a[66:67], v7 offset:512
    v_lshlrev_b32 v127, 16, v1
    v_mfma_f32_16x16x32_bf16 v[132:135], a[0:3], a[100:103], v[132:135]
    s_cmp_lt_u32 s7, 2
    s_cselect_b32 s25, 2, 3
    s_lshl_b32 s25, s25, 17
    v_mfma_f32_16x16x32_bf16 v[132:135], a[4:7], a[116:119], v[132:135]
    s_mov_b64 s[18:19], 0
    s_lshl_b32 s11, s6, 8
    ds_read_b64_tr_b16 a[68:69], v7 offset:4096
    v_mfma_f32_16x16x32_bf16 v[132:135], a[8:11], a[132:135], v[132:135]
    ds_read_b64_tr_b16 a[70:71], v7 offset:4608
    v_and_b32 v20, 0x3c, v28
    v_mfma_f32_16x16x32_bf16 v[132:135], a[12:15], a[148:151], v[132:135]
    v_add_u32 v20, s11, v20
    v_add_u32 v29, 0x2f80, v28
    v_mfma_f32_16x16x32_bf16 v[140:143], a[0:3], a[108:111], v[140:143]
    ds_read_b64_tr_b16 a[72:73], v7 offset:16384
    v_cmp_gt_u32 vcc, 32, v1
    v_mfma_f32_16x16x32_bf16 v[140:143], a[4:7], a[124:127], v[140:143]
    ds_read_b64_tr_b16 a[74:75], v7 offset:16896
    v_cndmask_b32 v20, v29, v20, vcc
    v_mfma_f32_16x16x32_bf16 v[140:143], a[8:11], a[140:143], v[140:143]
    v_lshlrev_b32 v125, 7, v1
    v_mov_b32 v29, 0x7f000000
    v_mfma_f32_16x16x32_bf16 v[140:143], a[12:15], a[156:159], v[140:143]
    ds_read_b64_tr_b16 a[76:77], v7 offset:20480
    v_cmp_gt_u32 vcc, 17, v1
    v_mfma_f32_16x16x32_bf16 v[196:199], a[0:3], a[96:99], v[196:199]
    ds_read_b64_tr_b16 a[78:79], v7 offset:20992
    v_mov_b32 v126, 1
    v_mfma_f32_16x16x32_bf16 v[196:199], a[4:7], a[112:115], v[196:199]
    v_cndmask_b32 v125, v29, v125, vcc
    v_mul_f32 v128, s97, v128
    v_mfma_f32_16x16x32_bf16 v[196:199], a[8:11], a[128:131], v[196:199]
    s_lshl_b32 s88, s7, 2
    s_lshr_b32 s12, 0x22211000, s88
    s_and_b32 s12, s12, 15
    v_mfma_f32_16x16x32_bf16 v[196:199], a[12:15], a[144:147], v[196:199]
    s_mul_i32 s12, s12, 7680
    v_mul_f32 v129, s97, v129
    v_mul_f32 v130, s97, v130
    v_mfma_f32_16x16x32_bf16 v[204:207], a[0:3], a[104:107], v[204:207]
    ds_read_b64_tr_b16 a[80:81], v4 offset:8192
    v_mul_f32 v131, s97, v131
    v_mfma_f32_16x16x32_bf16 v[204:207], a[4:7], a[120:123], v[204:207]
    s_waitcnt lgkmcnt(9)
    ds_read_b64_tr_b16 a[82:83], v4 offset:8704
    v_mul_f32 v132, s97, v132
    v_mfma_f32_16x16x32_bf16 v[204:207], a[8:11], a[136:139], v[204:207]
    s_cmp_ge_u32 s7, 4
    s_cselect_b32 s11, 0xe0, 0
    s_cselect_b32 s20, 0, 7680
    v_mfma_f32_16x16x32_bf16 v[204:207], a[12:15], a[152:155], v[204:207]
    s_xor_b32 m0, s15, 0x4000
    s_xor_b32 s11, s11, s2
    ds_read_b64_tr_b16 a[84:85], v4 offset:12288
    v_mfma_f32_16x16x32_bf16 v[144:147], a[16:19], a[100:103], v[144:147]
    buffer_load_dwordx4 v2, s[52:55], s10 offen offset:0 sc1 lds
    v_mfma_f32_16x16x32_bf16 v[144:147], a[20:23], a[116:119], v[144:147]
    s_lshl2_add_u32 s11, s11, s3
    s_mul_i32 s11, s11, 15360
    ds_read_b64_tr_b16 a[86:87], v4 offset:12800
    v_mfma_f32_16x16x32_bf16 v[144:147], a[24:27], a[132:135], v[144:147]
    s_add_u32 s11, s11, s20
    s_add_u32 s11, s11, 0x5100000
    ds_read_b64_tr_b16 a[88:89], v4 offset:24576
    v_mfma_f32_16x16x32_bf16 v[144:147], a[28:31], a[148:151], v[144:147]
    s_add_u32 s20, s42, s11
    s_addc_u32 s21, s43, 0
    ds_read_b64_tr_b16 a[90:91], v4 offset:25088
    v_mfma_f32_16x16x32_bf16 v[152:155], a[16:19], a[108:111], v[152:155]
    buffer_load_dwordx4 v2, s[52:55], s10 offen offset:1024 sc1 lds
    v_mfma_f32_16x16x32_bf16 v[152:155], a[20:23], a[124:127], v[152:155]
    s_mov_b32 s22, s12
    s_mov_b32 s23, 0x20000
    ds_read_b64_tr_b16 a[92:93], v4 offset:28672
    v_mfma_f32_16x16x32_bf16 v[152:155], a[24:27], a[140:143], v[152:155]
    s_lshr_b32 s12, 0x3a510000, s88
    s_and_b32 s12, s12, 15
    ds_read_b64_tr_b16 a[94:95], v4 offset:29184
    v_mfma_f32_16x16x32_bf16 v[152:155], a[28:31], a[156:159], v[152:155]
    s_lshl_b32 s12, s12, 19
    s_lshl_b32 s66, s7, 12
    s_and_b32 s11, s7, 3
    v_mfma_f32_16x16x32_bf16 v[208:211], a[16:19], a[96:99], v[208:211]
    s_cmp_eq_u32 s11, 3
    s_cselect_b64 s[64:65], s[26:27], s[32:33]
    v_mul_f32 v133, s97, v133
    v_mfma_f32_16x16x32_bf16 v[208:211], a[20:23], a[112:115], v[208:211]
    buffer_load_dwordx4 v2, s[52:55], s10 offen offset:2048 sc1 lds
    v_mfma_f32_16x16x32_bf16 v[208:211], a[24:27], a[128:131], v[208:211]
    ds_read_b64_tr_b16 a[0:1], v5 offset:8192
    v_mul_f32 v134, s97, v134
    v_mfma_f32_16x16x32_bf16 v[208:211], a[28:31], a[144:147], v[208:211]
    ds_read_b64_tr_b16 a[2:3], v5 offset:8704
    v_mul_f32 v135, s97, v135
    v_mfma_f32_16x16x32_bf16 v[216:219], a[16:19], a[104:107], v[216:219]
    s_cmp_eq_u32 s7, 2
    s_cselect_b64 s[64:65], s[36:37], s[64:65]
    s_cselect_b32 s66, 8704, s66
    s_cselect_b32 s88, 0x10e000, -1
    v_mfma_f32_16x16x32_bf16 v[216:219], a[20:23], a[120:123], v[216:219]
    s_waitcnt lgkmcnt(10)
    buffer_load_dwordx4 v2, s[52:55], s10 offen offset:3072 sc1 lds
    v_mfma_f32_16x16x32_bf16 v[216:219], a[24:27], a[136:139], v[216:219]
    s_cmp_lt_u32 s3, 2
    s_cselect_b32 m0, 3, 1
    s_lshl_b32 m0, m0, 13
    v_mfma_f32_16x16x32_bf16 v[216:219], a[28:31], a[152:155], v[216:219]
    s_add_u32 s10, s10, m0
    s_cmp_eq_u32 s10, s90
    s_cselect_b32 s10, s92, s10
    v_mfma_f32_16x16x32_bf16 v[148:151], a[64:67], a[100:103], v[148:151]
    s_lshl2_add_u32 s11, s6, s3
    s_mul_i32 s11, s11, s66
    ds_read_b64_tr_b16 a[4:5], v5 offset:12288
    v_mfma_f32_16x16x32_bf16 v[148:151], a[68:71], a[116:119], v[148:151]
    s_add_u32 s11, s11, s12
    s_sub_u32 s88, s88, s11
    ds_read_b64_tr_b16 a[6:7], v5 offset:12800
    v_mfma_f32_16x16x32_bf16 v[148:151], a[72:75], a[132:135], v[148:151]
    s_min_u32 s66, s66, s88
    ds_read_b64_tr_b16 a[8:9], v5 offset:24576
    v_cvt_pk_bf16_f32 v128, v128, v129
    v_mfma_f32_16x16x32_bf16 v[148:151], a[76:79], a[148:151], v[148:151]
    s_add_u32 s64, s64, s11
    s_addc_u32 s65, s65, 0
    ds_read_b64_tr_b16 a[10:11], v5 offset:25088
    v_mfma_f32_16x16x32_bf16 v[156:159], a[64:67], a[108:111], v[156:159]
    s_mov_b32 s67, 0x20000
    ds_read_b64_tr_b16 a[12:13], v5 offset:28672
    v_cvt_pk_bf16_f32 v129, v130, v131
    v_mfma_f32_16x16x32_bf16 v[156:159], a[68:71], a[124:127], v[156:159]
    ds_read_b64_tr_b16 a[14:15], v5 offset:29184
    v_cvt_pk_bf16_f32 v130, v132, v133
    v_mfma_f32_16x16x32_bf16 v[156:159], a[72:75], a[140:143], v[156:159]
    v_cvt_pk_bf16_f32 v131, v134, v135
    v_mfma_f32_16x16x32_bf16 v[156:159], a[76:79], a[156:159], v[156:159]
    ds_write_b128 v18, v[128:131] offset:0
    v_mfma_f32_16x16x32_bf16 v[212:215], a[64:67], a[96:99], v[212:215]
    ds_read_b64_tr_b16 a[16:17], v6 offset:8192
    v_mfma_f32_16x16x32_bf16 v[212:215], a[68:71], a[112:115], v[212:215]
    ds_read_b64_tr_b16 a[18:19], v6 offset:8704
    v_mfma_f32_16x16x32_bf16 v[212:215], a[72:75], a[128:131], v[212:215]
    s_lshl_b32 s98, s2, 7
    s_and_b32 s98, s98, 0xf00
    s_add_u32 s98, s98, 0x2000
    buffer_load_dword v27, v28, s[68:71], s98 offen sc1
    v_mfma_f32_16x16x32_bf16 v[212:215], a[76:79], a[144:147], v[212:215]
    ds_read_b64_tr_b16 a[20:21], v6 offset:12288
    ds_read_b128 a[160:163], v18 offset:0
    v_mfma_f32_16x16x32_bf16 v[220:223], a[64:67], a[104:107], v[220:223]
    ds_read_b64_tr_b16 a[22:23], v6 offset:12800
    v_mul_f32 v136, s97, v136
    v_mfma_f32_16x16x32_bf16 v[220:223], a[68:71], a[120:123], v[220:223]
    v_mul_f32 v137, s97, v137
    v_mul_f32 v138, s97, v138
    v_mul_f32 v139, s97, v139
    v_mul_f32 v140, s97, v140
    v_mul_f32 v141, s97, v141
    v_mul_f32 v142, s97, v142
    v_mul_f32 v143, s97, v143
    v_cvt_pk_bf16_f32 v136, v136, v137
    v_cvt_pk_bf16_f32 v137, v138, v139
    v_cvt_pk_bf16_f32 v138, v140, v141
    v_cvt_pk_bf16_f32 v139, v142, v143
    v_mfma_f32_16x16x32_bf16 v[220:223], a[72:75], a[136:139], v[220:223]
    ds_read_b64_tr_b16 a[24:25], v6 offset:24576
    ds_write_b128 v18, v[136:139] offset:1024
    ds_read_b128 a[176:179], v18 offset:1024
    v_mfma_f32_16x16x32_bf16 v[220:223], a[76:79], a[152:155], v[220:223]
    s_waitcnt lgkmcnt(14)
    ds_read_b64_tr_b16 a[26:27], v6 offset:25088
    v_mul_f32 v192, s97, v192
    v_mfma_f32_16x16x32_bf16 v[160:163], a[80:83], a[100:103], v[160:163]
    v_mul_f32 v193, s97, v193
    v_mul_f32 v194, s97, v194
    v_mfma_f32_16x16x32_bf16 v[160:163], a[84:87], a[116:119], v[160:163]
    ds_read_b64_tr_b16 a[28:29], v6 offset:28672
    v_mul_f32 v195, s97, v195
    v_mfma_f32_16x16x32_bf16 v[160:163], a[88:91], a[132:135], v[160:163]
    ds_read_b64_tr_b16 a[30:31], v6 offset:29184
    v_mul_f32 v196, s97, v196
    v_mfma_f32_16x16x32_bf16 v[160:163], a[92:95], a[148:151], v[160:163]
    v_mul_f32 v197, s97, v197
    v_mul_f32 v198, s97, v198
    v_mfma_f32_16x16x32_bf16 v[168:171], a[80:83], a[108:111], v[168:171]
    ds_read_b64_tr_b16 v[32:33], v7 offset:8192
    v_mul_f32 v199, s97, v199
    v_cvt_pk_bf16_f32 v192, v192, v193
    v_cvt_pk_bf16_f32 v193, v194, v195
    v_cvt_pk_bf16_f32 v194, v196, v197
    v_cvt_pk_bf16_f32 v195, v198, v199
    v_mfma_f32_16x16x32_bf16 v[168:171], a[84:87], a[124:127], v[168:171]
    ds_read_b64_tr_b16 v[34:35], v7 offset:8704
    ds_write_b128 v18, v[192:195] offset:0
    ds_read_b128 a[32:35], v18 offset:0
    v_mul_f32 v200, s97, v200
    v_mul_f32 v201, s97, v201
    v_mul_f32 v202, s97, v202
    v_mul_f32 v203, s97, v203
    v_mul_f32 v204, s97, v204
    v_mul_f32 v205, s97, v205
    v_mul_f32 v206, s97, v206
    v_mul_f32 v207, s97, v207
    v_cvt_pk_bf16_f32 v200, v200, v201
    v_cvt_pk_bf16_f32 v201, v202, v203
    v_cvt_pk_bf16_f32 v202, v204, v205
    v_cvt_pk_bf16_f32 v203, v206, v207
    v_mfma_f32_16x16x32_bf16 v[168:171], a[88:91], a[140:143], v[168:171]
    ds_write_b128 v18, v[200:203] offset:1024
    ds_read_b128 a[48:51], v18 offset:1024
    v_mfma_f32_16x16x32_bf16 v[168:171], a[92:95], a[156:159], v[168:171]
    s_xor_b32 m0, s15, 0x8000
    ds_read_b64_tr_b16 v[36:37], v7 offset:12288
    v_mul_f32 v144, s97, v144
    v_mfma_f32_16x16x32_bf16 v[224:227], a[80:83], a[96:99], v[224:227]
    buffer_load_dwordx4 v2, s[52:55], s10 offen offset:0 sc1 lds
    v_mfma_f32_16x16x32_bf16 v[224:227], a[84:87], a[112:115], v[224:227]
    ds_read_b64_tr_b16 v[38:39], v7 offset:12800
    v_mul_f32 v145, s97, v145
    v_mfma_f32_16x16x32_bf16 v[224:227], a[88:91], a[128:131], v[224:227]
    ds_read_b64_tr_b16 v[40:41], v7 offset:24576
    v_mul_f32 v146, s97, v146
    v_mfma_f32_16x16x32_bf16 v[224:227], a[92:95], a[144:147], v[224:227]
    ds_read_b64_tr_b16 v[42:43], v7 offset:25088
    v_mul_f32 v147, s97, v147
    v_mfma_f32_16x16x32_bf16 v[232:235], a[80:83], a[104:107], v[232:235]
    buffer_load_dwordx4 v2, s[52:55], s10 offen offset:1024 sc1 lds
    v_mfma_f32_16x16x32_bf16 v[232:235], a[84:87], a[120:123], v[232:235]
    ds_read_b64_tr_b16 v[44:45], v7 offset:28672
    v_mul_f32 v148, s97, v148
    v_mfma_f32_16x16x32_bf16 v[232:235], a[88:91], a[136:139], v[232:235]
    ds_read_b64_tr_b16 v[46:47], v7 offset:29184
    v_mul_f32 v149, s97, v149
    v_mfma_f32_16x16x32_bf16 v[232:235], a[92:95], a[152:155], v[232:235]
    v_mul_f32 v150, s97, v150
    v_mul_f32 v151, s97, v151
    v_mfma_f32_16x16x32_bf16 v[164:167], a[0:3], a[100:103], v[164:167]
    s_waitcnt vmcnt(11)
    s_barrier
    v_cvt_pk_bf16_f32 v144, v144, v145
    v_cvt_pk_bf16_f32 v145, v146, v147
    s_waitcnt lgkmcnt(15)
    v_mfma_f32_16x16x32_bf16 v[164:167], a[4:7], a[116:119], v[164:167]
    buffer_load_dwordx4 v2, s[52:55], s10 offen offset:2048 sc1 lds
    v_mfma_f32_16x16x32_bf16 v[164:167], a[8:11], a[132:135], v[164:167]
    ds_read_b128 a[64:67], v17 offset:32768
    v_cvt_pk_bf16_f32 v146, v148, v149
    v_mfma_f32_16x16x32_bf16 v[164:167], a[12:15], a[148:151], v[164:167]
    v_cvt_pk_bf16_f32 v147, v150, v151
    v_mfma_f32_16x16x32_bf16 v[172:175], a[0:3], a[108:111], v[172:175]
    ds_read_b128 a[68:71], v17 offset:33792
    v_mfma_f32_16x16x32_bf16 v[172:175], a[4:7], a[124:127], v[172:175]
    buffer_load_dwordx4 v2, s[52:55], s10 offen offset:3072 sc1 lds
    v_mfma_f32_16x16x32_bf16 v[172:175], a[8:11], a[140:143], v[172:175]
    s_cmp_lt_u32 s3, 2
    s_cselect_b32 m0, 1, -2
    s_lshl_b32 m0, m0, 13
    v_mfma_f32_16x16x32_bf16 v[172:175], a[12:15], a[156:159], v[172:175]
    s_add_u32 s10, s10, m0
    s_cmp_eq_u32 s10, s90
    s_cselect_b32 s10, s92, s10
    v_mfma_f32_16x16x32_bf16 v[228:231], a[0:3], a[96:99], v[228:231]
    ds_read_b128 a[72:75], v17 offset:34816
    v_mfma_f32_16x16x32_bf16 v[228:231], a[4:7], a[112:115], v[228:231]
    ds_read_b128 a[76:79], v17 offset:35840
    v_mfma_f32_16x16x32_bf16 v[228:231], a[8:11], a[128:131], v[228:231]
    ds_read_b128 a[80:83], v17 offset:36864
    v_mfma_f32_16x16x32_bf16 v[228:231], a[12:15], a[144:147], v[228:231]
    ds_write_b128 v18, v[144:147] offset:2048
    v_mfma_f32_16x16x32_bf16 v[236:239], a[0:3], a[104:107], v[236:239]
    ds_read_b128 a[84:87], v17 offset:37888
    v_mfma_f32_16x16x32_bf16 v[236:239], a[4:7], a[120:123], v[236:239]
    ds_read_b128 a[164:167], v18 offset:2048
    v_mul_f32 v152, s97, v152
    v_mul_f32 v153, s97, v153
    v_mul_f32 v154, s97, v154
    v_mul_f32 v155, s97, v155
    v_mul_f32 v156, s97, v156
    v_mul_f32 v157, s97, v157
    v_mul_f32 v158, s97, v158
    v_mul_f32 v159, s97, v159
    v_cvt_pk_bf16_f32 v152, v152, v153
    v_cvt_pk_bf16_f32 v153, v154, v155
    v_cvt_pk_bf16_f32 v154, v156, v157
    v_cvt_pk_bf16_f32 v155, v158, v159
    v_mfma_f32_16x16x32_bf16 v[236:239], a[8:11], a[136:139], v[236:239]
    ds_read_b128 a[88:91], v17 offset:38912
    ds_write_b128 v18, v[152:155] offset:3072
    ds_read_b128 a[180:183], v18 offset:3072
    v_mfma_f32_16x16x32_bf16 v[236:239], a[12:15], a[152:155], v[236:239]
    v_mul_f32 v208, s97, v208
    v_mul_f32 v209, s97, v209
    v_mfma_f32_16x16x32_bf16 v[176:179], a[16:19], a[100:103], v[176:179]
    ds_read_b128 a[92:95], v17 offset:39936
    v_mul_f32 v210, s97, v210
    v_mfma_f32_16x16x32_bf16 v[176:179], a[20:23], a[116:119], v[176:179]
    s_waitcnt lgkmcnt(12)
    v_mul_f32 v211, s97, v211
    v_mul_f32 v212, s97, v212
    v_mfma_f32_16x16x32_bf16 v[176:179], a[24:27], a[132:135], v[176:179]
    v_mul_f32 v213, s97, v213
    v_mul_f32 v214, s97, v214
    v_mfma_f32_16x16x32_bf16 v[176:179], a[28:31], a[148:151], v[176:179]
    v_mul_f32 v215, s97, v215
    v_cvt_pk_bf16_f32 v208, v208, v209
    v_mfma_f32_16x16x32_bf16 v[184:187], a[16:19], a[108:111], v[184:187]
    v_cvt_pk_bf16_f32 v209, v210, v211
    v_cvt_pk_bf16_f32 v210, v212, v213
    v_cvt_pk_bf16_f32 v211, v214, v215
    v_mfma_f32_16x16x32_bf16 v[184:187], a[20:23], a[124:127], v[184:187]
    ds_write_b128 v18, v[208:211] offset:2048
    ds_read_b128 a[36:39], v18 offset:2048
    v_mul_f32 v216, s97, v216
    v_mul_f32 v217, s97, v217
    v_mul_f32 v218, s97, v218
    v_mul_f32 v219, s97, v219
    v_mul_f32 v220, s97, v220
    v_mul_f32 v221, s97, v221
    v_mul_f32 v222, s97, v222
    v_mul_f32 v223, s97, v223
    v_cvt_pk_bf16_f32 v216, v216, v217
    v_cvt_pk_bf16_f32 v217, v218, v219
    v_cvt_pk_bf16_f32 v218, v220, v221
    v_cvt_pk_bf16_f32 v219, v222, v223
    v_mfma_f32_16x16x32_bf16 v[184:187], a[24:27], a[140:143], v[184:187]
    ds_write_b128 v18, v[216:219] offset:3072
    ds_read_b128 a[52:55], v18 offset:3072
    v_mfma_f32_16x16x32_bf16 v[184:187], a[28:31], a[156:159], v[184:187]
    v_mul_f32 v160, s97, v160
    v_mul_f32 v161, s97, v161
    v_mfma_f32_16x16x32_bf16 v[180:183], v[32:35], a[100:103], v[180:183]
    v_mul_f32 v162, s97, v162
    v_mul_f32 v163, s97, v163
    v_mfma_f32_16x16x32_bf16 v[180:183], v[36:39], a[116:119], v[180:183]
    v_mul_f32 v164, s97, v164
    v_mul_f32 v165, s97, v165
    v_mfma_f32_16x16x32_bf16 v[180:183], v[40:43], a[132:135], v[180:183]
    v_mul_f32 v166, s97, v166
    v_mul_f32 v167, s97, v167
    v_mfma_f32_16x16x32_bf16 v[180:183], v[44:47], a[148:151], v[180:183]
    v_cvt_pk_bf16_f32 v160, v160, v161
    v_cvt_pk_bf16_f32 v161, v162, v163
    v_mfma_f32_16x16x32_bf16 v[188:191], v[32:35], a[108:111], v[188:191]
    v_cvt_pk_bf16_f32 v162, v164, v165
    v_cvt_pk_bf16_f32 v163, v166, v167
    v_mfma_f32_16x16x32_bf16 v[188:191], v[36:39], a[124:127], v[188:191]
    ds_write_b128 v18, v[160:163] offset:4096
    v_mfma_f32_16x16x32_bf16 v[188:191], v[40:43], a[140:143], v[188:191]
    ds_read_b128 a[168:171], v18 offset:4096
    v_mul_f32 v168, s97, v168
    v_mfma_f32_16x16x32_bf16 v[188:191], v[44:47], a[156:159], v[188:191]
    s_xor_b32 m0, s15, 0xc000
    v_mul_f32 v169, s97, v169
    v_mul_f32 v170, s97, v170
    v_mfma_f32_16x16x32_bf16 v[240:243], a[16:19], a[96:99], v[240:243]
    buffer_load_dwordx4 v2, s[52:55], s10 offen offset:0 sc1 lds
    v_mfma_f32_16x16x32_bf16 v[240:243], a[20:23], a[112:115], v[240:243]
    v_mul_f32 v171, s97, v171
    v_mul_f32 v172, s97, v172
    v_mfma_f32_16x16x32_bf16 v[240:243], a[24:27], a[128:131], v[240:243]
    v_mul_f32 v173, s97, v173
    v_mul_f32 v174, s97, v174
    v_mfma_f32_16x16x32_bf16 v[240:243], a[28:31], a[144:147], v[240:243]
    v_mul_f32 v175, s97, v175
    v_cvt_pk_bf16_f32 v168, v168, v169
    v_mfma_f32_16x16x32_bf16 v[248:251], a[16:19], a[104:107], v[248:251]
    buffer_load_dwordx4 v2, s[52:55], s10 offen offset:1024 sc1 lds
    v_mfma_f32_16x16x32_bf16 v[248:251], a[20:23], a[120:123], v[248:251]
    v_cvt_pk_bf16_f32 v169, v170, v171
    v_cvt_pk_bf16_f32 v170, v172, v173
    v_mfma_f32_16x16x32_bf16 v[248:251], a[24:27], a[136:139], v[248:251]
    v_cvt_pk_bf16_f32 v171, v174, v175
    v_mfma_f32_16x16x32_bf16 v[248:251], a[28:31], a[152:155], v[248:251]
    ds_write_b128 v18, v[168:171] offset:5120
    v_mfma_f32_16x16x32_bf16 v[244:247], v[32:35], a[96:99], v[244:247]
    ds_read_b128 a[184:187], v18 offset:5120
    v_mul_f32 v224, s97, v224
    v_mfma_f32_16x16x32_bf16 v[244:247], v[36:39], a[112:115], v[244:247]
    buffer_load_dwordx4 v2, s[52:55], s10 offen offset:2048 sc1 lds
    v_mfma_f32_16x16x32_bf16 v[244:247], v[40:43], a[128:131], v[244:247]
    v_mul_f32 v225, s97, v225
    v_mul_f32 v226, s97, v226
    v_mfma_f32_16x16x32_bf16 v[244:247], v[44:47], a[144:147], v[244:247]
    v_mul_f32 v227, s97, v227
    v_mul_f32 v228, s97, v228
    v_mfma_f32_16x16x32_bf16 v[252:255], v[32:35], a[104:107], v[252:255]
    v_mul_f32 v229, s97, v229
    v_mul_f32 v230, s97, v230
    v_mfma_f32_16x16x32_bf16 v[252:255], v[36:39], a[120:123], v[252:255]
    buffer_load_dwordx4 v2, s[52:55], s10 offen offset:3072 sc1 lds
    v_mfma_f32_16x16x32_bf16 v[252:255], v[40:43], a[136:139], v[252:255]
    s_cmp_lt_u32 s3, 2
    s_cselect_b32 m0, 1, 3
    s_lshl_b32 m0, m0, 13
    v_mul_f32 v231, s97, v231
    v_cvt_pk_bf16_f32 v224, v224, v225
    v_cvt_pk_bf16_f32 v225, v226, v227
    v_cvt_pk_bf16_f32 v226, v228, v229
    v_cvt_pk_bf16_f32 v227, v230, v231
    v_mfma_f32_16x16x32_bf16 v[252:255], v[44:47], a[152:155], v[252:255]
    s_cmp_ge_u32 s5, 28
    s_cbranch_scc1 fk_ln
fk_lr0:
    s_add_u32 s10, s10, m0
    ds_write_b128 v18, v[224:227] offset:4096
    ds_read_b128 a[40:43], v18 offset:4096
    v_mul_f32 v232, s97, v232
    v_mul_f32 v233, s97, v233
    v_mul_f32 v234, s97, v234
    v_mul_f32 v235, s97, v235
    v_mul_f32 v236, s97, v236
    v_mul_f32 v237, s97, v237
    v_mul_f32 v238, s97, v238
    v_mul_f32 v239, s97, v239
    v_cvt_pk_bf16_f32 v232, v232, v233
    v_cvt_pk_bf16_f32 v233, v234, v235
    v_cvt_pk_bf16_f32 v234, v236, v237
    v_cvt_pk_bf16_f32 v235, v238, v239
    s_waitcnt lgkmcnt(4)
    v_mfma_f32_16x16x32_bf16 v[48:51], a[64:67], a[160:163], v[48:51]
    s_cmp_eq_u32 s10, s90
    s_cselect_b32 s10, s92, s10
    s_mov_b32 s92, s90
    ds_write_b128 v18, v[232:235] offset:5120
    ds_read_b128 a[56:59], v18 offset:5120
    v_mul_f32 v176, s97, v176
    v_mul_f32 v177, s97, v177
    v_mul_f32 v178, s97, v178
    v_mul_f32 v179, s97, v179
    v_mul_f32 v180, s97, v180
    v_mul_f32 v181, s97, v181
    v_mul_f32 v182, s97, v182
    v_mul_f32 v183, s97, v183
    v_cvt_pk_bf16_f32 v176, v176, v177
    v_cvt_pk_bf16_f32 v177, v178, v179
    v_cvt_pk_bf16_f32 v178, v180, v181
    v_cvt_pk_bf16_f32 v179, v182, v183
    v_mfma_f32_16x16x32_bf16 v[56:59], a[64:67], a[176:179], 0
    s_lshl_b32 s90, s7, 15
    ds_write_b128 v18, v[176:179] offset:6144
    ds_read_b128 a[172:175], v18 offset:6144
    v_mul_f32 v184, s97, v184
    v_mul_f32 v185, s97, v185
    v_mul_f32 v186, s97, v186
    v_mul_f32 v187, s97, v187
    v_mul_f32 v188, s97, v188
    v_mul_f32 v189, s97, v189
    v_mul_f32 v190, s97, v190
    v_mul_f32 v191, s97, v191
    v_cvt_pk_bf16_f32 v184, v184, v185
    v_cvt_pk_bf16_f32 v185, v186, v187
    v_cvt_pk_bf16_f32 v186, v188, v189
    v_cvt_pk_bf16_f32 v187, v190, v191
    v_mfma_f32_16x16x32_bf16 v[52:55], a[80:83], a[160:163], v[52:55]
    ds_write_b128 v18, v[184:187] offset:7168
    ds_read_b128 a[188:191], v18 offset:7168
    v_mfma_f32_16x16x32_bf16 v[60:63], a[80:83], a[176:179], 0
    v_mul_f32 v240, s97, v240
    v_mul_f32 v241, s97, v241
    v_mfma_f32_16x16x32_bf16 v[48:51], a[68:71], a[164:167], v[48:51]
    v_mul_f32 v242, s97, v242
    v_mul_f32 v243, s97, v243
    v_mfma_f32_16x16x32_bf16 v[56:59], a[68:71], a[180:183], v[56:59]
    v_mul_f32 v244, s97, v244
    v_mul_f32 v245, s97, v245
    v_mfma_f32_16x16x32_bf16 v[52:55], a[84:87], a[164:167], v[52:55]
    v_mul_f32 v246, s97, v246
    v_mul_f32 v247, s97, v247
    v_mfma_f32_16x16x32_bf16 v[60:63], a[84:87], a[180:183], v[60:63]
    v_cvt_pk_bf16_f32 v240, v240, v241
    v_cvt_pk_bf16_f32 v241, v242, v243
    v_mfma_f32_16x16x32_bf16 v[48:51], a[72:75], a[168:171], v[48:51]
    s_waitcnt lgkmcnt(8)
    v_cvt_pk_bf16_f32 v242, v244, v245
    v_cvt_pk_bf16_f32 v243, v246, v247
    v_mfma_f32_16x16x32_bf16 v[56:59], a[72:75], a[184:187], v[56:59]
    ds_write_b128 v18, v[240:243] offset:6144
    v_mfma_f32_16x16x32_bf16 v[52:55], a[88:91], a[168:171], v[52:55]
    ds_read_b128 a[44:47], v18 offset:6144
    v_mul_f32 v248, s97, v248
    v_mfma_f32_16x16x32_bf16 v[60:63], a[88:91], a[184:187], v[60:63]
    s_waitcnt lgkmcnt(2)
    v_mul_f32 v249, s97, v249
    v_mul_f32 v250, s97, v250
    v_mfma_f32_16x16x32_bf16 v[48:51], a[76:79], a[172:175], v[48:51]
    v_mul_f32 v251, s97, v251
    v_mul_f32 v252, s97, v252
    v_mfma_f32_16x16x32_bf16 v[56:59], a[76:79], a[188:191], v[56:59]
    v_mul_f32 v253, s97, v253
    v_mul_f32 v254, s97, v254
    v_mfma_f32_16x16x32_bf16 v[52:55], a[92:95], a[172:175], v[52:55]
    v_mul_f32 v255, s97, v255
    v_cvt_pk_bf16_f32 v248, v248, v249
    v_mfma_f32_16x16x32_bf16 v[60:63], a[92:95], a[188:191], v[60:63]
    v_cvt_pk_bf16_f32 v249, v250, v251
    v_cvt_pk_bf16_f32 v250, v252, v253
    v_cvt_pk_bf16_f32 v251, v254, v255
    ds_write_b128 v18, v[248:251] offset:7168
    ds_read_b128 a[60:63], v18 offset:7168
    v_max3_f32 v4, v48, v49, v50
    v_max3_f32 v5, v56, v57, v58
    v_max3_f32 v4, v4, v51, v52
    v_max3_f32 v5, v5, v59, v60
    v_max3_f32 v4, v4, v53, v54
    v_max3_f32 v5, v5, v61, v62
    v_max3_f32 v4, v4, v55, v55
    v_max3_f32 v5, v5, v63, v63
    s_nop 1
    v_permlane32_swap_b32 v4, v5
    v_max_f32 v4, v4, v5
    v_mov_b32 v5, v4
    s_nop 1
    v_permlane16_swap_b32 v4, v5
    v_max_f32 v4, v4, v5
    v_mov_b32 v5, v4
    s_nop 1
    v_permlane32_swap_b32 v4, v5
    v_sub_f32 v80, 0, v4
    v_sub_f32 v81, 0, v4
    v_sub_f32 v82, 0, v4
    v_sub_f32 v83, 0, v4
    v_sub_f32 v84, 0, v5
    v_sub_f32 v85, 0, v5
    v_sub_f32 v86, 0, v5
    v_sub_f32 v87, 0, v5
    v_sub_f32 v48, v48, v4
    v_sub_f32 v49, v49, v4
    v_sub_f32 v50, v50, v4
    v_sub_f32 v51, v51, v4
    v_sub_f32 v52, v52, v4
    v_sub_f32 v53, v53, v4
    v_sub_f32 v54, v54, v4
    v_sub_f32 v55, v55, v4
    v_sub_f32 v56, v56, v5
    v_sub_f32 v57, v57, v5
    v_sub_f32 v58, v58, v5
    v_sub_f32 v59, v59, v5
    v_sub_f32 v60, v60, v5
    v_sub_f32 v61, v61, v5
    v_sub_f32 v62, v62, v5
    v_sub_f32 v63, v63, v5
    s_cmp_ge_u32 s5, 28
    s_cbranch_scc1 fk_ln0
kX:
    s_cmp_eq_u32 s3, 0
    s_cselect_b32 s96, 1.0, 0
    v_mfma_f32_16x16x32_bf16 v[32:35], a[64:67], a[32:35], 0
    v_exp_f32 v4, v48
    v_mfma_f32_16x16x32_bf16 v[32:35], a[68:71], a[36:39], v[32:35]
    v_exp_f32 v5, v49
    v_mfma_f32_16x16x32_bf16 v[32:35], a[72:75], a[40:43], v[32:35]
    s_waitcnt lgkmcnt(2)
    v_exp_f32 v6, v50
    v_cvt_pk_bf16_f32 v72, v4, v5
    v_mfma_f32_16x16x32_bf16 v[32:35], a[76:79], a[44:47], v[32:35]
    v_exp_f32 v7, v51
    v_mfma_f32_16x16x32_bf16 v[40:43], a[64:67], a[48:51], 0
    v_exp_f32 v8, v52
    v_cvt_pk_bf16_f32 v73, v6, v7
    v_mfma_f32_16x16x32_bf16 v[40:43], a[68:71], a[52:55], v[40:43]
    s_waitcnt vmcnt(13) lgkmcnt(0)
    s_barrier
    v_exp_f32 v9, v53
    v_mfma_f32_16x16x32_bf16 v[40:43], a[72:75], a[56:59], v[40:43]
    ds_read_b128 a[96:99], v16 offset:8192
    v_exp_f32 v10, v54
    v_cvt_pk_bf16_f32 v74, v8, v9
    v_mfma_f32_16x16x32_bf16 v[40:43], a[76:79], a[60:63], v[40:43]
    s_mov_b32 s80, 0x0
    ds_read_b128 a[100:103], v16 offset:9216
    v_exp_f32 v11, v55
    v_mfma_f32_16x16x32_bf16 v[36:39], a[80:83], a[32:35], 0
    buffer_store_dwordx4 a[224:227], v25, s[84:87], s80 offen sc1
    ds_read_b128 a[64:67], v17 offset:49152
    v_exp_f32 v4, v56
    v_cvt_pk_bf16_f32 v75, v10, v11
    v_mfma_f32_16x16x32_bf16 v[36:39], a[84:87], a[36:39], v[36:39]
    ds_read_b128 a[68:71], v17 offset:50176
    v_exp_f32 v5, v57
    v_mfma_f32_16x16x32_bf16 v[36:39], a[88:91], a[40:43], v[36:39]
    ds_read_b128 a[72:75], v17 offset:51200
    v_exp_f32 v6, v58
    v_cvt_pk_bf16_f32 v76, v4, v5
    v_mfma_f32_16x16x32_bf16 v[36:39], a[92:95], a[44:47], v[36:39]
    ds_read_b128 a[76:79], v17 offset:52224
    v_exp_f32 v7, v59
    v_mfma_f32_16x16x32_bf16 v[44:47], a[80:83], a[48:51], 0
    ds_read_b128 a[104:107], v16 offset:10240
    v_exp_f32 v8, v60
    v_cvt_pk_bf16_f32 v77, v6, v7
    v_mfma_f32_16x16x32_bf16 v[44:47], a[84:87], a[52:55], v[44:47]
    ds_read_b128 a[108:111], v16 offset:11264
    v_exp_f32 v9, v61
    v_mfma_f32_16x16x32_bf16 v[44:47], a[88:91], a[56:59], v[44:47]
    v_exp_f32 v10, v62
    v_cvt_pk_bf16_f32 v78, v8, v9
    v_mfma_f32_16x16x32_bf16 v[44:47], a[92:95], a[60:63], v[44:47]
    buffer_store_dwordx4 a[228:231], v25, s[84:87], s80 offen offset:1024 sc1
    v_exp_f32 v11, v63
    s_nop 0
    v_cvt_pk_bf16_f32 v79, v10, v11
    v_max3_f32 v4, v32, v33, v34
    v_max3_f32 v5, v40, v41, v42
    v_max3_f32 v4, v4, v35, v36
    s_nop 0
    v_max3_f32 v5, v5, v43, v44
    v_max3_f32 v4, v4, v37, v38
    v_max3_f32 v5, v5, v45, v46
    v_max3_f32 v4, v4, v39, v39
    v_max3_f32 v5, v5, v47, v47
    s_nop 1
    v_permlane32_swap_b32 v4, v5
    v_max_f32 v4, v4, v5
    v_mov_b32 v5, v4
    s_nop 1
    v_permlane16_swap_b32 v4, v5
    v_max_f32 v4, v4, v5
    v_mov_b32 v5, v4
    s_nop 1
    v_permlane32_swap_b32 v4, v5
    v_sub_f32 v88, 0, v4
    v_sub_f32 v89, 0, v4
    v_sub_f32 v90, 0, v4
    v_sub_f32 v91, 0, v4
    v_sub_f32 v92, 0, v5
    v_sub_f32 v93, 0, v5
    v_sub_f32 v94, 0, v5
    v_sub_f32 v95, 0, v5
    v_sub_f32 v32, v32, v4
    v_sub_f32 v33, v33, v4
    v_sub_f32 v34, v34, v4
    v_sub_f32 v35, v35, v4
    v_sub_f32 v36, v36, v4
    v_sub_f32 v37, v37, v4
    v_sub_f32 v38, v38, v4
    v_sub_f32 v39, v39, v4
    v_sub_f32 v40, v40, v5
    v_sub_f32 v41, v41, v5
    v_sub_f32 v42, v42, v5
    v_sub_f32 v43, v43, v5
    v_sub_f32 v44, v44, v5
    v_sub_f32 v45, v45, v5
    v_sub_f32 v46, v46, v5
    v_sub_f32 v47, v47, v5
    s_waitcnt lgkmcnt(6)
    v_mfma_f32_16x16x32_bf16 v[128:131], a[96:99], v[72:75], 0
    ds_read_b128 a[112:115], v16 offset:12288
    v_fma_f32 v56, v96, s96, v84
    v_mfma_f32_16x16x32_bf16 v[136:139], a[96:99], v[76:79], 0
    ds_read_b128 a[116:119], v16 offset:13312
    v_fma_f32 v57, v97, s96, v84
    v_mfma_f32_16x16x32_bf16 v[132:135], a[100:103], v[72:75], 0
    s_waitcnt lgkmcnt(4)
    ds_read_b128 a[80:83], v17 offset:53248
    v_fma_f32 v58, v98, s96, v84
    v_fma_f32 v59, v99, s96, v84
    v_mfma_f32_16x16x32_bf16 v[140:143], a[100:103], v[76:79], 0
    s_cmp_eq_u32 s3, 1
    s_cselect_b32 s96, 1.0, 0
    ds_read_b128 a[84:87], v17 offset:54272
    v_mfma_f32_16x16x32_bf16 v[56:59], a[64:67], a[176:179], v[56:59]
    v_exp_f32 v4, v32
    v_mfma_f32_16x16x32_bf16 v[56:59], a[68:71], a[180:183], v[56:59]
    s_mov_b32 s80, 0x1000
    v_exp_f32 v5, v33
    v_mfma_f32_16x16x32_bf16 v[56:59], a[72:75], a[184:187], v[56:59]
    buffer_store_dwordx4 a[232:235], v25, s[84:87], s80 offen sc1
    ds_read_b128 a[88:91], v17 offset:55296
    v_exp_f32 v6, v34
    v_mfma_f32_16x16x32_bf16 v[56:59], a[76:79], a[188:191], v[56:59]
    s_waitcnt lgkmcnt(5)
    ds_read_b128 a[92:95], v17 offset:56320
    v_cvt_pk_bf16_f32 v64, v4, v5
    v_mfma_f32_16x16x32_bf16 v[144:147], a[104:107], v[72:75], 0
    v_exp_f32 v7, v35
    v_mfma_f32_16x16x32_bf16 v[152:155], a[104:107], v[76:79], 0
    v_exp_f32 v8, v40
    v_mfma_f32_16x16x32_bf16 v[148:151], a[108:111], v[72:75], 0
    ds_read_b128 a[120:123], v16 offset:14336
    v_cvt_pk_bf16_f32 v65, v6, v7
    v_mfma_f32_16x16x32_bf16 v[156:159], a[108:111], v[76:79], 0
    s_waitcnt lgkmcnt(3)
    v_exp_f32 v9, v41
    v_mfma_f32_16x16x32_bf16 v[160:163], a[112:115], v[72:75], 0
    s_cmp_lt_u32 s3, 1
    s_cselect_b32 s12, 0xf1800000, 0
    ds_read_b128 a[124:127], v16 offset:15360
    v_mfma_f32_16x16x32_bf16 v[168:171], a[112:115], v[76:79], 0
    buffer_store_dwordx4 a[236:239], v25, s[84:87], s80 offen offset:1024 sc1
    v_exp_f32 v10, v42
    v_add_f32 v29, s12, v84
    v_mfma_f32_16x16x32_bf16 v[164:167], a[116:119], v[72:75], 0
    v_cvt_pk_bf16_f32 v68, v8, v9
    v_fma_f32 v60, v96, s96, v29
    v_fma_f32 v61, v97, s96, v29
    v_fma_f32 v62, v98, s96, v29
    v_fma_f32 v63, v99, s96, v29
    v_mfma_f32_16x16x32_bf16 v[172:175], a[116:119], v[76:79], 0
    v_exp_f32 v11, v43
    v_mfma_f32_16x16x32_bf16 v[60:63], a[80:83], a[176:179], v[60:63]
    v_exp_f32 v4, v36
    v_mfma_f32_16x16x32_bf16 v[60:63], a[84:87], a[180:183], v[60:63]
    s_waitcnt lgkmcnt(2)
    ds_read_b128 a[128:131], v19 offset:0
    v_cvt_pk_bf16_f32 v69, v10, v11
    v_mfma_f32_16x16x32_bf16 v[60:63], a[88:91], a[184:187], v[60:63]
    s_waitcnt lgkmcnt(2)
    v_exp_f32 v5, v37
    v_mfma_f32_16x16x32_bf16 v[60:63], a[92:95], a[188:191], v[60:63]
    s_mov_b32 s80, 0x1000000
    v_exp_f32 v6, v38
    v_mfma_f32_16x16x32_bf16 v[176:179], a[120:123], v[72:75], 0
    buffer_store_dwordx4 a[192:195], v26, s[84:87], s80 offen sc1
    ds_read_b128 a[144:147], v19 offset:1024
    ds_read_b128 a[132:135], v19 offset:2048
    v_cvt_pk_bf16_f32 v66, v4, v5
    v_mfma_f32_16x16x32_bf16 v[184:187], a[120:123], v[76:79], 0
    s_waitcnt lgkmcnt(3)
    ds_read_b128 a[148:151], v19 offset:3072
    ds_read_b128 a[136:139], v19 offset:4096
    ds_read_b128 a[152:155], v19 offset:5120
    ds_read_b128 a[140:143], v19 offset:6144
    ds_read_b128 a[156:159], v19 offset:7168
    v_mfma_f32_16x16x32_bf16 v[180:183], a[124:127], v[72:75], 0
    v_exp_f32 v7, v39
    v_mfma_f32_16x16x32_bf16 v[188:191], a[124:127], v[76:79], 0
    v_exp_f32 v8, v44
    v_smfmac_f32_16x16x64_bf16 v[112:115], v[12:15], v[72:79], v124
    s_xor_b32 m0, s15, 0x10000
    v_cvt_pk_bf16_f32 v67, v6, v7
    v_mfma_f32_16x16x32_bf16 v[32:35], a[64:67], a[32:35], v[88:91]
    buffer_load_dwordx4 v2, s[52:55], s10 offen offset:0 sc1 lds
    v_mfma_f32_16x16x32_bf16 v[32:35], a[68:71], a[36:39], v[32:35]
    v_exp_f32 v9, v45
    v_mfma_f32_16x16x32_bf16 v[32:35], a[72:75], a[40:43], v[32:35]
    buffer_store_dwordx4 a[196:199], v26, s[84:87], s80 offen offset:1024 sc1
    v_exp_f32 v10, v46
    v_cvt_pk_bf16_f32 v70, v8, v9
    v_mfma_f32_16x16x32_bf16 v[32:35], a[76:79], a[44:47], v[32:35]
    v_exp_f32 v11, v47
    v_mfma_f32_16x16x32_bf16 v[40:43], a[64:67], a[48:51], v[92:95]
    v_cvt_pk_bf16_f32 v71, v10, v11
    v_mov_b32 v72, 0
    v_mfma_f32_16x16x32_bf16 v[40:43], a[68:71], a[52:55], v[40:43]
    buffer_load_dwordx4 v2, s[52:55], s10 offen offset:1024 sc1 lds
    v_mfma_f32_16x16x32_bf16 v[40:43], a[72:75], a[56:59], v[40:43]
    v_mov_b32 v73, 0
    v_mov_b32 v74, 0
    v_mfma_f32_16x16x32_bf16 v[40:43], a[76:79], a[60:63], v[40:43]
    v_exp_f32 v4, v56
    v_mfma_f32_16x16x32_bf16 v[192:195], a[96:99], v[64:67], 0
    v_exp_f32 v5, v57
    v_mfma_f32_16x16x32_bf16 v[200:203], a[96:99], v[68:71], 0
    buffer_store_dwordx4 a[200:203], v26, s[84:87], s80 offen offset:2048 sc1
    v_exp_f32 v6, v58
    v_cvt_pk_bf16_f32 v76, v4, v5
    v_mfma_f32_16x16x32_bf16 v[196:199], a[100:103], v[64:67], 0
    buffer_load_dwordx4 v2, s[52:55], s10 offen offset:2048 sc1 lds
    v_mfma_f32_16x16x32_bf16 v[204:207], a[100:103], v[68:71], 0
    v_exp_f32 v7, v59
    v_mfma_f32_16x16x32_bf16 v[208:211], a[104:107], v[64:67], 0
    v_exp_f32 v8, v60
    v_mfma_f32_16x16x32_bf16 v[216:219], a[104:107], v[68:71], 0
    v_cvt_pk_bf16_f32 v77, v6, v7
    v_mov_b32 v75, 0
    v_mfma_f32_16x16x32_bf16 v[212:215], a[108:111], v[64:67], 0
    s_waitcnt vmcnt(19) lgkmcnt(0)
    s_barrier
    v_exp_f32 v9, v61
    v_mfma_f32_16x16x32_bf16 v[220:223], a[108:111], v[68:71], 0
    buffer_load_dwordx4 v2, s[52:55], s10 offen offset:3072 sc1 lds
    v_mfma_f32_16x16x32_bf16 v[36:39], a[80:83], a[32:35], v[88:91]
    s_add_u32 s10, s10, 0x2000
    s_cmp_eq_u32 s10, s90
    s_cselect_b32 s10, s92, s10
    v_mfma_f32_16x16x32_bf16 v[36:39], a[84:87], a[36:39], v[36:39]
    buffer_store_dwordx4 a[204:207], v26, s[84:87], s80 offen offset:3072 sc1
    v_exp_f32 v10, v62
    v_cvt_pk_bf16_f32 v78, v8, v9
    v_mfma_f32_16x16x32_bf16 v[36:39], a[88:91], a[40:43], v[36:39]
    v_exp_f32 v11, v63
    v_mfma_f32_16x16x32_bf16 v[36:39], a[92:95], a[44:47], v[36:39]
    ds_read_b128 a[96:99], v16 offset:24576
    v_cvt_pk_bf16_f32 v79, v10, v11
    v_mfma_f32_16x16x32_bf16 v[224:227], a[112:115], v[64:67], 0
    s_cmp_eq_u32 s3, 2
    s_cselect_b32 s96, 1.0, 0
    ds_read_b128 a[100:103], v16 offset:25600
    v_mfma_f32_16x16x32_bf16 v[232:235], a[112:115], v[68:71], 0
    s_cmp_lt_u32 s3, 2
    s_cselect_b32 s12, 0xf1800000, 0
    ds_read_b128 a[104:107], v16 offset:26624
    v_mfma_f32_16x16x32_bf16 v[228:231], a[116:119], v[64:67], 0
    s_mov_b32 s80, 0x2000
    ds_read_b128 a[108:111], v16 offset:27648
    v_add_f32 v29, s12, v84
    v_mfma_f32_16x16x32_bf16 v[236:239], a[116:119], v[68:71], 0
    buffer_store_dwordx4 a[240:243], v25, s[84:87], s80 offen sc1
    ds_read_b128 a[64:67], v16 offset:0
    ds_read_b128 a[68:71], v16 offset:1024
    ds_write2_b32 v18, v88, v92 offset0:0 offset1:1
    v_mfma_f32_16x16x32_bf16 v[44:47], a[80:83], a[48:51], v[92:95]
    v_exp_f32 v4, v32
    v_mfma_f32_16x16x32_bf16 v[44:47], a[84:87], a[52:55], v[44:47]
    v_exp_f32 v5, v33
    v_mfma_f32_16x16x32_bf16 v[44:47], a[88:91], a[56:59], v[44:47]
    v_exp_f32 v6, v34
    v_mfma_f32_16x16x32_bf16 v[44:47], a[92:95], a[60:63], v[44:47]
    s_xor_b32 m0, s15, 0x14000
    ds_read_b128 a[72:75], v16 offset:2048
    ds_read_b128 a[76:79], v16 offset:3072
    v_mfma_f32_16x16x32_bf16 v[240:243], a[120:123], v[64:67], 0
    buffer_load_dwordx4 v2, s[52:55], s10 offen offset:0 sc1 lds
    v_mfma_f32_16x16x32_bf16 v[248:251], a[120:123], v[68:71], 0
    v_exp_f32 v7, v35
    v_mfma_f32_16x16x32_bf16 v[244:247], a[124:127], v[64:67], 0
    buffer_store_dwordx4 a[244:247], v25, s[84:87], s80 offen offset:1024 sc1
    ds_read_b128 a[112:115], v16 offset:28672
    ds_read_b128 a[116:119], v16 offset:29696
    ds_read_b128 a[80:83], v16 offset:4096
    v_mfma_f32_16x16x32_bf16 v[252:255], a[124:127], v[68:71], 0
    ds_read_b128 a[84:87], v16 offset:5120
    v_fma_f32 v56, v96, s96, v29
    v_smfmac_f32_16x16x64_bf16 v[120:123], v[12:15], v[64:71], v124
    s_waitcnt lgkmcnt(7)
    ds_read_b128 a[88:91], v16 offset:6144
    v_mfma_f32_16x16x32_bf16 v[136:139], a[96:99], v[76:79], v[136:139]
    buffer_load_dwordx4 v2, s[52:55], s10 offen offset:1024 sc1 lds
    v_fma_f32 v57, v97, s96, v29
    v_fma_f32 v58, v98, s96, v29
    v_fma_f32 v59, v99, s96, v29
    v_mfma_f32_16x16x32_bf16 v[140:143], a[100:103], v[76:79], v[140:143]
    v_cvt_pk_bf16_f32 v64, v4, v5
    v_exp_f32 v8, v40
    v_mfma_f32_16x16x32_bf16 v[56:59], a[64:67], a[176:179], v[56:59]
    s_waitcnt lgkmcnt(5)
    v_exp_f32 v9, v41
    v_mfma_f32_16x16x32_bf16 v[56:59], a[68:71], a[180:183], v[56:59]
    s_mov_b32 s80, 0x3000
    ds_read_b128 a[92:95], v16 offset:7168
    v_cvt_pk_bf16_f32 v65, v6, v7
    v_mfma_f32_16x16x32_bf16 v[56:59], a[72:75], a[184:187], v[56:59]
    buffer_store_dwordx4 a[248:251], v25, s[84:87], s80 offen sc1
    ds_read_b128 a[120:123], v16 offset:30720
    ds_read_b128 a[124:127], v16 offset:31744
    v_exp_f32 v10, v42
    v_mfma_f32_16x16x32_bf16 v[56:59], a[76:79], a[188:191], v[56:59]
    buffer_load_dwordx4 v2, s[52:55], s10 offen offset:2048 sc1 lds
    v_mfma_f32_16x16x32_bf16 v[152:155], a[104:107], v[76:79], v[152:155]
    s_waitcnt lgkmcnt(3)
    v_exp_f32 v11, v43
    v_mfma_f32_16x16x32_bf16 v[156:159], a[108:111], v[76:79], v[156:159]
    s_cmp_eq_u32 s3, 3
    s_cselect_b32 s96, 1.0, 0
    v_cvt_pk_bf16_f32 v68, v8, v9
    v_mfma_f32_16x16x32_bf16 v[168:171], a[112:115], v[76:79], v[168:171]
    s_cmp_lt_u32 s3, 3
    s_cselect_b32 s12, 0xf1800000, 0
    v_exp_f32 v4, v36
    v_add_f32 v29, s12, v84
    v_fma_f32 v60, v96, s96, v29
    v_fma_f32 v61, v97, s96, v29
    v_fma_f32 v62, v98, s96, v29
    v_fma_f32 v63, v99, s96, v29
    v_mfma_f32_16x16x32_bf16 v[172:175], a[116:119], v[76:79], v[172:175]
    v_exp_f32 v5, v37
    v_mfma_f32_16x16x32_bf16 v[60:63], a[80:83], a[176:179], v[60:63]
    buffer_load_dwordx4 v2, s[52:55], s10 offen offset:3072 sc1 lds
    v_mfma_f32_16x16x32_bf16 v[60:63], a[84:87], a[180:183], v[60:63]
    s_add_u32 s10, s10, 0x2000
    s_cmp_eq_u32 s10, s90
    s_cselect_b32 s10, s92, s10
    v_mfma_f32_16x16x32_bf16 v[60:63], a[88:91], a[184:187], v[60:63]
    s_waitcnt lgkmcnt(0)
    buffer_store_dwordx4 a[252:255], v25, s[84:87], s80 offen offset:1024 sc1
    v_cvt_pk_bf16_f32 v69, v10, v11
    v_exp_f32 v6, v38
    v_mfma_f32_16x16x32_bf16 v[60:63], a[92:95], a[188:191], v[60:63]
    v_exp_f32 v7, v39
    v_mfma_f32_16x16x32_bf16 v[184:187], a[120:123], v[76:79], v[184:187]
    s_cmp_eq_u32 s3, 2
    s_cselect_b32 s96, 1.0, 0
    v_cvt_pk_bf16_f32 v66, v4, v5
    v_mfma_f32_16x16x32_bf16 v[188:191], a[124:127], v[76:79], v[188:191]
    v_exp_f32 v8, v44
    v_smfmac_f32_16x16x64_bf16 v[112:115], v[12:15], v[72:79], v124
    s_cmp_lt_u32 s3, 2
    s_cselect_b32 s12, 0xf1800000, 0
    v_mfma_f32_16x16x32_bf16 v[32:35], a[64:67], a[32:35], v[88:91]
    s_mov_b32 s80, 0x1002000
    v_exp_f32 v9, v45
    v_xor_b32 v18, 0x6000, v18
    v_mfma_f32_16x16x32_bf16 v[32:35], a[68:71], a[36:39], v[32:35]
    buffer_store_dwordx4 a[208:211], v26, s[84:87], s80 offen sc1
    v_cvt_pk_bf16_f32 v67, v6, v7
    v_exp_f32 v10, v46
    v_mfma_f32_16x16x32_bf16 v[32:35], a[72:75], a[40:43], v[32:35]
    v_exp_f32 v11, v47
    v_mfma_f32_16x16x32_bf16 v[32:35], a[76:79], a[44:47], v[32:35]
    v_cvt_pk_bf16_f32 v70, v8, v9
    v_add_f32 v29, s12, v80
    v_mfma_f32_16x16x32_bf16 v[40:43], a[64:67], a[48:51], v[92:95]
    v_cvt_pk_bf16_f32 v71, v10, v11
    v_fma_f32 v48, v96, s96, v29
    v_mfma_f32_16x16x32_bf16 v[40:43], a[68:71], a[52:55], v[40:43]
    s_xor_b32 m0, s15, 0x18000
    v_fma_f32 v49, v97, s96, v29
    v_fma_f32 v50, v98, s96, v29
    v_mfma_f32_16x16x32_bf16 v[40:43], a[72:75], a[56:59], v[40:43]
    buffer_load_dwordx4 v2, s[52:55], s10 offen offset:0 sc1 lds
    v_mfma_f32_16x16x32_bf16 v[40:43], a[76:79], a[60:63], v[40:43]
    v_exp_f32 v4, v56
    v_mfma_f32_16x16x32_bf16 v[192:195], a[96:99], v[64:67], v[192:195]
    buffer_store_dwordx4 a[212:215], v26, s[84:87], s80 offen offset:1024 sc1
    v_exp_f32 v5, v57
    v_fma_f32 v51, v99, s96, v29
    v_mfma_f32_16x16x32_bf16 v[200:203], a[96:99], v[68:71], v[200:203]
    s_cmp_eq_u32 s3, 3
    s_cselect_b32 s96, 1.0, 0
    v_accvgpr_write_b32 a0, -1
    v_mfma_f32_16x16x32_bf16 v[196:199], a[100:103], v[64:67], v[196:199]
    v_exp_f32 v6, v58
    v_mfma_f32_16x16x32_bf16 v[204:207], a[100:103], v[68:71], v[204:207]
    buffer_load_dwordx4 v2, s[52:55], s10 offen offset:1024 sc1 lds
    v_mfma_f32_16x16x32_bf16 v[208:211], a[104:107], v[64:67], v[208:211]
    s_cmp_lt_u32 s3, 3
    s_cselect_b32 s12, 0xf1800000, 0
    v_cvt_pk_bf16_f32 v76, v4, v5
    v_mfma_f32_16x16x32_bf16 v[216:219], a[104:107], v[68:71], v[216:219]
    v_add_f32 v29, s12, v80
    v_fma_f32 v52, v96, s96, v29
    v_mfma_f32_16x16x32_bf16 v[212:215], a[108:111], v[64:67], v[212:215]
    s_waitcnt vmcnt(28)
    s_barrier
    v_exp_f32 v7, v59
    v_mfma_f32_16x16x32_bf16 v[220:223], a[108:111], v[68:71], v[220:223]
    buffer_store_dwordx4 a[216:219], v26, s[84:87], s80 offen offset:2048 sc1
    ds_read_b128 a[96:99], v16 offset:40960
    v_exp_f32 v8, v60
    v_mfma_f32_16x16x32_bf16 v[36:39], a[80:83], a[32:35], v[88:91]
    buffer_load_dwordx4 v2, s[52:55], s10 offen offset:2048 sc1 lds
    ds_read_b64 v[18:19], v18
    v_mfma_f32_16x16x32_bf16 v[36:39], a[84:87], a[36:39], v[36:39]
    ds_read_b128 a[100:103], v16 offset:41984
    v_cvt_pk_bf16_f32 v77, v6, v7
    v_mfma_f32_16x16x32_bf16 v[36:39], a[88:91], a[40:43], v[36:39]
    ds_read_b128 a[104:107], v16 offset:43008
    v_fma_f32 v53, v97, s96, v29
    v_mfma_f32_16x16x32_bf16 v[36:39], a[92:95], a[44:47], v[36:39]
    v_exp_f32 v9, v61
    v_mfma_f32_16x16x32_bf16 v[224:227], a[112:115], v[64:67], v[224:227]
    ds_read_b128 a[108:111], v16 offset:44032
    ds_read_b128 a[64:67], v16 offset:16384
    v_mfma_f32_16x16x32_bf16 v[232:235], a[112:115], v[68:71], v[232:235]
    buffer_load_dwordx4 v2, s[52:55], s10 offen offset:3072 sc1 lds
    v_mfma_f32_16x16x32_bf16 v[228:231], a[116:119], v[64:67], v[228:231]
    s_add_u32 s10, s10, 0x2000
    s_cmp_eq_u32 s10, s90
    s_cselect_b32 s10, s92, s10
    v_mfma_f32_16x16x32_bf16 v[236:239], a[116:119], v[68:71], v[236:239]
    buffer_store_dwordx4 a[220:223], v26, s[84:87], s80 offen offset:3072 sc1
    v_exp_f32 v10, v62
    v_cvt_pk_bf16_f32 v78, v8, v9
    v_mfma_f32_16x16x32_bf16 v[44:47], a[80:83], a[48:51], v[92:95]
    v_exp_f32 v11, v63
    v_mfma_f32_16x16x32_bf16 v[44:47], a[84:87], a[52:55], v[44:47]
    ds_read_b128 a[68:71], v16 offset:17408
    ds_read_b128 a[72:75], v16 offset:18432
    v_mfma_f32_16x16x32_bf16 v[44:47], a[88:91], a[56:59], v[44:47]
    ds_read_b128 a[76:79], v16 offset:19456
    v_cvt_pk_bf16_f32 v79, v10, v11
    v_mfma_f32_16x16x32_bf16 v[44:47], a[92:95], a[60:63], v[44:47]
    ds_read_b128 a[112:115], v16 offset:45056
    v_fma_f32 v54, v98, s96, v29
    v_mfma_f32_16x16x32_bf16 v[240:243], a[120:123], v[64:67], v[240:243]
    ds_read_b128 a[116:119], v16 offset:46080
    v_fma_f32 v55, v99, s96, v29
    v_mfma_f32_16x16x32_bf16 v[248:251], a[120:123], v[68:71], v[248:251]
    ds_read_b128 a[80:83], v16 offset:20480
    v_accvgpr_write_b32 a1, -1
    v_mfma_f32_16x16x32_bf16 v[244:247], a[124:127], v[64:67], v[244:247]
    v_exp_f32 v4, v32
    v_mfma_f32_16x16x32_bf16 v[252:255], a[124:127], v[68:71], v[252:255]
    v_exp_f32 v5, v33
    v_smfmac_f32_16x16x64_bf16 v[120:123], v[12:15], v[64:71], v124
    s_waitcnt lgkmcnt(6)
    ds_read_b128 a[84:87], v16 offset:21504
    v_mfma_f32_16x16x32_bf16 v[48:51], a[64:67], a[160:163], v[48:51]
    s_waitcnt lgkmcnt(5)
    v_exp_f32 v6, v34
    v_mfma_f32_16x16x32_bf16 v[48:51], a[68:71], a[164:167], v[48:51]
    v_exp_f32 v7, v35
    v_mfma_f32_16x16x32_bf16 v[48:51], a[72:75], a[168:171], v[48:51]
    s_waitcnt lgkmcnt(4)
    ds_read_b128 a[88:91], v16 offset:22528
    v_cvt_pk_bf16_f32 v64, v4, v5
    v_mfma_f32_16x16x32_bf16 v[48:51], a[76:79], a[172:175], v[48:51]
    s_xor_b32 m0, s15, 0x1c000
    v_exp_f32 v8, v40
    v_mfma_f32_16x16x32_bf16 v[136:139], a[96:99], v[76:79], v[136:139]
    buffer_load_dwordx4 v2, s[52:55], s10 offen offset:0 sc1 lds
    v_mfma_f32_16x16x32_bf16 v[140:143], a[100:103], v[76:79], v[140:143]
    v_exp_f32 v9, v41
    v_mfma_f32_16x16x32_bf16 v[56:59], a[64:67], a[176:179], v[84:87]
    ds_read_b128 a[92:95], v16 offset:23552
    v_cvt_pk_bf16_f32 v65, v6, v7
    v_mfma_f32_16x16x32_bf16 v[56:59], a[68:71], a[180:183], v[56:59]
    v_exp_f32 v10, v42
    v_mfma_f32_16x16x32_bf16 v[56:59], a[72:75], a[184:187], v[56:59]
    v_exp_f32 v11, v43
    v_mfma_f32_16x16x32_bf16 v[56:59], a[76:79], a[188:191], v[56:59]
    buffer_load_dwordx4 v2, s[52:55], s10 offen offset:1024 sc1 lds
    v_mfma_f32_16x16x32_bf16 v[152:155], a[104:107], v[76:79], v[152:155]
    ds_read_b128 a[120:123], v16 offset:47104
    v_cvt_pk_bf16_f32 v68, v8, v9
    v_mfma_f32_16x16x32_bf16 v[156:159], a[108:111], v[76:79], v[156:159]
    s_waitcnt lgkmcnt(2)
    v_exp_f32 v4, v36
    v_mfma_f32_16x16x32_bf16 v[52:55], a[80:83], a[160:163], v[52:55]
    v_exp_f32 v5, v37
    v_mfma_f32_16x16x32_bf16 v[52:55], a[84:87], a[164:167], v[52:55]
    ds_read_b128 a[124:127], v16 offset:48128
    v_cvt_pk_bf16_f32 v69, v10, v11
    v_mfma_f32_16x16x32_bf16 v[52:55], a[88:91], a[168:171], v[52:55]
    s_waitcnt lgkmcnt(2)
    buffer_load_dwordx4 v2, s[52:55], s10 offen offset:2048 sc1 lds
    v_mfma_f32_16x16x32_bf16 v[52:55], a[92:95], a[172:175], v[52:55]
    v_exp_f32 v6, v38
    v_mfma_f32_16x16x32_bf16 v[168:171], a[112:115], v[76:79], v[168:171]
    v_exp_f32 v7, v39
    v_mfma_f32_16x16x32_bf16 v[172:175], a[116:119], v[76:79], v[172:175]
    v_cvt_pk_bf16_f32 v66, v4, v5
    v_xor_b32 v16, 0x10000, v16
    v_mfma_f32_16x16x32_bf16 v[60:63], a[80:83], a[176:179], v[84:87]
    v_exp_f32 v8, v44
    v_mfma_f32_16x16x32_bf16 v[60:63], a[84:87], a[180:183], v[60:63]
    buffer_load_dwordx4 v2, s[52:55], s10 offen offset:3072 sc1 lds
    v_mfma_f32_16x16x32_bf16 v[60:63], a[88:91], a[184:187], v[60:63]
    s_add_u32 s10, s10, 0x2000
    s_cmp_eq_u32 s10, s90
    s_cselect_b32 s10, s92, s10
    v_mfma_f32_16x16x32_bf16 v[60:63], a[92:95], a[188:191], v[60:63]
    s_waitcnt lgkmcnt(0)
    v_exp_f32 v9, v45
    v_mfma_f32_16x16x32_bf16 v[184:187], a[120:123], v[76:79], v[184:187]
    v_cvt_pk_bf16_f32 v67, v6, v7
    v_xor_b32 v17, 0x10000, v17
    v_mfma_f32_16x16x32_bf16 v[188:191], a[124:127], v[76:79], v[188:191]
    v_exp_f32 v10, v46
    v_smfmac_f32_16x16x64_bf16 v[112:115], v[12:15], v[72:79], v124
    v_exp_f32 v11, v47
    v_cvt_pk_bf16_f32 v70, v8, v9
    v_cvt_pk_bf16_f32 v71, v10, v11
    v_accvgpr_write_b32 a2, -1
    v_accvgpr_write_b32 a3, -1
    s_sub_u32 s91, s7, 1
    s_cbranch_scc1 kTR
.p2align 6
kF:
    v_mfma_f32_16x16x32_bf16 v[32:35], a[64:67], a[32:35], v[88:91]
    v_mfma_f32_16x16x32_bf16 v[32:35], a[68:71], a[36:39], v[32:35]
    v_exp_f32 v4, v48
    v_mfma_f32_16x16x32_bf16 v[32:35], a[72:75], a[40:43], v[32:35]
    v_mfma_f32_16x16x32_bf16 v[32:35], a[76:79], a[44:47], v[32:35]
    v_exp_f32 v5, v49
    v_mfma_f32_16x16x32_bf16 v[192:195], a[96:99], v[64:67], v[192:195]
    v_cvt_pk_bf16_f32 v72, v4, v5
    v_mfma_f32_16x16x32_bf16 v[200:203], a[96:99], v[68:71], v[200:203]
    v_exp_f32 v6, v50
    v_mfma_f32_16x16x32_bf16 v[196:199], a[100:103], v[64:67], v[196:199]
    v_mfma_f32_16x16x32_bf16 v[204:207], a[100:103], v[68:71], v[204:207]
    v_exp_f32 v7, v51
    v_mfma_f32_16x16x32_bf16 v[40:43], a[64:67], a[48:51], v[92:95]
    v_cvt_pk_bf16_f32 v73, v6, v7
    v_mfma_f32_16x16x32_bf16 v[40:43], a[68:71], a[52:55], v[40:43]
    v_exp_f32 v8, v52
    v_mfma_f32_16x16x32_bf16 v[40:43], a[72:75], a[56:59], v[40:43]
    v_mfma_f32_16x16x32_bf16 v[40:43], a[76:79], a[60:63], v[40:43]
    v_exp_f32 v9, v53
    v_mfma_f32_16x16x32_bf16 v[208:211], a[104:107], v[64:67], v[208:211]
    v_cvt_pk_bf16_f32 v74, v8, v9
    v_mfma_f32_16x16x32_bf16 v[216:219], a[104:107], v[68:71], v[216:219]
    s_waitcnt vmcnt(15)
    v_exp_f32 v10, v54
    v_mfma_f32_16x16x32_bf16 v[212:215], a[108:111], v[64:67], v[212:215]
    s_barrier
    buffer_store_dwordx4 a[0:3], v2, s[20:23], s19 offen sc1
    v_mfma_f32_16x16x32_bf16 v[220:223], a[108:111], v[68:71], v[220:223]
    s_sub_u32 s25, s25, 0x20000
    v_exp_f32 v11, v55
    v_mfma_f32_16x16x32_bf16 v[36:39], a[80:83], a[32:35], v[88:91]
    ds_read_b128 a[64:67], v17 offset:32768
    v_cvt_pk_bf16_f32 v75, v10, v11
    v_mfma_f32_16x16x32_bf16 v[36:39], a[84:87], a[36:39], v[36:39]
    s_cselect_b64 s[88:89], -1, 0
    v_exp_f32 v4, v56
    v_mfma_f32_16x16x32_bf16 v[36:39], a[88:91], a[40:43], v[36:39]
    ds_read_b128 a[68:71], v17 offset:33792
    v_cmp_ne_u32 vcc, 1, v27
    v_mfma_f32_16x16x32_bf16 v[36:39], a[92:95], a[44:47], v[36:39]
    v_exp_f32 v5, v57
    v_mfma_f32_16x16x32_bf16 v[224:227], a[112:115], v[64:67], v[224:227]
    ds_read_b128 a[72:75], v17 offset:34816
    v_cvt_pk_bf16_f32 v76, v4, v5
    v_mfma_f32_16x16x32_bf16 v[232:235], a[112:115], v[68:71], v[232:235]
    s_and_b64 vcc, vcc, s[88:89]
    v_exp_f32 v6, v58
    v_mfma_f32_16x16x32_bf16 v[228:231], a[116:119], v[64:67], v[228:231]
    ds_read_b128 a[76:79], v17 offset:35840
    v_mfma_f32_16x16x32_bf16 v[236:239], a[116:119], v[68:71], v[236:239]
    s_cbranch_scc1 kFp_slow
kFp_ok:
    v_exp_f32 v7, v59
    v_mfma_f32_16x16x32_bf16 v[44:47], a[80:83], a[48:51], v[92:95]
    ds_read_b128 a[96:99], v17 offset:57344
    v_cvt_pk_bf16_f32 v77, v6, v7
    v_mfma_f32_16x16x32_bf16 v[44:47], a[84:87], a[52:55], v[44:47]
    v_exp_f32 v8, v60
    v_mfma_f32_16x16x32_bf16 v[44:47], a[88:91], a[56:59], v[44:47]
    ds_read_b128 a[100:103], v17 offset:58368
    v_mfma_f32_16x16x32_bf16 v[44:47], a[92:95], a[60:63], v[44:47]
    s_add_u32 s19, s19, 1024
    v_exp_f32 v9, v61
    v_mfma_f32_16x16x32_bf16 v[240:243], a[120:123], v[64:67], v[240:243]
    ds_read_b128 a[104:107], v17 offset:59392
    v_cvt_pk_bf16_f32 v78, v8, v9
    v_mfma_f32_16x16x32_bf16 v[248:251], a[120:123], v[68:71], v[248:251]
    v_exp_f32 v10, v62
    v_mfma_f32_16x16x32_bf16 v[244:247], a[124:127], v[64:67], v[244:247]
    ds_read_b128 a[108:111], v17 offset:60416
    v_mfma_f32_16x16x32_bf16 v[252:255], a[124:127], v[68:71], v[252:255]
    v_exp_f32 v11, v63
    v_smfmac_f32_16x16x64_bf16 v[120:123], v[12:15], v[64:71], v124
    s_waitcnt lgkmcnt(3)
    v_cvt_pk_bf16_f32 v79, v10, v11
    v_mfma_f32_16x16x32_bf16 v[48:51], a[64:67], a[160:163], v[80:83]
    ds_read_b128 a[80:83], v17 offset:36864
    v_mfma_f32_16x16x32_bf16 v[48:51], a[68:71], a[164:167], v[48:51]
    v_exp_f32 v4, v32
    v_mfma_f32_16x16x32_bf16 v[48:51], a[72:75], a[168:171], v[48:51]
    ds_read_b128 a[84:87], v17 offset:37888
    v_mfma_f32_16x16x32_bf16 v[48:51], a[76:79], a[172:175], v[48:51]
    v_exp_f32 v5, v33
    v_mfma_f32_16x16x32_bf16 v[128:131], a[96:99], v[72:75], v[128:131]
    ds_read_b128 a[88:91], v17 offset:38912
    v_cvt_pk_bf16_f32 v64, v4, v5
    v_mfma_f32_16x16x32_bf16 v[136:139], a[96:99], v[76:79], v[136:139]
    s_waitcnt lgkmcnt(3)
    v_exp_f32 v6, v34
    v_mfma_f32_16x16x32_bf16 v[132:135], a[100:103], v[72:75], v[132:135]
    ds_read_b128 a[92:95], v17 offset:39936
    v_mfma_f32_16x16x32_bf16 v[140:143], a[100:103], v[76:79], v[140:143]
    v_exp_f32 v7, v35
    v_mfma_f32_16x16x32_bf16 v[56:59], a[64:67], a[176:179], v[84:87]
    ds_read_b128 a[112:115], v17 offset:61440
    v_cvt_pk_bf16_f32 v65, v6, v7
    v_mfma_f32_16x16x32_bf16 v[56:59], a[68:71], a[180:183], v[56:59]
    v_exp_f32 v8, v36
    v_mfma_f32_16x16x32_bf16 v[56:59], a[72:75], a[184:187], v[56:59]
    ds_read_b128 a[116:119], v17 offset:62464
    v_mfma_f32_16x16x32_bf16 v[56:59], a[76:79], a[188:191], v[56:59]
    v_exp_f32 v9, v37
    v_mfma_f32_16x16x32_bf16 v[144:147], a[104:107], v[72:75], v[144:147]
    ds_read_b128 a[120:123], v17 offset:63488
    v_cvt_pk_bf16_f32 v66, v8, v9
    v_mfma_f32_16x16x32_bf16 v[152:155], a[104:107], v[76:79], v[152:155]
    v_exp_f32 v10, v38
    v_mfma_f32_16x16x32_bf16 v[148:151], a[108:111], v[72:75], v[148:151]
    ds_read_b128 a[124:127], v17 offset:64512
    v_mfma_f32_16x16x32_bf16 v[156:159], a[108:111], v[76:79], v[156:159]
    s_waitcnt lgkmcnt(4)
    v_exp_f32 v11, v39
    v_mfma_f32_16x16x32_bf16 v[52:55], a[80:83], a[160:163], v[80:83]
    v_cvt_pk_bf16_f32 v67, v10, v11
    v_mfma_f32_16x16x32_bf16 v[52:55], a[84:87], a[164:167], v[52:55]
    s_xor_b32 m0, s93, 0x10000
    v_exp_f32 v4, v40
    v_mfma_f32_16x16x32_bf16 v[52:55], a[88:91], a[168:171], v[52:55]
    s_waitcnt lgkmcnt(2)
    buffer_load_dwordx4 v2, s[52:55], s10 offen offset:0 sc1 lds
    v_mfma_f32_16x16x32_bf16 v[52:55], a[92:95], a[172:175], v[52:55]
    s_add_u32 s12, s10, 0x2000
    v_exp_f32 v5, v41
    v_mfma_f32_16x16x32_bf16 v[160:163], a[112:115], v[72:75], v[160:163]
    v_cvt_pk_bf16_f32 v68, v4, v5
    v_mfma_f32_16x16x32_bf16 v[168:171], a[112:115], v[76:79], v[168:171]
    v_exp_f32 v6, v42
    v_mfma_f32_16x16x32_bf16 v[164:167], a[116:119], v[72:75], v[164:167]
    buffer_load_dwordx4 v2, s[52:55], s10 offen offset:1024 sc1 lds
    v_mfma_f32_16x16x32_bf16 v[172:175], a[116:119], v[76:79], v[172:175]
    v_exp_f32 v7, v43
    v_mfma_f32_16x16x32_bf16 v[60:63], a[80:83], a[176:179], v[84:87]
    v_cvt_pk_bf16_f32 v69, v6, v7
    v_mfma_f32_16x16x32_bf16 v[60:63], a[84:87], a[180:183], v[60:63]
    v_exp_f32 v8, v44
    v_mfma_f32_16x16x32_bf16 v[60:63], a[88:91], a[184:187], v[60:63]
    buffer_load_dwordx4 v2, s[52:55], s10 offen offset:2048 sc1 lds
    v_mfma_f32_16x16x32_bf16 v[60:63], a[92:95], a[188:191], v[60:63]
    s_waitcnt lgkmcnt(0)
    v_exp_f32 v9, v45
    v_mfma_f32_16x16x32_bf16 v[176:179], a[120:123], v[72:75], v[176:179]
    v_cvt_pk_bf16_f32 v70, v8, v9
    v_mfma_f32_16x16x32_bf16 v[184:187], a[120:123], v[76:79], v[184:187]
    s_cmp_eq_u32 s12, s90
    v_exp_f32 v10, v46
    v_mfma_f32_16x16x32_bf16 v[180:183], a[124:127], v[72:75], v[180:183]
    buffer_load_dwordx4 v2, s[52:55], s10 offen offset:3072 sc1 lds
    v_mfma_f32_16x16x32_bf16 v[188:191], a[124:127], v[76:79], v[188:191]
    s_cselect_b32 s10, s92, s12
    v_exp_f32 v11, v47
    v_smfmac_f32_16x16x64_bf16 v[112:115], v[12:15], v[72:79], v124
    v_cvt_pk_bf16_f32 v71, v10, v11
    v_mfma_f32_16x16x32_bf16 v[32:35], a[64:67], a[32:35], v[88:91]
    v_mfma_f32_16x16x32_bf16 v[32:35], a[68:71], a[36:39], v[32:35]
    v_exp_f32 v4, v48
    v_mfma_f32_16x16x32_bf16 v[32:35], a[72:75], a[40:43], v[32:35]
    buffer_load_dword v3, v125, s[64:67], s18 offen
    v_mfma_f32_16x16x32_bf16 v[32:35], a[76:79], a[44:47], v[32:35]
    s_add_u32 s18, s18, 2176
    v_exp_f32 v5, v49
    v_mfma_f32_16x16x32_bf16 v[192:195], a[96:99], v[64:67], v[192:195]
    v_cvt_pk_bf16_f32 v72, v4, v5
    v_mfma_f32_16x16x32_bf16 v[200:203], a[96:99], v[68:71], v[200:203]
    v_exp_f32 v6, v50
    v_mfma_f32_16x16x32_bf16 v[196:199], a[100:103], v[64:67], v[196:199]
    v_mfma_f32_16x16x32_bf16 v[204:207], a[100:103], v[68:71], v[204:207]
    s_lshr_b32 s88, s25, 1
    v_exp_f32 v7, v51
    v_mfma_f32_16x16x32_bf16 v[40:43], a[64:67], a[48:51], v[92:95]
    v_cvt_pk_bf16_f32 v73, v6, v7
    v_mfma_f32_16x16x32_bf16 v[40:43], a[68:71], a[52:55], v[40:43]
    v_exp_f32 v8, v52
    v_mfma_f32_16x16x32_bf16 v[40:43], a[72:75], a[56:59], v[40:43]
    buffer_load_dword v27, v20, s[68:71], s88 offen sc1
    v_mfma_f32_16x16x32_bf16 v[40:43], a[76:79], a[60:63], v[40:43]
    v_exp_f32 v9, v53
    v_mfma_f32_16x16x32_bf16 v[208:211], a[104:107], v[64:67], v[208:211]
    v_cvt_pk_bf16_f32 v74, v8, v9
    v_mfma_f32_16x16x32_bf16 v[216:219], a[104:107], v[68:71], v[216:219]
    v_exp_f32 v10, v54
    v_mfma_f32_16x16x32_bf16 v[212:215], a[108:111], v[64:67], v[212:215]
    buffer_store_dwordx4 a[0:3], v2, s[20:23], s19 offen sc1
    v_mfma_f32_16x16x32_bf16 v[220:223], a[108:111], v[68:71], v[220:223]
    v_exp_f32 v11, v55
    v_mfma_f32_16x16x32_bf16 v[36:39], a[80:83], a[32:35], v[88:91]
    ds_read_b128 a[64:67], v17 offset:49152
    v_cvt_pk_bf16_f32 v75, v10, v11
    v_mfma_f32_16x16x32_bf16 v[36:39], a[84:87], a[36:39], v[36:39]
    v_exp_f32 v4, v56
    v_mfma_f32_16x16x32_bf16 v[36:39], a[88:91], a[40:43], v[36:39]
    ds_read_b128 a[68:71], v17 offset:50176
    v_mfma_f32_16x16x32_bf16 v[36:39], a[92:95], a[44:47], v[36:39]
    v_exp_f32 v5, v57
    v_mfma_f32_16x16x32_bf16 v[224:227], a[112:115], v[64:67], v[224:227]
    ds_read_b128 a[72:75], v17 offset:51200
    v_cvt_pk_bf16_f32 v76, v4, v5
    v_mfma_f32_16x16x32_bf16 v[232:235], a[112:115], v[68:71], v[232:235]
    v_exp_f32 v6, v58
    v_mfma_f32_16x16x32_bf16 v[228:231], a[116:119], v[64:67], v[228:231]
    ds_read_b128 a[76:79], v17 offset:52224
    v_mfma_f32_16x16x32_bf16 v[236:239], a[116:119], v[68:71], v[236:239]
    v_exp_f32 v7, v59
    v_mfma_f32_16x16x32_bf16 v[44:47], a[80:83], a[48:51], v[92:95]
    ds_read_b128 a[96:99], v16 offset:8192
    v_cvt_pk_bf16_f32 v77, v6, v7
    v_mfma_f32_16x16x32_bf16 v[44:47], a[84:87], a[52:55], v[44:47]
    v_exp_f32 v8, v60
    v_mfma_f32_16x16x32_bf16 v[44:47], a[88:91], a[56:59], v[44:47]
    ds_read_b128 a[100:103], v16 offset:9216
    v_mfma_f32_16x16x32_bf16 v[44:47], a[92:95], a[60:63], v[44:47]
    s_add_u32 s19, s19, 1024
    v_exp_f32 v9, v61
    v_mfma_f32_16x16x32_bf16 v[240:243], a[120:123], v[64:67], v[240:243]
    ds_read_b128 a[104:107], v16 offset:10240
    v_cvt_pk_bf16_f32 v78, v8, v9
    v_mfma_f32_16x16x32_bf16 v[248:251], a[120:123], v[68:71], v[248:251]
    v_exp_f32 v10, v62
    v_mfma_f32_16x16x32_bf16 v[244:247], a[124:127], v[64:67], v[244:247]
    ds_read_b128 a[108:111], v16 offset:11264
    v_mfma_f32_16x16x32_bf16 v[252:255], a[124:127], v[68:71], v[252:255]
    v_exp_f32 v11, v63
    v_smfmac_f32_16x16x64_bf16 v[120:123], v[12:15], v[64:71], v124
    s_waitcnt lgkmcnt(3)
    v_cvt_pk_bf16_f32 v79, v10, v11
    v_mfma_f32_16x16x32_bf16 v[48:51], a[64:67], a[160:163], v[80:83]
    ds_read_b128 a[80:83], v17 offset:53248
    v_mfma_f32_16x16x32_bf16 v[48:51], a[68:71], a[164:167], v[48:51]
    v_exp_f32 v4, v32
    v_mfma_f32_16x16x32_bf16 v[48:51], a[72:75], a[168:171], v[48:51]
    ds_read_b128 a[84:87], v17 offset:54272
    v_mfma_f32_16x16x32_bf16 v[48:51], a[76:79], a[172:175], v[48:51]
    v_exp_f32 v5, v33
    v_mfma_f32_16x16x32_bf16 v[128:131], a[96:99], v[72:75], v[128:131]
    ds_read_b128 a[88:91], v17 offset:55296
    v_cvt_pk_bf16_f32 v64, v4, v5
    v_mfma_f32_16x16x32_bf16 v[136:139], a[96:99], v[76:79], v[136:139]
    s_waitcnt lgkmcnt(3)
    v_exp_f32 v6, v34
    v_mfma_f32_16x16x32_bf16 v[132:135], a[100:103], v[72:75], v[132:135]
    ds_read_b128 a[92:95], v17 offset:56320
    v_mfma_f32_16x16x32_bf16 v[140:143], a[100:103], v[76:79], v[140:143]
    v_exp_f32 v7, v35
    v_mfma_f32_16x16x32_bf16 v[56:59], a[64:67], a[176:179], v[84:87]
    ds_read_b128 a[112:115], v16 offset:12288
    v_cvt_pk_bf16_f32 v65, v6, v7
    v_mfma_f32_16x16x32_bf16 v[56:59], a[68:71], a[180:183], v[56:59]
    v_exp_f32 v8, v36
    v_mfma_f32_16x16x32_bf16 v[56:59], a[72:75], a[184:187], v[56:59]
    ds_read_b128 a[116:119], v16 offset:13312
    v_mfma_f32_16x16x32_bf16 v[56:59], a[76:79], a[188:191], v[56:59]
    v_exp_f32 v9, v37
    v_mfma_f32_16x16x32_bf16 v[144:147], a[104:107], v[72:75], v[144:147]
    ds_read_b128 a[120:123], v16 offset:14336
    v_cvt_pk_bf16_f32 v66, v8, v9
    v_mfma_f32_16x16x32_bf16 v[152:155], a[104:107], v[76:79], v[152:155]
    v_exp_f32 v10, v38
    v_mfma_f32_16x16x32_bf16 v[148:151], a[108:111], v[72:75], v[148:151]
    ds_read_b128 a[124:127], v16 offset:15360
    v_mfma_f32_16x16x32_bf16 v[156:159], a[108:111], v[76:79], v[156:159]
    s_waitcnt lgkmcnt(4)
    v_exp_f32 v11, v39
    v_mfma_f32_16x16x32_bf16 v[52:55], a[80:83], a[160:163], v[80:83]
    v_cvt_pk_bf16_f32 v67, v10, v11
    v_mfma_f32_16x16x32_bf16 v[52:55], a[84:87], a[164:167], v[52:55]
    s_xor_b32 m0, s93, 0x14000
    v_exp_f32 v4, v40
    v_mfma_f32_16x16x32_bf16 v[52:55], a[88:91], a[168:171], v[52:55]
    s_waitcnt lgkmcnt(2)
    buffer_load_dwordx4 v2, s[52:55], s10 offen offset:0 sc1 lds
    v_mfma_f32_16x16x32_bf16 v[52:55], a[92:95], a[172:175], v[52:55]
    s_add_u32 s12, s10, 0x2000
    v_exp_f32 v5, v41
    v_mfma_f32_16x16x32_bf16 v[160:163], a[112:115], v[72:75], v[160:163]
    v_cvt_pk_bf16_f32 v68, v4, v5
    v_mfma_f32_16x16x32_bf16 v[168:171], a[112:115], v[76:79], v[168:171]
    v_exp_f32 v6, v42
    v_mfma_f32_16x16x32_bf16 v[164:167], a[116:119], v[72:75], v[164:167]
    buffer_load_dwordx4 v2, s[52:55], s10 offen offset:1024 sc1 lds
    v_mfma_f32_16x16x32_bf16 v[172:175], a[116:119], v[76:79], v[172:175]
    v_exp_f32 v7, v43
    v_mfma_f32_16x16x32_bf16 v[60:63], a[80:83], a[176:179], v[84:87]
    v_cvt_pk_bf16_f32 v69, v6, v7
    v_mfma_f32_16x16x32_bf16 v[60:63], a[84:87], a[180:183], v[60:63]
    v_exp_f32 v8, v44
    v_mfma_f32_16x16x32_bf16 v[60:63], a[88:91], a[184:187], v[60:63]
    buffer_load_dwordx4 v2, s[52:55], s10 offen offset:2048 sc1 lds
    v_mfma_f32_16x16x32_bf16 v[60:63], a[92:95], a[188:191], v[60:63]
    s_waitcnt lgkmcnt(0)
    v_exp_f32 v9, v45
    v_mfma_f32_16x16x32_bf16 v[176:179], a[120:123], v[72:75], v[176:179]
    v_cvt_pk_bf16_f32 v70, v8, v9
    v_mfma_f32_16x16x32_bf16 v[184:187], a[120:123], v[76:79], v[184:187]
    s_cmp_eq_u32 s12, s90
    v_exp_f32 v10, v46
    v_mfma_f32_16x16x32_bf16 v[180:183], a[124:127], v[72:75], v[180:183]
    buffer_load_dwordx4 v2, s[52:55], s10 offen offset:3072 sc1 lds
    v_mfma_f32_16x16x32_bf16 v[188:191], a[124:127], v[76:79], v[188:191]
    s_cselect_b32 s10, s92, s12
    v_exp_f32 v11, v47
    v_smfmac_f32_16x16x64_bf16 v[112:115], v[12:15], v[72:79], v124
    v_cvt_pk_bf16_f32 v71, v10, v11
    v_mfma_f32_16x16x32_bf16 v[32:35], a[64:67], a[32:35], v[88:91]
    v_mfma_f32_16x16x32_bf16 v[32:35], a[68:71], a[36:39], v[32:35]
    v_exp_f32 v4, v48
    v_mfma_f32_16x16x32_bf16 v[32:35], a[72:75], a[40:43], v[32:35]
    v_mfma_f32_16x16x32_bf16 v[32:35], a[76:79], a[44:47], v[32:35]
    v_exp_f32 v5, v49
    v_mfma_f32_16x16x32_bf16 v[192:195], a[96:99], v[64:67], v[192:195]
    v_cvt_pk_bf16_f32 v72, v4, v5
    v_mfma_f32_16x16x32_bf16 v[200:203], a[96:99], v[68:71], v[200:203]
    v_exp_f32 v6, v50
    v_mfma_f32_16x16x32_bf16 v[196:199], a[100:103], v[64:67], v[196:199]
    v_mfma_f32_16x16x32_bf16 v[204:207], a[100:103], v[68:71], v[204:207]
    v_exp_f32 v7, v51
    v_mfma_f32_16x16x32_bf16 v[40:43], a[64:67], a[48:51], v[92:95]
    v_cvt_pk_bf16_f32 v73, v6, v7
    v_mfma_f32_16x16x32_bf16 v[40:43], a[68:71], a[52:55], v[40:43]
    v_exp_f32 v8, v52
    v_mfma_f32_16x16x32_bf16 v[40:43], a[72:75], a[56:59], v[40:43]
    v_mfma_f32_16x16x32_bf16 v[40:43], a[76:79], a[60:63], v[40:43]
    v_exp_f32 v9, v53
    v_mfma_f32_16x16x32_bf16 v[208:211], a[104:107], v[64:67], v[208:211]
    v_cvt_pk_bf16_f32 v74, v8, v9
    v_mfma_f32_16x16x32_bf16 v[216:219], a[104:107], v[68:71], v[216:219]
    s_waitcnt vmcnt(16)
    v_exp_f32 v10, v54
    v_mfma_f32_16x16x32_bf16 v[212:215], a[108:111], v[64:67], v[212:215]
    s_barrier
    buffer_store_dword v126, v127, s[68:71], s24 offen sc1
    v_mfma_f32_16x16x32_bf16 v[220:223], a[108:111], v[68:71], v[220:223]
    v_exp_f32 v11, v55
    v_mfma_f32_16x16x32_bf16 v[36:39], a[80:83], a[32:35], v[88:91]
    ds_read_b128 a[64:67], v16 offset:0
    v_cvt_pk_bf16_f32 v75, v10, v11
    v_mfma_f32_16x16x32_bf16 v[36:39], a[84:87], a[36:39], v[36:39]
    v_exp_f32 v4, v56
    v_mfma_f32_16x16x32_bf16 v[36:39], a[88:91], a[40:43], v[36:39]
    ds_read_b128 a[68:71], v16 offset:1024
    v_mfma_f32_16x16x32_bf16 v[36:39], a[92:95], a[44:47], v[36:39]
    v_exp_f32 v5, v57
    v_mfma_f32_16x16x32_bf16 v[224:227], a[112:115], v[64:67], v[224:227]
    ds_read_b128 a[72:75], v16 offset:2048
    v_cvt_pk_bf16_f32 v76, v4, v5
    v_mfma_f32_16x16x32_bf16 v[232:235], a[112:115], v[68:71], v[232:235]
    v_exp_f32 v6, v58
    v_mfma_f32_16x16x32_bf16 v[228:231], a[116:119], v[64:67], v[228:231]
    ds_read_b128 a[76:79], v16 offset:3072
    v_mfma_f32_16x16x32_bf16 v[236:239], a[116:119], v[68:71], v[236:239]
    v_exp_f32 v7, v59
    v_mfma_f32_16x16x32_bf16 v[44:47], a[80:83], a[48:51], v[92:95]
    ds_read_b128 a[96:99], v16 offset:24576
    v_cvt_pk_bf16_f32 v77, v6, v7
    v_mfma_f32_16x16x32_bf16 v[44:47], a[84:87], a[52:55], v[44:47]
    s_mov_b32 s24, 0x7f000000
    v_exp_f32 v8, v60
    v_mfma_f32_16x16x32_bf16 v[44:47], a[88:91], a[56:59], v[44:47]
    ds_read_b128 a[100:103], v16 offset:25600
    v_mfma_f32_16x16x32_bf16 v[44:47], a[92:95], a[60:63], v[44:47]
    v_exp_f32 v9, v61
    v_mfma_f32_16x16x32_bf16 v[240:243], a[120:123], v[64:67], v[240:243]
    ds_read_b128 a[104:107], v16 offset:26624
    v_cvt_pk_bf16_f32 v78, v8, v9
    v_mfma_f32_16x16x32_bf16 v[248:251], a[120:123], v[68:71], v[248:251]
    v_exp_f32 v10, v62
    v_mfma_f32_16x16x32_bf16 v[244:247], a[124:127], v[64:67], v[244:247]
    ds_read_b128 a[108:111], v16 offset:27648
    v_mfma_f32_16x16x32_bf16 v[252:255], a[124:127], v[68:71], v[252:255]
    v_exp_f32 v11, v63
    v_smfmac_f32_16x16x64_bf16 v[120:123], v[12:15], v[64:71], v124
    s_waitcnt lgkmcnt(3)
    v_cvt_pk_bf16_f32 v79, v10, v11
    v_mfma_f32_16x16x32_bf16 v[48:51], a[64:67], a[160:163], v[80:83]
    ds_read_b128 a[80:83], v16 offset:4096
    v_mfma_f32_16x16x32_bf16 v[48:51], a[68:71], a[164:167], v[48:51]
    v_exp_f32 v4, v32
    v_mfma_f32_16x16x32_bf16 v[48:51], a[72:75], a[168:171], v[48:51]
    ds_read_b128 a[84:87], v16 offset:5120
    v_mfma_f32_16x16x32_bf16 v[48:51], a[76:79], a[172:175], v[48:51]
    v_exp_f32 v5, v33
    v_mfma_f32_16x16x32_bf16 v[128:131], a[96:99], v[72:75], v[128:131]
    ds_read_b128 a[88:91], v16 offset:6144
    v_cvt_pk_bf16_f32 v64, v4, v5
    v_mfma_f32_16x16x32_bf16 v[136:139], a[96:99], v[76:79], v[136:139]
    s_waitcnt lgkmcnt(3)
    v_exp_f32 v6, v34
    v_mfma_f32_16x16x32_bf16 v[132:135], a[100:103], v[72:75], v[132:135]
    ds_read_b128 a[92:95], v16 offset:7168
    v_mfma_f32_16x16x32_bf16 v[140:143], a[100:103], v[76:79], v[140:143]
    v_exp_f32 v7, v35
    v_mfma_f32_16x16x32_bf16 v[56:59], a[64:67], a[176:179], v[84:87]
    ds_read_b128 a[112:115], v16 offset:28672
    v_cvt_pk_bf16_f32 v65, v6, v7
    v_mfma_f32_16x16x32_bf16 v[56:59], a[68:71], a[180:183], v[56:59]
    v_exp_f32 v8, v36
    v_mfma_f32_16x16x32_bf16 v[56:59], a[72:75], a[184:187], v[56:59]
    ds_read_b128 a[116:119], v16 offset:29696
    v_mfma_f32_16x16x32_bf16 v[56:59], a[76:79], a[188:191], v[56:59]
    v_exp_f32 v9, v37
    v_mfma_f32_16x16x32_bf16 v[144:147], a[104:107], v[72:75], v[144:147]
    ds_read_b128 a[120:123], v16 offset:30720
    v_cvt_pk_bf16_f32 v66, v8, v9
    v_mfma_f32_16x16x32_bf16 v[152:155], a[104:107], v[76:79], v[152:155]
    v_exp_f32 v10, v38
    v_mfma_f32_16x16x32_bf16 v[148:151], a[108:111], v[72:75], v[148:151]
    ds_read_b128 a[124:127], v16 offset:31744
    v_mfma_f32_16x16x32_bf16 v[156:159], a[108:111], v[76:79], v[156:159]
    s_waitcnt lgkmcnt(4)
    v_exp_f32 v11, v39
    v_mfma_f32_16x16x32_bf16 v[52:55], a[80:83], a[160:163], v[80:83]
    v_cvt_pk_bf16_f32 v67, v10, v11
    v_mfma_f32_16x16x32_bf16 v[52:55], a[84:87], a[164:167], v[52:55]
    s_xor_b32 m0, s93, 0x18000
    v_exp_f32 v4, v40
    v_mfma_f32_16x16x32_bf16 v[52:55], a[88:91], a[168:171], v[52:55]
    s_waitcnt lgkmcnt(2)
    buffer_load_dwordx4 v2, s[52:55], s10 offen offset:0 sc1 lds
    v_mfma_f32_16x16x32_bf16 v[52:55], a[92:95], a[172:175], v[52:55]
    s_add_u32 s12, s10, 0x2000
    v_exp_f32 v5, v41
    v_mfma_f32_16x16x32_bf16 v[160:163], a[112:115], v[72:75], v[160:163]
    v_cvt_pk_bf16_f32 v68, v4, v5
    v_mfma_f32_16x16x32_bf16 v[168:171], a[112:115], v[76:79], v[168:171]
    v_exp_f32 v6, v42
    v_mfma_f32_16x16x32_bf16 v[164:167], a[116:119], v[72:75], v[164:167]
    buffer_load_dwordx4 v2, s[52:55], s10 offen offset:1024 sc1 lds
    v_mfma_f32_16x16x32_bf16 v[172:175], a[116:119], v[76:79], v[172:175]
    v_exp_f32 v7, v43
    v_mfma_f32_16x16x32_bf16 v[60:63], a[80:83], a[176:179], v[84:87]
    v_cvt_pk_bf16_f32 v69, v6, v7
    v_mfma_f32_16x16x32_bf16 v[60:63], a[84:87], a[180:183], v[60:63]
    v_exp_f32 v8, v44
    v_mfma_f32_16x16x32_bf16 v[60:63], a[88:91], a[184:187], v[60:63]
    buffer_load_dwordx4 v2, s[52:55], s10 offen offset:2048 sc1 lds
    v_mfma_f32_16x16x32_bf16 v[60:63], a[92:95], a[188:191], v[60:63]
    s_waitcnt lgkmcnt(0)
    v_exp_f32 v9, v45
    v_mfma_f32_16x16x32_bf16 v[176:179], a[120:123], v[72:75], v[176:179]
    v_cvt_pk_bf16_f32 v70, v8, v9
    v_mfma_f32_16x16x32_bf16 v[184:187], a[120:123], v[76:79], v[184:187]
    s_cmp_eq_u32 s12, s90
    v_exp_f32 v10, v46
    v_mfma_f32_16x16x32_bf16 v[180:183], a[124:127], v[72:75], v[180:183]
    buffer_load_dwordx4 v2, s[52:55], s10 offen offset:3072 sc1 lds
    v_mfma_f32_16x16x32_bf16 v[188:191], a[124:127], v[76:79], v[188:191]
    s_cselect_b32 s10, s92, s12
    v_exp_f32 v11, v47
    v_smfmac_f32_16x16x64_bf16 v[112:115], v[12:15], v[72:79], v124
    v_cvt_pk_bf16_f32 v71, v10, v11
    v_mfma_f32_16x16x32_bf16 v[32:35], a[64:67], a[32:35], v[88:91]
    v_mfma_f32_16x16x32_bf16 v[32:35], a[68:71], a[36:39], v[32:35]
    v_exp_f32 v4, v48
    v_mfma_f32_16x16x32_bf16 v[32:35], a[72:75], a[40:43], v[32:35]
    buffer_load_dword v3, v125, s[64:67], s18 offen
    v_mfma_f32_16x16x32_bf16 v[32:35], a[76:79], a[44:47], v[32:35]
    s_add_u32 s18, s18, 2176
    v_exp_f32 v5, v49
    v_mfma_f32_16x16x32_bf16 v[192:195], a[96:99], v[64:67], v[192:195]
    v_cvt_pk_bf16_f32 v72, v4, v5
    v_mfma_f32_16x16x32_bf16 v[200:203], a[96:99], v[68:71], v[200:203]
    v_exp_f32 v6, v50
    v_mfma_f32_16x16x32_bf16 v[196:199], a[100:103], v[64:67], v[196:199]
    v_mfma_f32_16x16x32_bf16 v[204:207], a[100:103], v[68:71], v[204:207]
    v_exp_f32 v7, v51
    v_mfma_f32_16x16x32_bf16 v[40:43], a[64:67], a[48:51], v[92:95]
    v_cvt_pk_bf16_f32 v73, v6, v7
    v_mfma_f32_16x16x32_bf16 v[40:43], a[68:71], a[52:55], v[40:43]
    v_exp_f32 v8, v52
    v_mfma_f32_16x16x32_bf16 v[40:43], a[72:75], a[56:59], v[40:43]
    v_mfma_f32_16x16x32_bf16 v[40:43], a[76:79], a[60:63], v[40:43]
    v_exp_f32 v9, v53
    v_mfma_f32_16x16x32_bf16 v[208:211], a[104:107], v[64:67], v[208:211]
    v_cvt_pk_bf16_f32 v74, v8, v9
    v_mfma_f32_16x16x32_bf16 v[216:219], a[104:107], v[68:71], v[216:219]
    v_exp_f32 v10, v54
    v_mfma_f32_16x16x32_bf16 v[212:215], a[108:111], v[64:67], v[212:215]
    buffer_store_dwordx4 a[0:3], v2, s[20:23], s19 offen sc1
    v_mfma_f32_16x16x32_bf16 v[220:223], a[108:111], v[68:71], v[220:223]
    v_exp_f32 v11, v55
    v_mfma_f32_16x16x32_bf16 v[36:39], a[80:83], a[32:35], v[88:91]
    ds_read_b128 a[64:67], v16 offset:16384
    v_cvt_pk_bf16_f32 v75, v10, v11
    v_mfma_f32_16x16x32_bf16 v[36:39], a[84:87], a[36:39], v[36:39]
    v_exp_f32 v4, v56
    v_mfma_f32_16x16x32_bf16 v[36:39], a[88:91], a[40:43], v[36:39]
    ds_read_b128 a[68:71], v16 offset:17408
    v_mfma_f32_16x16x32_bf16 v[36:39], a[92:95], a[44:47], v[36:39]
    v_exp_f32 v5, v57
    v_mfma_f32_16x16x32_bf16 v[224:227], a[112:115], v[64:67], v[224:227]
    ds_read_b128 a[72:75], v16 offset:18432
    v_cvt_pk_bf16_f32 v76, v4, v5
    v_mfma_f32_16x16x32_bf16 v[232:235], a[112:115], v[68:71], v[232:235]
    v_exp_f32 v6, v58
    v_mfma_f32_16x16x32_bf16 v[228:231], a[116:119], v[64:67], v[228:231]
    ds_read_b128 a[76:79], v16 offset:19456
    v_mfma_f32_16x16x32_bf16 v[236:239], a[116:119], v[68:71], v[236:239]
    v_exp_f32 v7, v59
    v_mfma_f32_16x16x32_bf16 v[44:47], a[80:83], a[48:51], v[92:95]
    ds_read_b128 a[96:99], v16 offset:40960
    v_cvt_pk_bf16_f32 v77, v6, v7
    v_mfma_f32_16x16x32_bf16 v[44:47], a[84:87], a[52:55], v[44:47]
    v_exp_f32 v8, v60
    v_mfma_f32_16x16x32_bf16 v[44:47], a[88:91], a[56:59], v[44:47]
    ds_read_b128 a[100:103], v16 offset:41984
    v_mfma_f32_16x16x32_bf16 v[44:47], a[92:95], a[60:63], v[44:47]
    s_add_u32 s19, s19, 1024
    v_exp_f32 v9, v61
    v_mfma_f32_16x16x32_bf16 v[240:243], a[120:123], v[64:67], v[240:243]
    ds_read_b128 a[104:107], v16 offset:43008
    v_cvt_pk_bf16_f32 v78, v8, v9
    v_mfma_f32_16x16x32_bf16 v[248:251], a[120:123], v[68:71], v[248:251]
    v_exp_f32 v10, v62
    v_mfma_f32_16x16x32_bf16 v[244:247], a[124:127], v[64:67], v[244:247]
    ds_read_b128 a[108:111], v16 offset:44032
    v_mfma_f32_16x16x32_bf16 v[252:255], a[124:127], v[68:71], v[252:255]
    v_exp_f32 v11, v63
    v_smfmac_f32_16x16x64_bf16 v[120:123], v[12:15], v[64:71], v124
    s_waitcnt lgkmcnt(3)
    v_cvt_pk_bf16_f32 v79, v10, v11
    v_mfma_f32_16x16x32_bf16 v[48:51], a[64:67], a[160:163], v[80:83]
    ds_read_b128 a[80:83], v16 offset:20480
    v_mfma_f32_16x16x32_bf16 v[48:51], a[68:71], a[164:167], v[48:51]
    v_exp_f32 v4, v32
    v_mfma_f32_16x16x32_bf16 v[48:51], a[72:75], a[168:171], v[48:51]
    ds_read_b128 a[84:87], v16 offset:21504
    v_mfma_f32_16x16x32_bf16 v[48:51], a[76:79], a[172:175], v[48:51]
    v_exp_f32 v5, v33
    v_mfma_f32_16x16x32_bf16 v[128:131], a[96:99], v[72:75], v[128:131]
    ds_read_b128 a[88:91], v16 offset:22528
    v_cvt_pk_bf16_f32 v64, v4, v5
    v_mfma_f32_16x16x32_bf16 v[136:139], a[96:99], v[76:79], v[136:139]
    s_waitcnt lgkmcnt(3)
    v_exp_f32 v6, v34
    v_mfma_f32_16x16x32_bf16 v[132:135], a[100:103], v[72:75], v[132:135]
    ds_read_b128 a[92:95], v16 offset:23552
    v_mfma_f32_16x16x32_bf16 v[140:143], a[100:103], v[76:79], v[140:143]
    v_exp_f32 v7, v35
    v_mfma_f32_16x16x32_bf16 v[56:59], a[64:67], a[176:179], v[84:87]
    ds_read_b128 a[112:115], v16 offset:45056
    v_cvt_pk_bf16_f32 v65, v6, v7
    v_mfma_f32_16x16x32_bf16 v[56:59], a[68:71], a[180:183], v[56:59]
    v_exp_f32 v8, v36
    v_mfma_f32_16x16x32_bf16 v[56:59], a[72:75], a[184:187], v[56:59]
    ds_read_b128 a[116:119], v16 offset:46080
    v_mfma_f32_16x16x32_bf16 v[56:59], a[76:79], a[188:191], v[56:59]
    v_exp_f32 v9, v37
    v_mfma_f32_16x16x32_bf16 v[144:147], a[104:107], v[72:75], v[144:147]
    ds_read_b128 a[120:123], v16 offset:47104
    v_cvt_pk_bf16_f32 v66, v8, v9
    v_mfma_f32_16x16x32_bf16 v[152:155], a[104:107], v[76:79], v[152:155]
    v_exp_f32 v10, v38
    v_mfma_f32_16x16x32_bf16 v[148:151], a[108:111], v[72:75], v[148:151]
    ds_read_b128 a[124:127], v16 offset:48128
    v_mfma_f32_16x16x32_bf16 v[156:159], a[108:111], v[76:79], v[156:159]
    s_waitcnt lgkmcnt(4)
    v_exp_f32 v11, v39
    v_mfma_f32_16x16x32_bf16 v[52:55], a[80:83], a[160:163], v[80:83]
    v_cvt_pk_bf16_f32 v67, v10, v11
    v_xor_b32 v16, 0x10000, v16
    v_mfma_f32_16x16x32_bf16 v[52:55], a[84:87], a[164:167], v[52:55]
    s_xor_b32 m0, s93, 0x1c000
    v_exp_f32 v4, v40
    v_mfma_f32_16x16x32_bf16 v[52:55], a[88:91], a[168:171], v[52:55]
    s_waitcnt lgkmcnt(2)
    buffer_load_dwordx4 v2, s[52:55], s10 offen offset:0 sc1 lds
    v_mfma_f32_16x16x32_bf16 v[52:55], a[92:95], a[172:175], v[52:55]
    s_add_u32 s12, s10, 0x2000
    v_exp_f32 v5, v41
    v_mfma_f32_16x16x32_bf16 v[160:163], a[112:115], v[72:75], v[160:163]
    v_cvt_pk_bf16_f32 v68, v4, v5
    v_xor_b32 v17, 0x10000, v17
    v_mfma_f32_16x16x32_bf16 v[168:171], a[112:115], v[76:79], v[168:171]
    s_xor_b32 s93, s93, 0x10000
    v_exp_f32 v6, v42
    v_mfma_f32_16x16x32_bf16 v[164:167], a[116:119], v[72:75], v[164:167]
    buffer_load_dwordx4 v2, s[52:55], s10 offen offset:1024 sc1 lds
    v_mfma_f32_16x16x32_bf16 v[172:175], a[116:119], v[76:79], v[172:175]
    v_exp_f32 v7, v43
    v_mfma_f32_16x16x32_bf16 v[60:63], a[80:83], a[176:179], v[84:87]
    v_cvt_pk_bf16_f32 v69, v6, v7
    v_mfma_f32_16x16x32_bf16 v[60:63], a[84:87], a[180:183], v[60:63]
    v_exp_f32 v8, v44
    v_mfma_f32_16x16x32_bf16 v[60:63], a[88:91], a[184:187], v[60:63]
    buffer_load_dwordx4 v2, s[52:55], s10 offen offset:2048 sc1 lds
    v_mfma_f32_16x16x32_bf16 v[60:63], a[92:95], a[188:191], v[60:63]
    s_waitcnt lgkmcnt(0)
    v_exp_f32 v9, v45
    v_mfma_f32_16x16x32_bf16 v[176:179], a[120:123], v[72:75], v[176:179]
    v_cvt_pk_bf16_f32 v70, v8, v9
    v_mfma_f32_16x16x32_bf16 v[184:187], a[120:123], v[76:79], v[184:187]
    s_cmp_eq_u32 s12, s90
    v_exp_f32 v10, v46
    v_mfma_f32_16x16x32_bf16 v[180:183], a[124:127], v[72:75], v[180:183]
    buffer_load_dwordx4 v2, s[52:55], s10 offen offset:3072 sc1 lds
    v_mfma_f32_16x16x32_bf16 v[188:191], a[124:127], v[76:79], v[188:191]
    s_cselect_b32 s10, s92, s12
    v_exp_f32 v11, v47
    v_smfmac_f32_16x16x64_bf16 v[112:115], v[12:15], v[72:79], v124
    v_cvt_pk_bf16_f32 v71, v10, v11
    s_sub_u32 s91, s91, 1
    s_cbranch_scc0 kF
    s_cmp_ge_u32 s5, 28
    s_cbranch_scc1 kSP
kTR:
    v_mfma_f32_16x16x32_bf16 v[32:35], a[64:67], a[32:35], v[88:91]
    s_lshr_b32 s11, s3, 1
    s_lshl_b32 s11, s11, 14
    v_add_u32 v16, s11, v2
    v_mfma_f32_16x16x32_bf16 v[32:35], a[68:71], a[36:39], v[32:35]
    v_exp_f32 v4, v48
    v_mfma_f32_16x16x32_bf16 v[32:35], a[72:75], a[40:43], v[32:35]
    v_add_u32 v17, 0x4000, v2
    v_mov_b32 v80, v18
    v_mfma_f32_16x16x32_bf16 v[32:35], a[76:79], a[44:47], v[32:35]
    v_exp_f32 v5, v49
    v_mfma_f32_16x16x32_bf16 v[192:195], a[96:99], v[64:67], v[192:195]
    v_cvt_pk_bf16_f32 v72, v4, v5
    v_mov_b32 v81, v18
    v_mfma_f32_16x16x32_bf16 v[200:203], a[96:99], v[68:71], v[200:203]
    v_exp_f32 v6, v50
    v_mfma_f32_16x16x32_bf16 v[196:199], a[100:103], v[64:67], v[196:199]
    v_mov_b32 v82, v18
    v_mov_b32 v83, v18
    v_mfma_f32_16x16x32_bf16 v[204:207], a[100:103], v[68:71], v[204:207]
    v_exp_f32 v7, v51
    v_mfma_f32_16x16x32_bf16 v[40:43], a[64:67], a[48:51], v[92:95]
    v_cvt_pk_bf16_f32 v73, v6, v7
    v_mov_b32 v84, v19
    v_mfma_f32_16x16x32_bf16 v[40:43], a[68:71], a[52:55], v[40:43]
    v_exp_f32 v8, v52
    v_mfma_f32_16x16x32_bf16 v[40:43], a[72:75], a[56:59], v[40:43]
    v_mov_b32 v85, v19
    v_mov_b32 v86, v19
    v_mfma_f32_16x16x32_bf16 v[40:43], a[76:79], a[60:63], v[40:43]
    v_exp_f32 v9, v53
    v_mfma_f32_16x16x32_bf16 v[208:211], a[104:107], v[64:67], v[208:211]
    v_cvt_pk_bf16_f32 v74, v8, v9
    v_mov_b32 v87, v19
    v_mfma_f32_16x16x32_bf16 v[216:219], a[104:107], v[68:71], v[216:219]
    v_exp_f32 v10, v54
    v_mfma_f32_16x16x32_bf16 v[212:215], a[108:111], v[64:67], v[212:215]
    s_waitcnt vmcnt(16)
    s_barrier
    v_mfma_f32_16x16x32_bf16 v[220:223], a[108:111], v[68:71], v[220:223]
    v_exp_f32 v11, v55
    v_mfma_f32_16x16x32_bf16 v[36:39], a[80:83], a[32:35], v[88:91]
    ds_read_b128 a[64:67], v16 offset:32768
    v_cvt_pk_bf16_f32 v75, v10, v11
    v_mfma_f32_16x16x32_bf16 v[36:39], a[84:87], a[36:39], v[36:39]
    v_exp_f32 v4, v56
    v_mfma_f32_16x16x32_bf16 v[36:39], a[88:91], a[40:43], v[36:39]
    ds_read_b128 a[68:71], v16 offset:33792
    v_mfma_f32_16x16x32_bf16 v[36:39], a[92:95], a[44:47], v[36:39]
    v_exp_f32 v5, v57
    v_mfma_f32_16x16x32_bf16 v[224:227], a[112:115], v[64:67], v[224:227]
    ds_read_b128 a[72:75], v16 offset:34816
    v_cvt_pk_bf16_f32 v76, v4, v5
    v_mfma_f32_16x16x32_bf16 v[232:235], a[112:115], v[68:71], v[232:235]
    v_exp_f32 v6, v58
    v_mfma_f32_16x16x32_bf16 v[228:231], a[116:119], v[64:67], v[228:231]
    ds_read_b128 a[76:79], v16 offset:35840
    v_mfma_f32_16x16x32_bf16 v[236:239], a[116:119], v[68:71], v[236:239]
    v_exp_f32 v7, v59
    v_mfma_f32_16x16x32_bf16 v[44:47], a[80:83], a[48:51], v[92:95]
    ds_read_b128 a[96:99], v17 offset:40960
    v_cvt_pk_bf16_f32 v77, v6, v7
    v_mfma_f32_16x16x32_bf16 v[44:47], a[84:87], a[52:55], v[44:47]
    v_exp_f32 v8, v60
    v_mfma_f32_16x16x32_bf16 v[44:47], a[88:91], a[56:59], v[44:47]
    ds_read_b128 a[100:103], v17 offset:41984
    v_mfma_f32_16x16x32_bf16 v[44:47], a[92:95], a[60:63], v[44:47]
    v_exp_f32 v9, v61
    v_mfma_f32_16x16x32_bf16 v[240:243], a[120:123], v[64:67], v[240:243]
    ds_read_b128 a[104:107], v17 offset:43008
    v_cvt_pk_bf16_f32 v78, v8, v9
    v_mfma_f32_16x16x32_bf16 v[248:251], a[120:123], v[68:71], v[248:251]
    v_exp_f32 v10, v62
    v_mfma_f32_16x16x32_bf16 v[244:247], a[124:127], v[64:67], v[244:247]
    ds_read_b128 a[108:111], v17 offset:44032
    v_mfma_f32_16x16x32_bf16 v[252:255], a[124:127], v[68:71], v[252:255]
    v_exp_f32 v11, v63
    v_smfmac_f32_16x16x64_bf16 v[120:123], v[12:15], v[64:71], v124
    s_waitcnt lgkmcnt(3)
    v_cvt_pk_bf16_f32 v79, v10, v11
    v_mfma_f32_16x16x32_bf16 v[48:51], a[64:67], a[128:131], v[80:83]
    ds_read_b128 a[80:83], v16 offset:36864
    v_mfma_f32_16x16x32_bf16 v[48:51], a[68:71], a[132:135], v[48:51]
    v_exp_f32 v4, v32
    v_mfma_f32_16x16x32_bf16 v[48:51], a[72:75], a[136:139], v[48:51]
    ds_read_b128 a[84:87], v16 offset:37888
    v_mfma_f32_16x16x32_bf16 v[48:51], a[76:79], a[140:143], v[48:51]
    v_exp_f32 v5, v33
    v_smfmac_f32_16x16x64_bf16 v[112:115], v[12:15], v[72:79], v124
    ds_read_b128 a[88:91], v16 offset:38912
    v_cvt_pk_bf16_f32 v64, v4, v5
    v_mfma_f32_16x16x32_bf16 v[128:131], a[96:99], v[72:75], v[128:131]
    v_exp_f32 v6, v34
    v_mfma_f32_16x16x32_bf16 v[136:139], a[96:99], v[76:79], v[136:139]
    ds_read_b128 a[92:95], v16 offset:39936
    s_waitcnt lgkmcnt(4)
    v_mfma_f32_16x16x32_bf16 v[132:135], a[100:103], v[72:75], v[132:135]
    v_exp_f32 v7, v35
    v_mfma_f32_16x16x32_bf16 v[140:143], a[100:103], v[76:79], v[140:143]
    ds_read_b128 a[112:115], v17 offset:45056
    v_cvt_pk_bf16_f32 v65, v6, v7
    v_mfma_f32_16x16x32_bf16 v[56:59], a[64:67], a[144:147], v[84:87]
    v_exp_f32 v8, v36
    v_mfma_f32_16x16x32_bf16 v[56:59], a[68:71], a[148:151], v[56:59]
    ds_read_b128 a[116:119], v17 offset:46080
    v_add_f32 v112, v112, v113
    v_mfma_f32_16x16x32_bf16 v[56:59], a[72:75], a[152:155], v[56:59]
    v_exp_f32 v9, v37
    v_mfma_f32_16x16x32_bf16 v[56:59], a[76:79], a[156:159], v[56:59]
    ds_read_b128 a[120:123], v17 offset:47104
    v_cvt_pk_bf16_f32 v66, v8, v9
    v_mfma_f32_16x16x32_bf16 v[144:147], a[104:107], v[72:75], v[144:147]
    v_exp_f32 v10, v38
    v_mfma_f32_16x16x32_bf16 v[152:155], a[104:107], v[76:79], v[152:155]
    ds_read_b128 a[124:127], v17 offset:48128
    v_add_f32 v114, v114, v115
    v_mfma_f32_16x16x32_bf16 v[148:151], a[108:111], v[72:75], v[148:151]
    v_exp_f32 v11, v39
    v_mfma_f32_16x16x32_bf16 v[156:159], a[108:111], v[76:79], v[156:159]
    s_waitcnt lgkmcnt(6)
    v_cvt_pk_bf16_f32 v67, v10, v11
    v_add_u32 v17, 0x10000, v16
    v_mfma_f32_16x16x32_bf16 v[52:55], a[80:83], a[128:131], v[80:83]
    s_add_u32 m0, s14, 0x0
    v_exp_f32 v4, v40
    v_subrev_u32 v113, 0x1f800000, v112
    v_subrev_u32 v115, 0x1f800000, v114
    v_max_u32 v113, v113, v115
    v_cmp_lt_u32 vcc, 0x40000000, v113
    v_mfma_f32_16x16x32_bf16 v[52:55], a[84:87], a[132:135], v[52:55]
    s_cbranch_vccnz kTb
kTb_r:
    buffer_load_dwordx4 v2, s[52:55], s10 offen offset:0 sc1 lds
    s_waitcnt lgkmcnt(2)
    v_mfma_f32_16x16x32_bf16 v[52:55], a[88:91], a[136:139], v[52:55]
    v_exp_f32 v5, v41
    v_mfma_f32_16x16x32_bf16 v[52:55], a[92:95], a[140:143], v[52:55]
    v_cvt_pk_bf16_f32 v68, v4, v5
    v_rcp_f32 v112, v112
    v_mfma_f32_16x16x32_bf16 v[160:163], a[112:115], v[72:75], v[160:163]
    v_exp_f32 v6, v42
    v_rcp_f32 v114, v114
    v_mfma_f32_16x16x32_bf16 v[168:171], a[112:115], v[76:79], v[168:171]
    buffer_load_dwordx4 v2, s[52:55], s10 offen offset:1024 sc1 lds
    v_mfma_f32_16x16x32_bf16 v[164:167], a[116:119], v[72:75], v[164:167]
    v_exp_f32 v7, v43
    v_mfma_f32_16x16x32_bf16 v[172:175], a[116:119], v[76:79], v[172:175]
    v_cvt_pk_bf16_f32 v69, v6, v7
    v_mul_f32 v128, v128, v112
    v_mfma_f32_16x16x32_bf16 v[60:63], a[80:83], a[144:147], v[84:87]
    v_exp_f32 v8, v44
    v_mfma_f32_16x16x32_bf16 v[60:63], a[84:87], a[148:151], v[60:63]
    buffer_load_dwordx4 v2, s[52:55], s10 offen offset:2048 sc1 lds
    v_mfma_f32_16x16x32_bf16 v[60:63], a[88:91], a[152:155], v[60:63]
    v_exp_f32 v9, v45
    v_mfma_f32_16x16x32_bf16 v[60:63], a[92:95], a[156:159], v[60:63]
    s_waitcnt lgkmcnt(0)
    v_cvt_pk_bf16_f32 v70, v8, v9
    v_mul_f32 v129, v129, v112
    v_mfma_f32_16x16x32_bf16 v[176:179], a[120:123], v[72:75], v[176:179]
    v_exp_f32 v10, v46
    v_mfma_f32_16x16x32_bf16 v[184:187], a[120:123], v[76:79], v[184:187]
    buffer_load_dwordx4 v2, s[52:55], s10 offen offset:3072 sc1 lds
    v_mfma_f32_16x16x32_bf16 v[180:183], a[124:127], v[72:75], v[180:183]
    s_add_u32 s10, s10, 0x2000
    v_exp_f32 v11, v47
    v_mfma_f32_16x16x32_bf16 v[188:191], a[124:127], v[76:79], v[188:191]
    s_add_u32 m0, s14, 0x4000
    v_cvt_pk_bf16_f32 v71, v10, v11
    v_mul_f32 v130, v130, v112
    v_mfma_f32_16x16x32_bf16 v[32:35], a[64:67], a[32:35], v[88:91]
    buffer_load_dwordx4 v2, s[52:55], s10 offen offset:0 sc1 lds
    v_mfma_f32_16x16x32_bf16 v[32:35], a[68:71], a[36:39], v[32:35]
    v_exp_f32 v4, v48
    v_mfma_f32_16x16x32_bf16 v[32:35], a[72:75], a[40:43], v[32:35]
    v_mul_f32 v131, v131, v112
    v_mul_f32 v132, v132, v112
    v_mfma_f32_16x16x32_bf16 v[32:35], a[76:79], a[44:47], v[32:35]
    v_exp_f32 v5, v49
    v_mfma_f32_16x16x32_bf16 v[192:195], a[96:99], v[64:67], v[192:195]
    v_cvt_pk_bf16_f32 v72, v4, v5
    v_mul_f32 v133, v133, v112
    v_mfma_f32_16x16x32_bf16 v[200:203], a[96:99], v[68:71], v[200:203]
    v_exp_f32 v6, v50
    v_mfma_f32_16x16x32_bf16 v[196:199], a[100:103], v[64:67], v[196:199]
    buffer_load_dwordx4 v2, s[52:55], s10 offen offset:1024 sc1 lds
    v_mfma_f32_16x16x32_bf16 v[204:207], a[100:103], v[68:71], v[204:207]
    v_exp_f32 v7, v51
    v_mfma_f32_16x16x32_bf16 v[40:43], a[64:67], a[48:51], v[92:95]
    v_cvt_pk_bf16_f32 v73, v6, v7
    v_mul_f32 v134, v134, v112
    v_mfma_f32_16x16x32_bf16 v[40:43], a[68:71], a[52:55], v[40:43]
    v_exp_f32 v8, v52
    v_mfma_f32_16x16x32_bf16 v[40:43], a[72:75], a[56:59], v[40:43]
    buffer_load_dwordx4 v2, s[52:55], s10 offen offset:2048 sc1 lds
    v_mfma_f32_16x16x32_bf16 v[40:43], a[76:79], a[60:63], v[40:43]
    v_exp_f32 v9, v53
    v_mfma_f32_16x16x32_bf16 v[208:211], a[104:107], v[64:67], v[208:211]
    v_cvt_pk_bf16_f32 v74, v8, v9
    v_mul_f32 v135, v135, v112
    v_mfma_f32_16x16x32_bf16 v[216:219], a[104:107], v[68:71], v[216:219]
    v_exp_f32 v10, v54
    v_mfma_f32_16x16x32_bf16 v[212:215], a[108:111], v[64:67], v[212:215]
    s_waitcnt vmcnt(15)
    s_barrier
    buffer_load_dwordx4 v2, s[52:55], s10 offen offset:3072 sc1 lds
    v_mfma_f32_16x16x32_bf16 v[220:223], a[108:111], v[68:71], v[220:223]
    s_add_u32 s10, s10, 0x2000
    v_exp_f32 v11, v55
    v_mfma_f32_16x16x32_bf16 v[36:39], a[80:83], a[32:35], v[88:91]
    ds_read_b128 a[64:67], v17 offset:0
    v_cvt_pk_bf16_f32 v75, v10, v11
    v_mfma_f32_16x16x32_bf16 v[36:39], a[84:87], a[36:39], v[36:39]
    v_exp_f32 v4, v56
    v_mfma_f32_16x16x32_bf16 v[36:39], a[88:91], a[40:43], v[36:39]
    ds_read_b128 a[68:71], v17 offset:1024
    v_cvt_pk_bf16_f32 v128, v128, v129
    v_mfma_f32_16x16x32_bf16 v[36:39], a[92:95], a[44:47], v[36:39]
    v_exp_f32 v5, v57
    v_mfma_f32_16x16x32_bf16 v[224:227], a[112:115], v[64:67], v[224:227]
    ds_read_b128 a[72:75], v17 offset:2048
    v_cvt_pk_bf16_f32 v76, v4, v5
    v_mfma_f32_16x16x32_bf16 v[232:235], a[112:115], v[68:71], v[232:235]
    v_exp_f32 v6, v58
    v_mfma_f32_16x16x32_bf16 v[228:231], a[116:119], v[64:67], v[228:231]
    ds_read_b128 a[76:79], v17 offset:3072
    v_cvt_pk_bf16_f32 v129, v130, v131
    v_mfma_f32_16x16x32_bf16 v[236:239], a[116:119], v[68:71], v[236:239]
    v_exp_f32 v7, v59
    v_mfma_f32_16x16x32_bf16 v[44:47], a[80:83], a[48:51], v[92:95]
    ds_read_b128 a[96:99], v17 offset:8192
    v_cvt_pk_bf16_f32 v77, v6, v7
    v_mfma_f32_16x16x32_bf16 v[44:47], a[84:87], a[52:55], v[44:47]
    v_exp_f32 v8, v60
    v_mfma_f32_16x16x32_bf16 v[44:47], a[88:91], a[56:59], v[44:47]
    ds_read_b128 a[100:103], v17 offset:9216
    v_cvt_pk_bf16_f32 v130, v132, v133
    v_mfma_f32_16x16x32_bf16 v[44:47], a[92:95], a[60:63], v[44:47]
    v_exp_f32 v9, v61
    v_mfma_f32_16x16x32_bf16 v[240:243], a[120:123], v[64:67], v[240:243]
    ds_read_b128 a[104:107], v17 offset:10240
    v_cvt_pk_bf16_f32 v78, v8, v9
    v_mfma_f32_16x16x32_bf16 v[248:251], a[120:123], v[68:71], v[248:251]
    v_exp_f32 v10, v62
    v_mfma_f32_16x16x32_bf16 v[244:247], a[124:127], v[64:67], v[244:247]
    ds_read_b128 a[108:111], v17 offset:11264
    v_cvt_pk_bf16_f32 v131, v134, v135
    v_mfma_f32_16x16x32_bf16 v[252:255], a[124:127], v[68:71], v[252:255]
    buffer_store_dwordx4 v[128:131], v0, s[56:59], s94 offen sc1
    v_exp_f32 v11, v63
    v_mul_f32 v136, v136, v114
    v_smfmac_f32_16x16x64_bf16 v[120:123], v[12:15], v[64:71], v124
    s_waitcnt lgkmcnt(3)
    v_cvt_pk_bf16_f32 v79, v10, v11
    v_mfma_f32_16x16x32_bf16 v[48:51], a[64:67], a[128:131], v[80:83]
    ds_read_b128 a[80:83], v17 offset:4096
    v_mul_f32 v137, v137, v114
    v_mfma_f32_16x16x32_bf16 v[48:51], a[68:71], a[132:135], v[48:51]
    v_exp_f32 v4, v32
    v_mul_f32 v138, v138, v114
    v_mul_f32 v139, v139, v114
    v_mul_f32 v140, v140, v114
    v_mul_f32 v141, v141, v114
    v_mul_f32 v142, v142, v114
    v_mul_f32 v143, v143, v114
    v_cvt_pk_bf16_f32 v136, v136, v137
    v_cvt_pk_bf16_f32 v137, v138, v139
    v_cvt_pk_bf16_f32 v138, v140, v141
    v_cvt_pk_bf16_f32 v139, v142, v143
    v_mfma_f32_16x16x32_bf16 v[48:51], a[72:75], a[136:139], v[48:51]
    s_add_u32 s97, s94, 0x9b000
    ds_read_b128 a[84:87], v17 offset:5120
    v_mfma_f32_16x16x32_bf16 v[48:51], a[76:79], a[140:143], v[48:51]
    buffer_store_dwordx4 v[136:139], v0, s[56:59], s97 offen sc1
    v_exp_f32 v5, v33
    v_mul_f32 v144, v144, v112
    v_mfma_f32_16x16x32_bf16 v[128:131], a[96:99], v[72:75], 0
    ds_read_b128 a[88:91], v17 offset:6144
    v_cvt_pk_bf16_f32 v64, v4, v5
    v_mfma_f32_16x16x32_bf16 v[136:139], a[96:99], v[76:79], 0
    s_waitcnt lgkmcnt(3)
    v_exp_f32 v6, v34
    v_mfma_f32_16x16x32_bf16 v[132:135], a[100:103], v[72:75], 0
    ds_read_b128 a[92:95], v17 offset:7168
    v_mul_f32 v145, v145, v112
    v_mfma_f32_16x16x32_bf16 v[140:143], a[100:103], v[76:79], 0
    v_exp_f32 v7, v35
    v_mfma_f32_16x16x32_bf16 v[56:59], a[64:67], a[144:147], v[84:87]
    ds_read_b128 a[112:115], v17 offset:12288
    v_cvt_pk_bf16_f32 v65, v6, v7
    v_mfma_f32_16x16x32_bf16 v[56:59], a[68:71], a[148:151], v[56:59]
    v_exp_f32 v8, v36
    v_mul_f32 v146, v146, v112
    v_mul_f32 v147, v147, v112
    v_mul_f32 v148, v148, v112
    v_mul_f32 v149, v149, v112
    v_mul_f32 v150, v150, v112
    v_mul_f32 v151, v151, v112
    v_cvt_pk_bf16_f32 v144, v144, v145
    v_cvt_pk_bf16_f32 v145, v146, v147
    v_cvt_pk_bf16_f32 v146, v148, v149
    v_cvt_pk_bf16_f32 v147, v150, v151
    v_mfma_f32_16x16x32_bf16 v[56:59], a[72:75], a[152:155], v[56:59]
    buffer_store_dwordx4 v[144:147], v0, s[56:59], s94 offen offset:2048 sc1
    ds_read_b128 a[116:119], v17 offset:13312
    v_mul_f32 v152, v152, v114
    v_mul_f32 v153, v153, v114
    v_mul_f32 v154, v154, v114
    v_mul_f32 v155, v155, v114
    v_mul_f32 v156, v156, v114
    v_mul_f32 v157, v157, v114
    v_mul_f32 v158, v158, v114
    v_mul_f32 v159, v159, v114
    v_cvt_pk_bf16_f32 v152, v152, v153
    v_cvt_pk_bf16_f32 v153, v154, v155
    v_cvt_pk_bf16_f32 v154, v156, v157
    v_cvt_pk_bf16_f32 v155, v158, v159
    v_mfma_f32_16x16x32_bf16 v[56:59], a[76:79], a[156:159], v[56:59]
    buffer_store_dwordx4 v[152:155], v0, s[56:59], s97 offen offset:2048 sc1
    v_exp_f32 v9, v37
    v_mul_f32 v160, v160, v112
    v_mfma_f32_16x16x32_bf16 v[144:147], a[104:107], v[72:75], 0
    ds_read_b128 a[120:123], v17 offset:14336
    v_cvt_pk_bf16_f32 v66, v8, v9
    v_mfma_f32_16x16x32_bf16 v[152:155], a[104:107], v[76:79], 0
    v_exp_f32 v10, v38
    v_mfma_f32_16x16x32_bf16 v[148:151], a[108:111], v[72:75], 0
    ds_read_b128 a[124:127], v17 offset:15360
    v_mul_f32 v161, v161, v112
    v_mfma_f32_16x16x32_bf16 v[156:159], a[108:111], v[76:79], 0
    s_waitcnt lgkmcnt(4)
    v_exp_f32 v11, v39
    v_mul_f32 v162, v162, v112
    v_mul_f32 v163, v163, v112
    v_mul_f32 v164, v164, v112
    v_mul_f32 v165, v165, v112
    v_mul_f32 v166, v166, v112
    v_mul_f32 v167, v167, v112
    v_cvt_pk_bf16_f32 v160, v160, v161
    v_cvt_pk_bf16_f32 v161, v162, v163
    v_cvt_pk_bf16_f32 v162, v164, v165
    v_cvt_pk_bf16_f32 v163, v166, v167
    v_mfma_f32_16x16x32_bf16 v[52:55], a[80:83], a[128:131], v[80:83]
    s_add_u32 s94, s94, 0x1000
    v_cvt_pk_bf16_f32 v67, v10, v11
    v_mfma_f32_16x16x32_bf16 v[52:55], a[84:87], a[132:135], v[52:55]
    s_add_u32 m0, s14, 0x8000
    buffer_store_dwordx4 v[160:163], v0, s[56:59], s94 offen sc1
    v_exp_f32 v4, v40
    v_mul_f32 v168, v168, v114
    v_mul_f32 v169, v169, v114
    v_mul_f32 v170, v170, v114
    v_mul_f32 v171, v171, v114
    v_mul_f32 v172, v172, v114
    v_mul_f32 v173, v173, v114
    v_mul_f32 v174, v174, v114
    v_mul_f32 v175, v175, v114
    v_cvt_pk_bf16_f32 v168, v168, v169
    v_cvt_pk_bf16_f32 v169, v170, v171
    v_cvt_pk_bf16_f32 v170, v172, v173
    v_cvt_pk_bf16_f32 v171, v174, v175
    v_mfma_f32_16x16x32_bf16 v[52:55], a[88:91], a[136:139], v[52:55]
    s_add_u32 s97, s94, 0x9b000
    buffer_load_dwordx4 v2, s[52:55], s10 offen offset:0 sc1 lds
    v_mfma_f32_16x16x32_bf16 v[52:55], a[92:95], a[140:143], v[52:55]
    s_waitcnt lgkmcnt(2)
    buffer_store_dwordx4 v[168:171], v0, s[56:59], s97 offen sc1
    v_exp_f32 v5, v41
    v_mul_f32 v176, v176, v112
    v_mfma_f32_16x16x32_bf16 v[160:163], a[112:115], v[72:75], 0
    v_cvt_pk_bf16_f32 v68, v4, v5
    v_mul_f32 v177, v177, v112
    v_mfma_f32_16x16x32_bf16 v[168:171], a[112:115], v[76:79], 0
    v_exp_f32 v6, v42
    v_mfma_f32_16x16x32_bf16 v[164:167], a[116:119], v[72:75], 0
    buffer_load_dwordx4 v2, s[52:55], s10 offen offset:1024 sc1 lds
    v_mfma_f32_16x16x32_bf16 v[172:175], a[116:119], v[76:79], 0
    v_exp_f32 v7, v43
    v_mfma_f32_16x16x32_bf16 v[60:63], a[80:83], a[144:147], v[84:87]
    v_cvt_pk_bf16_f32 v69, v6, v7
    v_mul_f32 v178, v178, v112
    v_mfma_f32_16x16x32_bf16 v[60:63], a[84:87], a[148:151], v[60:63]
    v_exp_f32 v8, v44
    v_mul_f32 v179, v179, v112
    v_mul_f32 v180, v180, v112
    v_mul_f32 v181, v181, v112
    v_mul_f32 v182, v182, v112
    v_mul_f32 v183, v183, v112
    v_cvt_pk_bf16_f32 v176, v176, v177
    v_cvt_pk_bf16_f32 v177, v178, v179
    v_cvt_pk_bf16_f32 v178, v180, v181
    v_cvt_pk_bf16_f32 v179, v182, v183
    v_mfma_f32_16x16x32_bf16 v[60:63], a[88:91], a[152:155], v[60:63]
    buffer_store_dwordx4 v[176:179], v0, s[56:59], s94 offen offset:2048 sc1
    buffer_load_dwordx4 v2, s[52:55], s10 offen offset:2048 sc1 lds
    v_mul_f32 v184, v184, v114
    v_mul_f32 v185, v185, v114
    v_mul_f32 v186, v186, v114
    v_mul_f32 v187, v187, v114
    v_mul_f32 v188, v188, v114
    v_mul_f32 v189, v189, v114
    v_mul_f32 v190, v190, v114
    v_mul_f32 v191, v191, v114
    v_cvt_pk_bf16_f32 v184, v184, v185
    v_cvt_pk_bf16_f32 v185, v186, v187
    v_cvt_pk_bf16_f32 v186, v188, v189
    v_cvt_pk_bf16_f32 v187, v190, v191
    v_mfma_f32_16x16x32_bf16 v[60:63], a[92:95], a[156:159], v[60:63]
    buffer_store_dwordx4 v[184:187], v0, s[56:59], s97 offen offset:2048 sc1
    v_exp_f32 v9, v45
    s_waitcnt lgkmcnt(0)
    v_mfma_f32_16x16x32_bf16 v[176:179], a[120:123], v[72:75], 0
    v_cvt_pk_bf16_f32 v70, v8, v9
    v_mfma_f32_16x16x32_bf16 v[184:187], a[120:123], v[76:79], 0
    v_exp_f32 v10, v46
    v_mfma_f32_16x16x32_bf16 v[180:183], a[124:127], v[72:75], 0
    buffer_load_dwordx4 v2, s[52:55], s10 offen offset:3072 sc1 lds
    v_mfma_f32_16x16x32_bf16 v[188:191], a[124:127], v[76:79], 0
    s_add_u32 s10, s10, 0x2000
    v_exp_f32 v11, v47
    v_smfmac_f32_16x16x64_bf16 v[116:119], v[12:15], v[72:79], v124
    v_cvt_pk_bf16_f32 v71, v10, v11
    s_sub_u32 s91, 5, s7
    s_cbranch_scc1 kST
.p2align 6
kS:
    s_add_u32 m0, s14, 0xc000
    v_mfma_f32_16x16x32_bf16 v[32:35], a[64:67], a[32:35], v[88:91]
    buffer_load_dwordx4 v2, s[52:55], s10 offen offset:0 sc1 lds
    v_mfma_f32_16x16x32_bf16 v[32:35], a[68:71], a[36:39], v[32:35]
    v_exp_f32 v4, v48
    v_mfma_f32_16x16x32_bf16 v[32:35], a[72:75], a[40:43], v[32:35]
    buffer_load_dwordx4 v2, s[52:55], s10 offen offset:1024 sc1 lds
    v_mfma_f32_16x16x32_bf16 v[32:35], a[76:79], a[44:47], v[32:35]
    v_exp_f32 v5, v49
    v_mfma_f32_16x16x32_bf16 v[192:195], a[96:99], v[64:67], v[192:195]
    v_cvt_pk_bf16_f32 v72, v4, v5
    v_mfma_f32_16x16x32_bf16 v[200:203], a[96:99], v[68:71], v[200:203]
    v_exp_f32 v6, v50
    v_mfma_f32_16x16x32_bf16 v[196:199], a[100:103], v[64:67], v[196:199]
    buffer_load_dwordx4 v2, s[52:55], s10 offen offset:2048 sc1 lds
    v_mfma_f32_16x16x32_bf16 v[204:207], a[100:103], v[68:71], v[204:207]
    v_exp_f32 v7, v51
    v_mfma_f32_16x16x32_bf16 v[40:43], a[64:67], a[48:51], v[92:95]
    v_cvt_pk_bf16_f32 v73, v6, v7
    v_mfma_f32_16x16x32_bf16 v[40:43], a[68:71], a[52:55], v[40:43]
    v_exp_f32 v8, v52
    v_mfma_f32_16x16x32_bf16 v[40:43], a[72:75], a[56:59], v[40:43]
    buffer_load_dwordx4 v2, s[52:55], s10 offen offset:3072 sc1 lds
    v_mfma_f32_16x16x32_bf16 v[40:43], a[76:79], a[60:63], v[40:43]
    s_add_u32 s10, s10, 0x2000
    v_exp_f32 v9, v53
    v_mfma_f32_16x16x32_bf16 v[208:211], a[104:107], v[64:67], v[208:211]
    v_cvt_pk_bf16_f32 v74, v8, v9
    v_mfma_f32_16x16x32_bf16 v[216:219], a[104:107], v[68:71], v[216:219]
    s_waitcnt vmcnt(16)
    v_exp_f32 v10, v54
    v_mfma_f32_16x16x32_bf16 v[212:215], a[108:111], v[64:67], v[212:215]
    s_barrier
    buffer_store_dword v126, v127, s[68:71], s24 offen sc1
    v_mfma_f32_16x16x32_bf16 v[220:223], a[108:111], v[68:71], v[220:223]
    s_sub_u32 s25, s25, 0x20000
    v_exp_f32 v11, v55
    v_mfma_f32_16x16x32_bf16 v[36:39], a[80:83], a[32:35], v[88:91]
    ds_read_b128 a[64:67], v17 offset:32768
    v_cvt_pk_bf16_f32 v75, v10, v11
    v_mfma_f32_16x16x32_bf16 v[36:39], a[84:87], a[36:39], v[36:39]
    s_cselect_b64 s[88:89], -1, 0
    v_exp_f32 v4, v56
    v_mfma_f32_16x16x32_bf16 v[36:39], a[88:91], a[40:43], v[36:39]
    ds_read_b128 a[68:71], v17 offset:33792
    v_cmp_ne_u32 vcc, 1, v27
    v_mfma_f32_16x16x32_bf16 v[36:39], a[92:95], a[44:47], v[36:39]
    v_exp_f32 v5, v57
    v_mfma_f32_16x16x32_bf16 v[224:227], a[112:115], v[64:67], v[224:227]
    ds_read_b128 a[72:75], v17 offset:34816
    v_cvt_pk_bf16_f32 v76, v4, v5
    v_mfma_f32_16x16x32_bf16 v[232:235], a[112:115], v[68:71], v[232:235]
    s_and_b64 vcc, vcc, s[88:89]
    v_exp_f32 v6, v58
    v_mfma_f32_16x16x32_bf16 v[228:231], a[116:119], v[64:67], v[228:231]
    ds_read_b128 a[76:79], v17 offset:35840
    v_mfma_f32_16x16x32_bf16 v[236:239], a[116:119], v[68:71], v[236:239]
    s_cbranch_scc1 kSp_slow
kSp_ok:
    v_exp_f32 v7, v59
    v_mfma_f32_16x16x32_bf16 v[44:47], a[80:83], a[48:51], v[92:95]
    ds_read_b128 a[96:99], v17 offset:40960
    v_cvt_pk_bf16_f32 v77, v6, v7
    v_mfma_f32_16x16x32_bf16 v[44:47], a[84:87], a[52:55], v[44:47]
    s_mov_b32 s24, 0x7f000000
    v_exp_f32 v8, v60
    v_mfma_f32_16x16x32_bf16 v[44:47], a[88:91], a[56:59], v[44:47]
    ds_read_b128 a[100:103], v17 offset:41984
    v_mfma_f32_16x16x32_bf16 v[44:47], a[92:95], a[60:63], v[44:47]
    v_exp_f32 v9, v61
    v_mfma_f32_16x16x32_bf16 v[240:243], a[120:123], v[64:67], v[240:243]
    ds_read_b128 a[104:107], v17 offset:43008
    v_cvt_pk_bf16_f32 v78, v8, v9
    v_mfma_f32_16x16x32_bf16 v[248:251], a[120:123], v[68:71], v[248:251]
    v_exp_f32 v10, v62
    v_mfma_f32_16x16x32_bf16 v[244:247], a[124:127], v[64:67], v[244:247]
    ds_read_b128 a[108:111], v17 offset:44032
    v_mfma_f32_16x16x32_bf16 v[252:255], a[124:127], v[68:71], v[252:255]
    v_exp_f32 v11, v63
    v_smfmac_f32_16x16x64_bf16 v[120:123], v[12:15], v[64:71], v124
    s_waitcnt lgkmcnt(3)
    v_cvt_pk_bf16_f32 v79, v10, v11
    v_mfma_f32_16x16x32_bf16 v[48:51], a[64:67], a[128:131], v[80:83]
    ds_read_b128 a[80:83], v17 offset:36864
    v_mfma_f32_16x16x32_bf16 v[48:51], a[68:71], a[132:135], v[48:51]
    v_exp_f32 v4, v32
    v_mfma_f32_16x16x32_bf16 v[48:51], a[72:75], a[136:139], v[48:51]
    ds_read_b128 a[84:87], v17 offset:37888
    v_mfma_f32_16x16x32_bf16 v[48:51], a[76:79], a[140:143], v[48:51]
    v_exp_f32 v5, v33
    v_mfma_f32_16x16x32_bf16 v[128:131], a[96:99], v[72:75], v[128:131]
    ds_read_b128 a[88:91], v17 offset:38912
    v_cvt_pk_bf16_f32 v64, v4, v5
    v_mfma_f32_16x16x32_bf16 v[136:139], a[96:99], v[76:79], v[136:139]
    s_waitcnt lgkmcnt(3)
    v_exp_f32 v6, v34
    v_mfma_f32_16x16x32_bf16 v[132:135], a[100:103], v[72:75], v[132:135]
    ds_read_b128 a[92:95], v17 offset:39936
    v_mfma_f32_16x16x32_bf16 v[140:143], a[100:103], v[76:79], v[140:143]
    v_exp_f32 v7, v35
    v_mfma_f32_16x16x32_bf16 v[56:59], a[64:67], a[144:147], v[84:87]
    ds_read_b128 a[112:115], v17 offset:45056
    v_cvt_pk_bf16_f32 v65, v6, v7
    v_mfma_f32_16x16x32_bf16 v[56:59], a[68:71], a[148:151], v[56:59]
    v_exp_f32 v8, v36
    v_mfma_f32_16x16x32_bf16 v[56:59], a[72:75], a[152:155], v[56:59]
    ds_read_b128 a[116:119], v17 offset:46080
    v_mfma_f32_16x16x32_bf16 v[56:59], a[76:79], a[156:159], v[56:59]
    v_exp_f32 v9, v37
    v_mfma_f32_16x16x32_bf16 v[144:147], a[104:107], v[72:75], v[144:147]
    ds_read_b128 a[120:123], v17 offset:47104
    v_cvt_pk_bf16_f32 v66, v8, v9
    v_mfma_f32_16x16x32_bf16 v[152:155], a[104:107], v[76:79], v[152:155]
    v_exp_f32 v10, v38
    v_mfma_f32_16x16x32_bf16 v[148:151], a[108:111], v[72:75], v[148:151]
    ds_read_b128 a[124:127], v17 offset:48128
    v_mfma_f32_16x16x32_bf16 v[156:159], a[108:111], v[76:79], v[156:159]
    s_waitcnt lgkmcnt(4)
    v_exp_f32 v11, v39
    v_mfma_f32_16x16x32_bf16 v[52:55], a[80:83], a[128:131], v[80:83]
    v_cvt_pk_bf16_f32 v67, v10, v11
    v_mfma_f32_16x16x32_bf16 v[52:55], a[84:87], a[132:135], v[52:55]
    s_add_u32 m0, s14, 0x10000
    v_exp_f32 v4, v40
    v_mfma_f32_16x16x32_bf16 v[52:55], a[88:91], a[136:139], v[52:55]
    buffer_load_dwordx4 v2, s[52:55], s10 offen offset:0 sc1 lds
    v_mfma_f32_16x16x32_bf16 v[52:55], a[92:95], a[140:143], v[52:55]
    s_waitcnt lgkmcnt(2)
    v_exp_f32 v5, v41
    v_mfma_f32_16x16x32_bf16 v[160:163], a[112:115], v[72:75], v[160:163]
    v_cvt_pk_bf16_f32 v68, v4, v5
    v_mfma_f32_16x16x32_bf16 v[168:171], a[112:115], v[76:79], v[168:171]
    v_exp_f32 v6, v42
    v_mfma_f32_16x16x32_bf16 v[164:167], a[116:119], v[72:75], v[164:167]
    buffer_load_dwordx4 v2, s[52:55], s10 offen offset:1024 sc1 lds
    v_mfma_f32_16x16x32_bf16 v[172:175], a[116:119], v[76:79], v[172:175]
    v_exp_f32 v7, v43
    v_mfma_f32_16x16x32_bf16 v[60:63], a[80:83], a[144:147], v[84:87]
    v_cvt_pk_bf16_f32 v69, v6, v7
    v_mfma_f32_16x16x32_bf16 v[60:63], a[84:87], a[148:151], v[60:63]
    v_exp_f32 v8, v44
    v_mfma_f32_16x16x32_bf16 v[60:63], a[88:91], a[152:155], v[60:63]
    buffer_load_dwordx4 v2, s[52:55], s10 offen offset:2048 sc1 lds
    v_mfma_f32_16x16x32_bf16 v[60:63], a[92:95], a[156:159], v[60:63]
    s_waitcnt lgkmcnt(0)
    v_exp_f32 v9, v45
    v_mfma_f32_16x16x32_bf16 v[176:179], a[120:123], v[72:75], v[176:179]
    v_cvt_pk_bf16_f32 v70, v8, v9
    v_mfma_f32_16x16x32_bf16 v[184:187], a[120:123], v[76:79], v[184:187]
    v_exp_f32 v10, v46
    v_mfma_f32_16x16x32_bf16 v[180:183], a[124:127], v[72:75], v[180:183]
    buffer_load_dwordx4 v2, s[52:55], s10 offen offset:3072 sc1 lds
    v_mfma_f32_16x16x32_bf16 v[188:191], a[124:127], v[76:79], v[188:191]
    s_add_u32 s10, s10, 0x2000
    v_exp_f32 v11, v47
    v_smfmac_f32_16x16x64_bf16 v[116:119], v[12:15], v[72:79], v124
    s_add_u32 m0, s14, 0x14000
    v_cvt_pk_bf16_f32 v71, v10, v11
    v_mfma_f32_16x16x32_bf16 v[32:35], a[64:67], a[32:35], v[88:91]
    buffer_load_dwordx4 v2, s[52:55], s10 offen offset:0 sc1 lds
    v_mfma_f32_16x16x32_bf16 v[32:35], a[68:71], a[36:39], v[32:35]
    v_exp_f32 v4, v48
    v_mfma_f32_16x16x32_bf16 v[32:35], a[72:75], a[40:43], v[32:35]
    buffer_load_dwordx4 v2, s[52:55], s10 offen offset:1024 sc1 lds
    v_mfma_f32_16x16x32_bf16 v[32:35], a[76:79], a[44:47], v[32:35]
    v_exp_f32 v5, v49
    v_mfma_f32_16x16x32_bf16 v[192:195], a[96:99], v[64:67], v[192:195]
    v_cvt_pk_bf16_f32 v72, v4, v5
    v_mfma_f32_16x16x32_bf16 v[200:203], a[96:99], v[68:71], v[200:203]
    v_exp_f32 v6, v50
    v_mfma_f32_16x16x32_bf16 v[196:199], a[100:103], v[64:67], v[196:199]
    buffer_load_dwordx4 v2, s[52:55], s10 offen offset:2048 sc1 lds
    v_mfma_f32_16x16x32_bf16 v[204:207], a[100:103], v[68:71], v[204:207]
    v_exp_f32 v7, v51
    v_mfma_f32_16x16x32_bf16 v[40:43], a[64:67], a[48:51], v[92:95]
    v_cvt_pk_bf16_f32 v73, v6, v7
    v_mfma_f32_16x16x32_bf16 v[40:43], a[68:71], a[52:55], v[40:43]
    v_exp_f32 v8, v52
    v_mfma_f32_16x16x32_bf16 v[40:43], a[72:75], a[56:59], v[40:43]
    buffer_load_dwordx4 v2, s[52:55], s10 offen offset:3072 sc1 lds
    v_mfma_f32_16x16x32_bf16 v[40:43], a[76:79], a[60:63], v[40:43]
    s_add_u32 s10, s10, 0x2000
    v_exp_f32 v9, v53
    v_mfma_f32_16x16x32_bf16 v[208:211], a[104:107], v[64:67], v[208:211]
    v_cvt_pk_bf16_f32 v74, v8, v9
    v_mfma_f32_16x16x32_bf16 v[216:219], a[104:107], v[68:71], v[216:219]
    s_waitcnt vmcnt(17)
    v_exp_f32 v10, v54
    v_mfma_f32_16x16x32_bf16 v[212:215], a[108:111], v[64:67], v[212:215]
    s_barrier
    v_mfma_f32_16x16x32_bf16 v[220:223], a[108:111], v[68:71], v[220:223]
    v_exp_f32 v11, v55
    v_mfma_f32_16x16x32_bf16 v[36:39], a[80:83], a[32:35], v[88:91]
    ds_read_b128 a[64:67], v16 offset:0
    v_cvt_pk_bf16_f32 v75, v10, v11
    v_mfma_f32_16x16x32_bf16 v[36:39], a[84:87], a[36:39], v[36:39]
    v_exp_f32 v4, v56
    v_mfma_f32_16x16x32_bf16 v[36:39], a[88:91], a[40:43], v[36:39]
    ds_read_b128 a[68:71], v16 offset:1024
    v_mfma_f32_16x16x32_bf16 v[36:39], a[92:95], a[44:47], v[36:39]
    v_exp_f32 v5, v57
    v_mfma_f32_16x16x32_bf16 v[224:227], a[112:115], v[64:67], v[224:227]
    ds_read_b128 a[72:75], v16 offset:2048
    v_cvt_pk_bf16_f32 v76, v4, v5
    v_mfma_f32_16x16x32_bf16 v[232:235], a[112:115], v[68:71], v[232:235]
    v_exp_f32 v6, v58
    v_mfma_f32_16x16x32_bf16 v[228:231], a[116:119], v[64:67], v[228:231]
    ds_read_b128 a[76:79], v16 offset:3072
    v_mfma_f32_16x16x32_bf16 v[236:239], a[116:119], v[68:71], v[236:239]
    v_exp_f32 v7, v59
    v_mfma_f32_16x16x32_bf16 v[44:47], a[80:83], a[48:51], v[92:95]
    ds_read_b128 a[96:99], v16 offset:8192
    v_cvt_pk_bf16_f32 v77, v6, v7
    v_mfma_f32_16x16x32_bf16 v[44:47], a[84:87], a[52:55], v[44:47]
    v_exp_f32 v8, v60
    v_mfma_f32_16x16x32_bf16 v[44:47], a[88:91], a[56:59], v[44:47]
    ds_read_b128 a[100:103], v16 offset:9216
    v_mfma_f32_16x16x32_bf16 v[44:47], a[92:95], a[60:63], v[44:47]
    v_exp_f32 v9, v61
    v_mfma_f32_16x16x32_bf16 v[240:243], a[120:123], v[64:67], v[240:243]
    ds_read_b128 a[104:107], v16 offset:10240
    v_cvt_pk_bf16_f32 v78, v8, v9
    v_mfma_f32_16x16x32_bf16 v[248:251], a[120:123], v[68:71], v[248:251]
    v_exp_f32 v10, v62
    v_mfma_f32_16x16x32_bf16 v[244:247], a[124:127], v[64:67], v[244:247]
    ds_read_b128 a[108:111], v16 offset:11264
    v_mfma_f32_16x16x32_bf16 v[252:255], a[124:127], v[68:71], v[252:255]
    v_exp_f32 v11, v63
    v_smfmac_f32_16x16x64_bf16 v[120:123], v[12:15], v[64:71], v124
    s_waitcnt lgkmcnt(3)
    v_cvt_pk_bf16_f32 v79, v10, v11
    v_mfma_f32_16x16x32_bf16 v[48:51], a[64:67], a[128:131], v[80:83]
    ds_read_b128 a[80:83], v16 offset:4096
    v_mfma_f32_16x16x32_bf16 v[48:51], a[68:71], a[132:135], v[48:51]
    v_exp_f32 v4, v32
    v_mfma_f32_16x16x32_bf16 v[48:51], a[72:75], a[136:139], v[48:51]
    ds_read_b128 a[84:87], v16 offset:5120
    v_mfma_f32_16x16x32_bf16 v[48:51], a[76:79], a[140:143], v[48:51]
    v_exp_f32 v5, v33
    v_mfma_f32_16x16x32_bf16 v[128:131], a[96:99], v[72:75], v[128:131]
    ds_read_b128 a[88:91], v16 offset:6144
    v_cvt_pk_bf16_f32 v64, v4, v5
    v_mfma_f32_16x16x32_bf16 v[136:139], a[96:99], v[76:79], v[136:139]
    s_waitcnt lgkmcnt(3)
    v_exp_f32 v6, v34
    v_mfma_f32_16x16x32_bf16 v[132:135], a[100:103], v[72:75], v[132:135]
    ds_read_b128 a[92:95], v16 offset:7168
    v_mfma_f32_16x16x32_bf16 v[140:143], a[100:103], v[76:79], v[140:143]
    v_exp_f32 v7, v35
    v_mfma_f32_16x16x32_bf16 v[56:59], a[64:67], a[144:147], v[84:87]
    ds_read_b128 a[112:115], v16 offset:12288
    v_cvt_pk_bf16_f32 v65, v6, v7
    v_mfma_f32_16x16x32_bf16 v[56:59], a[68:71], a[148:151], v[56:59]
    v_exp_f32 v8, v36
    v_mfma_f32_16x16x32_bf16 v[56:59], a[72:75], a[152:155], v[56:59]
    ds_read_b128 a[116:119], v16 offset:13312
    v_mfma_f32_16x16x32_bf16 v[56:59], a[76:79], a[156:159], v[56:59]
    v_exp_f32 v9, v37
    v_mfma_f32_16x16x32_bf16 v[144:147], a[104:107], v[72:75], v[144:147]
    ds_read_b128 a[120:123], v16 offset:14336
    v_cvt_pk_bf16_f32 v66, v8, v9
    v_mfma_f32_16x16x32_bf16 v[152:155], a[104:107], v[76:79], v[152:155]
    v_exp_f32 v10, v38
    v_mfma_f32_16x16x32_bf16 v[148:151], a[108:111], v[72:75], v[148:151]
    ds_read_b128 a[124:127], v16 offset:15360
    v_mfma_f32_16x16x32_bf16 v[156:159], a[108:111], v[76:79], v[156:159]
    s_waitcnt lgkmcnt(4)
    v_exp_f32 v11, v39
    v_mfma_f32_16x16x32_bf16 v[52:55], a[80:83], a[128:131], v[80:83]
    v_cvt_pk_bf16_f32 v67, v10, v11
    v_mfma_f32_16x16x32_bf16 v[52:55], a[84:87], a[132:135], v[52:55]
    s_add_u32 m0, s14, 0x18000
    v_exp_f32 v4, v40
    v_mfma_f32_16x16x32_bf16 v[52:55], a[88:91], a[136:139], v[52:55]
    buffer_load_dwordx4 v2, s[52:55], s10 offen offset:0 sc1 lds
    v_mfma_f32_16x16x32_bf16 v[52:55], a[92:95], a[140:143], v[52:55]
    s_waitcnt lgkmcnt(2)
    v_exp_f32 v5, v41
    v_mfma_f32_16x16x32_bf16 v[160:163], a[112:115], v[72:75], v[160:163]
    v_cvt_pk_bf16_f32 v68, v4, v5
    v_mfma_f32_16x16x32_bf16 v[168:171], a[112:115], v[76:79], v[168:171]
    v_exp_f32 v6, v42
    v_mfma_f32_16x16x32_bf16 v[164:167], a[116:119], v[72:75], v[164:167]
    buffer_load_dwordx4 v2, s[52:55], s10 offen offset:1024 sc1 lds
    v_mfma_f32_16x16x32_bf16 v[172:175], a[116:119], v[76:79], v[172:175]
    v_exp_f32 v7, v43
    v_mfma_f32_16x16x32_bf16 v[60:63], a[80:83], a[144:147], v[84:87]
    v_cvt_pk_bf16_f32 v69, v6, v7
    v_mfma_f32_16x16x32_bf16 v[60:63], a[84:87], a[148:151], v[60:63]
    v_exp_f32 v8, v44
    v_mfma_f32_16x16x32_bf16 v[60:63], a[88:91], a[152:155], v[60:63]
    buffer_load_dwordx4 v2, s[52:55], s10 offen offset:2048 sc1 lds
    v_mfma_f32_16x16x32_bf16 v[60:63], a[92:95], a[156:159], v[60:63]
    s_waitcnt lgkmcnt(0)
    v_exp_f32 v9, v45
    v_mfma_f32_16x16x32_bf16 v[176:179], a[120:123], v[72:75], v[176:179]
    v_cvt_pk_bf16_f32 v70, v8, v9
    v_mfma_f32_16x16x32_bf16 v[184:187], a[120:123], v[76:79], v[184:187]
    v_exp_f32 v10, v46
    v_mfma_f32_16x16x32_bf16 v[180:183], a[124:127], v[72:75], v[180:183]
    buffer_load_dwordx4 v2, s[52:55], s10 offen offset:3072 sc1 lds
    v_mfma_f32_16x16x32_bf16 v[188:191], a[124:127], v[76:79], v[188:191]
    s_add_u32 s10, s10, 0x2000
    v_exp_f32 v11, v47
    v_smfmac_f32_16x16x64_bf16 v[116:119], v[12:15], v[72:79], v124
    s_add_u32 m0, s14, 0x1c000
    v_cvt_pk_bf16_f32 v71, v10, v11
    v_mfma_f32_16x16x32_bf16 v[32:35], a[64:67], a[32:35], v[88:91]
    buffer_load_dwordx4 v2, s[52:55], s10 offen offset:0 sc1 lds
    v_mfma_f32_16x16x32_bf16 v[32:35], a[68:71], a[36:39], v[32:35]
    v_exp_f32 v4, v48
    v_mfma_f32_16x16x32_bf16 v[32:35], a[72:75], a[40:43], v[32:35]
    buffer_load_dwordx4 v2, s[52:55], s10 offen offset:1024 sc1 lds
    v_mfma_f32_16x16x32_bf16 v[32:35], a[76:79], a[44:47], v[32:35]
    v_exp_f32 v5, v49
    v_mfma_f32_16x16x32_bf16 v[192:195], a[96:99], v[64:67], v[192:195]
    v_cvt_pk_bf16_f32 v72, v4, v5
    v_mfma_f32_16x16x32_bf16 v[200:203], a[96:99], v[68:71], v[200:203]
    v_exp_f32 v6, v50
    v_mfma_f32_16x16x32_bf16 v[196:199], a[100:103], v[64:67], v[196:199]
    buffer_load_dwordx4 v2, s[52:55], s10 offen offset:2048 sc1 lds
    v_mfma_f32_16x16x32_bf16 v[204:207], a[100:103], v[68:71], v[204:207]
    s_lshr_b32 s88, s25, 1
    v_exp_f32 v7, v51
    v_mfma_f32_16x16x32_bf16 v[40:43], a[64:67], a[48:51], v[92:95]
    v_cvt_pk_bf16_f32 v73, v6, v7
    v_mfma_f32_16x16x32_bf16 v[40:43], a[68:71], a[52:55], v[40:43]
    v_exp_f32 v8, v52
    v_mfma_f32_16x16x32_bf16 v[40:43], a[72:75], a[56:59], v[40:43]
    buffer_load_dwordx4 v2, s[52:55], s10 offen offset:3072 sc1 lds
    v_mfma_f32_16x16x32_bf16 v[40:43], a[76:79], a[60:63], v[40:43]
    s_add_u32 s10, s10, 0x2000
    v_exp_f32 v9, v53
    v_mfma_f32_16x16x32_bf16 v[208:211], a[104:107], v[64:67], v[208:211]
    v_cvt_pk_bf16_f32 v74, v8, v9
    v_mfma_f32_16x16x32_bf16 v[216:219], a[104:107], v[68:71], v[216:219]
    s_waitcnt vmcnt(17)
    v_exp_f32 v10, v54
    v_mfma_f32_16x16x32_bf16 v[212:215], a[108:111], v[64:67], v[212:215]
    s_barrier
    buffer_load_dword v27, v20, s[68:71], s88 offen sc1
    v_mfma_f32_16x16x32_bf16 v[220:223], a[108:111], v[68:71], v[220:223]
    v_exp_f32 v11, v55
    v_mfma_f32_16x16x32_bf16 v[36:39], a[80:83], a[32:35], v[88:91]
    ds_read_b128 a[64:67], v16 offset:32768
    v_cvt_pk_bf16_f32 v75, v10, v11
    v_mfma_f32_16x16x32_bf16 v[36:39], a[84:87], a[36:39], v[36:39]
    v_exp_f32 v4, v56
    v_mfma_f32_16x16x32_bf16 v[36:39], a[88:91], a[40:43], v[36:39]
    ds_read_b128 a[68:71], v16 offset:33792
    v_mfma_f32_16x16x32_bf16 v[36:39], a[92:95], a[44:47], v[36:39]
    v_exp_f32 v5, v57
    v_mfma_f32_16x16x32_bf16 v[224:227], a[112:115], v[64:67], v[224:227]
    ds_read_b128 a[72:75], v16 offset:34816
    v_cvt_pk_bf16_f32 v76, v4, v5
    v_mfma_f32_16x16x32_bf16 v[232:235], a[112:115], v[68:71], v[232:235]
    v_exp_f32 v6, v58
    v_mfma_f32_16x16x32_bf16 v[228:231], a[116:119], v[64:67], v[228:231]
    ds_read_b128 a[76:79], v16 offset:35840
    v_mfma_f32_16x16x32_bf16 v[236:239], a[116:119], v[68:71], v[236:239]
    v_exp_f32 v7, v59
    v_mfma_f32_16x16x32_bf16 v[44:47], a[80:83], a[48:51], v[92:95]
    ds_read_b128 a[96:99], v16 offset:40960
    v_cvt_pk_bf16_f32 v77, v6, v7
    v_mfma_f32_16x16x32_bf16 v[44:47], a[84:87], a[52:55], v[44:47]
    v_exp_f32 v8, v60
    v_mfma_f32_16x16x32_bf16 v[44:47], a[88:91], a[56:59], v[44:47]
    ds_read_b128 a[100:103], v16 offset:41984
    v_mfma_f32_16x16x32_bf16 v[44:47], a[92:95], a[60:63], v[44:47]
    v_exp_f32 v9, v61
    v_mfma_f32_16x16x32_bf16 v[240:243], a[120:123], v[64:67], v[240:243]
    ds_read_b128 a[104:107], v16 offset:43008
    v_cvt_pk_bf16_f32 v78, v8, v9
    v_mfma_f32_16x16x32_bf16 v[248:251], a[120:123], v[68:71], v[248:251]
    v_exp_f32 v10, v62
    v_mfma_f32_16x16x32_bf16 v[244:247], a[124:127], v[64:67], v[244:247]
    ds_read_b128 a[108:111], v16 offset:44032
    v_mfma_f32_16x16x32_bf16 v[252:255], a[124:127], v[68:71], v[252:255]
    v_exp_f32 v11, v63
    v_smfmac_f32_16x16x64_bf16 v[120:123], v[12:15], v[64:71], v124
    s_waitcnt lgkmcnt(3)
    v_cvt_pk_bf16_f32 v79, v10, v11
    v_mfma_f32_16x16x32_bf16 v[48:51], a[64:67], a[128:131], v[80:83]
    ds_read_b128 a[80:83], v16 offset:36864
    v_mfma_f32_16x16x32_bf16 v[48:51], a[68:71], a[132:135], v[48:51]
    v_exp_f32 v4, v32
    v_mfma_f32_16x16x32_bf16 v[48:51], a[72:75], a[136:139], v[48:51]
    ds_read_b128 a[84:87], v16 offset:37888
    v_mfma_f32_16x16x32_bf16 v[48:51], a[76:79], a[140:143], v[48:51]
    v_exp_f32 v5, v33
    v_mfma_f32_16x16x32_bf16 v[128:131], a[96:99], v[72:75], v[128:131]
    ds_read_b128 a[88:91], v16 offset:38912
    v_cvt_pk_bf16_f32 v64, v4, v5
    v_mfma_f32_16x16x32_bf16 v[136:139], a[96:99], v[76:79], v[136:139]
    s_waitcnt lgkmcnt(3)
    v_exp_f32 v6, v34
    v_mfma_f32_16x16x32_bf16 v[132:135], a[100:103], v[72:75], v[132:135]
    ds_read_b128 a[92:95], v16 offset:39936
    v_mfma_f32_16x16x32_bf16 v[140:143], a[100:103], v[76:79], v[140:143]
    v_exp_f32 v7, v35
    v_mfma_f32_16x16x32_bf16 v[56:59], a[64:67], a[144:147], v[84:87]
    ds_read_b128 a[112:115], v16 offset:45056
    v_cvt_pk_bf16_f32 v65, v6, v7
    v_mfma_f32_16x16x32_bf16 v[56:59], a[68:71], a[148:151], v[56:59]
    v_exp_f32 v8, v36
    v_mfma_f32_16x16x32_bf16 v[56:59], a[72:75], a[152:155], v[56:59]
    ds_read_b128 a[116:119], v16 offset:46080
    v_mfma_f32_16x16x32_bf16 v[56:59], a[76:79], a[156:159], v[56:59]
    v_exp_f32 v9, v37
    v_mfma_f32_16x16x32_bf16 v[144:147], a[104:107], v[72:75], v[144:147]
    ds_read_b128 a[120:123], v16 offset:47104
    v_cvt_pk_bf16_f32 v66, v8, v9
    v_mfma_f32_16x16x32_bf16 v[152:155], a[104:107], v[76:79], v[152:155]
    v_exp_f32 v10, v38
    v_mfma_f32_16x16x32_bf16 v[148:151], a[108:111], v[72:75], v[148:151]
    ds_read_b128 a[124:127], v16 offset:48128
    v_mfma_f32_16x16x32_bf16 v[156:159], a[108:111], v[76:79], v[156:159]
    s_waitcnt lgkmcnt(4)
    v_exp_f32 v11, v39
    v_mfma_f32_16x16x32_bf16 v[52:55], a[80:83], a[128:131], v[80:83]
    v_cvt_pk_bf16_f32 v67, v10, v11
    v_mfma_f32_16x16x32_bf16 v[52:55], a[84:87], a[132:135], v[52:55]
    s_add_u32 m0, s14, 0x0
    v_exp_f32 v4, v40
    v_mfma_f32_16x16x32_bf16 v[52:55], a[88:91], a[136:139], v[52:55]
    buffer_load_dwordx4 v2, s[52:55], s10 offen offset:0 sc1 lds
    v_mfma_f32_16x16x32_bf16 v[52:55], a[92:95], a[140:143], v[52:55]
    s_waitcnt lgkmcnt(2)
    v_exp_f32 v5, v41
    v_mfma_f32_16x16x32_bf16 v[160:163], a[112:115], v[72:75], v[160:163]
    v_cvt_pk_bf16_f32 v68, v4, v5
    v_mfma_f32_16x16x32_bf16 v[168:171], a[112:115], v[76:79], v[168:171]
    v_exp_f32 v6, v42
    v_mfma_f32_16x16x32_bf16 v[164:167], a[116:119], v[72:75], v[164:167]
    buffer_load_dwordx4 v2, s[52:55], s10 offen offset:1024 sc1 lds
    v_mfma_f32_16x16x32_bf16 v[172:175], a[116:119], v[76:79], v[172:175]
    v_exp_f32 v7, v43
    v_mfma_f32_16x16x32_bf16 v[60:63], a[80:83], a[144:147], v[84:87]
    v_cvt_pk_bf16_f32 v69, v6, v7
    v_mfma_f32_16x16x32_bf16 v[60:63], a[84:87], a[148:151], v[60:63]
    v_exp_f32 v8, v44
    v_mfma_f32_16x16x32_bf16 v[60:63], a[88:91], a[152:155], v[60:63]
    buffer_load_dwordx4 v2, s[52:55], s10 offen offset:2048 sc1 lds
    v_mfma_f32_16x16x32_bf16 v[60:63], a[92:95], a[156:159], v[60:63]
    s_waitcnt lgkmcnt(0)
    v_exp_f32 v9, v45
    v_mfma_f32_16x16x32_bf16 v[176:179], a[120:123], v[72:75], v[176:179]
    v_cvt_pk_bf16_f32 v70, v8, v9
    v_mfma_f32_16x16x32_bf16 v[184:187], a[120:123], v[76:79], v[184:187]
    v_exp_f32 v10, v46
    v_mfma_f32_16x16x32_bf16 v[180:183], a[124:127], v[72:75], v[180:183]
    buffer_load_dwordx4 v2, s[52:55], s10 offen offset:3072 sc1 lds
    v_mfma_f32_16x16x32_bf16 v[188:191], a[124:127], v[76:79], v[188:191]
    s_add_u32 s10, s10, 0x2000
    v_exp_f32 v11, v47
    v_smfmac_f32_16x16x64_bf16 v[116:119], v[12:15], v[72:79], v124
    s_add_u32 m0, s14, 0x4000
    v_cvt_pk_bf16_f32 v71, v10, v11
    v_mfma_f32_16x16x32_bf16 v[32:35], a[64:67], a[32:35], v[88:91]
    buffer_load_dwordx4 v2, s[52:55], s10 offen offset:0 sc1 lds
    v_mfma_f32_16x16x32_bf16 v[32:35], a[68:71], a[36:39], v[32:35]
    v_exp_f32 v4, v48
    v_mfma_f32_16x16x32_bf16 v[32:35], a[72:75], a[40:43], v[32:35]
    buffer_load_dwordx4 v2, s[52:55], s10 offen offset:1024 sc1 lds
    v_mfma_f32_16x16x32_bf16 v[32:35], a[76:79], a[44:47], v[32:35]
    v_exp_f32 v5, v49
    v_mfma_f32_16x16x32_bf16 v[192:195], a[96:99], v[64:67], v[192:195]
    v_cvt_pk_bf16_f32 v72, v4, v5
    v_mfma_f32_16x16x32_bf16 v[200:203], a[96:99], v[68:71], v[200:203]
    v_exp_f32 v6, v50
    v_mfma_f32_16x16x32_bf16 v[196:199], a[100:103], v[64:67], v[196:199]
    buffer_load_dwordx4 v2, s[52:55], s10 offen offset:2048 sc1 lds
    v_mfma_f32_16x16x32_bf16 v[204:207], a[100:103], v[68:71], v[204:207]
    v_exp_f32 v7, v51
    v_mfma_f32_16x16x32_bf16 v[40:43], a[64:67], a[48:51], v[92:95]
    v_cvt_pk_bf16_f32 v73, v6, v7
    v_mfma_f32_16x16x32_bf16 v[40:43], a[68:71], a[52:55], v[40:43]
    v_exp_f32 v8, v52
    v_mfma_f32_16x16x32_bf16 v[40:43], a[72:75], a[56:59], v[40:43]
    buffer_load_dwordx4 v2, s[52:55], s10 offen offset:3072 sc1 lds
    v_mfma_f32_16x16x32_bf16 v[40:43], a[76:79], a[60:63], v[40:43]
    s_add_u32 s10, s10, 0x2000
    v_exp_f32 v9, v53
    v_mfma_f32_16x16x32_bf16 v[208:211], a[104:107], v[64:67], v[208:211]
    v_cvt_pk_bf16_f32 v74, v8, v9
    v_mfma_f32_16x16x32_bf16 v[216:219], a[104:107], v[68:71], v[216:219]
    s_waitcnt vmcnt(17)
    v_exp_f32 v10, v54
    v_mfma_f32_16x16x32_bf16 v[212:215], a[108:111], v[64:67], v[212:215]
    s_barrier
    v_mfma_f32_16x16x32_bf16 v[220:223], a[108:111], v[68:71], v[220:223]
    v_exp_f32 v11, v55
    v_mfma_f32_16x16x32_bf16 v[36:39], a[80:83], a[32:35], v[88:91]
    ds_read_b128 a[64:67], v17 offset:0
    v_cvt_pk_bf16_f32 v75, v10, v11
    v_mfma_f32_16x16x32_bf16 v[36:39], a[84:87], a[36:39], v[36:39]
    v_exp_f32 v4, v56
    v_mfma_f32_16x16x32_bf16 v[36:39], a[88:91], a[40:43], v[36:39]
    ds_read_b128 a[68:71], v17 offset:1024
    v_mfma_f32_16x16x32_bf16 v[36:39], a[92:95], a[44:47], v[36:39]
    v_exp_f32 v5, v57
    v_mfma_f32_16x16x32_bf16 v[224:227], a[112:115], v[64:67], v[224:227]
    ds_read_b128 a[72:75], v17 offset:2048
    v_cvt_pk_bf16_f32 v76, v4, v5
    v_mfma_f32_16x16x32_bf16 v[232:235], a[112:115], v[68:71], v[232:235]
    v_exp_f32 v6, v58
    v_mfma_f32_16x16x32_bf16 v[228:231], a[116:119], v[64:67], v[228:231]
    ds_read_b128 a[76:79], v17 offset:3072
    v_mfma_f32_16x16x32_bf16 v[236:239], a[116:119], v[68:71], v[236:239]
    v_exp_f32 v7, v59
    v_mfma_f32_16x16x32_bf16 v[44:47], a[80:83], a[48:51], v[92:95]
    ds_read_b128 a[96:99], v17 offset:8192
    v_cvt_pk_bf16_f32 v77, v6, v7
    v_mfma_f32_16x16x32_bf16 v[44:47], a[84:87], a[52:55], v[44:47]
    v_exp_f32 v8, v60
    v_mfma_f32_16x16x32_bf16 v[44:47], a[88:91], a[56:59], v[44:47]
    ds_read_b128 a[100:103], v17 offset:9216
    v_mfma_f32_16x16x32_bf16 v[44:47], a[92:95], a[60:63], v[44:47]
    v_exp_f32 v9, v61
    v_mfma_f32_16x16x32_bf16 v[240:243], a[120:123], v[64:67], v[240:243]
    ds_read_b128 a[104:107], v17 offset:10240
    v_cvt_pk_bf16_f32 v78, v8, v9
    v_mfma_f32_16x16x32_bf16 v[248:251], a[120:123], v[68:71], v[248:251]
    v_exp_f32 v10, v62
    v_mfma_f32_16x16x32_bf16 v[244:247], a[124:127], v[64:67], v[244:247]
    ds_read_b128 a[108:111], v17 offset:11264
    v_mfma_f32_16x16x32_bf16 v[252:255], a[124:127], v[68:71], v[252:255]
    v_exp_f32 v11, v63
    v_smfmac_f32_16x16x64_bf16 v[120:123], v[12:15], v[64:71], v124
    s_waitcnt lgkmcnt(3)
    v_cvt_pk_bf16_f32 v79, v10, v11
    v_mfma_f32_16x16x32_bf16 v[48:51], a[64:67], a[128:131], v[80:83]
    ds_read_b128 a[80:83], v17 offset:4096
    v_mfma_f32_16x16x32_bf16 v[48:51], a[68:71], a[132:135], v[48:51]
    v_exp_f32 v4, v32
    v_mfma_f32_16x16x32_bf16 v[48:51], a[72:75], a[136:139], v[48:51]
    ds_read_b128 a[84:87], v17 offset:5120
    v_mfma_f32_16x16x32_bf16 v[48:51], a[76:79], a[140:143], v[48:51]
    v_exp_f32 v5, v33
    v_mfma_f32_16x16x32_bf16 v[128:131], a[96:99], v[72:75], v[128:131]
    ds_read_b128 a[88:91], v17 offset:6144
    v_cvt_pk_bf16_f32 v64, v4, v5
    v_mfma_f32_16x16x32_bf16 v[136:139], a[96:99], v[76:79], v[136:139]
    s_waitcnt lgkmcnt(3)
    v_exp_f32 v6, v34
    v_mfma_f32_16x16x32_bf16 v[132:135], a[100:103], v[72:75], v[132:135]
    ds_read_b128 a[92:95], v17 offset:7168
    v_mfma_f32_16x16x32_bf16 v[140:143], a[100:103], v[76:79], v[140:143]
    v_exp_f32 v7, v35
    v_mfma_f32_16x16x32_bf16 v[56:59], a[64:67], a[144:147], v[84:87]
    ds_read_b128 a[112:115], v17 offset:12288
    v_cvt_pk_bf16_f32 v65, v6, v7
    v_mfma_f32_16x16x32_bf16 v[56:59], a[68:71], a[148:151], v[56:59]
    v_exp_f32 v8, v36
    v_mfma_f32_16x16x32_bf16 v[56:59], a[72:75], a[152:155], v[56:59]
    ds_read_b128 a[116:119], v17 offset:13312
    v_mfma_f32_16x16x32_bf16 v[56:59], a[76:79], a[156:159], v[56:59]
    v_exp_f32 v9, v37
    v_mfma_f32_16x16x32_bf16 v[144:147], a[104:107], v[72:75], v[144:147]
    ds_read_b128 a[120:123], v17 offset:14336
    v_cvt_pk_bf16_f32 v66, v8, v9
    v_mfma_f32_16x16x32_bf16 v[152:155], a[104:107], v[76:79], v[152:155]
    v_exp_f32 v10, v38
    v_mfma_f32_16x16x32_bf16 v[148:151], a[108:111], v[72:75], v[148:151]
    ds_read_b128 a[124:127], v17 offset:15360
    v_mfma_f32_16x16x32_bf16 v[156:159], a[108:111], v[76:79], v[156:159]
    s_waitcnt lgkmcnt(4)
    v_exp_f32 v11, v39
    v_mfma_f32_16x16x32_bf16 v[52:55], a[80:83], a[128:131], v[80:83]
    v_cvt_pk_bf16_f32 v67, v10, v11
    v_mfma_f32_16x16x32_bf16 v[52:55], a[84:87], a[132:135], v[52:55]
    s_add_u32 m0, s14, 0x8000
    v_exp_f32 v4, v40
    v_mfma_f32_16x16x32_bf16 v[52:55], a[88:91], a[136:139], v[52:55]
    buffer_load_dwordx4 v2, s[52:55], s10 offen offset:0 sc1 lds
    v_mfma_f32_16x16x32_bf16 v[52:55], a[92:95], a[140:143], v[52:55]
    s_waitcnt lgkmcnt(2)
    v_exp_f32 v5, v41
    v_mfma_f32_16x16x32_bf16 v[160:163], a[112:115], v[72:75], v[160:163]
    v_cvt_pk_bf16_f32 v68, v4, v5
    v_mfma_f32_16x16x32_bf16 v[168:171], a[112:115], v[76:79], v[168:171]
    v_exp_f32 v6, v42
    v_mfma_f32_16x16x32_bf16 v[164:167], a[116:119], v[72:75], v[164:167]
    buffer_load_dwordx4 v2, s[52:55], s10 offen offset:1024 sc1 lds
    v_mfma_f32_16x16x32_bf16 v[172:175], a[116:119], v[76:79], v[172:175]
    v_exp_f32 v7, v43
    v_mfma_f32_16x16x32_bf16 v[60:63], a[80:83], a[144:147], v[84:87]
    v_cvt_pk_bf16_f32 v69, v6, v7
    v_mfma_f32_16x16x32_bf16 v[60:63], a[84:87], a[148:151], v[60:63]
    v_exp_f32 v8, v44
    v_mfma_f32_16x16x32_bf16 v[60:63], a[88:91], a[152:155], v[60:63]
    buffer_load_dwordx4 v2, s[52:55], s10 offen offset:2048 sc1 lds
    v_mfma_f32_16x16x32_bf16 v[60:63], a[92:95], a[156:159], v[60:63]
    s_waitcnt lgkmcnt(0)
    v_exp_f32 v9, v45
    v_mfma_f32_16x16x32_bf16 v[176:179], a[120:123], v[72:75], v[176:179]
    v_cvt_pk_bf16_f32 v70, v8, v9
    v_mfma_f32_16x16x32_bf16 v[184:187], a[120:123], v[76:79], v[184:187]
    v_exp_f32 v10, v46
    v_mfma_f32_16x16x32_bf16 v[180:183], a[124:127], v[72:75], v[180:183]
    buffer_load_dwordx4 v2, s[52:55], s10 offen offset:3072 sc1 lds
    v_mfma_f32_16x16x32_bf16 v[188:191], a[124:127], v[76:79], v[188:191]
    s_add_u32 s10, s10, 0x2000
    v_exp_f32 v11, v47
    v_smfmac_f32_16x16x64_bf16 v[116:119], v[12:15], v[72:79], v124
    v_cvt_pk_bf16_f32 v71, v10, v11
    s_sub_u32 s91, s91, 1
    s_cbranch_scc0 kS
kST:
    s_add_u32 m0, s14, 0xc000
    v_mfma_f32_16x16x32_bf16 v[32:35], a[64:67], a[32:35], v[88:91]
    buffer_load_dwordx4 v2, s[52:55], s10 offen offset:0 sc1 lds
    v_mfma_f32_16x16x32_bf16 v[32:35], a[68:71], a[36:39], v[32:35]
    v_exp_f32 v4, v48
    v_mfma_f32_16x16x32_bf16 v[32:35], a[72:75], a[40:43], v[32:35]
    buffer_load_dword v3, v2, s[28:31], 0 offen sc1
    v_mfma_f32_16x16x32_bf16 v[32:35], a[76:79], a[44:47], v[32:35]
    s_mov_b32 s13, 0x0
    v_exp_f32 v5, v49
    v_mfma_f32_16x16x32_bf16 v[192:195], a[96:99], v[64:67], v[192:195]
    buffer_load_dwordx4 a[0:3], v0, s[72:75], s13 offen sc1
    v_cvt_pk_bf16_f32 v72, v4, v5
    v_mfma_f32_16x16x32_bf16 v[200:203], a[96:99], v[68:71], v[200:203]
    v_exp_f32 v6, v50
    v_mfma_f32_16x16x32_bf16 v[196:199], a[100:103], v[64:67], v[196:199]
    buffer_load_dwordx4 v2, s[52:55], s10 offen offset:1024 sc1 lds
    v_mfma_f32_16x16x32_bf16 v[204:207], a[100:103], v[68:71], v[204:207]
    v_exp_f32 v7, v51
    v_mfma_f32_16x16x32_bf16 v[40:43], a[64:67], a[48:51], v[92:95]
    buffer_load_dwordx4 a[4:7], v0, s[72:75], s13 offen offset:256 sc1
    v_cvt_pk_bf16_f32 v73, v6, v7
    v_mfma_f32_16x16x32_bf16 v[40:43], a[68:71], a[52:55], v[40:43]
    v_exp_f32 v8, v52
    v_mfma_f32_16x16x32_bf16 v[40:43], a[72:75], a[56:59], v[40:43]
    buffer_load_dwordx4 v2, s[52:55], s10 offen offset:2048 sc1 lds
    v_mfma_f32_16x16x32_bf16 v[40:43], a[76:79], a[60:63], v[40:43]
    v_exp_f32 v9, v53
    v_mfma_f32_16x16x32_bf16 v[208:211], a[104:107], v[64:67], v[208:211]
    v_cvt_pk_bf16_f32 v74, v8, v9
    v_mfma_f32_16x16x32_bf16 v[216:219], a[104:107], v[68:71], v[216:219]
    v_exp_f32 v10, v54
    v_mfma_f32_16x16x32_bf16 v[212:215], a[108:111], v[64:67], v[212:215]
    s_waitcnt vmcnt(18)
    s_barrier
    buffer_load_dwordx4 a[8:11], v0, s[72:75], s13 offen offset:2048 sc1
    v_mfma_f32_16x16x32_bf16 v[220:223], a[108:111], v[68:71], v[220:223]
    buffer_load_dwordx4 v2, s[52:55], s10 offen offset:3072 sc1 lds
    v_exp_f32 v11, v55
    v_mfma_f32_16x16x32_bf16 v[36:39], a[80:83], a[32:35], v[88:91]
    s_add_u32 s10, s10, 0x2000
    ds_read_b128 a[64:67], v17 offset:32768
    v_cvt_pk_bf16_f32 v75, v10, v11
    v_mfma_f32_16x16x32_bf16 v[36:39], a[84:87], a[36:39], v[36:39]
    v_exp_f32 v4, v56
    v_mfma_f32_16x16x32_bf16 v[36:39], a[88:91], a[40:43], v[36:39]
    ds_read_b128 a[68:71], v17 offset:33792
    buffer_load_dwordx4 a[12:15], v0, s[72:75], s13 offen offset:2304 sc1
    v_mfma_f32_16x16x32_bf16 v[36:39], a[92:95], a[44:47], v[36:39]
    v_exp_f32 v5, v57
    v_mfma_f32_16x16x32_bf16 v[224:227], a[112:115], v[64:67], v[224:227]
    ds_read_b128 a[72:75], v17 offset:34816
    v_cvt_pk_bf16_f32 v76, v4, v5
    v_mfma_f32_16x16x32_bf16 v[232:235], a[112:115], v[68:71], v[232:235]
    v_exp_f32 v6, v58
    v_mfma_f32_16x16x32_bf16 v[228:231], a[116:119], v[64:67], v[228:231]
    s_mov_b32 s13, 0x1000
    ds_read_b128 a[76:79], v17 offset:35840
    buffer_load_dwordx4 a[16:19], v0, s[72:75], s13 offen sc1
    v_mfma_f32_16x16x32_bf16 v[236:239], a[116:119], v[68:71], v[236:239]
    v_exp_f32 v7, v59
    v_mfma_f32_16x16x32_bf16 v[44:47], a[80:83], a[48:51], v[92:95]
    ds_read_b128 a[96:99], v17 offset:40960
    v_cvt_pk_bf16_f32 v77, v6, v7
    v_mfma_f32_16x16x32_bf16 v[44:47], a[84:87], a[52:55], v[44:47]
    v_exp_f32 v8, v60
    v_mfma_f32_16x16x32_bf16 v[44:47], a[88:91], a[56:59], v[44:47]
    ds_read_b128 a[100:103], v17 offset:41984
    v_mfma_f32_16x16x32_bf16 v[44:47], a[92:95], a[60:63], v[44:47]
    v_exp_f32 v9, v61
    v_mfma_f32_16x16x32_bf16 v[240:243], a[120:123], v[64:67], v[240:243]
    ds_read_b128 a[104:107], v17 offset:43008
    v_cvt_pk_bf16_f32 v78, v8, v9
    v_mfma_f32_16x16x32_bf16 v[248:251], a[120:123], v[68:71], v[248:251]
    v_exp_f32 v10, v62
    v_mfma_f32_16x16x32_bf16 v[244:247], a[124:127], v[64:67], v[244:247]
    ds_read_b128 a[108:111], v17 offset:44032
    buffer_load_dwordx4 a[20:23], v0, s[72:75], s13 offen offset:256 sc1
    v_mfma_f32_16x16x32_bf16 v[252:255], a[124:127], v[68:71], v[252:255]
    v_exp_f32 v11, v63
    v_smfmac_f32_16x16x64_bf16 v[120:123], v[12:15], v[64:71], v124
    s_waitcnt lgkmcnt(3)
    v_cvt_pk_bf16_f32 v79, v10, v11
    v_mfma_f32_16x16x32_bf16 v[48:51], a[64:67], a[128:131], v[80:83]
    ds_read_b128 a[80:83], v17 offset:36864
    buffer_load_dwordx4 a[24:27], v0, s[72:75], s13 offen offset:2048 sc1
    v_mfma_f32_16x16x32_bf16 v[48:51], a[68:71], a[132:135], v[48:51]
    v_exp_f32 v4, v32
    v_mfma_f32_16x16x32_bf16 v[48:51], a[72:75], a[136:139], v[48:51]
    ds_read_b128 a[84:87], v17 offset:37888
    v_mfma_f32_16x16x32_bf16 v[48:51], a[76:79], a[140:143], v[48:51]
    v_exp_f32 v5, v33
    v_mfma_f32_16x16x32_bf16 v[128:131], a[96:99], v[72:75], v[128:131]
    ds_read_b128 a[88:91], v17 offset:38912
    v_cvt_pk_bf16_f32 v64, v4, v5
    v_mfma_f32_16x16x32_bf16 v[136:139], a[96:99], v[76:79], v[136:139]
    s_waitcnt lgkmcnt(3)
    v_exp_f32 v6, v34
    v_mfma_f32_16x16x32_bf16 v[132:135], a[100:103], v[72:75], v[132:135]
    ds_read_b128 a[92:95], v17 offset:39936
    buffer_load_dwordx4 a[28:31], v0, s[72:75], s13 offen offset:2304 sc1
    v_mfma_f32_16x16x32_bf16 v[140:143], a[100:103], v[76:79], v[140:143]
    v_exp_f32 v7, v35
    v_mfma_f32_16x16x32_bf16 v[56:59], a[64:67], a[144:147], v[84:87]
    ds_read_b128 a[112:115], v17 offset:45056
    v_cvt_pk_bf16_f32 v65, v6, v7
    v_mfma_f32_16x16x32_bf16 v[56:59], a[68:71], a[148:151], v[56:59]
    v_exp_f32 v8, v36
    v_mfma_f32_16x16x32_bf16 v[56:59], a[72:75], a[152:155], v[56:59]
    s_mov_b32 s13, 0x2000
    ds_read_b128 a[116:119], v17 offset:46080
    buffer_load_dwordx4 a[160:163], v0, s[72:75], s13 offen sc1
    v_mfma_f32_16x16x32_bf16 v[56:59], a[76:79], a[156:159], v[56:59]
    v_exp_f32 v9, v37
    v_mfma_f32_16x16x32_bf16 v[144:147], a[104:107], v[72:75], v[144:147]
    ds_read_b128 a[120:123], v17 offset:47104
    v_cvt_pk_bf16_f32 v66, v8, v9
    v_mfma_f32_16x16x32_bf16 v[152:155], a[104:107], v[76:79], v[152:155]
    v_exp_f32 v10, v38
    v_mfma_f32_16x16x32_bf16 v[148:151], a[108:111], v[72:75], v[148:151]
    ds_read_b128 a[124:127], v17 offset:48128
    v_mfma_f32_16x16x32_bf16 v[156:159], a[108:111], v[76:79], v[156:159]
    s_waitcnt lgkmcnt(4)
    v_exp_f32 v11, v39
    v_mfma_f32_16x16x32_bf16 v[52:55], a[80:83], a[128:131], v[80:83]
    v_cvt_pk_bf16_f32 v67, v10, v11
    v_mfma_f32_16x16x32_bf16 v[52:55], a[84:87], a[132:135], v[52:55]
    v_exp_f32 v4, v40
    v_mfma_f32_16x16x32_bf16 v[52:55], a[88:91], a[136:139], v[52:55]
    s_waitcnt lgkmcnt(2)
    buffer_load_dwordx4 a[164:167], v0, s[72:75], s13 offen offset:256 sc1
    v_mfma_f32_16x16x32_bf16 v[52:55], a[92:95], a[140:143], v[52:55]
    s_add_u32 m0, s14, 0x10000
    v_exp_f32 v5, v41
    v_mfma_f32_16x16x32_bf16 v[160:163], a[112:115], v[72:75], v[160:163]
    buffer_load_dwordx4 v2, s[52:55], s10 offen offset:0 sc1 lds
    v_cvt_pk_bf16_f32 v68, v4, v5
    v_mfma_f32_16x16x32_bf16 v[168:171], a[112:115], v[76:79], v[168:171]
    v_exp_f32 v6, v42
    v_mfma_f32_16x16x32_bf16 v[164:167], a[116:119], v[72:75], v[164:167]
    buffer_load_dwordx4 a[168:171], v0, s[72:75], s13 offen offset:2048 sc1
    v_mfma_f32_16x16x32_bf16 v[172:175], a[116:119], v[76:79], v[172:175]
    v_exp_f32 v7, v43
    v_mfma_f32_16x16x32_bf16 v[60:63], a[80:83], a[144:147], v[84:87]
    buffer_load_dwordx4 v2, s[52:55], s10 offen offset:1024 sc1 lds
    v_cvt_pk_bf16_f32 v69, v6, v7
    v_mfma_f32_16x16x32_bf16 v[60:63], a[84:87], a[148:151], v[60:63]
    v_exp_f32 v8, v44
    v_mfma_f32_16x16x32_bf16 v[60:63], a[88:91], a[152:155], v[60:63]
    buffer_load_dwordx4 v2, s[52:55], s10 offen offset:2048 sc1 lds
    v_mfma_f32_16x16x32_bf16 v[60:63], a[92:95], a[156:159], v[60:63]
    s_waitcnt lgkmcnt(0)
    v_exp_f32 v9, v45
    v_mfma_f32_16x16x32_bf16 v[176:179], a[120:123], v[72:75], v[176:179]
    buffer_load_dwordx4 a[172:175], v0, s[72:75], s13 offen offset:2304 sc1
    v_cvt_pk_bf16_f32 v70, v8, v9
    v_mfma_f32_16x16x32_bf16 v[184:187], a[120:123], v[76:79], v[184:187]
    v_exp_f32 v10, v46
    v_mfma_f32_16x16x32_bf16 v[180:183], a[124:127], v[72:75], v[180:183]
    buffer_load_dwordx4 v2, s[52:55], s10 offen offset:3072 sc1 lds
    v_mfma_f32_16x16x32_bf16 v[188:191], a[124:127], v[76:79], v[188:191]
    s_add_u32 s10, s10, 0x2000
    v_exp_f32 v11, v47
    v_smfmac_f32_16x16x64_bf16 v[116:119], v[12:15], v[72:79], v124
    s_mov_b32 s13, 0x3000
    v_cvt_pk_bf16_f32 v71, v10, v11
    v_mfma_f32_16x16x32_bf16 v[32:35], a[64:67], a[32:35], v[88:91]
    buffer_load_dwordx4 a[176:179], v0, s[72:75], s13 offen sc1
    v_mfma_f32_16x16x32_bf16 v[32:35], a[68:71], a[36:39], v[32:35]
    s_add_u32 m0, s14, 0x14000
    v_exp_f32 v4, v48
    v_mfma_f32_16x16x32_bf16 v[32:35], a[72:75], a[40:43], v[32:35]
    buffer_load_dwordx4 v2, s[52:55], s10 offen offset:0 sc1 lds
    v_mfma_f32_16x16x32_bf16 v[32:35], a[76:79], a[44:47], v[32:35]
    v_exp_f32 v5, v49
    v_mfma_f32_16x16x32_bf16 v[192:195], a[96:99], v[64:67], v[192:195]
    v_cvt_pk_bf16_f32 v72, v4, v5
    v_mov_b32 v17, v16
    v_mfma_f32_16x16x32_bf16 v[200:203], a[96:99], v[68:71], v[200:203]
    v_exp_f32 v6, v50
    v_mfma_f32_16x16x32_bf16 v[196:199], a[100:103], v[64:67], v[196:199]
    buffer_load_dwordx4 v2, s[52:55], s10 offen offset:1024 sc1 lds
    v_mfma_f32_16x16x32_bf16 v[204:207], a[100:103], v[68:71], v[204:207]
    v_exp_f32 v7, v51
    v_mfma_f32_16x16x32_bf16 v[40:43], a[64:67], a[48:51], v[92:95]
    buffer_load_dwordx4 a[180:183], v0, s[72:75], s13 offen offset:256 sc1
    v_cvt_pk_bf16_f32 v73, v6, v7
    v_mfma_f32_16x16x32_bf16 v[40:43], a[68:71], a[52:55], v[40:43]
    v_exp_f32 v8, v52
    v_mfma_f32_16x16x32_bf16 v[40:43], a[72:75], a[56:59], v[40:43]
    buffer_load_dwordx4 v2, s[52:55], s10 offen offset:2048 sc1 lds
    v_mfma_f32_16x16x32_bf16 v[40:43], a[76:79], a[60:63], v[40:43]
    v_exp_f32 v9, v53
    v_mfma_f32_16x16x32_bf16 v[208:211], a[104:107], v[64:67], v[208:211]
    buffer_load_dwordx4 a[184:187], v0, s[72:75], s13 offen offset:2048 sc1
    v_cvt_pk_bf16_f32 v74, v8, v9
    v_mfma_f32_16x16x32_bf16 v[216:219], a[104:107], v[68:71], v[216:219]
    v_exp_f32 v10, v54
    v_mfma_f32_16x16x32_bf16 v[212:215], a[108:111], v[64:67], v[212:215]
    s_waitcnt vmcnt(31)
    s_barrier
    buffer_load_dwordx4 v2, s[52:55], s10 offen offset:3072 sc1 lds
    v_mfma_f32_16x16x32_bf16 v[220:223], a[108:111], v[68:71], v[220:223]
    s_add_u32 s10, s10, 0x2000
    v_exp_f32 v11, v55
    v_mfma_f32_16x16x32_bf16 v[36:39], a[80:83], a[32:35], v[88:91]
    ds_read_b128 a[64:67], v16 offset:0
    v_cvt_pk_bf16_f32 v75, v10, v11
    v_mfma_f32_16x16x32_bf16 v[36:39], a[84:87], a[36:39], v[36:39]
    v_exp_f32 v4, v56
    v_mfma_f32_16x16x32_bf16 v[36:39], a[88:91], a[40:43], v[36:39]
    s_add_u32 m0, s14, 0x18000
    ds_read_b128 a[68:71], v16 offset:1024
    buffer_load_dwordx4 a[188:191], v0, s[72:75], s13 offen offset:2304 sc1
    v_mfma_f32_16x16x32_bf16 v[36:39], a[92:95], a[44:47], v[36:39]
    buffer_load_dwordx4 v2, s[52:55], s10 offen offset:0 sc1 lds
    v_exp_f32 v5, v57
    v_mfma_f32_16x16x32_bf16 v[224:227], a[112:115], v[64:67], v[224:227]
    ds_read_b128 a[72:75], v16 offset:2048
    v_cvt_pk_bf16_f32 v76, v4, v5
    v_mfma_f32_16x16x32_bf16 v[232:235], a[112:115], v[68:71], v[232:235]
    v_exp_f32 v6, v58
    v_mfma_f32_16x16x32_bf16 v[228:231], a[116:119], v[64:67], v[228:231]
    s_mov_b32 s13, 0x4000
    ds_read_b128 a[76:79], v16 offset:3072
    buffer_load_dwordx4 a[192:195], v0, s[72:75], s13 offen sc1
    v_mfma_f32_16x16x32_bf16 v[236:239], a[116:119], v[68:71], v[236:239]
    buffer_load_dwordx4 v2, s[52:55], s10 offen offset:1024 sc1 lds
    v_exp_f32 v7, v59
    v_mfma_f32_16x16x32_bf16 v[44:47], a[80:83], a[48:51], v[92:95]
    ds_read_b128 a[96:99], v16 offset:8192
    v_cvt_pk_bf16_f32 v77, v6, v7
    v_mfma_f32_16x16x32_bf16 v[44:47], a[84:87], a[52:55], v[44:47]
    v_exp_f32 v8, v60
    v_mfma_f32_16x16x32_bf16 v[44:47], a[88:91], a[56:59], v[44:47]
    ds_read_b128 a[100:103], v16 offset:9216
    buffer_load_dwordx4 a[196:199], v0, s[72:75], s13 offen offset:256 sc1
    v_mfma_f32_16x16x32_bf16 v[44:47], a[92:95], a[60:63], v[44:47]
    buffer_load_dwordx4 v2, s[52:55], s10 offen offset:2048 sc1 lds
    v_exp_f32 v9, v61
    v_mfma_f32_16x16x32_bf16 v[240:243], a[120:123], v[64:67], v[240:243]
    ds_read_b128 a[104:107], v16 offset:10240
    v_cvt_pk_bf16_f32 v78, v8, v9
    v_mfma_f32_16x16x32_bf16 v[248:251], a[120:123], v[68:71], v[248:251]
    v_exp_f32 v10, v62
    v_mfma_f32_16x16x32_bf16 v[244:247], a[124:127], v[64:67], v[244:247]
    ds_read_b128 a[108:111], v16 offset:11264
    buffer_load_dwordx4 v2, s[52:55], s10 offen offset:3072 sc1 lds
    v_mfma_f32_16x16x32_bf16 v[252:255], a[124:127], v[68:71], v[252:255]
    s_add_u32 s10, s10, 0x2000
    v_exp_f32 v11, v63
    v_smfmac_f32_16x16x64_bf16 v[120:123], v[12:15], v[64:71], v124
    s_waitcnt lgkmcnt(3)
    v_cvt_pk_bf16_f32 v79, v10, v11
    v_mfma_f32_16x16x32_bf16 v[48:51], a[64:67], a[128:131], v[80:83]
    ds_read_b128 a[80:83], v16 offset:4096
    buffer_load_dwordx4 a[200:203], v0, s[72:75], s13 offen offset:2048 sc1
    v_mfma_f32_16x16x32_bf16 v[48:51], a[68:71], a[132:135], v[48:51]
    v_exp_f32 v4, v32
    v_mfma_f32_16x16x32_bf16 v[48:51], a[72:75], a[136:139], v[48:51]
    ds_read_b128 a[84:87], v16 offset:5120
    v_mfma_f32_16x16x32_bf16 v[48:51], a[76:79], a[140:143], v[48:51]
    v_exp_f32 v5, v33
    v_mfma_f32_16x16x32_bf16 v[128:131], a[96:99], v[72:75], v[128:131]
    ds_read_b128 a[88:91], v16 offset:6144
    v_cvt_pk_bf16_f32 v64, v4, v5
    v_mfma_f32_16x16x32_bf16 v[136:139], a[96:99], v[76:79], v[136:139]
    s_waitcnt lgkmcnt(3)
    v_exp_f32 v6, v34
    v_mfma_f32_16x16x32_bf16 v[132:135], a[100:103], v[72:75], v[132:135]
    ds_read_b128 a[92:95], v16 offset:7168
    buffer_load_dwordx4 a[204:207], v0, s[72:75], s13 offen offset:2304 sc1
    v_mfma_f32_16x16x32_bf16 v[140:143], a[100:103], v[76:79], v[140:143]
    v_exp_f32 v7, v35
    v_mfma_f32_16x16x32_bf16 v[56:59], a[64:67], a[144:147], v[84:87]
    ds_read_b128 a[112:115], v16 offset:12288
    v_cvt_pk_bf16_f32 v65, v6, v7
    v_mfma_f32_16x16x32_bf16 v[56:59], a[68:71], a[148:151], v[56:59]
    v_exp_f32 v8, v36
    v_mfma_f32_16x16x32_bf16 v[56:59], a[72:75], a[152:155], v[56:59]
    s_mov_b32 s13, 0x5000
    ds_read_b128 a[116:119], v16 offset:13312
    buffer_load_dwordx4 a[208:211], v0, s[72:75], s13 offen sc1
    v_mfma_f32_16x16x32_bf16 v[56:59], a[76:79], a[156:159], v[56:59]
    v_exp_f32 v9, v37
    v_mfma_f32_16x16x32_bf16 v[144:147], a[104:107], v[72:75], v[144:147]
    ds_read_b128 a[120:123], v16 offset:14336
    v_cvt_pk_bf16_f32 v66, v8, v9
    v_mfma_f32_16x16x32_bf16 v[152:155], a[104:107], v[76:79], v[152:155]
    v_exp_f32 v10, v38
    v_mfma_f32_16x16x32_bf16 v[148:151], a[108:111], v[72:75], v[148:151]
    ds_read_b128 a[124:127], v16 offset:15360
    buffer_load_dwordx4 a[212:215], v0, s[72:75], s13 offen offset:256 sc1
    v_mfma_f32_16x16x32_bf16 v[156:159], a[108:111], v[76:79], v[156:159]
    s_waitcnt lgkmcnt(4)
    v_exp_f32 v11, v39
    v_mfma_f32_16x16x32_bf16 v[52:55], a[80:83], a[128:131], v[80:83]
    v_cvt_pk_bf16_f32 v67, v10, v11
    v_mfma_f32_16x16x32_bf16 v[52:55], a[84:87], a[132:135], v[52:55]
    s_add_u32 m0, s14, 0x1c000
    v_exp_f32 v4, v40
    v_mfma_f32_16x16x32_bf16 v[52:55], a[88:91], a[136:139], v[52:55]
    buffer_load_dwordx4 v2, s[52:55], s10 offen offset:0 sc1 lds
    v_mfma_f32_16x16x32_bf16 v[52:55], a[92:95], a[140:143], v[52:55]
    s_waitcnt lgkmcnt(2)
    v_exp_f32 v5, v41
    v_mfma_f32_16x16x32_bf16 v[160:163], a[112:115], v[72:75], v[160:163]
    v_cvt_pk_bf16_f32 v68, v4, v5
    v_mfma_f32_16x16x32_bf16 v[168:171], a[112:115], v[76:79], v[168:171]
    v_exp_f32 v6, v42
    v_mfma_f32_16x16x32_bf16 v[164:167], a[116:119], v[72:75], v[164:167]
    buffer_load_dwordx4 a[216:219], v0, s[72:75], s13 offen offset:2048 sc1
    v_mfma_f32_16x16x32_bf16 v[172:175], a[116:119], v[76:79], v[172:175]
    v_exp_f32 v7, v43
    v_mfma_f32_16x16x32_bf16 v[60:63], a[80:83], a[144:147], v[84:87]
    buffer_load_dwordx4 v2, s[52:55], s10 offen offset:1024 sc1 lds
    v_cvt_pk_bf16_f32 v69, v6, v7
    v_mfma_f32_16x16x32_bf16 v[60:63], a[84:87], a[148:151], v[60:63]
    v_exp_f32 v8, v44
    v_mfma_f32_16x16x32_bf16 v[60:63], a[88:91], a[152:155], v[60:63]
    buffer_load_dwordx4 a[220:223], v0, s[72:75], s13 offen offset:2304 sc1
    v_mfma_f32_16x16x32_bf16 v[60:63], a[92:95], a[156:159], v[60:63]
    s_waitcnt lgkmcnt(0)
    v_exp_f32 v9, v45
    v_mfma_f32_16x16x32_bf16 v[176:179], a[120:123], v[72:75], v[176:179]
    buffer_load_dwordx4 v2, s[52:55], s10 offen offset:2048 sc1 lds
    v_cvt_pk_bf16_f32 v70, v8, v9
    v_mfma_f32_16x16x32_bf16 v[184:187], a[120:123], v[76:79], v[184:187]
    v_exp_f32 v10, v46
    v_mfma_f32_16x16x32_bf16 v[180:183], a[124:127], v[72:75], v[180:183]
    buffer_load_dwordx4 v2, s[52:55], s10 offen offset:3072 sc1 lds
    v_mfma_f32_16x16x32_bf16 v[188:191], a[124:127], v[76:79], v[188:191]
    s_add_u32 s10, s10, 0x2000
    v_exp_f32 v11, v47
    v_smfmac_f32_16x16x64_bf16 v[116:119], v[12:15], v[72:79], v124
    v_cvt_pk_bf16_f32 v71, v10, v11
kU:
    s_cmp_ge_u32 s3, 2
    s_cbranch_scc1 kU1
kU0:
    s_mov_b32 s13, 0x6000
    v_mfma_f32_16x16x32_bf16 v[32:35], a[64:67], a[32:35], v[88:91]
    buffer_load_dwordx4 a[224:227], v0, s[72:75], s13 offen sc1
    v_mfma_f32_16x16x32_bf16 v[32:35], a[68:71], a[36:39], v[32:35]
    v_exp_f32 v4, v48
    v_mfma_f32_16x16x32_bf16 v[32:35], a[72:75], a[40:43], v[32:35]
    s_cmp_eq_u32 s3, 0
    s_cselect_b32 s96, 1.0, 0
    v_fma_f32 v48, v96, s96, v88
    v_mfma_f32_16x16x32_bf16 v[32:35], a[76:79], a[44:47], v[32:35]
    v_exp_f32 v5, v49
    v_mfma_f32_16x16x32_bf16 v[192:195], a[96:99], v[64:67], v[192:195]
    v_cvt_pk_bf16_f32 v72, v4, v5
    v_fma_f32 v49, v97, s96, v88
    v_mfma_f32_16x16x32_bf16 v[200:203], a[96:99], v[68:71], v[200:203]
    v_exp_f32 v6, v50
    v_mfma_f32_16x16x32_bf16 v[196:199], a[100:103], v[64:67], v[196:199]
    buffer_load_dwordx4 a[228:231], v0, s[72:75], s13 offen offset:256 sc1
    v_mfma_f32_16x16x32_bf16 v[204:207], a[100:103], v[68:71], v[204:207]
    v_exp_f32 v7, v51
    v_mfma_f32_16x16x32_bf16 v[40:43], a[64:67], a[48:51], v[92:95]
    v_cvt_pk_bf16_f32 v73, v6, v7
    v_fma_f32 v50, v98, s96, v88
    v_mfma_f32_16x16x32_bf16 v[40:43], a[68:71], a[52:55], v[40:43]
    v_exp_f32 v8, v52
    v_mfma_f32_16x16x32_bf16 v[40:43], a[72:75], a[56:59], v[40:43]
    buffer_load_dwordx4 a[232:235], v0, s[72:75], s13 offen offset:2048 sc1
    v_mfma_f32_16x16x32_bf16 v[40:43], a[76:79], a[60:63], v[40:43]
    v_exp_f32 v9, v53
    v_mfma_f32_16x16x32_bf16 v[208:211], a[104:107], v[64:67], v[208:211]
    v_cvt_pk_bf16_f32 v74, v8, v9
    v_fma_f32 v51, v99, s96, v88
    v_mfma_f32_16x16x32_bf16 v[216:219], a[104:107], v[68:71], v[216:219]
    v_exp_f32 v10, v54
    v_mfma_f32_16x16x32_bf16 v[212:215], a[108:111], v[64:67], v[212:215]
    s_waitcnt vmcnt(40)
    s_barrier
    buffer_load_dwordx4 a[236:239], v0, s[72:75], s13 offen offset:2304 sc1
    v_mfma_f32_16x16x32_bf16 v[220:223], a[108:111], v[68:71], v[220:223]
    v_exp_f32 v11, v55
    v_mfma_f32_16x16x32_bf16 v[36:39], a[80:83], a[32:35], v[88:91]
    ds_read_b128 a[64:67], v16 offset:32768
    v_cvt_pk_bf16_f32 v75, v10, v11
    v_mfma_f32_16x16x32_bf16 v[36:39], a[84:87], a[36:39], v[36:39]
    v_exp_f32 v4, v56
    v_mfma_f32_16x16x32_bf16 v[36:39], a[88:91], a[40:43], v[36:39]
    s_mov_b32 s13, 0x7000
    ds_read_b128 a[68:71], v16 offset:33792
    buffer_load_dwordx4 a[240:243], v0, s[72:75], s13 offen sc1
    v_mfma_f32_16x16x32_bf16 v[36:39], a[92:95], a[44:47], v[36:39]
    v_exp_f32 v5, v57
    v_mfma_f32_16x16x32_bf16 v[224:227], a[112:115], v[64:67], v[224:227]
    ds_read_b128 a[72:75], v16 offset:34816
    v_cvt_pk_bf16_f32 v76, v4, v5
    v_mfma_f32_16x16x32_bf16 v[232:235], a[112:115], v[68:71], v[232:235]
    v_exp_f32 v6, v58
    v_mfma_f32_16x16x32_bf16 v[228:231], a[116:119], v[64:67], v[228:231]
    ds_read_b128 a[76:79], v16 offset:35840
    buffer_load_dwordx4 a[244:247], v0, s[72:75], s13 offen offset:256 sc1
    v_mfma_f32_16x16x32_bf16 v[236:239], a[116:119], v[68:71], v[236:239]
    v_exp_f32 v7, v59
    v_mfma_f32_16x16x32_bf16 v[44:47], a[80:83], a[48:51], v[92:95]
    ds_read_b128 a[96:99], v17 offset:40960
    v_cvt_pk_bf16_f32 v77, v6, v7
    v_mfma_f32_16x16x32_bf16 v[44:47], a[84:87], a[52:55], v[44:47]
    v_exp_f32 v8, v60
    v_mfma_f32_16x16x32_bf16 v[44:47], a[88:91], a[56:59], v[44:47]
    ds_read_b128 a[100:103], v17 offset:41984
    buffer_load_dwordx4 a[248:251], v0, s[72:75], s13 offen offset:2048 sc1
    v_mfma_f32_16x16x32_bf16 v[44:47], a[92:95], a[60:63], v[44:47]
    v_exp_f32 v9, v61
    v_mfma_f32_16x16x32_bf16 v[240:243], a[120:123], v[64:67], v[240:243]
    ds_read_b128 a[104:107], v17 offset:43008
    v_cvt_pk_bf16_f32 v78, v8, v9
    v_mfma_f32_16x16x32_bf16 v[248:251], a[120:123], v[68:71], v[248:251]
    v_exp_f32 v10, v62
    v_mfma_f32_16x16x32_bf16 v[244:247], a[124:127], v[64:67], v[244:247]
    ds_read_b128 a[108:111], v17 offset:44032
    buffer_load_dwordx4 a[252:255], v0, s[72:75], s13 offen offset:2304 sc1
    v_mfma_f32_16x16x32_bf16 v[252:255], a[124:127], v[68:71], v[252:255]
    v_exp_f32 v11, v63
    v_smfmac_f32_16x16x64_bf16 v[120:123], v[12:15], v[64:71], v124
    s_waitcnt lgkmcnt(3)
    v_cvt_pk_bf16_f32 v79, v10, v11
    v_mfma_f32_16x16x32_bf16 v[48:51], a[64:67], a[32:35], v[48:51]
    ds_read_b128 a[80:83], v16 offset:36864
    v_fma_f32 v52, v100, s96, v88
    v_mfma_f32_16x16x32_bf16 v[48:51], a[68:71], a[36:39], v[48:51]
    v_exp_f32 v4, v32
    v_mfma_f32_16x16x32_bf16 v[48:51], a[72:75], a[40:43], v[48:51]
    ds_read_b128 a[84:87], v16 offset:37888
    v_fma_f32 v53, v101, s96, v88
    v_mfma_f32_16x16x32_bf16 v[48:51], a[76:79], a[44:47], v[48:51]
    v_exp_f32 v5, v33
    v_mfma_f32_16x16x32_bf16 v[128:131], a[96:99], v[72:75], v[128:131]
    ds_read_b128 a[88:91], v16 offset:38912
    v_cvt_pk_bf16_f32 v64, v4, v5
    v_mfma_f32_16x16x32_bf16 v[136:139], a[96:99], v[76:79], v[136:139]
    s_waitcnt lgkmcnt(3)
    v_exp_f32 v6, v34
    v_mfma_f32_16x16x32_bf16 v[132:135], a[100:103], v[72:75], v[132:135]
    ds_read_b128 a[92:95], v16 offset:39936
    v_fma_f32 v54, v102, s96, v88
    v_fma_f32 v55, v103, s96, v88
    v_fma_f32 v56, v104, s96, v92
    v_fma_f32 v57, v105, s96, v92
    v_fma_f32 v58, v106, s96, v92
    v_fma_f32 v59, v107, s96, v92
    v_mfma_f32_16x16x32_bf16 v[140:143], a[100:103], v[76:79], v[140:143]
    v_exp_f32 v7, v35
    v_mfma_f32_16x16x32_bf16 v[56:59], a[64:67], a[48:51], v[56:59]
    ds_read_b128 a[112:115], v17 offset:45056
    v_cvt_pk_bf16_f32 v65, v6, v7
    v_mfma_f32_16x16x32_bf16 v[56:59], a[68:71], a[52:55], v[56:59]
    v_exp_f32 v8, v36
    v_mfma_f32_16x16x32_bf16 v[56:59], a[72:75], a[56:59], v[56:59]
    ds_read_b128 a[116:119], v17 offset:46080
    v_fma_f32 v60, v108, s96, v92
    v_mfma_f32_16x16x32_bf16 v[56:59], a[76:79], a[60:63], v[56:59]
    v_exp_f32 v9, v37
    v_mfma_f32_16x16x32_bf16 v[144:147], a[104:107], v[72:75], v[144:147]
    ds_read_b128 a[120:123], v17 offset:47104
    v_cvt_pk_bf16_f32 v66, v8, v9
    v_mfma_f32_16x16x32_bf16 v[152:155], a[104:107], v[76:79], v[152:155]
    v_exp_f32 v10, v38
    v_mfma_f32_16x16x32_bf16 v[148:151], a[108:111], v[72:75], v[148:151]
    ds_read_b128 a[124:127], v17 offset:48128
    v_fma_f32 v61, v109, s96, v92
    v_mfma_f32_16x16x32_bf16 v[156:159], a[108:111], v[76:79], v[156:159]
    s_waitcnt lgkmcnt(4)
    v_exp_f32 v11, v39
    v_mfma_f32_16x16x32_bf16 v[52:55], a[80:83], a[32:35], v[52:55]
    s_movk_i32 s10, 0x0
    v_cvt_pk_bf16_f32 v67, v10, v11
    v_add_u32 v17, 0x10000, v16
    v_lshrrev_b32 v20, 3, v1
    v_lshrrev_b32 v21, 4, v1
    v_and_b32 v22, 7, v1
    v_lshlrev_b32 v20, 12, v20
    v_xor_b32 v21, v21, v22
    v_lshl_add_u32 v20, v21, 4, v20
    v_xor_b32 v21, 64, v20
    v_add_u32 v21, 0x7c00, v21
    v_add_u32 v22, 0xf800, v20
    v_add_u32 v23, 0xf800, v21
    v_mfma_f32_16x16x32_bf16 v[52:55], a[84:87], a[36:39], v[52:55]
    s_add_u32 m0, s14, 0x0
    v_exp_f32 v4, v40
    v_mfma_f32_16x16x32_bf16 v[52:55], a[88:91], a[40:43], v[52:55]
    buffer_load_dwordx4 v20, s[76:79], s10 offen offset:0 lds
    v_mfma_f32_16x16x32_bf16 v[52:55], a[92:95], a[44:47], v[52:55]
    s_waitcnt lgkmcnt(2)
    v_exp_f32 v5, v41
    v_mfma_f32_16x16x32_bf16 v[160:163], a[112:115], v[72:75], v[160:163]
    v_cvt_pk_bf16_f32 v68, v4, v5
    v_fma_f32 v62, v110, s96, v92
    v_mfma_f32_16x16x32_bf16 v[168:171], a[112:115], v[76:79], v[168:171]
    v_exp_f32 v6, v42
    v_mfma_f32_16x16x32_bf16 v[164:167], a[116:119], v[72:75], v[164:167]
    buffer_load_dwordx4 v21, s[76:79], s10 offen offset:1024 lds
    v_fma_f32 v63, v111, s96, v92
    v_mfma_f32_16x16x32_bf16 v[172:175], a[116:119], v[76:79], v[172:175]
    v_exp_f32 v7, v43
    v_mfma_f32_16x16x32_bf16 v[60:63], a[80:83], a[48:51], v[60:63]
    v_cvt_pk_bf16_f32 v69, v6, v7
    v_mfma_f32_16x16x32_bf16 v[60:63], a[84:87], a[52:55], v[60:63]
    v_exp_f32 v8, v44
    v_mfma_f32_16x16x32_bf16 v[60:63], a[88:91], a[56:59], v[60:63]
    buffer_load_dwordx4 v22, s[76:79], s10 offen offset:2048 lds
    v_mfma_f32_16x16x32_bf16 v[60:63], a[92:95], a[60:63], v[60:63]
    s_waitcnt lgkmcnt(0)
    v_exp_f32 v9, v45
    v_mfma_f32_16x16x32_bf16 v[176:179], a[120:123], v[72:75], v[176:179]
    v_cvt_pk_bf16_f32 v70, v8, v9
    v_mfma_f32_16x16x32_bf16 v[184:187], a[120:123], v[76:79], v[184:187]
    v_exp_f32 v10, v46
    v_mfma_f32_16x16x32_bf16 v[180:183], a[124:127], v[72:75], v[180:183]
    buffer_load_dwordx4 v23, s[76:79], s10 offen offset:3072 lds
    v_mfma_f32_16x16x32_bf16 v[188:191], a[124:127], v[76:79], v[188:191]
    v_exp_f32 v11, v47
    v_smfmac_f32_16x16x64_bf16 v[116:119], v[12:15], v[72:79], v124
    s_cmp_ge_u32 s5, 28
    s_cbranch_scc1 kU0_se
kU0_sr:
    v_cvt_pk_bf16_f32 v71, v10, v11
    v_mfma_f32_16x16x32_bf16 v[32:35], a[64:67], a[128:131], v[80:83]
    s_movk_i32 s10, 0x80
    v_mfma_f32_16x16x32_bf16 v[32:35], a[68:71], a[132:135], v[32:35]
    s_add_u32 m0, s14, 0x4000
    v_exp_f32 v4, v48
    v_mfma_f32_16x16x32_bf16 v[32:35], a[72:75], a[136:139], v[32:35]
    buffer_load_dwordx4 v20, s[76:79], s10 offen offset:0 lds
    v_mfma_f32_16x16x32_bf16 v[32:35], a[76:79], a[140:143], v[32:35]
    v_exp_f32 v5, v49
    v_mfma_f32_16x16x32_bf16 v[192:195], a[96:99], v[64:67], v[192:195]
    s_cmp_eq_u32 s3, 1
    s_cselect_b32 s96, 1.0, 0
    v_cvt_pk_bf16_f32 v72, v4, v5
    v_mfma_f32_16x16x32_bf16 v[200:203], a[96:99], v[68:71], v[200:203]
    v_exp_f32 v6, v50
    v_mfma_f32_16x16x32_bf16 v[196:199], a[100:103], v[64:67], v[196:199]
    buffer_load_dwordx4 v21, s[76:79], s10 offen offset:1024 lds
    v_mfma_f32_16x16x32_bf16 v[204:207], a[100:103], v[68:71], v[204:207]
    v_exp_f32 v7, v51
    v_mfma_f32_16x16x32_bf16 v[40:43], a[64:67], a[144:147], v[84:87]
    v_cvt_pk_bf16_f32 v73, v6, v7
    v_fma_f32 v48, v96, s96, v80
    v_mfma_f32_16x16x32_bf16 v[40:43], a[68:71], a[148:151], v[40:43]
    v_exp_f32 v8, v52
    v_mfma_f32_16x16x32_bf16 v[40:43], a[72:75], a[152:155], v[40:43]
    buffer_load_dwordx4 v22, s[76:79], s10 offen offset:2048 lds
    v_mfma_f32_16x16x32_bf16 v[40:43], a[76:79], a[156:159], v[40:43]
    v_exp_f32 v9, v53
    v_mfma_f32_16x16x32_bf16 v[208:211], a[104:107], v[64:67], v[208:211]
    v_cvt_pk_bf16_f32 v74, v8, v9
    v_fma_f32 v49, v97, s96, v80
    v_mfma_f32_16x16x32_bf16 v[216:219], a[104:107], v[68:71], v[216:219]
    v_exp_f32 v10, v54
    v_mfma_f32_16x16x32_bf16 v[212:215], a[108:111], v[64:67], v[212:215]
    s_waitcnt vmcnt(32)
    s_barrier
    buffer_load_dwordx4 v23, s[76:79], s10 offen offset:3072 lds
    v_mfma_f32_16x16x32_bf16 v[220:223], a[108:111], v[68:71], v[220:223]
    s_lshl_b32 s12, s7, 2
    v_exp_f32 v11, v55
    v_mfma_f32_16x16x32_bf16 v[36:39], a[80:83], a[128:131], v[80:83]
    s_add_u32 s90, 60, s3
    ds_read_b128 a[64:67], v17 offset:0
    v_cvt_pk_bf16_f32 v75, v10, v11
    v_mfma_f32_16x16x32_bf16 v[36:39], a[84:87], a[132:135], v[36:39]
    s_movk_i32 s10, 0x100
    v_exp_f32 v4, v56
    v_mfma_f32_16x16x32_bf16 v[36:39], a[88:91], a[136:139], v[36:39]
    s_add_u32 m0, s14, 0x8000
    ds_read_b128 a[68:71], v17 offset:1024
    buffer_load_dwordx4 v20, s[76:79], s10 offen offset:0 lds
    v_mfma_f32_16x16x32_bf16 v[36:39], a[92:95], a[140:143], v[36:39]
    s_sub_u32 s90, s90, s12
    v_exp_f32 v5, v57
    v_mfma_f32_16x16x32_bf16 v[224:227], a[112:115], v[64:67], v[224:227]
    s_mul_i32 s90, s90, 155
    ds_read_b128 a[72:75], v17 offset:2048
    v_cvt_pk_bf16_f32 v76, v4, v5
    v_mfma_f32_16x16x32_bf16 v[232:235], a[112:115], v[68:71], v[232:235]
    s_lshl_b32 s12, s6, 2
    v_exp_f32 v6, v58
    v_mfma_f32_16x16x32_bf16 v[228:231], a[116:119], v[64:67], v[228:231]
    s_add_u32 s90, s90, s12
    ds_read_b128 a[76:79], v17 offset:3072
    buffer_load_dwordx4 v21, s[76:79], s10 offen offset:1024 lds
    v_mfma_f32_16x16x32_bf16 v[236:239], a[116:119], v[68:71], v[236:239]
    s_lshl_b32 s90, s90, 11
    v_exp_f32 v7, v59
    v_mfma_f32_16x16x32_bf16 v[44:47], a[80:83], a[144:147], v[84:87]
    s_lshl_b32 s12, s7, 2
    ds_read_b128 a[96:99], v17 offset:8192
    v_cvt_pk_bf16_f32 v77, v6, v7
    v_mfma_f32_16x16x32_bf16 v[44:47], a[84:87], a[148:151], v[44:47]
    s_sub_u32 s92, 63, s3
    v_exp_f32 v8, v60
    v_mfma_f32_16x16x32_bf16 v[44:47], a[88:91], a[152:155], v[44:47]
    s_sub_u32 s92, s92, s12
    ds_read_b128 a[100:103], v17 offset:9216
    buffer_load_dwordx4 v22, s[76:79], s10 offen offset:2048 lds
    v_mfma_f32_16x16x32_bf16 v[44:47], a[92:95], a[156:159], v[44:47]
    s_mul_i32 s92, s92, 155
    v_exp_f32 v9, v61
    v_mfma_f32_16x16x32_bf16 v[240:243], a[120:123], v[64:67], v[240:243]
    s_lshl_b32 s12, s6, 2
    ds_read_b128 a[104:107], v17 offset:10240
    v_cvt_pk_bf16_f32 v78, v8, v9
    v_mfma_f32_16x16x32_bf16 v[248:251], a[120:123], v[68:71], v[248:251]
    s_add_u32 s92, s92, s12
    v_exp_f32 v10, v62
    v_mfma_f32_16x16x32_bf16 v[244:247], a[124:127], v[64:67], v[244:247]
    s_lshl_b32 s92, s92, 11
    ds_read_b128 a[108:111], v17 offset:11264
    buffer_load_dwordx4 v23, s[76:79], s10 offen offset:3072 lds
    v_mfma_f32_16x16x32_bf16 v[252:255], a[124:127], v[68:71], v[252:255]
    s_lshl_b32 s12, s3, 13
    v_exp_f32 v11, v63
    v_fma_f32 v50, v98, s96, v80
    v_fma_f32 v51, v99, s96, v80
    v_smfmac_f32_16x16x64_bf16 v[120:123], v[12:15], v[64:71], v124
    s_add_u32 s12, s12, 0x18000
    v_cvt_pk_bf16_f32 v79, v10, v11
    s_waitcnt lgkmcnt(3)
    v_mfma_f32_16x16x32_bf16 v[48:51], a[64:67], a[128:131], v[48:51]
    ds_read_b128 a[80:83], v17 offset:4096
    v_fma_f32 v52, v100, s96, v80
    v_mfma_f32_16x16x32_bf16 v[48:51], a[68:71], a[132:135], v[48:51]
    v_exp_f32 v4, v32
    v_mfma_f32_16x16x32_bf16 v[48:51], a[72:75], a[136:139], v[48:51]
    ds_read_b128 a[84:87], v17 offset:5120
    v_fma_f32 v53, v101, s96, v80
    v_mfma_f32_16x16x32_bf16 v[48:51], a[76:79], a[140:143], v[48:51]
    v_exp_f32 v5, v33
    v_mfma_f32_16x16x32_bf16 v[192:195], a[96:99], v[72:75], v[192:195]
    ds_read_b128 a[88:91], v17 offset:6144
    v_cvt_pk_bf16_f32 v64, v4, v5
    v_mfma_f32_16x16x32_bf16 v[200:203], a[96:99], v[76:79], v[200:203]
    s_waitcnt lgkmcnt(3)
    v_exp_f32 v6, v34
    v_mfma_f32_16x16x32_bf16 v[196:199], a[100:103], v[72:75], v[196:199]
    ds_read_b128 a[92:95], v17 offset:7168
    v_fma_f32 v54, v102, s96, v80
    v_fma_f32 v55, v103, s96, v80
    v_fma_f32 v56, v104, s96, v84
    v_fma_f32 v57, v105, s96, v84
    v_fma_f32 v58, v106, s96, v84
    v_fma_f32 v59, v107, s96, v84
    v_mfma_f32_16x16x32_bf16 v[204:207], a[100:103], v[76:79], v[204:207]
    v_exp_f32 v7, v35
    v_mfma_f32_16x16x32_bf16 v[56:59], a[64:67], a[144:147], v[56:59]
    ds_read_b128 a[112:115], v17 offset:12288
    v_cvt_pk_bf16_f32 v65, v6, v7
    v_mfma_f32_16x16x32_bf16 v[56:59], a[68:71], a[148:151], v[56:59]
    v_exp_f32 v8, v36
    v_mfma_f32_16x16x32_bf16 v[56:59], a[72:75], a[152:155], v[56:59]
    ds_read_b128 a[116:119], v17 offset:13312
    v_fma_f32 v60, v108, s96, v84
    v_mfma_f32_16x16x32_bf16 v[56:59], a[76:79], a[156:159], v[56:59]
    v_exp_f32 v9, v37
    v_mfma_f32_16x16x32_bf16 v[208:211], a[104:107], v[72:75], v[208:211]
    ds_read_b128 a[120:123], v17 offset:14336
    v_cvt_pk_bf16_f32 v66, v8, v9
    v_mfma_f32_16x16x32_bf16 v[216:219], a[104:107], v[76:79], v[216:219]
    s_movk_i32 s10, 0x180
    v_exp_f32 v10, v38
    v_mfma_f32_16x16x32_bf16 v[212:215], a[108:111], v[72:75], v[212:215]
    s_add_u32 m0, s14, 0xc000
    ds_read_b128 a[124:127], v17 offset:15360
    buffer_load_dwordx4 v20, s[76:79], s10 offen offset:0 lds
    v_mfma_f32_16x16x32_bf16 v[220:223], a[108:111], v[76:79], v[220:223]
    s_waitcnt lgkmcnt(4)
    v_exp_f32 v11, v39
    v_mfma_f32_16x16x32_bf16 v[52:55], a[80:83], a[128:131], v[52:55]
    v_cvt_pk_bf16_f32 v67, v10, v11
    v_fma_f32 v61, v109, s96, v84
    v_mfma_f32_16x16x32_bf16 v[52:55], a[84:87], a[132:135], v[52:55]
    v_exp_f32 v4, v40
    v_mfma_f32_16x16x32_bf16 v[52:55], a[88:91], a[136:139], v[52:55]
    buffer_load_dwordx4 v21, s[76:79], s10 offen offset:1024 lds
    v_mfma_f32_16x16x32_bf16 v[52:55], a[92:95], a[140:143], v[52:55]
    s_waitcnt lgkmcnt(2)
    v_exp_f32 v5, v41
    v_mfma_f32_16x16x32_bf16 v[224:227], a[112:115], v[72:75], v[224:227]
    v_cvt_pk_bf16_f32 v68, v4, v5
    v_fma_f32 v62, v110, s96, v84
    v_mfma_f32_16x16x32_bf16 v[232:235], a[112:115], v[76:79], v[232:235]
    v_exp_f32 v6, v42
    v_mfma_f32_16x16x32_bf16 v[228:231], a[116:119], v[72:75], v[228:231]
    buffer_load_dwordx4 v22, s[76:79], s10 offen offset:2048 lds
    v_fma_f32 v63, v111, s96, v84
    v_mfma_f32_16x16x32_bf16 v[236:239], a[116:119], v[76:79], v[236:239]
    v_exp_f32 v7, v43
    v_mfma_f32_16x16x32_bf16 v[60:63], a[80:83], a[144:147], v[60:63]
    v_cvt_pk_bf16_f32 v69, v6, v7
    v_add_u32 v18, s12, v2
    v_mfma_f32_16x16x32_bf16 v[60:63], a[84:87], a[148:151], v[60:63]
    s_xor_b32 s12, s3, 3
    s_lshl_b32 s12, s12, 13
    s_add_u32 s12, s12, 0x18000
    v_exp_f32 v8, v44
    v_add_u32 v19, s12, v2
    v_mfma_f32_16x16x32_bf16 v[60:63], a[88:91], a[152:155], v[60:63]
    s_lshl_b32 s12, s3, 10
    s_add_u32 s12, s12, 0x18000
    buffer_load_dwordx4 v23, s[76:79], s10 offen offset:3072 lds
    v_add_u32 v25, s12, v2
    v_xor_b32 v26, 0xc00, v25
    v_mfma_f32_16x16x32_bf16 v[60:63], a[92:95], a[156:159], v[60:63]
    s_waitcnt lgkmcnt(1)
    v_exp_f32 v9, v45
    v_mfma_f32_16x16x32_bf16 v[240:243], a[120:123], v[72:75], v[240:243]
    s_waitcnt lgkmcnt(0)
    s_waitcnt vmcnt(24)
    s_barrier
    v_cvt_pk_bf16_f32 v70, v8, v9
    v_mfma_f32_16x16x32_bf16 v[248:251], a[120:123], v[76:79], v[248:251]
    ds_read_b128 a[80:83], v17 offset:45056
    v_exp_f32 v10, v46
    v_mfma_f32_16x16x32_bf16 v[244:247], a[124:127], v[72:75], v[244:247]
    v_mfma_f32_16x16x32_bf16 v[252:255], a[124:127], v[76:79], v[252:255]
    ds_read_b128 a[84:87], v17 offset:46080
    v_exp_f32 v11, v47
    v_smfmac_f32_16x16x64_bf16 v[120:123], v[12:15], v[72:79], v124
    ds_read_b128 a[88:91], v17 offset:47104
    v_cvt_pk_bf16_f32 v71, v10, v11
    v_mfma_f32_16x16x32_bf16 v[128:131], a[96:99], v[64:67], v[128:131]
    v_exp_f32 v4, v48
    v_mfma_f32_16x16x32_bf16 v[136:139], a[96:99], v[68:71], v[136:139]
    s_mov_b32 s13, 0x8000
    ds_read_b128 a[92:95], v17 offset:48128
    buffer_load_dwordx4 a[128:131], v0, s[72:75], s13 offen sc1
    v_exp_f32 v5, v49
    v_mfma_f32_16x16x32_bf16 v[132:135], a[100:103], v[64:67], v[132:135]
    ds_read_b128 a[64:67], v17 offset:40960
    v_exp_f32 v6, v50
    v_mfma_f32_16x16x32_bf16 v[140:143], a[100:103], v[68:71], v[140:143]
    ds_read_b128 a[68:71], v17 offset:41984
    v_exp_f32 v7, v51
    v_cvt_pk_bf16_f32 v72, v4, v5
    v_mfma_f32_16x16x32_bf16 v[144:147], a[104:107], v[64:67], v[144:147]
    s_movk_i32 s10, 0x200
    ds_read_b128 a[72:75], v17 offset:43008
    buffer_load_dwordx4 a[132:135], v0, s[72:75], s13 offen offset:256 sc1
    v_exp_f32 v8, v52
    v_mfma_f32_16x16x32_bf16 v[152:155], a[104:107], v[68:71], v[152:155]
    s_add_u32 m0, s14, 0x10000
    ds_read_b128 a[76:79], v17 offset:44032
    v_exp_f32 v9, v53
    v_cvt_pk_bf16_f32 v73, v6, v7
    v_mfma_f32_16x16x32_bf16 v[148:151], a[108:111], v[64:67], v[148:151]
    buffer_load_dwordx4 v20, s[76:79], s10 offen offset:0 lds
    v_exp_f32 v10, v54
    v_mfma_f32_16x16x32_bf16 v[156:159], a[108:111], v[68:71], v[156:159]
    buffer_load_dwordx4 a[136:139], v0, s[72:75], s13 offen offset:2048 sc1
    v_exp_f32 v11, v55
    v_cvt_pk_bf16_f32 v74, v8, v9
    v_mfma_f32_16x16x32_bf16 v[160:163], a[112:115], v[64:67], v[160:163]
    v_exp_f32 v4, v56
    v_mfma_f32_16x16x32_bf16 v[168:171], a[112:115], v[68:71], v[168:171]
    buffer_load_dwordx4 v21, s[76:79], s10 offen offset:1024 lds
    v_exp_f32 v5, v57
    v_cvt_pk_bf16_f32 v75, v10, v11
    v_mfma_f32_16x16x32_bf16 v[164:167], a[116:119], v[64:67], v[164:167]
    buffer_load_dwordx4 a[140:143], v0, s[72:75], s13 offen offset:2304 sc1
    v_exp_f32 v6, v58
    v_mfma_f32_16x16x32_bf16 v[172:175], a[116:119], v[68:71], v[172:175]
    s_mov_b32 s13, 0x9000
    v_exp_f32 v7, v59
    v_cvt_pk_bf16_f32 v76, v4, v5
    v_mfma_f32_16x16x32_bf16 v[176:179], a[120:123], v[64:67], v[176:179]
    buffer_load_dwordx4 v22, s[76:79], s10 offen offset:2048 lds
    ds_write_b128 v18, v[224:227] offset:32768
    ds_write_b128 v18, v[228:231] offset:33792
    ds_write_b128 v18, v[232:235] offset:34816
    ds_write_b128 v18, v[236:239] offset:35840
    v_exp_f32 v8, v60
    v_add_f32 v120, v120, v121
    v_add_f32 v122, v122, v123
    v_mfma_f32_16x16x32_bf16 v[184:187], a[120:123], v[68:71], v[184:187]
    buffer_load_dwordx4 a[144:147], v0, s[72:75], s13 offen sc1
    ds_write2_b32 v25, v120, v122 offset0:0 offset1:1
    ds_write_b128 v18, v[240:243] offset:36864
    ds_write_b128 v18, v[244:247] offset:37888
    ds_write_b128 v18, v[248:251] offset:38912
    ds_write_b128 v18, v[252:255] offset:39936
    v_exp_f32 v9, v61
    v_cvt_pk_bf16_f32 v77, v6, v7
    v_mfma_f32_16x16x32_bf16 v[180:183], a[124:127], v[64:67], v[180:183]
    v_exp_f32 v10, v62
    v_mfma_f32_16x16x32_bf16 v[188:191], a[124:127], v[68:71], v[188:191]
    v_exp_f32 v11, v63
    v_cvt_pk_bf16_f32 v78, v8, v9
    v_smfmac_f32_16x16x64_bf16 v[116:119], v[12:15], v[64:71], v124
    s_waitcnt lgkmcnt(0)
    s_barrier
    ds_read_b64 v[112:113], v26 offset:0
    ds_read_b128 v[224:227], v19 offset:32768
    v_cvt_pk_bf16_f32 v79, v10, v11
    s_nop 1
    v_smfmac_f32_16x16x64_bf16 v[116:119], v[12:15], v[72:79], v124
    ds_read_b128 v[228:231], v19 offset:33792
    ds_read_b128 v[232:235], v19 offset:34816
    ds_read_b128 v[236:239], v19 offset:35840
    ds_read_b128 v[240:243], v19 offset:36864
    ds_read_b128 v[244:247], v19 offset:37888
    ds_read_b128 v[248:251], v19 offset:38912
    ds_read_b128 v[252:255], v19 offset:39936
    v_mfma_f32_16x16x32_bf16 v[160:163], a[80:83], v[72:75], v[160:163]
    buffer_load_dwordx4 v23, s[76:79], s10 offen offset:3072 lds
    v_mfma_f32_16x16x32_bf16 v[168:171], a[80:83], v[76:79], v[168:171]
    buffer_load_dwordx4 a[148:151], v0, s[72:75], s13 offen offset:256 sc1
    v_mfma_f32_16x16x32_bf16 v[164:167], a[84:87], v[72:75], v[164:167]
    s_movk_i32 s10, 0x280
    s_add_u32 m0, s14, 0x14000
    s_nop 0
    buffer_load_dwordx4 v20, s[76:79], s10 offen offset:0 lds
    v_mfma_f32_16x16x32_bf16 v[172:175], a[84:87], v[76:79], v[172:175]
    buffer_load_dwordx4 a[152:155], v0, s[72:75], s13 offen offset:2048 sc1
    v_mfma_f32_16x16x32_bf16 v[176:179], a[88:91], v[72:75], v[176:179]
    buffer_load_dwordx4 v21, s[76:79], s10 offen offset:1024 lds
    v_mfma_f32_16x16x32_bf16 v[184:187], a[88:91], v[76:79], v[184:187]
    buffer_load_dwordx4 a[156:159], v0, s[72:75], s13 offen offset:2304 sc1
    v_mfma_f32_16x16x32_bf16 v[180:183], a[92:95], v[72:75], v[180:183]
    v_add_f32 v116, v116, v117
    v_add_f32 v118, v118, v119
    v_mfma_f32_16x16x32_bf16 v[188:191], a[92:95], v[76:79], v[188:191]
    buffer_load_dwordx4 v22, s[76:79], s10 offen offset:2048 lds
    v_mfma_f32_16x16x32_bf16 v[128:131], a[64:67], v[72:75], v[128:131]
    ds_write2_b32 v25, v116, v118 offset0:2 offset1:3
    v_mfma_f32_16x16x32_bf16 v[136:139], a[64:67], v[76:79], v[136:139]
    ds_write_b128 v19, v[160:163] offset:32768
    v_mfma_f32_16x16x32_bf16 v[132:135], a[68:71], v[72:75], v[132:135]
    buffer_load_dwordx4 v23, s[76:79], s10 offen offset:3072 lds
    v_mfma_f32_16x16x32_bf16 v[140:143], a[68:71], v[76:79], v[140:143]
    ds_write_b128 v19, v[168:171] offset:34816
    v_mfma_f32_16x16x32_bf16 v[144:147], a[72:75], v[72:75], v[144:147]
    ds_write_b128 v19, v[164:167] offset:33792
    v_mfma_f32_16x16x32_bf16 v[152:155], a[72:75], v[76:79], v[152:155]
    ds_write_b128 v19, v[172:175] offset:35840
    v_mfma_f32_16x16x32_bf16 v[148:151], a[76:79], v[72:75], v[148:151]
    ds_write_b128 v19, v[176:179] offset:36864
    v_mfma_f32_16x16x32_bf16 v[156:159], a[76:79], v[76:79], v[156:159]
    ds_write_b128 v19, v[184:187] offset:38912
    ds_write_b128 v19, v[180:183] offset:37888
    ds_write_b128 v19, v[188:191] offset:39936
    s_waitcnt lgkmcnt(15)
    v_add_f32 v120, v120, v112
    v_add_f32 v122, v122, v113
    v_subrev_u32 v121, 0x1f800000, v120
    v_subrev_u32 v123, 0x1f800000, v122
    v_max_u32 v121, v121, v123
    v_cmp_lt_u32 vcc, 0x40000000, v121
    v_rcp_f32 v120, v120
    v_rcp_f32 v122, v122
    s_cmp_lg_u64 vcc, 0
    s_cselect_b32 s90, 0x7f000000, s90
    s_cselect_b32 s11, 2, 0
    s_or_b32 s95, s95, s11
    v_pk_add_f32 v[192:193], v[192:193], v[224:225]
    v_pk_add_f32 v[194:195], v[194:195], v[226:227]
    v_pk_add_f32 v[196:197], v[196:197], v[228:229]
    v_pk_add_f32 v[198:199], v[198:199], v[230:231]
    v_pk_mul_f32 v[192:193], v[192:193], v[120:121] op_sel_hi:[1,0]
    v_pk_mul_f32 v[194:195], v[194:195], v[120:121] op_sel_hi:[1,0]
    v_pk_mul_f32 v[196:197], v[196:197], v[120:121] op_sel_hi:[1,0]
    v_pk_mul_f32 v[198:199], v[198:199], v[120:121] op_sel_hi:[1,0]
    v_cvt_pk_bf16_f32 v192, v192, v193
    v_cvt_pk_bf16_f32 v193, v194, v195
    s_waitcnt vmcnt(24) lgkmcnt(0)
    s_barrier
    ds_read_b64 v[114:115], v26 offset:8
    ds_read_b128 v[160:163], v18 offset:32768
    ds_read_b128 v[164:167], v18 offset:33792
    ds_read_b128 v[168:171], v18 offset:34816
    ds_read_b128 v[172:175], v18 offset:35840
    ds_read_b128 v[176:179], v18 offset:36864
    ds_read_b128 v[180:183], v18 offset:37888
    ds_read_b128 v[184:187], v18 offset:38912
    ds_read_b128 v[188:191], v18 offset:39936
    v_cvt_pk_bf16_f32 v194, v196, v197
    v_cvt_pk_bf16_f32 v195, v198, v199
    buffer_store_dwordx4 v[192:195], v0, s[56:59], s90 offen sc1
    v_pk_add_f32 v[200:201], v[200:201], v[232:233]
    v_pk_add_f32 v[202:203], v[202:203], v[234:235]
    v_pk_add_f32 v[204:205], v[204:205], v[236:237]
    v_pk_add_f32 v[206:207], v[206:207], v[238:239]
    v_pk_mul_f32 v[200:201], v[200:201], v[122:123] op_sel_hi:[1,0]
    v_pk_mul_f32 v[202:203], v[202:203], v[122:123] op_sel_hi:[1,0]
    v_pk_mul_f32 v[204:205], v[204:205], v[122:123] op_sel_hi:[1,0]
    v_pk_mul_f32 v[206:207], v[206:207], v[122:123] op_sel_hi:[1,0]
    v_cvt_pk_bf16_f32 v200, v200, v201
    v_cvt_pk_bf16_f32 v201, v202, v203
    v_cvt_pk_bf16_f32 v202, v204, v205
    v_cvt_pk_bf16_f32 v203, v206, v207
    buffer_store_dwordx4 v[200:203], v0, s[56:59], s90 offen offset:256 sc1
    v_pk_add_f32 v[208:209], v[208:209], v[240:241]
    v_pk_add_f32 v[210:211], v[210:211], v[242:243]
    v_pk_add_f32 v[212:213], v[212:213], v[244:245]
    v_pk_add_f32 v[214:215], v[214:215], v[246:247]
    v_pk_mul_f32 v[208:209], v[208:209], v[120:121] op_sel_hi:[1,0]
    v_pk_mul_f32 v[210:211], v[210:211], v[120:121] op_sel_hi:[1,0]
    v_pk_mul_f32 v[212:213], v[212:213], v[120:121] op_sel_hi:[1,0]
    v_pk_mul_f32 v[214:215], v[214:215], v[120:121] op_sel_hi:[1,0]
    v_cvt_pk_bf16_f32 v208, v208, v209
    v_cvt_pk_bf16_f32 v209, v210, v211
    v_cvt_pk_bf16_f32 v210, v212, v213
    v_cvt_pk_bf16_f32 v211, v214, v215
    buffer_store_dwordx4 v[208:211], v0, s[56:59], s90 offen offset:2048 sc1
    v_pk_add_f32 v[216:217], v[216:217], v[248:249]
    v_pk_add_f32 v[218:219], v[218:219], v[250:251]
    v_pk_add_f32 v[220:221], v[220:221], v[252:253]
    v_pk_add_f32 v[222:223], v[222:223], v[254:255]
    v_pk_mul_f32 v[216:217], v[216:217], v[122:123] op_sel_hi:[1,0]
    v_pk_mul_f32 v[218:219], v[218:219], v[122:123] op_sel_hi:[1,0]
    v_pk_mul_f32 v[220:221], v[220:221], v[122:123] op_sel_hi:[1,0]
    v_pk_mul_f32 v[222:223], v[222:223], v[122:123] op_sel_hi:[1,0]
    v_cvt_pk_bf16_f32 v216, v216, v217
    v_cvt_pk_bf16_f32 v217, v218, v219
    v_cvt_pk_bf16_f32 v218, v220, v221
    v_cvt_pk_bf16_f32 v219, v222, v223
    buffer_store_dwordx4 v[216:219], v0, s[56:59], s90 offen offset:2304 sc1
    s_waitcnt lgkmcnt(8)
    v_add_f32 v116, v116, v114
    v_add_f32 v118, v118, v115
    v_subrev_u32 v117, 0x1f800000, v116
    v_subrev_u32 v119, 0x1f800000, v118
    v_max_u32 v117, v117, v119
    v_cmp_lt_u32 vcc, 0x40000000, v117
    v_rcp_f32 v116, v116
    v_rcp_f32 v118, v118
    s_cmp_lg_u64 vcc, 0
    s_cselect_b32 s92, 0x7f000000, s92
    s_waitcnt lgkmcnt(7)
    v_pk_add_f32 v[128:129], v[128:129], v[160:161]
    v_pk_add_f32 v[130:131], v[130:131], v[162:163]
    s_waitcnt lgkmcnt(6)
    v_pk_add_f32 v[132:133], v[132:133], v[164:165]
    v_pk_add_f32 v[134:135], v[134:135], v[166:167]
    v_pk_mul_f32 v[128:129], v[128:129], v[116:117] op_sel_hi:[1,0]
    v_pk_mul_f32 v[130:131], v[130:131], v[116:117] op_sel_hi:[1,0]
    v_pk_mul_f32 v[132:133], v[132:133], v[116:117] op_sel_hi:[1,0]
    v_pk_mul_f32 v[134:135], v[134:135], v[116:117] op_sel_hi:[1,0]
    v_cvt_pk_bf16_f32 v128, v128, v129
    v_cvt_pk_bf16_f32 v129, v130, v131
    v_cvt_pk_bf16_f32 v130, v132, v133
    v_cvt_pk_bf16_f32 v131, v134, v135
    buffer_store_dwordx4 v[128:131], v0, s[56:59], s92 offen sc1
    s_waitcnt lgkmcnt(5)
    v_pk_add_f32 v[136:137], v[136:137], v[168:169]
    v_pk_add_f32 v[138:139], v[138:139], v[170:171]
    s_waitcnt lgkmcnt(4)
    v_pk_add_f32 v[140:141], v[140:141], v[172:173]
    v_pk_add_f32 v[142:143], v[142:143], v[174:175]
    v_pk_mul_f32 v[136:137], v[136:137], v[118:119] op_sel_hi:[1,0]
    v_pk_mul_f32 v[138:139], v[138:139], v[118:119] op_sel_hi:[1,0]
    v_pk_mul_f32 v[140:141], v[140:141], v[118:119] op_sel_hi:[1,0]
    v_pk_mul_f32 v[142:143], v[142:143], v[118:119] op_sel_hi:[1,0]
    v_cvt_pk_bf16_f32 v136, v136, v137
    v_cvt_pk_bf16_f32 v137, v138, v139
    v_cvt_pk_bf16_f32 v138, v140, v141
    v_cvt_pk_bf16_f32 v139, v142, v143
    buffer_store_dwordx4 v[136:139], v0, s[56:59], s92 offen offset:256 sc1
    s_waitcnt lgkmcnt(3)
    v_pk_add_f32 v[144:145], v[144:145], v[176:177]
    v_pk_add_f32 v[146:147], v[146:147], v[178:179]
    s_waitcnt lgkmcnt(2)
    v_pk_add_f32 v[148:149], v[148:149], v[180:181]
    v_pk_add_f32 v[150:151], v[150:151], v[182:183]
    v_pk_mul_f32 v[144:145], v[144:145], v[116:117] op_sel_hi:[1,0]
    v_pk_mul_f32 v[146:147], v[146:147], v[116:117] op_sel_hi:[1,0]
    v_pk_mul_f32 v[148:149], v[148:149], v[116:117] op_sel_hi:[1,0]
    v_pk_mul_f32 v[150:151], v[150:151], v[116:117] op_sel_hi:[1,0]
    v_cvt_pk_bf16_f32 v144, v144, v145
    v_cvt_pk_bf16_f32 v145, v146, v147
    v_cvt_pk_bf16_f32 v146, v148, v149
    v_cvt_pk_bf16_f32 v147, v150, v151
    buffer_store_dwordx4 v[144:147], v0, s[56:59], s92 offen offset:2048 sc1
    s_waitcnt lgkmcnt(1)
    v_pk_add_f32 v[152:153], v[152:153], v[184:185]
    v_pk_add_f32 v[154:155], v[154:155], v[186:187]
    s_waitcnt lgkmcnt(0)
    v_pk_add_f32 v[156:157], v[156:157], v[188:189]
    v_pk_add_f32 v[158:159], v[158:159], v[190:191]
    v_pk_mul_f32 v[152:153], v[152:153], v[118:119] op_sel_hi:[1,0]
    v_pk_mul_f32 v[154:155], v[154:155], v[118:119] op_sel_hi:[1,0]
    v_pk_mul_f32 v[156:157], v[156:157], v[118:119] op_sel_hi:[1,0]
    v_pk_mul_f32 v[158:159], v[158:159], v[118:119] op_sel_hi:[1,0]
    v_cvt_pk_bf16_f32 v152, v152, v153
    v_cvt_pk_bf16_f32 v153, v154, v155
    v_cvt_pk_bf16_f32 v154, v156, v157
    v_cvt_pk_bf16_f32 v155, v158, v159
    buffer_store_dwordx4 v[152:155], v0, s[56:59], s92 offen offset:2304 sc1
    s_branch fk_done
kU1:
    s_mov_b32 s13, 0x6000
    v_mfma_f32_16x16x32_bf16 v[32:35], a[64:67], a[32:35], v[88:91]
    buffer_load_dwordx4 a[224:227], v0, s[72:75], s13 offen sc1
    v_mfma_f32_16x16x32_bf16 v[32:35], a[68:71], a[36:39], v[32:35]
    v_exp_f32 v4, v48
    v_mfma_f32_16x16x32_bf16 v[32:35], a[72:75], a[40:43], v[32:35]
    s_cmp_eq_u32 s3, 3
    s_cselect_b32 s96, 0xf1800000, 0
    v_add_f32 v29, s96, v80
    v_mfma_f32_16x16x32_bf16 v[32:35], a[76:79], a[44:47], v[32:35]
    v_exp_f32 v5, v49
    v_mfma_f32_16x16x32_bf16 v[192:195], a[96:99], v[64:67], v[192:195]
    v_cvt_pk_bf16_f32 v72, v4, v5
    v_add_f32 v30, s96, v84
    v_mfma_f32_16x16x32_bf16 v[200:203], a[96:99], v[68:71], v[200:203]
    v_exp_f32 v6, v50
    v_mfma_f32_16x16x32_bf16 v[196:199], a[100:103], v[64:67], v[196:199]
    buffer_load_dwordx4 a[228:231], v0, s[72:75], s13 offen offset:256 sc1
    v_mfma_f32_16x16x32_bf16 v[204:207], a[100:103], v[68:71], v[204:207]
    v_exp_f32 v7, v51
    v_mfma_f32_16x16x32_bf16 v[40:43], a[64:67], a[48:51], v[92:95]
    v_cvt_pk_bf16_f32 v73, v6, v7
    v_add_f32 v48, v96, v29
    v_mfma_f32_16x16x32_bf16 v[40:43], a[68:71], a[52:55], v[40:43]
    v_exp_f32 v8, v52
    v_mfma_f32_16x16x32_bf16 v[40:43], a[72:75], a[56:59], v[40:43]
    buffer_load_dwordx4 a[232:235], v0, s[72:75], s13 offen offset:2048 sc1
    v_mfma_f32_16x16x32_bf16 v[40:43], a[76:79], a[60:63], v[40:43]
    v_exp_f32 v9, v53
    v_mfma_f32_16x16x32_bf16 v[208:211], a[104:107], v[64:67], v[208:211]
    v_cvt_pk_bf16_f32 v74, v8, v9
    v_add_f32 v49, v97, v29
    v_mfma_f32_16x16x32_bf16 v[216:219], a[104:107], v[68:71], v[216:219]
    v_exp_f32 v10, v54
    v_mfma_f32_16x16x32_bf16 v[212:215], a[108:111], v[64:67], v[212:215]
    s_waitcnt vmcnt(40)
    s_barrier
    buffer_load_dwordx4 a[236:239], v0, s[72:75], s13 offen offset:2304 sc1
    v_mfma_f32_16x16x32_bf16 v[220:223], a[108:111], v[68:71], v[220:223]
    v_exp_f32 v11, v55
    v_mfma_f32_16x16x32_bf16 v[36:39], a[80:83], a[32:35], v[88:91]
    ds_read_b128 a[64:67], v16 offset:32768
    v_cvt_pk_bf16_f32 v75, v10, v11
    v_mfma_f32_16x16x32_bf16 v[36:39], a[84:87], a[36:39], v[36:39]
    v_exp_f32 v4, v56
    v_mfma_f32_16x16x32_bf16 v[36:39], a[88:91], a[40:43], v[36:39]
    s_mov_b32 s13, 0x7000
    ds_read_b128 a[68:71], v16 offset:33792
    buffer_load_dwordx4 a[240:243], v0, s[72:75], s13 offen sc1
    v_mfma_f32_16x16x32_bf16 v[36:39], a[92:95], a[44:47], v[36:39]
    v_exp_f32 v5, v57
    v_mfma_f32_16x16x32_bf16 v[224:227], a[112:115], v[64:67], v[224:227]
    ds_read_b128 a[72:75], v16 offset:34816
    v_cvt_pk_bf16_f32 v76, v4, v5
    v_mfma_f32_16x16x32_bf16 v[232:235], a[112:115], v[68:71], v[232:235]
    v_exp_f32 v6, v58
    v_mfma_f32_16x16x32_bf16 v[228:231], a[116:119], v[64:67], v[228:231]
    ds_read_b128 a[76:79], v16 offset:35840
    buffer_load_dwordx4 a[244:247], v0, s[72:75], s13 offen offset:256 sc1
    v_mfma_f32_16x16x32_bf16 v[236:239], a[116:119], v[68:71], v[236:239]
    v_exp_f32 v7, v59
    v_mfma_f32_16x16x32_bf16 v[44:47], a[80:83], a[48:51], v[92:95]
    ds_read_b128 a[96:99], v17 offset:40960
    v_cvt_pk_bf16_f32 v77, v6, v7
    v_mfma_f32_16x16x32_bf16 v[44:47], a[84:87], a[52:55], v[44:47]
    v_exp_f32 v8, v60
    v_mfma_f32_16x16x32_bf16 v[44:47], a[88:91], a[56:59], v[44:47]
    ds_read_b128 a[100:103], v17 offset:41984
    buffer_load_dwordx4 a[248:251], v0, s[72:75], s13 offen offset:2048 sc1
    v_mfma_f32_16x16x32_bf16 v[44:47], a[92:95], a[60:63], v[44:47]
    v_exp_f32 v9, v61
    v_mfma_f32_16x16x32_bf16 v[240:243], a[120:123], v[64:67], v[240:243]
    ds_read_b128 a[104:107], v17 offset:43008
    v_cvt_pk_bf16_f32 v78, v8, v9
    v_mfma_f32_16x16x32_bf16 v[248:251], a[120:123], v[68:71], v[248:251]
    v_exp_f32 v10, v62
    v_mfma_f32_16x16x32_bf16 v[244:247], a[124:127], v[64:67], v[244:247]
    ds_read_b128 a[108:111], v17 offset:44032
    buffer_load_dwordx4 a[252:255], v0, s[72:75], s13 offen offset:2304 sc1
    v_mfma_f32_16x16x32_bf16 v[252:255], a[124:127], v[68:71], v[252:255]
    v_exp_f32 v11, v63
    v_add_f32 v50, v98, v29
    v_add_f32 v51, v99, v29
    v_smfmac_f32_16x16x64_bf16 v[120:123], v[12:15], v[64:71], v124
    s_waitcnt lgkmcnt(3)
    v_cvt_pk_bf16_f32 v79, v10, v11
    v_mfma_f32_16x16x32_bf16 v[48:51], a[64:67], a[128:131], v[48:51]
    ds_read_b128 a[80:83], v16 offset:36864
    v_add_f32 v52, v100, v29
    v_mfma_f32_16x16x32_bf16 v[48:51], a[68:71], a[132:135], v[48:51]
    v_exp_f32 v4, v32
    v_mfma_f32_16x16x32_bf16 v[48:51], a[72:75], a[136:139], v[48:51]
    ds_read_b128 a[84:87], v16 offset:37888
    v_add_f32 v53, v101, v29
    v_mfma_f32_16x16x32_bf16 v[48:51], a[76:79], a[140:143], v[48:51]
    v_exp_f32 v5, v33
    v_mfma_f32_16x16x32_bf16 v[128:131], a[96:99], v[72:75], v[128:131]
    ds_read_b128 a[88:91], v16 offset:38912
    v_cvt_pk_bf16_f32 v64, v4, v5
    v_mfma_f32_16x16x32_bf16 v[136:139], a[96:99], v[76:79], v[136:139]
    s_waitcnt lgkmcnt(3)
    v_exp_f32 v6, v34
    v_mfma_f32_16x16x32_bf16 v[132:135], a[100:103], v[72:75], v[132:135]
    ds_read_b128 a[92:95], v16 offset:39936
    v_add_f32 v54, v102, v29
    v_add_f32 v55, v103, v29
    v_add_f32 v56, v104, v30
    v_add_f32 v57, v105, v30
    v_add_f32 v58, v106, v30
    v_add_f32 v59, v107, v30
    v_mfma_f32_16x16x32_bf16 v[140:143], a[100:103], v[76:79], v[140:143]
    v_exp_f32 v7, v35
    v_mfma_f32_16x16x32_bf16 v[56:59], a[64:67], a[144:147], v[56:59]
    ds_read_b128 a[112:115], v17 offset:45056
    v_cvt_pk_bf16_f32 v65, v6, v7
    v_mfma_f32_16x16x32_bf16 v[56:59], a[68:71], a[148:151], v[56:59]
    v_exp_f32 v8, v36
    v_mfma_f32_16x16x32_bf16 v[56:59], a[72:75], a[152:155], v[56:59]
    ds_read_b128 a[116:119], v17 offset:46080
    v_add_f32 v60, v108, v30
    v_mfma_f32_16x16x32_bf16 v[56:59], a[76:79], a[156:159], v[56:59]
    v_exp_f32 v9, v37
    v_mfma_f32_16x16x32_bf16 v[144:147], a[104:107], v[72:75], v[144:147]
    ds_read_b128 a[120:123], v17 offset:47104
    v_cvt_pk_bf16_f32 v66, v8, v9
    v_mfma_f32_16x16x32_bf16 v[152:155], a[104:107], v[76:79], v[152:155]
    v_exp_f32 v10, v38
    v_mfma_f32_16x16x32_bf16 v[148:151], a[108:111], v[72:75], v[148:151]
    ds_read_b128 a[124:127], v17 offset:48128
    v_add_f32 v61, v109, v30
    v_mfma_f32_16x16x32_bf16 v[156:159], a[108:111], v[76:79], v[156:159]
    s_waitcnt lgkmcnt(4)
    v_exp_f32 v11, v39
    v_mfma_f32_16x16x32_bf16 v[52:55], a[80:83], a[128:131], v[52:55]
    s_movk_i32 s10, 0x0
    v_cvt_pk_bf16_f32 v67, v10, v11
    v_add_u32 v17, 0x10000, v16
    v_lshrrev_b32 v20, 3, v1
    v_lshrrev_b32 v21, 4, v1
    v_and_b32 v22, 7, v1
    v_lshlrev_b32 v20, 12, v20
    v_xor_b32 v21, v21, v22
    v_lshl_add_u32 v20, v21, 4, v20
    v_xor_b32 v21, 64, v20
    v_add_u32 v21, 0x7c00, v21
    v_add_u32 v22, 0xf800, v20
    v_add_u32 v23, 0xf800, v21
    v_mfma_f32_16x16x32_bf16 v[52:55], a[84:87], a[132:135], v[52:55]
    s_add_u32 m0, s14, 0x0
    v_exp_f32 v4, v40
    v_mfma_f32_16x16x32_bf16 v[52:55], a[88:91], a[136:139], v[52:55]
    buffer_load_dwordx4 v20, s[76:79], s10 offen offset:0 lds
    v_mfma_f32_16x16x32_bf16 v[52:55], a[92:95], a[140:143], v[52:55]
    s_waitcnt lgkmcnt(2)
    v_exp_f32 v5, v41
    v_mfma_f32_16x16x32_bf16 v[160:163], a[112:115], v[72:75], v[160:163]
    v_cvt_pk_bf16_f32 v68, v4, v5
    v_add_f32 v62, v110, v30
    v_mfma_f32_16x16x32_bf16 v[168:171], a[112:115], v[76:79], v[168:171]
    v_exp_f32 v6, v42
    v_mfma_f32_16x16x32_bf16 v[164:167], a[116:119], v[72:75], v[164:167]
    buffer_load_dwordx4 v21, s[76:79], s10 offen offset:1024 lds
    v_add_f32 v63, v111, v30
    v_mfma_f32_16x16x32_bf16 v[172:175], a[116:119], v[76:79], v[172:175]
    v_exp_f32 v7, v43
    v_mfma_f32_16x16x32_bf16 v[60:63], a[80:83], a[144:147], v[60:63]
    v_cvt_pk_bf16_f32 v69, v6, v7
    v_mfma_f32_16x16x32_bf16 v[60:63], a[84:87], a[148:151], v[60:63]
    v_exp_f32 v8, v44
    v_mfma_f32_16x16x32_bf16 v[60:63], a[88:91], a[152:155], v[60:63]
    buffer_load_dwordx4 v22, s[76:79], s10 offen offset:2048 lds
    v_mfma_f32_16x16x32_bf16 v[60:63], a[92:95], a[156:159], v[60:63]
    s_waitcnt lgkmcnt(0)
    v_exp_f32 v9, v45
    v_mfma_f32_16x16x32_bf16 v[176:179], a[120:123], v[72:75], v[176:179]
    v_cvt_pk_bf16_f32 v70, v8, v9
    v_mfma_f32_16x16x32_bf16 v[184:187], a[120:123], v[76:79], v[184:187]
    v_exp_f32 v10, v46
    v_mfma_f32_16x16x32_bf16 v[180:183], a[124:127], v[72:75], v[180:183]
    buffer_load_dwordx4 v23, s[76:79], s10 offen offset:3072 lds
    v_mfma_f32_16x16x32_bf16 v[188:191], a[124:127], v[76:79], v[188:191]
    v_exp_f32 v11, v47
    v_smfmac_f32_16x16x64_bf16 v[116:119], v[12:15], v[72:79], v124
    s_cmp_ge_u32 s5, 28
    s_cbranch_scc1 kU1_se
kU1_sr:
    v_cvt_pk_bf16_f32 v71, v10, v11
    v_mfma_f32_16x16x32_bf16 v[32:35], a[64:67], a[32:35], v[88:91]
    s_movk_i32 s10, 0x80
    v_mfma_f32_16x16x32_bf16 v[32:35], a[68:71], a[36:39], v[32:35]
    s_add_u32 m0, s14, 0x4000
    v_exp_f32 v4, v48
    v_mfma_f32_16x16x32_bf16 v[32:35], a[72:75], a[40:43], v[32:35]
    buffer_load_dwordx4 v20, s[76:79], s10 offen offset:0 lds
    v_mfma_f32_16x16x32_bf16 v[32:35], a[76:79], a[44:47], v[32:35]
    v_exp_f32 v5, v49
    v_mfma_f32_16x16x32_bf16 v[192:195], a[96:99], v[64:67], v[192:195]
    s_cmp_eq_u32 s3, 2
    s_cselect_b32 s96, 0xf1800000, 0
    v_cvt_pk_bf16_f32 v72, v4, v5
    v_mfma_f32_16x16x32_bf16 v[200:203], a[96:99], v[68:71], v[200:203]
    v_exp_f32 v6, v50
    v_mfma_f32_16x16x32_bf16 v[196:199], a[100:103], v[64:67], v[196:199]
    buffer_load_dwordx4 v21, s[76:79], s10 offen offset:1024 lds
    v_mfma_f32_16x16x32_bf16 v[204:207], a[100:103], v[68:71], v[204:207]
    v_exp_f32 v7, v51
    v_mfma_f32_16x16x32_bf16 v[40:43], a[64:67], a[48:51], v[92:95]
    v_cvt_pk_bf16_f32 v73, v6, v7
    v_add_f32 v29, s96, v88
    v_mfma_f32_16x16x32_bf16 v[40:43], a[68:71], a[52:55], v[40:43]
    v_exp_f32 v8, v52
    v_mfma_f32_16x16x32_bf16 v[40:43], a[72:75], a[56:59], v[40:43]
    buffer_load_dwordx4 v22, s[76:79], s10 offen offset:2048 lds
    v_mfma_f32_16x16x32_bf16 v[40:43], a[76:79], a[60:63], v[40:43]
    v_exp_f32 v9, v53
    v_mfma_f32_16x16x32_bf16 v[208:211], a[104:107], v[64:67], v[208:211]
    v_cvt_pk_bf16_f32 v74, v8, v9
    v_add_f32 v30, s96, v92
    v_mfma_f32_16x16x32_bf16 v[216:219], a[104:107], v[68:71], v[216:219]
    v_exp_f32 v10, v54
    v_mfma_f32_16x16x32_bf16 v[212:215], a[108:111], v[64:67], v[212:215]
    s_waitcnt vmcnt(32)
    s_barrier
    buffer_load_dwordx4 v23, s[76:79], s10 offen offset:3072 lds
    v_mfma_f32_16x16x32_bf16 v[220:223], a[108:111], v[68:71], v[220:223]
    s_lshl_b32 s12, s7, 2
    v_exp_f32 v11, v55
    v_mfma_f32_16x16x32_bf16 v[36:39], a[80:83], a[32:35], v[88:91]
    s_sub_u32 s90, 63, s3
    ds_read_b128 a[64:67], v17 offset:0
    v_cvt_pk_bf16_f32 v75, v10, v11
    v_mfma_f32_16x16x32_bf16 v[36:39], a[84:87], a[36:39], v[36:39]
    s_movk_i32 s10, 0x100
    v_exp_f32 v4, v56
    v_mfma_f32_16x16x32_bf16 v[36:39], a[88:91], a[40:43], v[36:39]
    s_add_u32 m0, s14, 0x8000
    ds_read_b128 a[68:71], v17 offset:1024
    buffer_load_dwordx4 v20, s[76:79], s10 offen offset:0 lds
    v_mfma_f32_16x16x32_bf16 v[36:39], a[92:95], a[44:47], v[36:39]
    s_sub_u32 s90, s90, s12
    v_exp_f32 v5, v57
    v_mfma_f32_16x16x32_bf16 v[224:227], a[112:115], v[64:67], v[224:227]
    s_mul_i32 s90, s90, 155
    ds_read_b128 a[72:75], v17 offset:2048
    v_cvt_pk_bf16_f32 v76, v4, v5
    v_mfma_f32_16x16x32_bf16 v[232:235], a[112:115], v[68:71], v[232:235]
    s_lshl_b32 s12, s6, 2
    v_exp_f32 v6, v58
    v_mfma_f32_16x16x32_bf16 v[228:231], a[116:119], v[64:67], v[228:231]
    s_add_u32 s90, s90, s12
    ds_read_b128 a[76:79], v17 offset:3072
    buffer_load_dwordx4 v21, s[76:79], s10 offen offset:1024 lds
    v_mfma_f32_16x16x32_bf16 v[236:239], a[116:119], v[68:71], v[236:239]
    s_lshl_b32 s90, s90, 11
    v_exp_f32 v7, v59
    v_mfma_f32_16x16x32_bf16 v[44:47], a[80:83], a[48:51], v[92:95]
    s_add_u32 s90, s90, 0x1000
    ds_read_b128 a[96:99], v17 offset:8192
    v_cvt_pk_bf16_f32 v77, v6, v7
    v_mfma_f32_16x16x32_bf16 v[44:47], a[84:87], a[52:55], v[44:47]
    s_lshl_b32 s12, s7, 2
    v_exp_f32 v8, v60
    v_mfma_f32_16x16x32_bf16 v[44:47], a[88:91], a[56:59], v[44:47]
    s_add_u32 s92, 60, s3
    ds_read_b128 a[100:103], v17 offset:9216
    buffer_load_dwordx4 v22, s[76:79], s10 offen offset:2048 lds
    v_mfma_f32_16x16x32_bf16 v[44:47], a[92:95], a[60:63], v[44:47]
    s_sub_u32 s92, s92, s12
    v_exp_f32 v9, v61
    v_mfma_f32_16x16x32_bf16 v[240:243], a[120:123], v[64:67], v[240:243]
    s_mul_i32 s92, s92, 155
    ds_read_b128 a[104:107], v17 offset:10240
    v_cvt_pk_bf16_f32 v78, v8, v9
    v_mfma_f32_16x16x32_bf16 v[248:251], a[120:123], v[68:71], v[248:251]
    s_lshl_b32 s12, s6, 2
    v_exp_f32 v10, v62
    v_mfma_f32_16x16x32_bf16 v[244:247], a[124:127], v[64:67], v[244:247]
    s_add_u32 s92, s92, s12
    ds_read_b128 a[108:111], v17 offset:11264
    buffer_load_dwordx4 v23, s[76:79], s10 offen offset:3072 lds
    v_mfma_f32_16x16x32_bf16 v[252:255], a[124:127], v[68:71], v[252:255]
    s_lshl_b32 s92, s92, 11
    v_exp_f32 v11, v63
    v_add_f32 v48, v96, v29
    v_add_f32 v49, v97, v29
    v_add_f32 v50, v98, v29
    v_add_f32 v51, v99, v29
    v_smfmac_f32_16x16x64_bf16 v[120:123], v[12:15], v[64:71], v124
    s_add_u32 s92, s92, 0x1000
    v_cvt_pk_bf16_f32 v79, v10, v11
    s_waitcnt lgkmcnt(3)
    v_mfma_f32_16x16x32_bf16 v[48:51], a[64:67], a[32:35], v[48:51]
    s_lshl_b32 s12, s3, 13
    ds_read_b128 a[80:83], v17 offset:4096
    v_add_f32 v52, v100, v29
    v_mfma_f32_16x16x32_bf16 v[48:51], a[68:71], a[36:39], v[48:51]
    s_add_u32 s12, s12, 0x18000
    v_exp_f32 v4, v32
    v_mfma_f32_16x16x32_bf16 v[48:51], a[72:75], a[40:43], v[48:51]
    ds_read_b128 a[84:87], v17 offset:5120
    v_add_f32 v53, v101, v29
    v_mfma_f32_16x16x32_bf16 v[48:51], a[76:79], a[44:47], v[48:51]
    v_exp_f32 v5, v33
    v_mfma_f32_16x16x32_bf16 v[128:131], a[96:99], v[72:75], v[128:131]
    ds_read_b128 a[88:91], v17 offset:6144
    v_cvt_pk_bf16_f32 v64, v4, v5
    v_mfma_f32_16x16x32_bf16 v[136:139], a[96:99], v[76:79], v[136:139]
    s_waitcnt lgkmcnt(3)
    v_exp_f32 v6, v34
    v_mfma_f32_16x16x32_bf16 v[132:135], a[100:103], v[72:75], v[132:135]
    ds_read_b128 a[92:95], v17 offset:7168
    v_add_f32 v54, v102, v29
    v_add_f32 v55, v103, v29
    v_add_f32 v56, v104, v30
    v_add_f32 v57, v105, v30
    v_add_f32 v58, v106, v30
    v_add_f32 v59, v107, v30
    v_mfma_f32_16x16x32_bf16 v[140:143], a[100:103], v[76:79], v[140:143]
    v_exp_f32 v7, v35
    v_mfma_f32_16x16x32_bf16 v[56:59], a[64:67], a[48:51], v[56:59]
    ds_read_b128 a[112:115], v17 offset:12288
    v_cvt_pk_bf16_f32 v65, v6, v7
    v_mfma_f32_16x16x32_bf16 v[56:59], a[68:71], a[52:55], v[56:59]
    v_exp_f32 v8, v36
    v_mfma_f32_16x16x32_bf16 v[56:59], a[72:75], a[56:59], v[56:59]
    ds_read_b128 a[116:119], v17 offset:13312
    v_add_f32 v60, v108, v30
    v_mfma_f32_16x16x32_bf16 v[56:59], a[76:79], a[60:63], v[56:59]
    v_exp_f32 v9, v37
    v_mfma_f32_16x16x32_bf16 v[144:147], a[104:107], v[72:75], v[144:147]
    ds_read_b128 a[120:123], v17 offset:14336
    v_cvt_pk_bf16_f32 v66, v8, v9
    v_mfma_f32_16x16x32_bf16 v[152:155], a[104:107], v[76:79], v[152:155]
    s_movk_i32 s10, 0x180
    v_exp_f32 v10, v38
    v_mfma_f32_16x16x32_bf16 v[148:151], a[108:111], v[72:75], v[148:151]
    s_add_u32 m0, s14, 0xc000
    ds_read_b128 a[124:127], v17 offset:15360
    buffer_load_dwordx4 v20, s[76:79], s10 offen offset:0 lds
    v_mfma_f32_16x16x32_bf16 v[156:159], a[108:111], v[76:79], v[156:159]
    s_waitcnt lgkmcnt(4)
    v_exp_f32 v11, v39
    v_mfma_f32_16x16x32_bf16 v[52:55], a[80:83], a[32:35], v[52:55]
    v_cvt_pk_bf16_f32 v67, v10, v11
    v_add_f32 v61, v109, v30
    v_mfma_f32_16x16x32_bf16 v[52:55], a[84:87], a[36:39], v[52:55]
    v_exp_f32 v4, v40
    v_mfma_f32_16x16x32_bf16 v[52:55], a[88:91], a[40:43], v[52:55]
    buffer_load_dwordx4 v21, s[76:79], s10 offen offset:1024 lds
    v_mfma_f32_16x16x32_bf16 v[52:55], a[92:95], a[44:47], v[52:55]
    s_waitcnt lgkmcnt(2)
    v_exp_f32 v5, v41
    v_mfma_f32_16x16x32_bf16 v[160:163], a[112:115], v[72:75], v[160:163]
    v_cvt_pk_bf16_f32 v68, v4, v5
    v_add_f32 v62, v110, v30
    v_mfma_f32_16x16x32_bf16 v[168:171], a[112:115], v[76:79], v[168:171]
    v_exp_f32 v6, v42
    v_mfma_f32_16x16x32_bf16 v[164:167], a[116:119], v[72:75], v[164:167]
    buffer_load_dwordx4 v22, s[76:79], s10 offen offset:2048 lds
    v_add_f32 v63, v111, v30
    v_mfma_f32_16x16x32_bf16 v[172:175], a[116:119], v[76:79], v[172:175]
    v_exp_f32 v7, v43
    v_mfma_f32_16x16x32_bf16 v[60:63], a[80:83], a[48:51], v[60:63]
    v_cvt_pk_bf16_f32 v69, v6, v7
    v_add_u32 v18, s12, v2
    v_mfma_f32_16x16x32_bf16 v[60:63], a[84:87], a[52:55], v[60:63]
    s_xor_b32 s12, s3, 3
    s_lshl_b32 s12, s12, 13
    s_add_u32 s12, s12, 0x18000
    v_exp_f32 v8, v44
    v_add_u32 v19, s12, v2
    v_mfma_f32_16x16x32_bf16 v[60:63], a[88:91], a[56:59], v[60:63]
    s_lshl_b32 s12, s3, 10
    s_add_u32 s12, s12, 0x18000
    buffer_load_dwordx4 v23, s[76:79], s10 offen offset:3072 lds
    v_add_u32 v25, s12, v2
    v_xor_b32 v26, 0xc00, v25
    v_mfma_f32_16x16x32_bf16 v[60:63], a[92:95], a[60:63], v[60:63]
    s_waitcnt lgkmcnt(1)
    v_exp_f32 v9, v45
    v_mfma_f32_16x16x32_bf16 v[176:179], a[120:123], v[72:75], v[176:179]
    s_waitcnt lgkmcnt(0)
    s_waitcnt vmcnt(24)
    s_barrier
    v_cvt_pk_bf16_f32 v70, v8, v9
    v_mfma_f32_16x16x32_bf16 v[184:187], a[120:123], v[76:79], v[184:187]
    ds_read_b128 a[64:67], v17 offset:40960
    v_exp_f32 v10, v46
    v_mfma_f32_16x16x32_bf16 v[180:183], a[124:127], v[72:75], v[180:183]
    v_mfma_f32_16x16x32_bf16 v[188:191], a[124:127], v[76:79], v[188:191]
    ds_read_b128 a[68:71], v17 offset:41984
    v_exp_f32 v11, v47
    v_smfmac_f32_16x16x64_bf16 v[116:119], v[12:15], v[72:79], v124
    ds_read_b128 a[72:75], v17 offset:43008
    v_cvt_pk_bf16_f32 v71, v10, v11
    v_mfma_f32_16x16x32_bf16 v[192:195], a[96:99], v[64:67], v[192:195]
    v_exp_f32 v4, v48
    v_mfma_f32_16x16x32_bf16 v[200:203], a[96:99], v[68:71], v[200:203]
    s_mov_b32 s13, 0x8000
    ds_read_b128 a[76:79], v17 offset:44032
    buffer_load_dwordx4 a[128:131], v0, s[72:75], s13 offen sc1
    v_exp_f32 v5, v49
    v_mfma_f32_16x16x32_bf16 v[196:199], a[100:103], v[64:67], v[196:199]
    ds_read_b128 a[80:83], v17 offset:45056
    v_exp_f32 v6, v50
    v_mfma_f32_16x16x32_bf16 v[204:207], a[100:103], v[68:71], v[204:207]
    ds_read_b128 a[84:87], v17 offset:46080
    v_exp_f32 v7, v51
    v_cvt_pk_bf16_f32 v72, v4, v5
    v_mfma_f32_16x16x32_bf16 v[208:211], a[104:107], v[64:67], v[208:211]
    s_movk_i32 s10, 0x200
    ds_read_b128 a[88:91], v17 offset:47104
    buffer_load_dwordx4 a[132:135], v0, s[72:75], s13 offen offset:256 sc1
    v_exp_f32 v8, v52
    v_mfma_f32_16x16x32_bf16 v[216:219], a[104:107], v[68:71], v[216:219]
    s_add_u32 m0, s14, 0x10000
    ds_read_b128 a[92:95], v17 offset:48128
    v_exp_f32 v9, v53
    v_cvt_pk_bf16_f32 v73, v6, v7
    v_mfma_f32_16x16x32_bf16 v[212:215], a[108:111], v[64:67], v[212:215]
    buffer_load_dwordx4 v20, s[76:79], s10 offen offset:0 lds
    v_exp_f32 v10, v54
    v_mfma_f32_16x16x32_bf16 v[220:223], a[108:111], v[68:71], v[220:223]
    buffer_load_dwordx4 a[136:139], v0, s[72:75], s13 offen offset:2048 sc1
    v_exp_f32 v11, v55
    v_cvt_pk_bf16_f32 v74, v8, v9
    v_mfma_f32_16x16x32_bf16 v[224:227], a[112:115], v[64:67], v[224:227]
    v_exp_f32 v4, v56
    v_mfma_f32_16x16x32_bf16 v[232:235], a[112:115], v[68:71], v[232:235]
    buffer_load_dwordx4 v21, s[76:79], s10 offen offset:1024 lds
    v_exp_f32 v5, v57
    v_cvt_pk_bf16_f32 v75, v10, v11
    v_mfma_f32_16x16x32_bf16 v[228:231], a[116:119], v[64:67], v[228:231]
    buffer_load_dwordx4 a[140:143], v0, s[72:75], s13 offen offset:2304 sc1
    v_exp_f32 v6, v58
    v_mfma_f32_16x16x32_bf16 v[236:239], a[116:119], v[68:71], v[236:239]
    s_mov_b32 s13, 0x9000
    v_exp_f32 v7, v59
    v_cvt_pk_bf16_f32 v76, v4, v5
    v_mfma_f32_16x16x32_bf16 v[240:243], a[120:123], v[64:67], v[240:243]
    buffer_load_dwordx4 v22, s[76:79], s10 offen offset:2048 lds
    ds_write_b128 v18, v[128:131] offset:32768
    ds_write_b128 v18, v[132:135] offset:33792
    ds_write_b128 v18, v[136:139] offset:34816
    ds_write_b128 v18, v[140:143] offset:35840
    v_exp_f32 v8, v60
    v_add_f32 v116, v116, v117
    v_add_f32 v118, v118, v119
    v_mfma_f32_16x16x32_bf16 v[248:251], a[120:123], v[68:71], v[248:251]
    buffer_load_dwordx4 a[144:147], v0, s[72:75], s13 offen sc1
    ds_write2_b32 v25, v116, v118 offset0:0 offset1:1
    ds_write_b128 v18, v[144:147] offset:36864
    ds_write_b128 v18, v[148:151] offset:37888
    ds_write_b128 v18, v[152:155] offset:38912
    ds_write_b128 v18, v[156:159] offset:39936
    v_exp_f32 v9, v61
    v_cvt_pk_bf16_f32 v77, v6, v7
    v_mfma_f32_16x16x32_bf16 v[244:247], a[124:127], v[64:67], v[244:247]
    v_exp_f32 v10, v62
    v_mfma_f32_16x16x32_bf16 v[252:255], a[124:127], v[68:71], v[252:255]
    v_exp_f32 v11, v63
    v_cvt_pk_bf16_f32 v78, v8, v9
    v_smfmac_f32_16x16x64_bf16 v[120:123], v[12:15], v[64:71], v124
    s_waitcnt lgkmcnt(0)
    s_barrier
    ds_read_b64 v[112:113], v26 offset:0
    ds_read_b128 v[128:131], v19 offset:32768
    v_cvt_pk_bf16_f32 v79, v10, v11
    s_nop 1
    v_smfmac_f32_16x16x64_bf16 v[120:123], v[12:15], v[72:79], v124
    ds_read_b128 v[132:135], v19 offset:33792
    ds_read_b128 v[136:139], v19 offset:34816
    ds_read_b128 v[140:143], v19 offset:35840
    ds_read_b128 v[144:147], v19 offset:36864
    ds_read_b128 v[148:151], v19 offset:37888
    ds_read_b128 v[152:155], v19 offset:38912
    ds_read_b128 v[156:159], v19 offset:39936
    v_mfma_f32_16x16x32_bf16 v[192:195], a[64:67], v[72:75], v[192:195]
    buffer_load_dwordx4 v23, s[76:79], s10 offen offset:3072 lds
    v_mfma_f32_16x16x32_bf16 v[200:203], a[64:67], v[76:79], v[200:203]
    buffer_load_dwordx4 a[148:151], v0, s[72:75], s13 offen offset:256 sc1
    v_mfma_f32_16x16x32_bf16 v[196:199], a[68:71], v[72:75], v[196:199]
    s_movk_i32 s10, 0x280
    s_add_u32 m0, s14, 0x14000
    s_nop 0
    buffer_load_dwordx4 v20, s[76:79], s10 offen offset:0 lds
    v_mfma_f32_16x16x32_bf16 v[204:207], a[68:71], v[76:79], v[204:207]
    buffer_load_dwordx4 a[152:155], v0, s[72:75], s13 offen offset:2048 sc1
    v_mfma_f32_16x16x32_bf16 v[208:211], a[72:75], v[72:75], v[208:211]
    buffer_load_dwordx4 v21, s[76:79], s10 offen offset:1024 lds
    v_mfma_f32_16x16x32_bf16 v[216:219], a[72:75], v[76:79], v[216:219]
    buffer_load_dwordx4 a[156:159], v0, s[72:75], s13 offen offset:2304 sc1
    v_mfma_f32_16x16x32_bf16 v[212:215], a[76:79], v[72:75], v[212:215]
    v_add_f32 v120, v120, v121
    v_add_f32 v122, v122, v123
    v_mfma_f32_16x16x32_bf16 v[220:223], a[76:79], v[76:79], v[220:223]
    buffer_load_dwordx4 v22, s[76:79], s10 offen offset:2048 lds
    v_mfma_f32_16x16x32_bf16 v[224:227], a[80:83], v[72:75], v[224:227]
    ds_write2_b32 v25, v120, v122 offset0:2 offset1:3
    v_mfma_f32_16x16x32_bf16 v[232:235], a[80:83], v[76:79], v[232:235]
    ds_write_b128 v19, v[192:195] offset:32768
    v_mfma_f32_16x16x32_bf16 v[228:231], a[84:87], v[72:75], v[228:231]
    buffer_load_dwordx4 v23, s[76:79], s10 offen offset:3072 lds
    v_mfma_f32_16x16x32_bf16 v[236:239], a[84:87], v[76:79], v[236:239]
    ds_write_b128 v19, v[200:203] offset:34816
    v_mfma_f32_16x16x32_bf16 v[240:243], a[88:91], v[72:75], v[240:243]
    ds_write_b128 v19, v[196:199] offset:33792
    v_mfma_f32_16x16x32_bf16 v[248:251], a[88:91], v[76:79], v[248:251]
    ds_write_b128 v19, v[204:207] offset:35840
    v_mfma_f32_16x16x32_bf16 v[244:247], a[92:95], v[72:75], v[244:247]
    ds_write_b128 v19, v[208:211] offset:36864
    v_mfma_f32_16x16x32_bf16 v[252:255], a[92:95], v[76:79], v[252:255]
    ds_write_b128 v19, v[216:219] offset:38912
    ds_write_b128 v19, v[212:215] offset:37888
    ds_write_b128 v19, v[220:223] offset:39936
    s_waitcnt lgkmcnt(15)
    v_add_f32 v116, v116, v112
    v_add_f32 v118, v118, v113
    v_subrev_u32 v117, 0x1f800000, v116
    v_subrev_u32 v119, 0x1f800000, v118
    v_max_u32 v117, v117, v119
    v_cmp_lt_u32 vcc, 0x40000000, v117
    v_rcp_f32 v116, v116
    v_rcp_f32 v118, v118
    s_cmp_lg_u64 vcc, 0
    s_cselect_b32 s90, 0x7f000000, s90
    v_pk_add_f32 v[160:161], v[160:161], v[128:129]
    v_pk_add_f32 v[162:163], v[162:163], v[130:131]
    v_pk_add_f32 v[164:165], v[164:165], v[132:133]
    v_pk_add_f32 v[166:167], v[166:167], v[134:135]
    v_pk_mul_f32 v[160:161], v[160:161], v[116:117] op_sel_hi:[1,0]
    v_pk_mul_f32 v[162:163], v[162:163], v[116:117] op_sel_hi:[1,0]
    v_pk_mul_f32 v[164:165], v[164:165], v[116:117] op_sel_hi:[1,0]
    v_pk_mul_f32 v[166:167], v[166:167], v[116:117] op_sel_hi:[1,0]
    v_cvt_pk_bf16_f32 v160, v160, v161
    v_cvt_pk_bf16_f32 v161, v162, v163
    v_cvt_pk_bf16_f32 v162, v164, v165
    v_cvt_pk_bf16_f32 v163, v166, v167
    s_waitcnt vmcnt(24) lgkmcnt(0)
    s_barrier
    ds_read_b64 v[114:115], v26 offset:8
    ds_read_b128 v[192:195], v18 offset:32768
    ds_read_b128 v[196:199], v18 offset:33792
    ds_read_b128 v[200:203], v18 offset:34816
    ds_read_b128 v[204:207], v18 offset:35840
    ds_read_b128 v[208:211], v18 offset:36864
    ds_read_b128 v[212:215], v18 offset:37888
    ds_read_b128 v[216:219], v18 offset:38912
    ds_read_b128 v[220:223], v18 offset:39936
    buffer_store_dwordx4 v[160:163], v0, s[56:59], s90 offen sc1
    v_pk_add_f32 v[168:169], v[168:169], v[136:137]
    v_pk_add_f32 v[170:171], v[170:171], v[138:139]
    v_pk_add_f32 v[172:173], v[172:173], v[140:141]
    v_pk_add_f32 v[174:175], v[174:175], v[142:143]
    v_pk_mul_f32 v[168:169], v[168:169], v[118:119] op_sel_hi:[1,0]
    v_pk_mul_f32 v[170:171], v[170:171], v[118:119] op_sel_hi:[1,0]
    v_pk_mul_f32 v[172:173], v[172:173], v[118:119] op_sel_hi:[1,0]
    v_pk_mul_f32 v[174:175], v[174:175], v[118:119] op_sel_hi:[1,0]
    v_cvt_pk_bf16_f32 v168, v168, v169
    v_cvt_pk_bf16_f32 v169, v170, v171
    v_cvt_pk_bf16_f32 v170, v172, v173
    v_cvt_pk_bf16_f32 v171, v174, v175
    buffer_store_dwordx4 v[168:171], v0, s[56:59], s90 offen offset:256 sc1
    v_pk_add_f32 v[176:177], v[176:177], v[144:145]
    v_pk_add_f32 v[178:179], v[178:179], v[146:147]
    v_pk_add_f32 v[180:181], v[180:181], v[148:149]
    v_pk_add_f32 v[182:183], v[182:183], v[150:151]
    v_pk_mul_f32 v[176:177], v[176:177], v[116:117] op_sel_hi:[1,0]
    v_pk_mul_f32 v[178:179], v[178:179], v[116:117] op_sel_hi:[1,0]
    v_pk_mul_f32 v[180:181], v[180:181], v[116:117] op_sel_hi:[1,0]
    v_pk_mul_f32 v[182:183], v[182:183], v[116:117] op_sel_hi:[1,0]
    v_cvt_pk_bf16_f32 v176, v176, v177
    v_cvt_pk_bf16_f32 v177, v178, v179
    v_cvt_pk_bf16_f32 v178, v180, v181
    v_cvt_pk_bf16_f32 v179, v182, v183
    buffer_store_dwordx4 v[176:179], v0, s[56:59], s90 offen offset:2048 sc1
    v_pk_add_f32 v[184:185], v[184:185], v[152:153]
    v_pk_add_f32 v[186:187], v[186:187], v[154:155]
    v_pk_add_f32 v[188:189], v[188:189], v[156:157]
    v_pk_add_f32 v[190:191], v[190:191], v[158:159]
    v_pk_mul_f32 v[184:185], v[184:185], v[118:119] op_sel_hi:[1,0]
    v_pk_mul_f32 v[186:187], v[186:187], v[118:119] op_sel_hi:[1,0]
    v_pk_mul_f32 v[188:189], v[188:189], v[118:119] op_sel_hi:[1,0]
    v_pk_mul_f32 v[190:191], v[190:191], v[118:119] op_sel_hi:[1,0]
    v_cvt_pk_bf16_f32 v184, v184, v185
    v_cvt_pk_bf16_f32 v185, v186, v187
    v_cvt_pk_bf16_f32 v186, v188, v189
    v_cvt_pk_bf16_f32 v187, v190, v191
    buffer_store_dwordx4 v[184:187], v0, s[56:59], s90 offen offset:2304 sc1
    s_waitcnt lgkmcnt(8)
    v_add_f32 v120, v120, v114
    v_add_f32 v122, v122, v115
    v_subrev_u32 v121, 0x1f800000, v120
    v_subrev_u32 v123, 0x1f800000, v122
    v_max_u32 v121, v121, v123
    v_cmp_lt_u32 vcc, 0x40000000, v121
    v_rcp_f32 v120, v120
    v_rcp_f32 v122, v122
    s_cmp_lg_u64 vcc, 0
    s_cselect_b32 s92, 0x7f000000, s92
    s_cselect_b32 s11, 2, 0
    s_or_b32 s95, s95, s11
    s_waitcnt lgkmcnt(7)
    v_pk_add_f32 v[224:225], v[224:225], v[192:193]
    v_pk_add_f32 v[226:227], v[226:227], v[194:195]
    s_waitcnt lgkmcnt(6)
    v_pk_add_f32 v[228:229], v[228:229], v[196:197]
    v_pk_add_f32 v[230:231], v[230:231], v[198:199]
    v_pk_mul_f32 v[224:225], v[224:225], v[120:121] op_sel_hi:[1,0]
    v_pk_mul_f32 v[226:227], v[226:227], v[120:121] op_sel_hi:[1,0]
    v_pk_mul_f32 v[228:229], v[228:229], v[120:121] op_sel_hi:[1,0]
    v_pk_mul_f32 v[230:231], v[230:231], v[120:121] op_sel_hi:[1,0]
    v_cvt_pk_bf16_f32 v224, v224, v225
    v_cvt_pk_bf16_f32 v225, v226, v227
    v_cvt_pk_bf16_f32 v226, v228, v229
    v_cvt_pk_bf16_f32 v227, v230, v231
    buffer_store_dwordx4 v[224:227], v0, s[56:59], s92 offen sc1
    s_waitcnt lgkmcnt(5)
    v_pk_add_f32 v[232:233], v[232:233], v[200:201]
    v_pk_add_f32 v[234:235], v[234:235], v[202:203]
    s_waitcnt lgkmcnt(4)
    v_pk_add_f32 v[236:237], v[236:237], v[204:205]
    v_pk_add_f32 v[238:239], v[238:239], v[206:207]
    v_pk_mul_f32 v[232:233], v[232:233], v[122:123] op_sel_hi:[1,0]
    v_pk_mul_f32 v[234:235], v[234:235], v[122:123] op_sel_hi:[1,0]
    v_pk_mul_f32 v[236:237], v[236:237], v[122:123] op_sel_hi:[1,0]
    v_pk_mul_f32 v[238:239], v[238:239], v[122:123] op_sel_hi:[1,0]
    v_cvt_pk_bf16_f32 v232, v232, v233
    v_cvt_pk_bf16_f32 v233, v234, v235
    v_cvt_pk_bf16_f32 v234, v236, v237
    v_cvt_pk_bf16_f32 v235, v238, v239
    buffer_store_dwordx4 v[232:235], v0, s[56:59], s92 offen offset:256 sc1
    s_waitcnt lgkmcnt(3)
    v_pk_add_f32 v[240:241], v[240:241], v[208:209]
    v_pk_add_f32 v[242:243], v[242:243], v[210:211]
    s_waitcnt lgkmcnt(2)
    v_pk_add_f32 v[244:245], v[244:245], v[212:213]
    v_pk_add_f32 v[246:247], v[246:247], v[214:215]
    v_pk_mul_f32 v[240:241], v[240:241], v[120:121] op_sel_hi:[1,0]
    v_pk_mul_f32 v[242:243], v[242:243], v[120:121] op_sel_hi:[1,0]
    v_pk_mul_f32 v[244:245], v[244:245], v[120:121] op_sel_hi:[1,0]
    v_pk_mul_f32 v[246:247], v[246:247], v[120:121] op_sel_hi:[1,0]
    v_cvt_pk_bf16_f32 v240, v240, v241
    v_cvt_pk_bf16_f32 v241, v242, v243
    v_cvt_pk_bf16_f32 v242, v244, v245
    v_cvt_pk_bf16_f32 v243, v246, v247
    buffer_store_dwordx4 v[240:243], v0, s[56:59], s92 offen offset:2048 sc1
    s_waitcnt lgkmcnt(1)
    v_pk_add_f32 v[248:249], v[248:249], v[216:217]
    v_pk_add_f32 v[250:251], v[250:251], v[218:219]
    s_waitcnt lgkmcnt(0)
    v_pk_add_f32 v[252:253], v[252:253], v[220:221]
    v_pk_add_f32 v[254:255], v[254:255], v[222:223]
    v_pk_mul_f32 v[248:249], v[248:249], v[122:123] op_sel_hi:[1,0]
    v_pk_mul_f32 v[250:251], v[250:251], v[122:123] op_sel_hi:[1,0]
    v_pk_mul_f32 v[252:253], v[252:253], v[122:123] op_sel_hi:[1,0]
    v_pk_mul_f32 v[254:255], v[254:255], v[122:123] op_sel_hi:[1,0]
    v_cvt_pk_bf16_f32 v248, v248, v249
    v_cvt_pk_bf16_f32 v249, v250, v251
    v_cvt_pk_bf16_f32 v250, v252, v253
    v_cvt_pk_bf16_f32 v251, v254, v255
    buffer_store_dwordx4 v[248:251], v0, s[56:59], s92 offen offset:2304 sc1
fk_done:
    s_cmp_lg_u32 s95, 0
    s_cbranch_scc1 kSL
kSLr:
    s_branch fk_g
fk_zs:
    s_waitcnt vmcnt(0) lgkmcnt(0)
    s_barrier
    s_xor_b32 m0, s14, 0x20000
    s_mov_b32 s10, 0x0
    buffer_load_dwordx4 v8, s[48:51], s10 offen offset:0 lds
    buffer_load_dwordx4 v9, s[48:51], s10 offen offset:1024 lds
    buffer_load_dwordx4 v10, s[48:51], s10 offen offset:2048 lds
    buffer_load_dwordx4 v11, s[48:51], s10 offen offset:3072 lds
    s_xor_b32 m0, s14, 0x24000
    s_mov_b32 s10, 0x80000
    buffer_load_dwordx4 v8, s[48:51], s10 offen offset:0 lds
    buffer_load_dwordx4 v9, s[48:51], s10 offen offset:1024 lds
    buffer_load_dwordx4 v10, s[48:51], s10 offen offset:2048 lds
    buffer_load_dwordx4 v11, s[48:51], s10 offen offset:3072 lds
    s_xor_b32 m0, s15, 0x18000
    s_mov_b32 s10, 0x100000
    buffer_load_dwordx4 v8, s[48:51], s10 offen offset:0 lds
    buffer_load_dwordx4 v9, s[48:51], s10 offen offset:1024 lds
    buffer_load_dwordx4 v10, s[48:51], s10 offen offset:2048 lds
    buffer_load_dwordx4 v11, s[48:51], s10 offen offset:3072 lds
    v_accvgpr_read_b32 v144, a128
    v_accvgpr_read_b32 v145, a129
    v_accvgpr_read_b32 v146, a130
    v_accvgpr_read_b32 v147, a131
    v_accvgpr_read_b32 v148, a132
    v_accvgpr_read_b32 v149, a133
    v_accvgpr_read_b32 v150, a134
    v_accvgpr_read_b32 v151, a135
    v_accvgpr_read_b32 v152, a136
    v_accvgpr_read_b32 v153, a137
    v_accvgpr_read_b32 v154, a138
    v_accvgpr_read_b32 v155, a139
    v_accvgpr_read_b32 v156, a140
    v_accvgpr_read_b32 v157, a141
    v_accvgpr_read_b32 v158, a142
    v_accvgpr_read_b32 v159, a143
    v_cvt_pk_bf16_f32 v160, v144, v145
    v_cvt_pk_bf16_f32 v161, v146, v147
    v_cvt_pk_bf16_f32 v162, v148, v149
    v_cvt_pk_bf16_f32 v163, v150, v151
    s_mov_b32 s13, 0x0
    buffer_store_dwordx4 v[160:163], v26, s[88:91], s13 offen sc1
    v_cvt_pk_bf16_f32 v164, v152, v153
    v_cvt_pk_bf16_f32 v165, v154, v155
    v_cvt_pk_bf16_f32 v166, v156, v157
    v_cvt_pk_bf16_f32 v167, v158, v159
    v_accvgpr_read_b32 v144, a192
    v_accvgpr_read_b32 v145, a193
    v_accvgpr_read_b32 v146, a194
    v_accvgpr_read_b32 v147, a195
    v_accvgpr_read_b32 v148, a196
    v_accvgpr_read_b32 v149, a197
    v_accvgpr_read_b32 v150, a198
    v_accvgpr_read_b32 v151, a199
    v_accvgpr_read_b32 v152, a200
    v_accvgpr_read_b32 v153, a201
    v_accvgpr_read_b32 v154, a202
    v_accvgpr_read_b32 v155, a203
    v_accvgpr_read_b32 v156, a204
    v_accvgpr_read_b32 v157, a205
    v_accvgpr_read_b32 v158, a206
    v_accvgpr_read_b32 v159, a207
    v_cvt_pk_bf16_f32 v168, v144, v145
    v_cvt_pk_bf16_f32 v169, v146, v147
    v_cvt_pk_bf16_f32 v170, v148, v149
    v_cvt_pk_bf16_f32 v171, v150, v151
    v_cvt_pk_bf16_f32 v172, v152, v153
    v_cvt_pk_bf16_f32 v173, v154, v155
    v_cvt_pk_bf16_f32 v174, v156, v157
    v_cvt_pk_bf16_f32 v175, v158, v159
    buffer_store_dwordx4 v[164:167], v26, s[88:91], s13 offen offset:1024 sc1
    v_accvgpr_write_b32 a192, v168
    v_accvgpr_write_b32 a193, v169
    v_accvgpr_write_b32 a194, v170
    v_accvgpr_write_b32 a195, v171
    v_accvgpr_write_b32 a196, v172
    v_accvgpr_write_b32 a197, v173
    v_accvgpr_write_b32 a198, v174
    v_accvgpr_write_b32 a199, v175
    v_accvgpr_read_b32 v144, a144
    v_accvgpr_read_b32 v145, a145
    v_accvgpr_read_b32 v146, a146
    v_accvgpr_read_b32 v147, a147
    v_accvgpr_read_b32 v148, a148
    v_accvgpr_read_b32 v149, a149
    v_accvgpr_read_b32 v150, a150
    v_accvgpr_read_b32 v151, a151
    v_accvgpr_read_b32 v152, a152
    v_accvgpr_read_b32 v153, a153
    v_accvgpr_read_b32 v154, a154
    v_accvgpr_read_b32 v155, a155
    v_accvgpr_read_b32 v156, a156
    v_accvgpr_read_b32 v157, a157
    v_accvgpr_read_b32 v158, a158
    v_accvgpr_read_b32 v159, a159
    v_cvt_pk_bf16_f32 v160, v144, v145
    v_cvt_pk_bf16_f32 v161, v146, v147
    v_cvt_pk_bf16_f32 v162, v148, v149
    v_cvt_pk_bf16_f32 v163, v150, v151
    buffer_store_dwordx4 v[160:163], v26, s[88:91], s13 offen offset:2048 sc1
    v_cvt_pk_bf16_f32 v164, v152, v153
    v_cvt_pk_bf16_f32 v165, v154, v155
    v_cvt_pk_bf16_f32 v166, v156, v157
    v_cvt_pk_bf16_f32 v167, v158, v159
    v_accvgpr_read_b32 v144, a208
    v_accvgpr_read_b32 v145, a209
    v_accvgpr_read_b32 v146, a210
    v_accvgpr_read_b32 v147, a211
    v_accvgpr_read_b32 v148, a212
    v_accvgpr_read_b32 v149, a213
    v_accvgpr_read_b32 v150, a214
    v_accvgpr_read_b32 v151, a215
    v_accvgpr_read_b32 v152, a216
    v_accvgpr_read_b32 v153, a217
    v_accvgpr_read_b32 v154, a218
    v_accvgpr_read_b32 v155, a219
    v_accvgpr_read_b32 v156, a220
    v_accvgpr_read_b32 v157, a221
    v_accvgpr_read_b32 v158, a222
    v_accvgpr_read_b32 v159, a223
    v_cvt_pk_bf16_f32 v168, v144, v145
    v_cvt_pk_bf16_f32 v169, v146, v147
    v_cvt_pk_bf16_f32 v170, v148, v149
    v_cvt_pk_bf16_f32 v171, v150, v151
    v_cvt_pk_bf16_f32 v172, v152, v153
    v_cvt_pk_bf16_f32 v173, v154, v155
    v_cvt_pk_bf16_f32 v174, v156, v157
    v_cvt_pk_bf16_f32 v175, v158, v159
    buffer_store_dwordx4 v[164:167], v26, s[88:91], s13 offen offset:3072 sc1
    v_accvgpr_write_b32 a200, v168
    v_accvgpr_write_b32 a201, v169
    v_accvgpr_write_b32 a202, v170
    v_accvgpr_write_b32 a203, v171
    v_accvgpr_write_b32 a204, v172
    v_accvgpr_write_b32 a205, v173
    v_accvgpr_write_b32 a206, v174
    v_accvgpr_write_b32 a207, v175
    v_accvgpr_read_b32 v144, a160
    v_accvgpr_read_b32 v145, a161
    v_accvgpr_read_b32 v146, a162
    v_accvgpr_read_b32 v147, a163
    v_accvgpr_read_b32 v148, a164
    v_accvgpr_read_b32 v149, a165
    v_accvgpr_read_b32 v150, a166
    v_accvgpr_read_b32 v151, a167
    v_accvgpr_read_b32 v152, a168
    v_accvgpr_read_b32 v153, a169
    v_accvgpr_read_b32 v154, a170
    v_accvgpr_read_b32 v155, a171
    v_accvgpr_read_b32 v156, a172
    v_accvgpr_read_b32 v157, a173
    v_accvgpr_read_b32 v158, a174
    v_accvgpr_read_b32 v159, a175
    v_cvt_pk_bf16_f32 v160, v144, v145
    v_cvt_pk_bf16_f32 v161, v146, v147
    v_cvt_pk_bf16_f32 v162, v148, v149
    v_cvt_pk_bf16_f32 v163, v150, v151
    s_mov_b32 s13, 0x2000
    buffer_store_dwordx4 v[160:163], v26, s[88:91], s13 offen sc1
    v_cvt_pk_bf16_f32 v164, v152, v153
    v_cvt_pk_bf16_f32 v165, v154, v155
    v_cvt_pk_bf16_f32 v166, v156, v157
    v_cvt_pk_bf16_f32 v167, v158, v159
    v_accvgpr_read_b32 v144, a224
    v_accvgpr_read_b32 v145, a225
    v_accvgpr_read_b32 v146, a226
    v_accvgpr_read_b32 v147, a227
    v_accvgpr_read_b32 v148, a228
    v_accvgpr_read_b32 v149, a229
    v_accvgpr_read_b32 v150, a230
    v_accvgpr_read_b32 v151, a231
    v_accvgpr_read_b32 v152, a232
    v_accvgpr_read_b32 v153, a233
    v_accvgpr_read_b32 v154, a234
    v_accvgpr_read_b32 v155, a235
    v_accvgpr_read_b32 v156, a236
    v_accvgpr_read_b32 v157, a237
    v_accvgpr_read_b32 v158, a238
    v_accvgpr_read_b32 v159, a239
    v_cvt_pk_bf16_f32 v168, v144, v145
    v_cvt_pk_bf16_f32 v169, v146, v147
    v_cvt_pk_bf16_f32 v170, v148, v149
    v_cvt_pk_bf16_f32 v171, v150, v151
    v_cvt_pk_bf16_f32 v172, v152, v153
    v_cvt_pk_bf16_f32 v173, v154, v155
    v_cvt_pk_bf16_f32 v174, v156, v157
    v_cvt_pk_bf16_f32 v175, v158, v159
    buffer_store_dwordx4 v[164:167], v26, s[88:91], s13 offen offset:1024 sc1
    v_accvgpr_write_b32 a208, v168
    v_accvgpr_write_b32 a209, v169
    v_accvgpr_write_b32 a210, v170
    v_accvgpr_write_b32 a211, v171
    v_accvgpr_write_b32 a212, v172
    v_accvgpr_write_b32 a213, v173
    v_accvgpr_write_b32 a214, v174
    v_accvgpr_write_b32 a215, v175
    v_accvgpr_read_b32 v144, a176
    v_accvgpr_read_b32 v145, a177
    v_accvgpr_read_b32 v146, a178
    v_accvgpr_read_b32 v147, a179
    v_accvgpr_read_b32 v148, a180
    v_accvgpr_read_b32 v149, a181
    v_accvgpr_read_b32 v150, a182
    v_accvgpr_read_b32 v151, a183
    v_accvgpr_read_b32 v152, a184
    v_accvgpr_read_b32 v153, a185
    v_accvgpr_read_b32 v154, a186
    v_accvgpr_read_b32 v155, a187
    v_accvgpr_read_b32 v156, a188
    v_accvgpr_read_b32 v157, a189
    v_accvgpr_read_b32 v158, a190
    v_accvgpr_read_b32 v159, a191
    v_cvt_pk_bf16_f32 v160, v144, v145
    v_cvt_pk_bf16_f32 v161, v146, v147
    v_cvt_pk_bf16_f32 v162, v148, v149
    v_cvt_pk_bf16_f32 v163, v150, v151
    buffer_store_dwordx4 v[160:163], v26, s[88:91], s13 offen offset:2048 sc1
    v_cvt_pk_bf16_f32 v164, v152, v153
    v_cvt_pk_bf16_f32 v165, v154, v155
    v_cvt_pk_bf16_f32 v166, v156, v157
    v_cvt_pk_bf16_f32 v167, v158, v159
    v_accvgpr_read_b32 v144, a240
    v_accvgpr_read_b32 v145, a241
    v_accvgpr_read_b32 v146, a242
    v_accvgpr_read_b32 v147, a243
    v_accvgpr_read_b32 v148, a244
    v_accvgpr_read_b32 v149, a245
    v_accvgpr_read_b32 v150, a246
    v_accvgpr_read_b32 v151, a247
    v_accvgpr_read_b32 v152, a248
    v_accvgpr_read_b32 v153, a249
    v_accvgpr_read_b32 v154, a250
    v_accvgpr_read_b32 v155, a251
    v_accvgpr_read_b32 v156, a252
    v_accvgpr_read_b32 v157, a253
    v_accvgpr_read_b32 v158, a254
    v_accvgpr_read_b32 v159, a255
    v_cvt_pk_bf16_f32 v168, v144, v145
    v_cvt_pk_bf16_f32 v169, v146, v147
    v_cvt_pk_bf16_f32 v170, v148, v149
    v_cvt_pk_bf16_f32 v171, v150, v151
    v_cvt_pk_bf16_f32 v172, v152, v153
    v_cvt_pk_bf16_f32 v173, v154, v155
    v_cvt_pk_bf16_f32 v174, v156, v157
    v_cvt_pk_bf16_f32 v175, v158, v159
    buffer_store_dwordx4 v[164:167], v26, s[88:91], s13 offen offset:3072 sc1
    v_accvgpr_write_b32 a216, v168
    v_accvgpr_write_b32 a217, v169
    v_accvgpr_write_b32 a218, v170
    v_accvgpr_write_b32 a219, v171
    v_accvgpr_write_b32 a220, v172
    v_accvgpr_write_b32 a221, v173
    v_accvgpr_write_b32 a222, v174
    v_accvgpr_write_b32 a223, v175
    v_add_u32 v21, 0x13f80, v23
    s_mov_b32 s98, 0x0
    buffer_load_dwordx4 a[128:131], v22, s[64:67], s98 offen sc1
    buffer_load_dwordx4 a[132:135], v23, s[64:67], s98 offen sc1
    buffer_load_dwordx4 a[136:139], v22, s[64:67], s98 offen offset:128 sc1
    buffer_load_dwordx4 a[140:143], v21, s[64:67], s98 offen offset:128 sc1
    buffer_load_dwordx4 a[144:147], v22, s[64:67], s98 offen offset:2048 sc1
    buffer_load_dwordx4 a[148:151], v23, s[64:67], s98 offen offset:2048 sc1
    buffer_load_dwordx4 a[152:155], v22, s[64:67], s98 offen offset:2176 sc1
    buffer_load_dwordx4 a[156:159], v21, s[64:67], s98 offen offset:2176 sc1
    s_mov_b32 s98, 0x1000
    buffer_load_dwordx4 a[160:163], v22, s[64:67], s98 offen sc1
    buffer_load_dwordx4 a[164:167], v23, s[64:67], s98 offen sc1
    buffer_load_dwordx4 a[168:171], v22, s[64:67], s98 offen offset:128 sc1
    buffer_load_dwordx4 a[172:175], v21, s[64:67], s98 offen offset:128 sc1
    buffer_load_dwordx4 a[176:179], v22, s[64:67], s98 offen offset:2048 sc1
    buffer_load_dwordx4 a[180:183], v23, s[64:67], s98 offen offset:2048 sc1
    buffer_load_dwordx4 a[184:187], v22, s[64:67], s98 offen offset:2176 sc1
    buffer_load_dwordx4 a[188:191], v21, s[64:67], s98 offen offset:2176 sc1
    v_accvgpr_read_b32 v144, a0
    v_accvgpr_read_b32 v145, a1
    v_accvgpr_read_b32 v146, a2
    v_accvgpr_read_b32 v147, a3
    v_accvgpr_read_b32 v148, a4
    v_accvgpr_read_b32 v149, a5
    v_accvgpr_read_b32 v150, a6
    v_accvgpr_read_b32 v151, a7
    v_accvgpr_read_b32 v152, a8
    v_accvgpr_read_b32 v153, a9
    v_accvgpr_read_b32 v154, a10
    v_accvgpr_read_b32 v155, a11
    v_accvgpr_read_b32 v156, a12
    v_accvgpr_read_b32 v157, a13
    v_accvgpr_read_b32 v158, a14
    v_accvgpr_read_b32 v159, a15
    v_cvt_pk_bf16_f32 v160, v144, v145
    v_cvt_pk_bf16_f32 v161, v146, v147
    v_cvt_pk_bf16_f32 v162, v148, v149
    v_cvt_pk_bf16_f32 v163, v150, v151
    s_mov_b32 s13, 0x0
    buffer_store_dwordx4 v[160:163], v25, s[84:87], s13 offen sc1
    v_cvt_pk_bf16_f32 v164, v152, v153
    v_cvt_pk_bf16_f32 v165, v154, v155
    v_cvt_pk_bf16_f32 v166, v156, v157
    v_cvt_pk_bf16_f32 v167, v158, v159
    v_accvgpr_read_b32 v144, a64
    v_accvgpr_read_b32 v145, a65
    v_accvgpr_read_b32 v146, a66
    v_accvgpr_read_b32 v147, a67
    v_accvgpr_read_b32 v148, a68
    v_accvgpr_read_b32 v149, a69
    v_accvgpr_read_b32 v150, a70
    v_accvgpr_read_b32 v151, a71
    v_accvgpr_read_b32 v152, a72
    v_accvgpr_read_b32 v153, a73
    v_accvgpr_read_b32 v154, a74
    v_accvgpr_read_b32 v155, a75
    v_accvgpr_read_b32 v156, a76
    v_accvgpr_read_b32 v157, a77
    v_accvgpr_read_b32 v158, a78
    v_accvgpr_read_b32 v159, a79
    v_cvt_pk_bf16_f32 v168, v144, v145
    v_cvt_pk_bf16_f32 v169, v146, v147
    v_cvt_pk_bf16_f32 v170, v148, v149
    v_cvt_pk_bf16_f32 v171, v150, v151
    v_cvt_pk_bf16_f32 v172, v152, v153
    v_cvt_pk_bf16_f32 v173, v154, v155
    v_cvt_pk_bf16_f32 v174, v156, v157
    v_cvt_pk_bf16_f32 v175, v158, v159
    buffer_store_dwordx4 v[164:167], v25, s[84:87], s13 offen offset:1024 sc1
    v_accvgpr_write_b32 a224, v168
    v_accvgpr_write_b32 a225, v169
    v_accvgpr_write_b32 a226, v170
    v_accvgpr_write_b32 a227, v171
    v_accvgpr_write_b32 a228, v172
    v_accvgpr_write_b32 a229, v173
    v_accvgpr_write_b32 a230, v174
    v_accvgpr_write_b32 a231, v175
    v_accvgpr_read_b32 v144, a16
    v_accvgpr_read_b32 v145, a17
    v_accvgpr_read_b32 v146, a18
    v_accvgpr_read_b32 v147, a19
    v_accvgpr_read_b32 v148, a20
    v_accvgpr_read_b32 v149, a21
    v_accvgpr_read_b32 v150, a22
    v_accvgpr_read_b32 v151, a23
    v_accvgpr_read_b32 v152, a24
    v_accvgpr_read_b32 v153, a25
    v_accvgpr_read_b32 v154, a26
    v_accvgpr_read_b32 v155, a27
    v_accvgpr_read_b32 v156, a28
    v_accvgpr_read_b32 v157, a29
    v_accvgpr_read_b32 v158, a30
    v_accvgpr_read_b32 v159, a31
    v_cvt_pk_bf16_f32 v160, v144, v145
    v_cvt_pk_bf16_f32 v161, v146, v147
    v_cvt_pk_bf16_f32 v162, v148, v149
    v_cvt_pk_bf16_f32 v163, v150, v151
    s_mov_b32 s13, 0x1000
    buffer_store_dwordx4 v[160:163], v25, s[84:87], s13 offen sc1
    v_cvt_pk_bf16_f32 v164, v152, v153
    v_cvt_pk_bf16_f32 v165, v154, v155
    v_cvt_pk_bf16_f32 v166, v156, v157
    v_cvt_pk_bf16_f32 v167, v158, v159
    v_accvgpr_read_b32 v144, a80
    v_accvgpr_read_b32 v145, a81
    v_accvgpr_read_b32 v146, a82
    v_accvgpr_read_b32 v147, a83
    v_accvgpr_read_b32 v148, a84
    v_accvgpr_read_b32 v149, a85
    v_accvgpr_read_b32 v150, a86
    v_accvgpr_read_b32 v151, a87
    v_accvgpr_read_b32 v152, a88
    v_accvgpr_read_b32 v153, a89
    v_accvgpr_read_b32 v154, a90
    v_accvgpr_read_b32 v155, a91
    v_accvgpr_read_b32 v156, a92
    v_accvgpr_read_b32 v157, a93
    v_accvgpr_read_b32 v158, a94
    v_accvgpr_read_b32 v159, a95
    v_cvt_pk_bf16_f32 v168, v144, v145
    v_cvt_pk_bf16_f32 v169, v146, v147
    v_cvt_pk_bf16_f32 v170, v148, v149
    v_cvt_pk_bf16_f32 v171, v150, v151
    v_cvt_pk_bf16_f32 v172, v152, v153
    v_cvt_pk_bf16_f32 v173, v154, v155
    v_cvt_pk_bf16_f32 v174, v156, v157
    v_cvt_pk_bf16_f32 v175, v158, v159
    buffer_store_dwordx4 v[164:167], v25, s[84:87], s13 offen offset:1024 sc1
    v_accvgpr_write_b32 a232, v168
    v_accvgpr_write_b32 a233, v169
    v_accvgpr_write_b32 a234, v170
    v_accvgpr_write_b32 a235, v171
    v_accvgpr_write_b32 a236, v172
    v_accvgpr_write_b32 a237, v173
    v_accvgpr_write_b32 a238, v174
    v_accvgpr_write_b32 a239, v175
    v_accvgpr_read_b32 v144, a32
    v_accvgpr_read_b32 v145, a33
    v_accvgpr_read_b32 v146, a34
    v_accvgpr_read_b32 v147, a35
    v_accvgpr_read_b32 v148, a36
    v_accvgpr_read_b32 v149, a37
    v_accvgpr_read_b32 v150, a38
    v_accvgpr_read_b32 v151, a39
    v_accvgpr_read_b32 v152, a40
    v_accvgpr_read_b32 v153, a41
    v_accvgpr_read_b32 v154, a42
    v_accvgpr_read_b32 v155, a43
    v_accvgpr_read_b32 v156, a44
    v_accvgpr_read_b32 v157, a45
    v_accvgpr_read_b32 v158, a46
    v_accvgpr_read_b32 v159, a47
    v_cvt_pk_bf16_f32 v160, v144, v145
    v_cvt_pk_bf16_f32 v161, v146, v147
    v_cvt_pk_bf16_f32 v162, v148, v149
    v_cvt_pk_bf16_f32 v163, v150, v151
    s_mov_b32 s13, 0x2000
    buffer_store_dwordx4 v[160:163], v25, s[84:87], s13 offen sc1
    v_cvt_pk_bf16_f32 v164, v152, v153
    v_cvt_pk_bf16_f32 v165, v154, v155
    v_cvt_pk_bf16_f32 v166, v156, v157
    v_cvt_pk_bf16_f32 v167, v158, v159
    v_accvgpr_read_b32 v144, a96
    v_accvgpr_read_b32 v145, a97
    v_accvgpr_read_b32 v146, a98
    v_accvgpr_read_b32 v147, a99
    v_accvgpr_read_b32 v148, a100
    v_accvgpr_read_b32 v149, a101
    v_accvgpr_read_b32 v150, a102
    v_accvgpr_read_b32 v151, a103
    v_accvgpr_read_b32 v152, a104
    v_accvgpr_read_b32 v153, a105
    v_accvgpr_read_b32 v154, a106
    v_accvgpr_read_b32 v155, a107
    v_accvgpr_read_b32 v156, a108
    v_accvgpr_read_b32 v157, a109
    v_accvgpr_read_b32 v158, a110
    v_accvgpr_read_b32 v159, a111
    v_cvt_pk_bf16_f32 v168, v144, v145
    v_cvt_pk_bf16_f32 v169, v146, v147
    v_cvt_pk_bf16_f32 v170, v148, v149
    v_cvt_pk_bf16_f32 v171, v150, v151
    v_cvt_pk_bf16_f32 v172, v152, v153
    v_cvt_pk_bf16_f32 v173, v154, v155
    v_cvt_pk_bf16_f32 v174, v156, v157
    v_cvt_pk_bf16_f32 v175, v158, v159
    buffer_store_dwordx4 v[164:167], v25, s[84:87], s13 offen offset:1024 sc1
    v_accvgpr_write_b32 a240, v168
    v_accvgpr_write_b32 a241, v169
    v_accvgpr_write_b32 a242, v170
    v_accvgpr_write_b32 a243, v171
    v_accvgpr_write_b32 a244, v172
    v_accvgpr_write_b32 a245, v173
    v_accvgpr_write_b32 a246, v174
    v_accvgpr_write_b32 a247, v175
    v_accvgpr_read_b32 v144, a48
    v_accvgpr_read_b32 v145, a49
    v_accvgpr_read_b32 v146, a50
    v_accvgpr_read_b32 v147, a51
    v_accvgpr_read_b32 v148, a52
    v_accvgpr_read_b32 v149, a53
    v_accvgpr_read_b32 v150, a54
    v_accvgpr_read_b32 v151, a55
    v_accvgpr_read_b32 v152, a56
    v_accvgpr_read_b32 v153, a57
    v_accvgpr_read_b32 v154, a58
    v_accvgpr_read_b32 v155, a59
    v_accvgpr_read_b32 v156, a60
    v_accvgpr_read_b32 v157, a61
    v_accvgpr_read_b32 v158, a62
    v_accvgpr_read_b32 v159, a63
    v_cvt_pk_bf16_f32 v160, v144, v145
    v_cvt_pk_bf16_f32 v161, v146, v147
    v_cvt_pk_bf16_f32 v162, v148, v149
    v_cvt_pk_bf16_f32 v163, v150, v151
    s_mov_b32 s13, 0x3000
    buffer_store_dwordx4 v[160:163], v25, s[84:87], s13 offen sc1
    v_cvt_pk_bf16_f32 v164, v152, v153
    v_cvt_pk_bf16_f32 v165, v154, v155
    v_cvt_pk_bf16_f32 v166, v156, v157
    v_cvt_pk_bf16_f32 v167, v158, v159
    v_accvgpr_read_b32 v144, a112
    v_accvgpr_read_b32 v145, a113
    v_accvgpr_read_b32 v146, a114
    v_accvgpr_read_b32 v147, a115
    v_accvgpr_read_b32 v148, a116
    v_accvgpr_read_b32 v149, a117
    v_accvgpr_read_b32 v150, a118
    v_accvgpr_read_b32 v151, a119
    v_accvgpr_read_b32 v152, a120
    v_accvgpr_read_b32 v153, a121
    v_accvgpr_read_b32 v154, a122
    v_accvgpr_read_b32 v155, a123
    v_accvgpr_read_b32 v156, a124
    v_accvgpr_read_b32 v157, a125
    v_accvgpr_read_b32 v158, a126
    v_accvgpr_read_b32 v159, a127
    v_cvt_pk_bf16_f32 v168, v144, v145
    v_cvt_pk_bf16_f32 v169, v146, v147
    v_cvt_pk_bf16_f32 v170, v148, v149
    v_cvt_pk_bf16_f32 v171, v150, v151
    v_cvt_pk_bf16_f32 v172, v152, v153
    v_cvt_pk_bf16_f32 v173, v154, v155
    v_cvt_pk_bf16_f32 v174, v156, v157
    v_cvt_pk_bf16_f32 v175, v158, v159
    buffer_store_dwordx4 v[164:167], v25, s[84:87], s13 offen offset:1024 sc1
    v_accvgpr_write_b32 a248, v168
    v_accvgpr_write_b32 a249, v169
    v_accvgpr_write_b32 a250, v170
    v_accvgpr_write_b32 a251, v171
    v_accvgpr_write_b32 a252, v172
    v_accvgpr_write_b32 a253, v173
    v_accvgpr_write_b32 a254, v174
    v_accvgpr_write_b32 a255, v175
    s_add_u32 s44, s42, 0x2300000
    s_addc_u32 s45, s43, 0
    s_mov_b32 s46, 0x0
    s_mov_b32 s47, 0x20000
    s_add_u32 s11, s8, s3
    s_mul_i32 s100, s11, 27
    s_lshl_b32 s12, s95, 1
    s_add_u32 s100, s100, s12
    s_lshl_b32 s100, s100, 11
    s_lshl_b32 s12, s12, 6
    s_add_u32 s11, s11, s12
    s_lshl_b32 s11, s11, 11
    s_add_u32 s96, s11, 0x400000
    v_xor_b32 v4, 0x30000, v4
    v_xor_b32 v5, 0x30000, v5
    v_xor_b32 v6, 0x30000, v6
    v_xor_b32 v7, 0x30000, v7
    s_waitcnt vmcnt(0)
    s_barrier
    v_xor_b32 v4, 0x30000, v4
    v_xor_b32 v5, 0x30000, v5
    v_xor_b32 v6, 0x30000, v6
    v_xor_b32 v7, 0x30000, v7
    ds_read_b64_tr_b16 a[0:1], v4 offset:0
    ds_read_b64_tr_b16 a[2:3], v4 offset:512
    ds_read_b64_tr_b16 a[4:5], v4 offset:4096
    ds_read_b64_tr_b16 a[6:7], v4 offset:4608
    ds_read_b64_tr_b16 a[8:9], v5 offset:0
    ds_read_b64_tr_b16 a[10:11], v5 offset:512
    ds_read_b64_tr_b16 a[12:13], v5 offset:4096
    ds_read_b64_tr_b16 a[14:15], v5 offset:4608
    ds_read_b64_tr_b16 a[16:17], v6 offset:0
    ds_read_b64_tr_b16 a[18:19], v6 offset:512
    ds_read_b64_tr_b16 a[20:21], v6 offset:4096
    ds_read_b64_tr_b16 a[22:23], v6 offset:4608
    s_waitcnt lgkmcnt(0)
    s_branch fk_q
fk_end0:
    s_endpgm
fk_wr_slow:
    s_mov_b32 s12, 0x20000
fk_wr_spin:
    s_sleep 8
    buffer_load_dword v27, v28, s[60:63], 0 offen sc1
    s_waitcnt vmcnt(0)
    v_cmp_eq_u32 vcc, 1, v27
    s_nop 0
    s_bcnt1_i32_b64 s11, vcc
    s_cmp_ge_u32 s11, 16
    s_cbranch_scc1 fk_wr_ok
    s_sub_u32 s12, s12, 1
    s_cmp_lg_u32 s12, 0
    s_cbranch_scc1 fk_wr_spin
    s_branch fk_wr_ok
fk_w0_slow:
    s_mov_b32 s12, 0x20000
fk_w0_spin:
    s_sleep 8
    buffer_load_dword v27, v170, s[68:71], s98 offen sc1
    s_waitcnt vmcnt(0)
    v_cmp_eq_u32 vcc, 0x101, v27
    s_nop 0
    s_bcnt1_i32_b64 s11, vcc
    s_cmp_ge_u32 s11, 64
    s_cbranch_scc1 fk_w0_ok
    s_sub_u32 s12, s12, 1
    s_cmp_lg_u32 s12, 0
    s_cbranch_scc1 fk_w0_spin
    s_branch fk_w0_ok
fk_w1_slow:
    s_mov_b32 s12, 0x20000
fk_w1_spin:
    s_sleep 8
    buffer_load_dword v27, v28, s[68:71], s97 offen sc1
    s_waitcnt vmcnt(0)
    v_cmp_eq_u32 vcc, 1, v27
    s_nop 0
    s_bfe_u32 s11, vcc_lo, 0x80000
    s_cmp_ge_u32 s11, 255
    s_cbranch_scc1 fk_w1_ok
    s_sub_u32 s12, s12, 1
    s_cmp_lg_u32 s12, 0
    s_cbranch_scc1 fk_w1_spin
    s_branch fk_w1_ok
fk_w2_slow:
    s_mov_b32 s12, 0x20000
fk_w2_spin:
    s_sleep 2
    buffer_load_dword v27, v28, s[68:71], s98 offen sc1
    s_waitcnt vmcnt(0)
    v_cmp_eq_u32 vcc, 1, v27
    s_nop 0
    s_bcnt1_i32_b64 s11, vcc
    s_cmp_ge_u32 s11, 14
    s_cbranch_scc1 fk_w2_ok
    s_sub_u32 s12, s12, 1
    s_cmp_lg_u32 s12, 0
    s_cbranch_scc1 fk_w2_spin
    s_branch fk_w2_ok
fk_ln:
    s_add_u32 s60, s42, 0x2700000
    s_addc_u32 s61, s43, 0
    s_mov_b32 s62, 0x360000
    s_mov_b32 s63, 0x20000
    s_and_b32 s13, s2, 31
    s_lshl_b32 s13, s13, 2
    s_add_u32 s100, s13, 0x3000
    s_add_u32 s13, s13, s3
    s_lshl_b32 s13, s13, 10
    v_lshrrev_b32 v29, 5, v1
    v_lshlrev_b32 v29, 17, v29
    v_and_b32 v22, 0x1f0, v2
    v_add3_u32 v22, v22, v29, s13
    s_waitcnt vmcnt(8)
    v_cmp_eq_u32 vcc, 1, v27
    s_nop 0
    s_bcnt1_i32_b64 s11, vcc
    s_cmp_ge_u32 s11, 14
    s_cbranch_scc0 fk_w2_slow
fk_w2_ok:
    s_mov_b32 s13, 0x0
    buffer_load_dwordx4 a[96:99], v22, s[60:63], s13 offen sc1
    s_mov_b32 s13, 0x40000
    buffer_load_dwordx4 a[100:103], v22, s[60:63], s13 offen sc1
    s_mov_b32 s13, 0x80000
    buffer_load_dwordx4 a[104:107], v22, s[60:63], s13 offen sc1
    s_mov_b32 s13, 0xc0000
    buffer_load_dwordx4 a[108:111], v22, s[60:63], s13 offen sc1
    s_mov_b32 s13, 0x100000
    buffer_load_dwordx4 a[112:115], v22, s[60:63], s13 offen sc1
    s_mov_b32 s13, 0x140000
    buffer_load_dwordx4 a[116:119], v22, s[60:63], s13 offen sc1
    s_mov_b32 s13, 0x180000
    buffer_load_dwordx4 a[120:123], v22, s[60:63], s13 offen sc1
    s_mov_b32 s13, 0x1c0000
    buffer_load_dwordx4 a[124:127], v22, s[60:63], s13 offen sc1
    s_mov_b32 s13, 0x200000
    buffer_load_dwordx4 a[128:131], v22, s[60:63], s13 offen sc1
    s_mov_b32 s13, 0x240000
    buffer_load_dwordx4 a[132:135], v22, s[60:63], s13 offen sc1
    s_mov_b32 s13, 0x280000
    buffer_load_dwordx4 a[136:139], v22, s[60:63], s13 offen sc1
    s_mov_b32 s13, 0x2c0000
    buffer_load_dwordx4 a[140:143], v22, s[60:63], s13 offen sc1
    s_mov_b32 s13, 0x300000
    buffer_load_dwordx4 a[144:147], v22, s[60:63], s13 offen sc1
    s_mov_b32 s13, 0x340000
    buffer_load_dwordx4 a[148:151], v22, s[60:63], s13 offen sc1
    s_add_u32 s72, s42, 0x2b00000
    s_addc_u32 s73, s43, 0
    s_mov_b32 s74, 0x360000
    s_mov_b32 s75, 0x20000
    s_branch fk_lr0
kFp_slow:
    s_mov_b32 s12, 0x20000
kFp_spin:
    s_sleep 8
    buffer_load_dword v27, v20, s[68:71], 0 offen sc1
    s_waitcnt vmcnt(0)
    v_cmp_eq_u32 vcc, 1, v27
    s_nop 0
    s_bcnt1_i32_b64 s11, vcc
    s_cmp_ge_u32 s11, 64
    s_cbranch_scc1 kFp_ok
    s_sub_u32 s12, s12, 1
    s_cmp_lg_u32 s12, 0
    s_cbranch_scc1 kFp_spin
    s_branch kFp_ok
kTb:
    s_or_b32 s95, s95, 1
    s_lshl_b32 s11, s2, 2
    s_add_u32 s11, s11, s3
    s_lshl_b32 s11, s11, 13
    s_add_u32 s11, s11, 0x6000000
    s_add_u32 s44, s42, s11
    s_addc_u32 s45, s43, 0
    s_mov_b32 s46, 0x2000
    s_mov_b32 s47, 0x20000
    s_movk_i32 s11, 0x1000
    buffer_store_dwordx4 a[160:163], v2, s[44:47], 0 offen sc1
    buffer_store_dwordx4 a[164:167], v2, s[44:47], 0 offen offset:1024 sc1
    buffer_store_dwordx4 a[168:171], v2, s[44:47], 0 offen offset:2048 sc1
    buffer_store_dwordx4 a[172:175], v2, s[44:47], 0 offen offset:3072 sc1
    buffer_store_dwordx4 a[176:179], v2, s[44:47], s11 offen sc1
    buffer_store_dwordx4 a[180:183], v2, s[44:47], s11 offen offset:1024 sc1
    buffer_store_dwordx4 a[184:187], v2, s[44:47], s11 offen offset:2048 sc1
    buffer_store_dwordx4 a[188:191], v2, s[44:47], s11 offen offset:3072 sc1
    s_branch kTb_r
kSp_slow:
    s_mov_b32 s12, 0x20000
kSp_spin:
    s_sleep 8
    buffer_load_dword v27, v20, s[68:71], 0 offen sc1
    s_waitcnt vmcnt(0)
    v_cmp_eq_u32 vcc, 1, v27
    s_nop 0
    s_bcnt1_i32_b64 s11, vcc
    s_cmp_ge_u32 s11, 64
    s_cbranch_scc1 kSp_ok
    s_sub_u32 s12, s12, 1
    s_cmp_lg_u32 s12, 0
    s_cbranch_scc1 kSp_spin
    s_branch kSp_ok
kU0_b:
    s_or_b32 s95, s95, 1
    s_lshl_b32 s11, s2, 2
    s_add_u32 s11, s11, s3
    s_lshl_b32 s11, s11, 13
    s_add_u32 s11, s11, 0x6000000
    s_add_u32 s44, s42, s11
    s_addc_u32 s45, s43, 0
    s_mov_b32 s46, 0x2000
    s_mov_b32 s47, 0x20000
    s_movk_i32 s11, 0x1000
    buffer_store_dwordx4 a[160:163], v2, s[44:47], 0 offen sc1
    buffer_store_dwordx4 a[164:167], v2, s[44:47], 0 offen offset:1024 sc1
    buffer_store_dwordx4 a[168:171], v2, s[44:47], 0 offen offset:2048 sc1
    buffer_store_dwordx4 a[172:175], v2, s[44:47], 0 offen offset:3072 sc1
    buffer_store_dwordx4 a[176:179], v2, s[44:47], s11 offen sc1
    buffer_store_dwordx4 a[180:183], v2, s[44:47], s11 offen offset:1024 sc1
    buffer_store_dwordx4 a[184:187], v2, s[44:47], s11 offen offset:2048 sc1
    buffer_store_dwordx4 a[188:191], v2, s[44:47], s11 offen offset:3072 sc1
    s_branch kU0_b_r
kU0_se:
    s_nop 7
    s_waitcnt vmcnt(12)
    v_add_f32 v112, v112, v116
    v_add_f32 v113, v113, v117
    v_add_f32 v114, v114, v118
    v_add_f32 v115, v115, v119
    v_add_f32 v112, v112, v113
    v_add_f32 v114, v114, v115
    v_subrev_u32 v113, 0x1f800000, v112
    v_subrev_u32 v115, 0x1f800000, v114
    v_max_u32 v113, v113, v115
    v_cmp_lt_u32 vcc, 0x40000000, v113
    s_nop 0
    s_cbranch_vccnz kU0_b
kU0_b_r:
    v_rcp_f32 v112, v112
    v_rcp_f32 v114, v114
    s_add_u32 s97, s94, 0x9b000
    v_pk_mul_f32 v[128:129], v[128:129], v[112:113] op_sel_hi:[1,0]
    v_pk_mul_f32 v[130:131], v[130:131], v[112:113] op_sel_hi:[1,0]
    v_pk_mul_f32 v[132:133], v[132:133], v[112:113] op_sel_hi:[1,0]
    v_pk_mul_f32 v[134:135], v[134:135], v[112:113] op_sel_hi:[1,0]
    v_cvt_pk_bf16_f32 v128, v128, v129
    v_cvt_pk_bf16_f32 v129, v130, v131
    v_cvt_pk_bf16_f32 v130, v132, v133
    v_cvt_pk_bf16_f32 v131, v134, v135
    buffer_store_dwordx4 v[128:131], v0, s[56:59], s94 offen sc1
    v_pk_mul_f32 v[136:137], v[136:137], v[114:115] op_sel_hi:[1,0]
    v_pk_mul_f32 v[138:139], v[138:139], v[114:115] op_sel_hi:[1,0]
    v_pk_mul_f32 v[140:141], v[140:141], v[114:115] op_sel_hi:[1,0]
    v_pk_mul_f32 v[142:143], v[142:143], v[114:115] op_sel_hi:[1,0]
    v_cvt_pk_bf16_f32 v136, v136, v137
    v_cvt_pk_bf16_f32 v137, v138, v139
    v_cvt_pk_bf16_f32 v138, v140, v141
    v_cvt_pk_bf16_f32 v139, v142, v143
    buffer_store_dwordx4 v[136:139], v0, s[56:59], s97 offen sc1
    v_pk_mul_f32 v[144:145], v[144:145], v[112:113] op_sel_hi:[1,0]
    v_pk_mul_f32 v[146:147], v[146:147], v[112:113] op_sel_hi:[1,0]
    v_pk_mul_f32 v[148:149], v[148:149], v[112:113] op_sel_hi:[1,0]
    v_pk_mul_f32 v[150:151], v[150:151], v[112:113] op_sel_hi:[1,0]
    v_cvt_pk_bf16_f32 v144, v144, v145
    v_cvt_pk_bf16_f32 v145, v146, v147
    v_cvt_pk_bf16_f32 v146, v148, v149
    v_cvt_pk_bf16_f32 v147, v150, v151
    buffer_store_dwordx4 v[144:147], v0, s[56:59], s94 offen offset:2048 sc1
    v_pk_mul_f32 v[152:153], v[152:153], v[114:115] op_sel_hi:[1,0]
    v_pk_mul_f32 v[154:155], v[154:155], v[114:115] op_sel_hi:[1,0]
    v_pk_mul_f32 v[156:157], v[156:157], v[114:115] op_sel_hi:[1,0]
    v_pk_mul_f32 v[158:159], v[158:159], v[114:115] op_sel_hi:[1,0]
    v_cvt_pk_bf16_f32 v152, v152, v153
    v_cvt_pk_bf16_f32 v153, v154, v155
    v_cvt_pk_bf16_f32 v154, v156, v157
    v_cvt_pk_bf16_f32 v155, v158, v159
    buffer_store_dwordx4 v[152:155], v0, s[56:59], s97 offen offset:2048 sc1
    s_add_u32 s94, s94, 0x1000
    s_add_u32 s97, s94, 0x9b000
    v_pk_mul_f32 v[160:161], v[160:161], v[112:113] op_sel_hi:[1,0]
    v_pk_mul_f32 v[162:163], v[162:163], v[112:113] op_sel_hi:[1,0]
    v_pk_mul_f32 v[164:165], v[164:165], v[112:113] op_sel_hi:[1,0]
    v_pk_mul_f32 v[166:167], v[166:167], v[112:113] op_sel_hi:[1,0]
    v_cvt_pk_bf16_f32 v160, v160, v161
    v_cvt_pk_bf16_f32 v161, v162, v163
    v_cvt_pk_bf16_f32 v162, v164, v165
    v_cvt_pk_bf16_f32 v163, v166, v167
    buffer_store_dwordx4 v[160:163], v0, s[56:59], s94 offen sc1
    v_pk_mul_f32 v[168:169], v[168:169], v[114:115] op_sel_hi:[1,0]
    v_pk_mul_f32 v[170:171], v[170:171], v[114:115] op_sel_hi:[1,0]
    v_pk_mul_f32 v[172:173], v[172:173], v[114:115] op_sel_hi:[1,0]
    v_pk_mul_f32 v[174:175], v[174:175], v[114:115] op_sel_hi:[1,0]
    v_cvt_pk_bf16_f32 v168, v168, v169
    v_cvt_pk_bf16_f32 v169, v170, v171
    v_cvt_pk_bf16_f32 v170, v172, v173
    v_cvt_pk_bf16_f32 v171, v174, v175
    buffer_store_dwordx4 v[168:171], v0, s[56:59], s97 offen sc1
    v_pk_mul_f32 v[176:177], v[176:177], v[112:113] op_sel_hi:[1,0]
    v_pk_mul_f32 v[178:179], v[178:179], v[112:113] op_sel_hi:[1,0]
    v_pk_mul_f32 v[180:181], v[180:181], v[112:113] op_sel_hi:[1,0]
    v_pk_mul_f32 v[182:183], v[182:183], v[112:113] op_sel_hi:[1,0]
    v_cvt_pk_bf16_f32 v176, v176, v177
    v_cvt_pk_bf16_f32 v177, v178, v179
    v_cvt_pk_bf16_f32 v178, v180, v181
    v_cvt_pk_bf16_f32 v179, v182, v183
    buffer_store_dwordx4 v[176:179], v0, s[56:59], s94 offen offset:2048 sc1
    v_pk_mul_f32 v[184:185], v[184:185], v[114:115] op_sel_hi:[1,0]
    v_pk_mul_f32 v[186:187], v[186:187], v[114:115] op_sel_hi:[1,0]
    v_pk_mul_f32 v[188:189], v[188:189], v[114:115] op_sel_hi:[1,0]
    v_pk_mul_f32 v[190:191], v[190:191], v[114:115] op_sel_hi:[1,0]
    v_cvt_pk_bf16_f32 v184, v184, v185
    v_cvt_pk_bf16_f32 v185, v186, v187
    v_cvt_pk_bf16_f32 v186, v188, v189
    v_cvt_pk_bf16_f32 v187, v190, v191
    buffer_store_dwordx4 v[184:187], v0, s[56:59], s97 offen offset:2048 sc1
    v_mov_b32 v116, 0
    v_mov_b32 v117, 0
    v_mov_b32 v118, 0
    v_mov_b32 v119, 0
    v_mov_b32 v128, 0
    v_mov_b32 v129, 0
    v_mov_b32 v130, 0
    v_mov_b32 v131, 0
    v_mov_b32 v132, 0
    v_mov_b32 v133, 0
    v_mov_b32 v134, 0
    v_mov_b32 v135, 0
    v_mov_b32 v136, 0
    v_mov_b32 v137, 0
    v_mov_b32 v138, 0
    v_mov_b32 v139, 0
    v_mov_b32 v140, 0
    v_mov_b32 v141, 0
    v_mov_b32 v142, 0
    v_mov_b32 v143, 0
    v_mov_b32 v144, 0
    v_mov_b32 v145, 0
    v_mov_b32 v146, 0
    v_mov_b32 v147, 0
    v_mov_b32 v148, 0
    v_mov_b32 v149, 0
    v_mov_b32 v150, 0
    v_mov_b32 v151, 0
    v_mov_b32 v152, 0
    v_mov_b32 v153, 0
    v_mov_b32 v154, 0
    v_mov_b32 v155, 0
    v_mov_b32 v156, 0
    v_mov_b32 v157, 0
    v_mov_b32 v158, 0
    v_mov_b32 v159, 0
    v_mov_b32 v160, 0
    v_mov_b32 v161, 0
    v_mov_b32 v162, 0
    v_mov_b32 v163, 0
    v_mov_b32 v164, 0
    v_mov_b32 v165, 0
    v_mov_b32 v166, 0
    v_mov_b32 v167, 0
    v_mov_b32 v168, 0
    v_mov_b32 v169, 0
    v_mov_b32 v170, 0
    v_mov_b32 v171, 0
    v_mov_b32 v172, 0
    v_mov_b32 v173, 0
    v_mov_b32 v174, 0
    v_mov_b32 v175, 0
    v_mov_b32 v176, 0
    v_mov_b32 v177, 0
    v_mov_b32 v178, 0
    v_mov_b32 v179, 0
    v_mov_b32 v180, 0
    v_mov_b32 v181, 0
    v_mov_b32 v182, 0
    v_mov_b32 v183, 0
    v_mov_b32 v184, 0
    v_mov_b32 v185, 0
    v_mov_b32 v186, 0
    v_mov_b32 v187, 0
    v_mov_b32 v188, 0
    v_mov_b32 v189, 0
    v_mov_b32 v190, 0
    v_mov_b32 v191, 0
    s_branch kU0_sr
kU1_b:
    s_or_b32 s95, s95, 1
    s_lshl_b32 s11, s2, 2
    s_add_u32 s11, s11, s3
    s_lshl_b32 s11, s11, 13
    s_add_u32 s11, s11, 0x6000000
    s_add_u32 s44, s42, s11
    s_addc_u32 s45, s43, 0
    s_mov_b32 s46, 0x2000
    s_mov_b32 s47, 0x20000
    s_movk_i32 s11, 0x1000
    buffer_store_dwordx4 a[160:163], v2, s[44:47], 0 offen sc1
    buffer_store_dwordx4 a[164:167], v2, s[44:47], 0 offen offset:1024 sc1
    buffer_store_dwordx4 a[168:171], v2, s[44:47], 0 offen offset:2048 sc1
    buffer_store_dwordx4 a[172:175], v2, s[44:47], 0 offen offset:3072 sc1
    buffer_store_dwordx4 a[176:179], v2, s[44:47], s11 offen sc1
    buffer_store_dwordx4 a[180:183], v2, s[44:47], s11 offen offset:1024 sc1
    buffer_store_dwordx4 a[184:187], v2, s[44:47], s11 offen offset:2048 sc1
    buffer_store_dwordx4 a[188:191], v2, s[44:47], s11 offen offset:3072 sc1
    s_branch kU1_b_r
kU1_se:
    s_nop 7
    s_waitcnt vmcnt(12)
    v_add_f32 v112, v112, v116
    v_add_f32 v113, v113, v117
    v_add_f32 v114, v114, v118
    v_add_f32 v115, v115, v119
    v_add_f32 v112, v112, v113
    v_add_f32 v114, v114, v115
    v_subrev_u32 v113, 0x1f800000, v112
    v_subrev_u32 v115, 0x1f800000, v114
    v_max_u32 v113, v113, v115
    v_cmp_lt_u32 vcc, 0x40000000, v113
    s_nop 0
    s_cbranch_vccnz kU1_b
kU1_b_r:
    v_rcp_f32 v112, v112
    v_rcp_f32 v114, v114
    s_add_u32 s97, s94, 0x9b000
    v_pk_mul_f32 v[128:129], v[128:129], v[112:113] op_sel_hi:[1,0]
    v_pk_mul_f32 v[130:131], v[130:131], v[112:113] op_sel_hi:[1,0]
    v_pk_mul_f32 v[132:133], v[132:133], v[112:113] op_sel_hi:[1,0]
    v_pk_mul_f32 v[134:135], v[134:135], v[112:113] op_sel_hi:[1,0]
    v_cvt_pk_bf16_f32 v128, v128, v129
    v_cvt_pk_bf16_f32 v129, v130, v131
    v_cvt_pk_bf16_f32 v130, v132, v133
    v_cvt_pk_bf16_f32 v131, v134, v135
    buffer_store_dwordx4 v[128:131], v0, s[56:59], s94 offen sc1
    v_pk_mul_f32 v[136:137], v[136:137], v[114:115] op_sel_hi:[1,0]
    v_pk_mul_f32 v[138:139], v[138:139], v[114:115] op_sel_hi:[1,0]
    v_pk_mul_f32 v[140:141], v[140:141], v[114:115] op_sel_hi:[1,0]
    v_pk_mul_f32 v[142:143], v[142:143], v[114:115] op_sel_hi:[1,0]
    v_cvt_pk_bf16_f32 v136, v136, v137
    v_cvt_pk_bf16_f32 v137, v138, v139
    v_cvt_pk_bf16_f32 v138, v140, v141
    v_cvt_pk_bf16_f32 v139, v142, v143
    buffer_store_dwordx4 v[136:139], v0, s[56:59], s97 offen sc1
    v_pk_mul_f32 v[144:145], v[144:145], v[112:113] op_sel_hi:[1,0]
    v_pk_mul_f32 v[146:147], v[146:147], v[112:113] op_sel_hi:[1,0]
    v_pk_mul_f32 v[148:149], v[148:149], v[112:113] op_sel_hi:[1,0]
    v_pk_mul_f32 v[150:151], v[150:151], v[112:113] op_sel_hi:[1,0]
    v_cvt_pk_bf16_f32 v144, v144, v145
    v_cvt_pk_bf16_f32 v145, v146, v147
    v_cvt_pk_bf16_f32 v146, v148, v149
    v_cvt_pk_bf16_f32 v147, v150, v151
    buffer_store_dwordx4 v[144:147], v0, s[56:59], s94 offen offset:2048 sc1
    v_pk_mul_f32 v[152:153], v[152:153], v[114:115] op_sel_hi:[1,0]
    v_pk_mul_f32 v[154:155], v[154:155], v[114:115] op_sel_hi:[1,0]
    v_pk_mul_f32 v[156:157], v[156:157], v[114:115] op_sel_hi:[1,0]
    v_pk_mul_f32 v[158:159], v[158:159], v[114:115] op_sel_hi:[1,0]
    v_cvt_pk_bf16_f32 v152, v152, v153
    v_cvt_pk_bf16_f32 v153, v154, v155
    v_cvt_pk_bf16_f32 v154, v156, v157
    v_cvt_pk_bf16_f32 v155, v158, v159
    buffer_store_dwordx4 v[152:155], v0, s[56:59], s97 offen offset:2048 sc1
    s_add_u32 s94, s94, 0x1000
    s_add_u32 s97, s94, 0x9b000
    v_pk_mul_f32 v[160:161], v[160:161], v[112:113] op_sel_hi:[1,0]
    v_pk_mul_f32 v[162:163], v[162:163], v[112:113] op_sel_hi:[1,0]
    v_pk_mul_f32 v[164:165], v[164:165], v[112:113] op_sel_hi:[1,0]
    v_pk_mul_f32 v[166:167], v[166:167], v[112:113] op_sel_hi:[1,0]
    v_cvt_pk_bf16_f32 v160, v160, v161
    v_cvt_pk_bf16_f32 v161, v162, v163
    v_cvt_pk_bf16_f32 v162, v164, v165
    v_cvt_pk_bf16_f32 v163, v166, v167
    buffer_store_dwordx4 v[160:163], v0, s[56:59], s94 offen sc1
    v_pk_mul_f32 v[168:169], v[168:169], v[114:115] op_sel_hi:[1,0]
    v_pk_mul_f32 v[170:171], v[170:171], v[114:115] op_sel_hi:[1,0]
    v_pk_mul_f32 v[172:173], v[172:173], v[114:115] op_sel_hi:[1,0]
    v_pk_mul_f32 v[174:175], v[174:175], v[114:115] op_sel_hi:[1,0]
    v_cvt_pk_bf16_f32 v168, v168, v169
    v_cvt_pk_bf16_f32 v169, v170, v171
    v_cvt_pk_bf16_f32 v170, v172, v173
    v_cvt_pk_bf16_f32 v171, v174, v175
    buffer_store_dwordx4 v[168:171], v0, s[56:59], s97 offen sc1
    v_pk_mul_f32 v[176:177], v[176:177], v[112:113] op_sel_hi:[1,0]
    v_pk_mul_f32 v[178:179], v[178:179], v[112:113] op_sel_hi:[1,0]
    v_pk_mul_f32 v[180:181], v[180:181], v[112:113] op_sel_hi:[1,0]
    v_pk_mul_f32 v[182:183], v[182:183], v[112:113] op_sel_hi:[1,0]
    v_cvt_pk_bf16_f32 v176, v176, v177
    v_cvt_pk_bf16_f32 v177, v178, v179
    v_cvt_pk_bf16_f32 v178, v180, v181
    v_cvt_pk_bf16_f32 v179, v182, v183
    buffer_store_dwordx4 v[176:179], v0, s[56:59], s94 offen offset:2048 sc1
    v_pk_mul_f32 v[184:185], v[184:185], v[114:115] op_sel_hi:[1,0]
    v_pk_mul_f32 v[186:187], v[186:187], v[114:115] op_sel_hi:[1,0]
    v_pk_mul_f32 v[188:189], v[188:189], v[114:115] op_sel_hi:[1,0]
    v_pk_mul_f32 v[190:191], v[190:191], v[114:115] op_sel_hi:[1,0]
    v_cvt_pk_bf16_f32 v184, v184, v185
    v_cvt_pk_bf16_f32 v185, v186, v187
    v_cvt_pk_bf16_f32 v186, v188, v189
    v_cvt_pk_bf16_f32 v187, v190, v191
    buffer_store_dwordx4 v[184:187], v0, s[56:59], s97 offen offset:2048 sc1
    v_mov_b32 v116, 0
    v_mov_b32 v117, 0
    v_mov_b32 v118, 0
    v_mov_b32 v119, 0
    v_mov_b32 v128, 0
    v_mov_b32 v129, 0
    v_mov_b32 v130, 0
    v_mov_b32 v131, 0
    v_mov_b32 v132, 0
    v_mov_b32 v133, 0
    v_mov_b32 v134, 0
    v_mov_b32 v135, 0
    v_mov_b32 v136, 0
    v_mov_b32 v137, 0
    v_mov_b32 v138, 0
    v_mov_b32 v139, 0
    v_mov_b32 v140, 0
    v_mov_b32 v141, 0
    v_mov_b32 v142, 0
    v_mov_b32 v143, 0
    v_mov_b32 v144, 0
    v_mov_b32 v145, 0
    v_mov_b32 v146, 0
    v_mov_b32 v147, 0
    v_mov_b32 v148, 0
    v_mov_b32 v149, 0
    v_mov_b32 v150, 0
    v_mov_b32 v151, 0
    v_mov_b32 v152, 0
    v_mov_b32 v153, 0
    v_mov_b32 v154, 0
    v_mov_b32 v155, 0
    v_mov_b32 v156, 0
    v_mov_b32 v157, 0
    v_mov_b32 v158, 0
    v_mov_b32 v159, 0
    v_mov_b32 v160, 0
    v_mov_b32 v161, 0
    v_mov_b32 v162, 0
    v_mov_b32 v163, 0
    v_mov_b32 v164, 0
    v_mov_b32 v165, 0
    v_mov_b32 v166, 0
    v_mov_b32 v167, 0
    v_mov_b32 v168, 0
    v_mov_b32 v169, 0
    v_mov_b32 v170, 0
    v_mov_b32 v171, 0
    v_mov_b32 v172, 0
    v_mov_b32 v173, 0
    v_mov_b32 v174, 0
    v_mov_b32 v175, 0
    v_mov_b32 v176, 0
    v_mov_b32 v177, 0
    v_mov_b32 v178, 0
    v_mov_b32 v179, 0
    v_mov_b32 v180, 0
    v_mov_b32 v181, 0
    v_mov_b32 v182, 0
    v_mov_b32 v183, 0
    v_mov_b32 v184, 0
    v_mov_b32 v185, 0
    v_mov_b32 v186, 0
    v_mov_b32 v187, 0
    v_mov_b32 v188, 0
    v_mov_b32 v189, 0
    v_mov_b32 v190, 0
    v_mov_b32 v191, 0
    s_branch kU1_sr
kSP:
    s_lshr_b32 s11, s3, 1
    s_lshl_b32 s11, s11, 14
    v_add_u32 v16, s11, v2
    v_add_u32 v17, 0x4000, v2
    v_mov_b32 v80, v18
    v_mov_b32 v81, v18
    v_mov_b32 v82, v18
    v_mov_b32 v83, v18
    v_mov_b32 v84, v19
    v_mov_b32 v85, v19
    v_mov_b32 v86, v19
    v_mov_b32 v87, v19
    s_waitcnt vmcnt(8)
    s_branch kU
kSL:
    s_waitcnt vmcnt(0) lgkmcnt(0)
    s_lshl_b32 s11, s6, 19
    s_add_u32 s11, s11, 0x300000
    s_add_u32 s52, s42, s11
    s_addc_u32 s53, s43, 0
    s_mov_b32 s54, 0x1080000
    s_mov_b32 s55, 0x20000
    s_lshl_b32 s90, s7, 2
    s_bitcmp1_b32 s95, 1
    s_cbranch_scc0 kSLa
    s_sub_u32 s90, 60, s90
    s_and_b32 s95, s95, 1
    s_branch kSLb
kSLa:
    s_mov_b32 s95, 0
    s_lshl_b32 s11, s2, 2
    s_add_u32 s11, s11, s3
    s_lshl_b32 s11, s11, 13
    s_add_u32 s11, s11, 0x6000000
    s_add_u32 s44, s42, s11
    s_addc_u32 s45, s43, 0
    s_mov_b32 s46, 0x2000
    s_mov_b32 s47, 0x20000
    s_movk_i32 s11, 0x1000
    buffer_load_dwordx4 a[32:35], v2, s[44:47], 0 offen sc1
    buffer_load_dwordx4 a[36:39], v2, s[44:47], 0 offen offset:1024 sc1
    buffer_load_dwordx4 a[40:43], v2, s[44:47], 0 offen offset:2048 sc1
    buffer_load_dwordx4 a[44:47], v2, s[44:47], 0 offen offset:3072 sc1
    buffer_load_dwordx4 a[48:51], v2, s[44:47], s11 offen sc1
    buffer_load_dwordx4 a[52:55], v2, s[44:47], s11 offen offset:1024 sc1
    buffer_load_dwordx4 a[56:59], v2, s[44:47], s11 offen offset:2048 sc1
    buffer_load_dwordx4 a[60:63], v2, s[44:47], s11 offen offset:3072 sc1
    s_lshr_b32 s94, s3, 1
    s_lshl2_add_u32 s94, s7, s94
    s_mul_i32 s94, s94, 155
    s_lshl_b32 s12, s6, 2
    s_add_u32 s94, s94, s12
    s_lshl_b32 s94, s94, 11
    s_and_b32 s12, s3, 1
    s_lshl_b32 s12, s12, 8
    s_add_u32 s94, s94, s12
    s_add_u32 s97, s94, 0x9b000
    s_lshl1_add_u32 s84, s90, s3
    s_lshl_b32 s84, s84, 4
    s_add_u32 s85, s84, 64
    s_lshr_b32 s90, s85, 5
    s_branch kSLc
kSLb:
    s_add_u32 s90, s90, s3
    s_mov_b32 s94, s90
    s_mul_i32 s94, s94, 155
    s_lshl_b32 s12, s6, 2
    s_add_u32 s94, s94, s12
    s_lshl_b32 s94, s94, 11
    s_add_u32 s97, s94, 256
    s_lshl_b32 s84, s90, 5
    s_add_u32 s85, s84, 16
kSLc:
    v_mov_b32 v4, 0xff800000
    v_mov_b32 v5, 0xff800000
    s_mov_b32 s92, 0
kSL1:
    s_lshl_b32 s80, s92, 13
    s_add_u32 s81, s80, 0x1000
    s_add_u32 s82, s80, 0x1000000
    s_add_u32 s83, s82, 0x1000
    s_cmp_eq_u32 s92, s90
    s_cselect_b32 s96, 1.0, 0
    v_and_b32 v29, 15, v1
    v_lshrrev_b32 v30, 2, v1
    v_and_b32 v30, 12, v30
    v_sub_u32 v29, v29, v30
    s_lshl_b32 s86, s92, 5
    v_subrev_u32 v29, s86, v29
    v_add_u32 v30, s85, v29
    v_add_u32 v29, s84, v29
    s_mov_b32 s96, 0xf1800000
    v_cmp_gt_i32 vcc, 0, v29
    s_nop 1
    v_cndmask_b32 v96, 0, 1.0, vcc
    v_cmp_gt_i32 vcc, 1, v29
    s_nop 1
    v_cndmask_b32 v97, 0, 1.0, vcc
    v_cmp_gt_i32 vcc, 2, v29
    s_nop 1
    v_cndmask_b32 v98, 0, 1.0, vcc
    v_cmp_gt_i32 vcc, 3, v29
    s_nop 1
    v_cndmask_b32 v99, 0, 1.0, vcc
    v_cmp_gt_i32 vcc, 16, v29
    s_nop 1
    v_cndmask_b32 v100, 0, 1.0, vcc
    v_cmp_gt_i32 vcc, 17, v29
    s_nop 1
    v_cndmask_b32 v101, 0, 1.0, vcc
    v_cmp_gt_i32 vcc, 18, v29
    s_nop 1
    v_cndmask_b32 v102, 0, 1.0, vcc
    v_cmp_gt_i32 vcc, 19, v29
    s_nop 1
    v_cndmask_b32 v103, 0, 1.0, vcc
    v_cmp_gt_i32 vcc, 0, v30
    s_nop 1
    v_cndmask_b32 v104, 0, 1.0, vcc
    v_cmp_gt_i32 vcc, 1, v30
    s_nop 1
    v_cndmask_b32 v105, 0, 1.0, vcc
    v_cmp_gt_i32 vcc, 2, v30
    s_nop 1
    v_cndmask_b32 v106, 0, 1.0, vcc
    v_cmp_gt_i32 vcc, 3, v30
    s_nop 1
    v_cndmask_b32 v107, 0, 1.0, vcc
    v_cmp_gt_i32 vcc, 16, v30
    s_nop 1
    v_cndmask_b32 v108, 0, 1.0, vcc
    v_cmp_gt_i32 vcc, 17, v30
    s_nop 1
    v_cndmask_b32 v109, 0, 1.0, vcc
    v_cmp_gt_i32 vcc, 18, v30
    s_nop 1
    v_cndmask_b32 v110, 0, 1.0, vcc
    v_cmp_gt_i32 vcc, 19, v30
    s_nop 1
    v_cndmask_b32 v111, 0, 1.0, vcc
    buffer_load_dwordx4 a[64:67], v2, s[52:55], s80 offen sc1
    buffer_load_dwordx4 a[68:71], v2, s[52:55], s80 offen offset:1024 sc1
    buffer_load_dwordx4 a[72:75], v2, s[52:55], s80 offen offset:2048 sc1
    buffer_load_dwordx4 a[76:79], v2, s[52:55], s80 offen offset:3072 sc1
    buffer_load_dwordx4 a[80:83], v2, s[52:55], s81 offen sc1
    buffer_load_dwordx4 a[84:87], v2, s[52:55], s81 offen offset:1024 sc1
    buffer_load_dwordx4 a[88:91], v2, s[52:55], s81 offen offset:2048 sc1
    buffer_load_dwordx4 a[92:95], v2, s[52:55], s81 offen offset:3072 sc1
    v_mul_f32 v48, s96, v96
    v_mul_f32 v49, s96, v97
    v_mul_f32 v50, s96, v98
    v_mul_f32 v51, s96, v99
    v_mul_f32 v52, s96, v100
    v_mul_f32 v53, s96, v101
    v_mul_f32 v54, s96, v102
    v_mul_f32 v55, s96, v103
    v_mul_f32 v56, s96, v104
    v_mul_f32 v57, s96, v105
    v_mul_f32 v58, s96, v106
    v_mul_f32 v59, s96, v107
    v_mul_f32 v60, s96, v108
    v_mul_f32 v61, s96, v109
    v_mul_f32 v62, s96, v110
    v_mul_f32 v63, s96, v111
    s_waitcnt vmcnt(7)
    v_mfma_f32_16x16x32_bf16 v[48:51], a[64:67], a[32:35], v[48:51]
    s_waitcnt vmcnt(6)
    v_mfma_f32_16x16x32_bf16 v[48:51], a[68:71], a[36:39], v[48:51]
    s_waitcnt vmcnt(5)
    v_mfma_f32_16x16x32_bf16 v[48:51], a[72:75], a[40:43], v[48:51]
    s_waitcnt vmcnt(4)
    v_mfma_f32_16x16x32_bf16 v[48:51], a[76:79], a[44:47], v[48:51]
    v_mfma_f32_16x16x32_bf16 v[56:59], a[64:67], a[48:51], v[56:59]
    v_mfma_f32_16x16x32_bf16 v[56:59], a[68:71], a[52:55], v[56:59]
    v_mfma_f32_16x16x32_bf16 v[56:59], a[72:75], a[56:59], v[56:59]
    v_mfma_f32_16x16x32_bf16 v[56:59], a[76:79], a[60:63], v[56:59]
    s_waitcnt vmcnt(3)
    v_mfma_f32_16x16x32_bf16 v[52:55], a[80:83], a[32:35], v[52:55]
    s_waitcnt vmcnt(2)
    v_mfma_f32_16x16x32_bf16 v[52:55], a[84:87], a[36:39], v[52:55]
    s_waitcnt vmcnt(1)
    v_mfma_f32_16x16x32_bf16 v[52:55], a[88:91], a[40:43], v[52:55]
    s_waitcnt vmcnt(0)
    v_mfma_f32_16x16x32_bf16 v[52:55], a[92:95], a[44:47], v[52:55]
    v_mfma_f32_16x16x32_bf16 v[60:63], a[80:83], a[48:51], v[60:63]
    v_mfma_f32_16x16x32_bf16 v[60:63], a[84:87], a[52:55], v[60:63]
    v_mfma_f32_16x16x32_bf16 v[60:63], a[88:91], a[56:59], v[60:63]
    v_mfma_f32_16x16x32_bf16 v[60:63], a[92:95], a[60:63], v[60:63]
    v_max3_f32 v4, v4, v48, v49
    v_max3_f32 v4, v4, v50, v51
    s_nop 1
    v_max3_f32 v4, v4, v52, v53
    v_max3_f32 v4, v4, v54, v55
    v_max3_f32 v5, v5, v56, v57
    v_max3_f32 v5, v5, v58, v59
    v_max3_f32 v5, v5, v60, v61
    v_max3_f32 v5, v5, v62, v63
    s_add_u32 s92, s92, 1
    s_cmp_le_u32 s92, s90
    s_cbranch_scc1 kSL1
    v_permlane32_swap_b32 v4, v5
    v_max_f32 v4, v4, v5
    v_mov_b32 v5, v4
    s_nop 1
    v_permlane16_swap_b32 v4, v5
    v_max_f32 v4, v4, v5
    v_mov_b32 v5, v4
    s_nop 1
    v_permlane32_swap_b32 v4, v5
    v_sub_f32 v88, 0, v4
    v_sub_f32 v89, 0, v4
    v_sub_f32 v90, 0, v4
    v_sub_f32 v91, 0, v4
    v_sub_f32 v92, 0, v5
    v_sub_f32 v93, 0, v5
    v_sub_f32 v94, 0, v5
    v_sub_f32 v95, 0, v5
    v_mov_b32 v120, 0
    v_mov_b32 v121, 0
    v_mov_b32 v122, 0
    v_mov_b32 v123, 0
    v_mov_b32 v192, 0
    v_mov_b32 v193, 0
    v_mov_b32 v194, 0
    v_mov_b32 v195, 0
    v_mov_b32 v196, 0
    v_mov_b32 v197, 0
    v_mov_b32 v198, 0
    v_mov_b32 v199, 0
    v_mov_b32 v200, 0
    v_mov_b32 v201, 0
    v_mov_b32 v202, 0
    v_mov_b32 v203, 0
    v_mov_b32 v204, 0
    v_mov_b32 v205, 0
    v_mov_b32 v206, 0
    v_mov_b32 v207, 0
    v_mov_b32 v208, 0
    v_mov_b32 v209, 0
    v_mov_b32 v210, 0
    v_mov_b32 v211, 0
    v_mov_b32 v212, 0
    v_mov_b32 v213, 0
    v_mov_b32 v214, 0
    v_mov_b32 v215, 0
    v_mov_b32 v216, 0
    v_mov_b32 v217, 0
    v_mov_b32 v218, 0
    v_mov_b32 v219, 0
    v_mov_b32 v220, 0
    v_mov_b32 v221, 0
    v_mov_b32 v222, 0
    v_mov_b32 v223, 0
    v_mov_b32 v224, 0
    v_mov_b32 v225, 0
    v_mov_b32 v226, 0
    v_mov_b32 v227, 0
    v_mov_b32 v228, 0
    v_mov_b32 v229, 0
    v_mov_b32 v230, 0
    v_mov_b32 v231, 0
    v_mov_b32 v232, 0
    v_mov_b32 v233, 0
    v_mov_b32 v234, 0
    v_mov_b32 v235, 0
    v_mov_b32 v236, 0
    v_mov_b32 v237, 0
    v_mov_b32 v238, 0
    v_mov_b32 v239, 0
    v_mov_b32 v240, 0
    v_mov_b32 v241, 0
    v_mov_b32 v242, 0
    v_mov_b32 v243, 0
    v_mov_b32 v244, 0
    v_mov_b32 v245, 0
    v_mov_b32 v246, 0
    v_mov_b32 v247, 0
    v_mov_b32 v248, 0
    v_mov_b32 v249, 0
    v_mov_b32 v250, 0
    v_mov_b32 v251, 0
    v_mov_b32 v252, 0
    v_mov_b32 v253, 0
    v_mov_b32 v254, 0
    v_mov_b32 v255, 0
    s_mov_b32 s92, 0
kSL2:
    s_lshl_b32 s80, s92, 13
    s_add_u32 s81, s80, 0x1000
    s_add_u32 s82, s80, 0x1000000
    s_add_u32 s83, s82, 0x1000
    s_cmp_eq_u32 s92, s90
    s_cselect_b32 s96, 1.0, 0
    v_and_b32 v29, 15, v1
    v_lshrrev_b32 v30, 2, v1
    v_and_b32 v30, 12, v30
    v_sub_u32 v29, v29, v30
    s_lshl_b32 s86, s92, 5
    v_subrev_u32 v29, s86, v29
    v_add_u32 v30, s85, v29
    v_add_u32 v29, s84, v29
    s_mov_b32 s96, 0xf1800000
    v_cmp_gt_i32 vcc, 0, v29
    s_nop 1
    v_cndmask_b32 v96, 0, 1.0, vcc
    v_cmp_gt_i32 vcc, 1, v29
    s_nop 1
    v_cndmask_b32 v97, 0, 1.0, vcc
    v_cmp_gt_i32 vcc, 2, v29
    s_nop 1
    v_cndmask_b32 v98, 0, 1.0, vcc
    v_cmp_gt_i32 vcc, 3, v29
    s_nop 1
    v_cndmask_b32 v99, 0, 1.0, vcc
    v_cmp_gt_i32 vcc, 16, v29
    s_nop 1
    v_cndmask_b32 v100, 0, 1.0, vcc
    v_cmp_gt_i32 vcc, 17, v29
    s_nop 1
    v_cndmask_b32 v101, 0, 1.0, vcc
    v_cmp_gt_i32 vcc, 18, v29
    s_nop 1
    v_cndmask_b32 v102, 0, 1.0, vcc
    v_cmp_gt_i32 vcc, 19, v29
    s_nop 1
    v_cndmask_b32 v103, 0, 1.0, vcc
    v_cmp_gt_i32 vcc, 0, v30
    s_nop 1
    v_cndmask_b32 v104, 0, 1.0, vcc
    v_cmp_gt_i32 vcc, 1, v30
    s_nop 1
    v_cndmask_b32 v105, 0, 1.0, vcc
    v_cmp_gt_i32 vcc, 2, v30
    s_nop 1
    v_cndmask_b32 v106, 0, 1.0, vcc
    v_cmp_gt_i32 vcc, 3, v30
    s_nop 1
    v_cndmask_b32 v107, 0, 1.0, vcc
    v_cmp_gt_i32 vcc, 16, v30
    s_nop 1
    v_cndmask_b32 v108, 0, 1.0, vcc
    v_cmp_gt_i32 vcc, 17, v30
    s_nop 1
    v_cndmask_b32 v109, 0, 1.0, vcc
    v_cmp_gt_i32 vcc, 18, v30
    s_nop 1
    v_cndmask_b32 v110, 0, 1.0, vcc
    v_cmp_gt_i32 vcc, 19, v30
    s_nop 1
    v_cndmask_b32 v111, 0, 1.0, vcc
    buffer_load_dwordx4 a[64:67], v2, s[52:55], s80 offen sc1
    buffer_load_dwordx4 a[68:71], v2, s[52:55], s80 offen offset:1024 sc1
    buffer_load_dwordx4 a[72:75], v2, s[52:55], s80 offen offset:2048 sc1
    buffer_load_dwordx4 a[76:79], v2, s[52:55], s80 offen offset:3072 sc1
    buffer_load_dwordx4 a[80:83], v2, s[52:55], s81 offen sc1
    buffer_load_dwordx4 a[84:87], v2, s[52:55], s81 offen offset:1024 sc1
    buffer_load_dwordx4 a[88:91], v2, s[52:55], s81 offen offset:2048 sc1
    buffer_load_dwordx4 a[92:95], v2, s[52:55], s81 offen offset:3072 sc1
    buffer_load_dwordx4 a[96:99], v2, s[52:55], s82 offen sc1
    buffer_load_dwordx4 a[100:103], v2, s[52:55], s82 offen offset:1024 sc1
    buffer_load_dwordx4 a[104:107], v2, s[52:55], s82 offen offset:2048 sc1
    buffer_load_dwordx4 a[108:111], v2, s[52:55], s82 offen offset:3072 sc1
    buffer_load_dwordx4 a[112:115], v2, s[52:55], s83 offen sc1
    buffer_load_dwordx4 a[116:119], v2, s[52:55], s83 offen offset:1024 sc1
    buffer_load_dwordx4 a[120:123], v2, s[52:55], s83 offen offset:2048 sc1
    buffer_load_dwordx4 a[124:127], v2, s[52:55], s83 offen offset:3072 sc1
    v_fma_f32 v48, v96, s96, v88
    v_fma_f32 v49, v97, s96, v88
    v_fma_f32 v50, v98, s96, v88
    v_fma_f32 v51, v99, s96, v88
    v_fma_f32 v52, v100, s96, v88
    v_fma_f32 v53, v101, s96, v88
    v_fma_f32 v54, v102, s96, v88
    v_fma_f32 v55, v103, s96, v88
    v_fma_f32 v56, v104, s96, v92
    v_fma_f32 v57, v105, s96, v92
    v_fma_f32 v58, v106, s96, v92
    v_fma_f32 v59, v107, s96, v92
    v_fma_f32 v60, v108, s96, v92
    v_fma_f32 v61, v109, s96, v92
    v_fma_f32 v62, v110, s96, v92
    v_fma_f32 v63, v111, s96, v92
    s_waitcnt vmcnt(15)
    v_mfma_f32_16x16x32_bf16 v[48:51], a[64:67], a[32:35], v[48:51]
    s_waitcnt vmcnt(14)
    v_mfma_f32_16x16x32_bf16 v[48:51], a[68:71], a[36:39], v[48:51]
    s_waitcnt vmcnt(13)
    v_mfma_f32_16x16x32_bf16 v[48:51], a[72:75], a[40:43], v[48:51]
    s_waitcnt vmcnt(12)
    v_mfma_f32_16x16x32_bf16 v[48:51], a[76:79], a[44:47], v[48:51]
    v_mfma_f32_16x16x32_bf16 v[56:59], a[64:67], a[48:51], v[56:59]
    v_mfma_f32_16x16x32_bf16 v[56:59], a[68:71], a[52:55], v[56:59]
    v_mfma_f32_16x16x32_bf16 v[56:59], a[72:75], a[56:59], v[56:59]
    v_mfma_f32_16x16x32_bf16 v[56:59], a[76:79], a[60:63], v[56:59]
    s_waitcnt vmcnt(11)
    v_mfma_f32_16x16x32_bf16 v[52:55], a[80:83], a[32:35], v[52:55]
    s_waitcnt vmcnt(10)
    v_mfma_f32_16x16x32_bf16 v[52:55], a[84:87], a[36:39], v[52:55]
    s_waitcnt vmcnt(9)
    v_mfma_f32_16x16x32_bf16 v[52:55], a[88:91], a[40:43], v[52:55]
    s_waitcnt vmcnt(8)
    v_mfma_f32_16x16x32_bf16 v[52:55], a[92:95], a[44:47], v[52:55]
    v_mfma_f32_16x16x32_bf16 v[60:63], a[80:83], a[48:51], v[60:63]
    v_mfma_f32_16x16x32_bf16 v[60:63], a[84:87], a[52:55], v[60:63]
    v_mfma_f32_16x16x32_bf16 v[60:63], a[88:91], a[56:59], v[60:63]
    v_mfma_f32_16x16x32_bf16 v[60:63], a[92:95], a[60:63], v[60:63]
    v_exp_f32 v4, v48
    v_exp_f32 v5, v49
    s_nop 0
    v_cvt_pk_bf16_f32 v72, v4, v5
    v_exp_f32 v6, v50
    v_exp_f32 v7, v51
    s_nop 0
    v_cvt_pk_bf16_f32 v73, v6, v7
    v_exp_f32 v8, v52
    v_exp_f32 v9, v53
    s_nop 0
    v_cvt_pk_bf16_f32 v74, v8, v9
    v_exp_f32 v10, v54
    v_exp_f32 v11, v55
    s_nop 0
    v_cvt_pk_bf16_f32 v75, v10, v11
    v_exp_f32 v4, v56
    v_exp_f32 v5, v57
    s_nop 0
    v_cvt_pk_bf16_f32 v76, v4, v5
    v_exp_f32 v6, v58
    v_exp_f32 v7, v59
    s_nop 0
    v_cvt_pk_bf16_f32 v77, v6, v7
    v_exp_f32 v8, v60
    v_exp_f32 v9, v61
    s_nop 0
    v_cvt_pk_bf16_f32 v78, v8, v9
    v_exp_f32 v10, v62
    v_exp_f32 v11, v63
    s_nop 0
    v_cvt_pk_bf16_f32 v79, v10, v11
    s_nop 1
    v_smfmac_f32_16x16x64_bf16 v[120:123], v[12:15], v[72:79], v124
    s_waitcnt vmcnt(7)
    v_mfma_f32_16x16x32_bf16 v[192:195], a[96:99], v[72:75], v[192:195]
    v_mfma_f32_16x16x32_bf16 v[200:203], a[96:99], v[76:79], v[200:203]
    s_waitcnt vmcnt(6)
    v_mfma_f32_16x16x32_bf16 v[196:199], a[100:103], v[72:75], v[196:199]
    v_mfma_f32_16x16x32_bf16 v[204:207], a[100:103], v[76:79], v[204:207]
    s_waitcnt vmcnt(5)
    v_mfma_f32_16x16x32_bf16 v[208:211], a[104:107], v[72:75], v[208:211]
    v_mfma_f32_16x16x32_bf16 v[216:219], a[104:107], v[76:79], v[216:219]
    s_waitcnt vmcnt(4)
    v_mfma_f32_16x16x32_bf16 v[212:215], a[108:111], v[72:75], v[212:215]
    v_mfma_f32_16x16x32_bf16 v[220:223], a[108:111], v[76:79], v[220:223]
    s_waitcnt vmcnt(3)
    v_mfma_f32_16x16x32_bf16 v[224:227], a[112:115], v[72:75], v[224:227]
    v_mfma_f32_16x16x32_bf16 v[232:235], a[112:115], v[76:79], v[232:235]
    s_waitcnt vmcnt(2)
    v_mfma_f32_16x16x32_bf16 v[228:231], a[116:119], v[72:75], v[228:231]
    v_mfma_f32_16x16x32_bf16 v[236:239], a[116:119], v[76:79], v[236:239]
    s_waitcnt vmcnt(1)
    v_mfma_f32_16x16x32_bf16 v[240:243], a[120:123], v[72:75], v[240:243]
    v_mfma_f32_16x16x32_bf16 v[248:251], a[120:123], v[76:79], v[248:251]
    s_waitcnt vmcnt(0)
    v_mfma_f32_16x16x32_bf16 v[244:247], a[124:127], v[72:75], v[244:247]
    v_mfma_f32_16x16x32_bf16 v[252:255], a[124:127], v[76:79], v[252:255]
    s_nop 7
    s_add_u32 s92, s92, 1
    s_cmp_le_u32 s92, s90
    s_cbranch_scc1 kSL2
    v_add_f32 v120, v120, v121
    v_add_f32 v122, v122, v123
    v_rcp_f32 v120, v120
    v_rcp_f32 v122, v122
    v_mul_f32 v192, v192, v120
    v_mul_f32 v193, v193, v120
    v_mul_f32 v194, v194, v120
    v_mul_f32 v195, v195, v120
    v_mul_f32 v196, v196, v120
    v_mul_f32 v197, v197, v120
    v_mul_f32 v198, v198, v120
    v_mul_f32 v199, v199, v120
    v_cvt_pk_bf16_f32 v192, v192, v193
    v_cvt_pk_bf16_f32 v193, v194, v195
    v_cvt_pk_bf16_f32 v194, v196, v197
    v_cvt_pk_bf16_f32 v195, v198, v199
    buffer_store_dwordx4 v[192:195], v0, s[56:59], s94 offen sc1
    v_mul_f32 v200, v200, v122
    v_mul_f32 v201, v201, v122
    v_mul_f32 v202, v202, v122
    v_mul_f32 v203, v203, v122
    v_mul_f32 v204, v204, v122
    v_mul_f32 v205, v205, v122
    v_mul_f32 v206, v206, v122
    v_mul_f32 v207, v207, v122
    v_cvt_pk_bf16_f32 v200, v200, v201
    v_cvt_pk_bf16_f32 v201, v202, v203
    v_cvt_pk_bf16_f32 v202, v204, v205
    v_cvt_pk_bf16_f32 v203, v206, v207
    buffer_store_dwordx4 v[200:203], v0, s[56:59], s97 offen sc1
    v_mul_f32 v208, v208, v120
    v_mul_f32 v209, v209, v120
    v_mul_f32 v210, v210, v120
    v_mul_f32 v211, v211, v120
    v_mul_f32 v212, v212, v120
    v_mul_f32 v213, v213, v120
    v_mul_f32 v214, v214, v120
    v_mul_f32 v215, v215, v120
    v_cvt_pk_bf16_f32 v208, v208, v209
    v_cvt_pk_bf16_f32 v209, v210, v211
    v_cvt_pk_bf16_f32 v210, v212, v213
    v_cvt_pk_bf16_f32 v211, v214, v215
    buffer_store_dwordx4 v[208:211], v0, s[56:59], s94 offen offset:2048 sc1
    v_mul_f32 v216, v216, v122
    v_mul_f32 v217, v217, v122
    v_mul_f32 v218, v218, v122
    v_mul_f32 v219, v219, v122
    v_mul_f32 v220, v220, v122
    v_mul_f32 v221, v221, v122
    v_mul_f32 v222, v222, v122
    v_mul_f32 v223, v223, v122
    v_cvt_pk_bf16_f32 v216, v216, v217
    v_cvt_pk_bf16_f32 v217, v218, v219
    v_cvt_pk_bf16_f32 v218, v220, v221
    v_cvt_pk_bf16_f32 v219, v222, v223
    buffer_store_dwordx4 v[216:219], v0, s[56:59], s97 offen offset:2048 sc1
    s_add_u32 s94, s94, 0x1000
    s_add_u32 s97, s97, 0x1000
    v_mul_f32 v224, v224, v120
    v_mul_f32 v225, v225, v120
    v_mul_f32 v226, v226, v120
    v_mul_f32 v227, v227, v120
    v_mul_f32 v228, v228, v120
    v_mul_f32 v229, v229, v120
    v_mul_f32 v230, v230, v120
    v_mul_f32 v231, v231, v120
    v_cvt_pk_bf16_f32 v224, v224, v225
    v_cvt_pk_bf16_f32 v225, v226, v227
    v_cvt_pk_bf16_f32 v226, v228, v229
    v_cvt_pk_bf16_f32 v227, v230, v231
    buffer_store_dwordx4 v[224:227], v0, s[56:59], s94 offen sc1
    v_mul_f32 v232, v232, v122
    v_mul_f32 v233, v233, v122
    v_mul_f32 v234, v234, v122
    v_mul_f32 v235, v235, v122
    v_mul_f32 v236, v236, v122
    v_mul_f32 v237, v237, v122
    v_mul_f32 v238, v238, v122
    v_mul_f32 v239, v239, v122
    v_cvt_pk_bf16_f32 v232, v232, v233
    v_cvt_pk_bf16_f32 v233, v234, v235
    v_cvt_pk_bf16_f32 v234, v236, v237
    v_cvt_pk_bf16_f32 v235, v238, v239
    buffer_store_dwordx4 v[232:235], v0, s[56:59], s97 offen sc1
    v_mul_f32 v240, v240, v120
    v_mul_f32 v241, v241, v120
    v_mul_f32 v242, v242, v120
    v_mul_f32 v243, v243, v120
    v_mul_f32 v244, v244, v120
    v_mul_f32 v245, v245, v120
    v_mul_f32 v246, v246, v120
    v_mul_f32 v247, v247, v120
    v_cvt_pk_bf16_f32 v240, v240, v241
    v_cvt_pk_bf16_f32 v241, v242, v243
    v_cvt_pk_bf16_f32 v242, v244, v245
    v_cvt_pk_bf16_f32 v243, v246, v247
    buffer_store_dwordx4 v[240:243], v0, s[56:59], s94 offen offset:2048 sc1
    v_mul_f32 v248, v248, v122
    v_mul_f32 v249, v249, v122
    v_mul_f32 v250, v250, v122
    v_mul_f32 v251, v251, v122
    v_mul_f32 v252, v252, v122
    v_mul_f32 v253, v253, v122
    v_mul_f32 v254, v254, v122
    v_mul_f32 v255, v255, v122
    v_cvt_pk_bf16_f32 v248, v248, v249
    v_cvt_pk_bf16_f32 v249, v250, v251
    v_cvt_pk_bf16_f32 v250, v252, v253
    v_cvt_pk_bf16_f32 v251, v254, v255
    buffer_store_dwordx4 v[248:251], v0, s[56:59], s97 offen offset:2048 sc1
    s_waitcnt vmcnt(0)
    s_cmp_lg_u32 s95, 0
    s_cbranch_scc1 kSL
    s_branch kSLr
fk_w4_slow:
    s_mov_b32 s12, 0x20000
fk_w4_spin:
    s_sleep 8
    buffer_load_dword v27, v28, s[68:71], s89 offen sc1
    s_waitcnt vmcnt(0)
    v_cmp_eq_u32 vcc, 1, v27
    s_nop 0
    s_bfe_u32 s11, vcc_lo, 0x80000
    s_cmp_ge_u32 s11, 255
    s_cbranch_scc1 fk_w4_ok
    s_sub_u32 s12, s12, 1
    s_cmp_lg_u32 s12, 0
    s_cbranch_scc1 fk_w4_spin
    s_branch fk_w4_ok
fk_w5_slow:
    s_mov_b32 s12, 0x20000
fk_w5_spin:
    s_sleep 1
    buffer_load_dword v27, v28, s[68:71], s89 offen sc1
    s_waitcnt vmcnt(0)
    v_cmp_eq_u32 vcc, 1, v27
    s_nop 0
    s_bfe_u32 s11, vcc_lo, 0x80000
    s_cmp_ge_u32 s11, 255
    s_cbranch_scc1 fk_w5_ok
    s_sub_u32 s12, s12, 1
    s_cmp_lg_u32 s12, 0
    s_cbranch_scc1 fk_w5_spin
    s_branch fk_w5_ok
fk_w6_slow:
    s_mov_b32 s12, 0x20000
fk_w6_spin:
    s_sleep 8
    buffer_load_dword v27, v28, s[68:71], s98 offen sc1
    s_waitcnt vmcnt(0)
    v_cmp_eq_u32 vcc, 1, v27
    s_nop 0
    s_bfe_u32 s11, vcc_lo, 0x10000
    s_cmp_ge_u32 s11, 1
    s_cbranch_scc1 fk_w6_ok
    s_sub_u32 s12, s12, 1
    s_cmp_lg_u32 s12, 0
    s_cbranch_scc1 fk_w6_spin
    s_branch fk_w6_ok
fk_w8_slow:
    s_mov_b32 s12, 0x20000
fk_w8_spin:
    s_sleep 8
    buffer_load_dword v27, v28, s[68:71], s101 offen sc1
    s_waitcnt vmcnt(0)
    v_cmp_eq_u32 vcc, 1, v27
    s_nop 0
    s_bfe_u32 s11, vcc_lo, 0x70000
    s_cmp_ge_u32 s11, 127
    s_cbranch_scc1 fk_w8_ok
    s_sub_u32 s12, s12, 1
    s_cmp_lg_u32 s12, 0
    s_cbranch_scc1 fk_w8_spin
    s_branch fk_w8_ok
fk_w7_slow:
    s_mov_b32 s12, 0x20000
fk_w7_spin:
    s_sleep 8
    buffer_load_dword v27, v28, s[68:71], s100 offen sc1
    s_waitcnt vmcnt(0)
    v_cmp_eq_u32 vcc, 1, v27
    s_nop 0
    s_bcnt1_i32_b64 s11, vcc
    s_cmp_ge_u32 s11, 16
    s_cbranch_scc1 fk_w7_ok
    s_sub_u32 s12, s12, 1
    s_cmp_lg_u32 s12, 0
    s_cbranch_scc1 fk_w7_spin
    s_branch fk_w7_ok
fk_ln0:
    s_waitcnt vmcnt(0) lgkmcnt(0)
    s_branch fk_ln1
fk_ln2:
    s_waitcnt vmcnt(14)
    s_mov_b32 s62, 0
    v_add_u32 v22, 0x200, v22
fk_ln1:
    v_accvgpr_read_b32 v132, a96
    v_accvgpr_read_b32 v133, a97
    v_accvgpr_read_b32 v134, a98
    v_accvgpr_read_b32 v135, a99
    s_mov_b32 s13, 0x0
    buffer_load_dwordx4 a[96:99], v22, s[60:63], s13 offen offset:512 sc1
    v_lshlrev_b32 v128, 16, v132
    v_and_b32 v129, 0xffff0000, v132
    v_lshlrev_b32 v130, 16, v133
    v_and_b32 v131, 0xffff0000, v133
    v_lshlrev_b32 v132, 16, v134
    v_and_b32 v133, 0xffff0000, v134
    v_lshlrev_b32 v134, 16, v135
    v_and_b32 v135, 0xffff0000, v135
    v_pk_mul_f32 v[72:73], v[128:129], v[128:129]
    v_pk_mul_f32 v[74:75], v[130:131], v[130:131]
    v_pk_mul_f32 v[76:77], v[132:133], v[132:133]
    v_pk_mul_f32 v[78:79], v[134:135], v[134:135]
    v_accvgpr_read_b32 v140, a100
    v_accvgpr_read_b32 v141, a101
    v_accvgpr_read_b32 v142, a102
    v_accvgpr_read_b32 v143, a103
    s_mov_b32 s13, 0x40000
    buffer_load_dwordx4 a[100:103], v22, s[60:63], s13 offen offset:512 sc1
    v_lshlrev_b32 v136, 16, v140
    v_and_b32 v137, 0xffff0000, v140
    v_lshlrev_b32 v138, 16, v141
    v_and_b32 v139, 0xffff0000, v141
    v_lshlrev_b32 v140, 16, v142
    v_and_b32 v141, 0xffff0000, v142
    v_lshlrev_b32 v142, 16, v143
    v_and_b32 v143, 0xffff0000, v143
    v_pk_add_f32 v[64:65], v[128:129], v[136:137]
    v_pk_add_f32 v[66:67], v[130:131], v[138:139]
    v_pk_add_f32 v[68:69], v[132:133], v[140:141]
    v_pk_add_f32 v[70:71], v[134:135], v[142:143]
    v_pk_fma_f32 v[72:73], v[136:137], v[136:137], v[72:73]
    v_pk_fma_f32 v[74:75], v[138:139], v[138:139], v[74:75]
    v_pk_fma_f32 v[76:77], v[140:141], v[140:141], v[76:77]
    v_pk_fma_f32 v[78:79], v[142:143], v[142:143], v[78:79]
    v_accvgpr_read_b32 v148, a104
    v_accvgpr_read_b32 v149, a105
    v_accvgpr_read_b32 v150, a106
    v_accvgpr_read_b32 v151, a107
    s_mov_b32 s13, 0x80000
    buffer_load_dwordx4 a[104:107], v22, s[60:63], s13 offen offset:512 sc1
    v_lshlrev_b32 v144, 16, v148
    v_and_b32 v145, 0xffff0000, v148
    v_lshlrev_b32 v146, 16, v149
    v_and_b32 v147, 0xffff0000, v149
    v_lshlrev_b32 v148, 16, v150
    v_and_b32 v149, 0xffff0000, v150
    v_lshlrev_b32 v150, 16, v151
    v_and_b32 v151, 0xffff0000, v151
    v_pk_add_f32 v[64:65], v[64:65], v[144:145]
    v_pk_add_f32 v[66:67], v[66:67], v[146:147]
    v_pk_add_f32 v[68:69], v[68:69], v[148:149]
    v_pk_add_f32 v[70:71], v[70:71], v[150:151]
    v_pk_fma_f32 v[72:73], v[144:145], v[144:145], v[72:73]
    v_pk_fma_f32 v[74:75], v[146:147], v[146:147], v[74:75]
    v_pk_fma_f32 v[76:77], v[148:149], v[148:149], v[76:77]
    v_pk_fma_f32 v[78:79], v[150:151], v[150:151], v[78:79]
    v_accvgpr_read_b32 v156, a108
    v_accvgpr_read_b32 v157, a109
    v_accvgpr_read_b32 v158, a110
    v_accvgpr_read_b32 v159, a111
    s_mov_b32 s13, 0xc0000
    buffer_load_dwordx4 a[108:111], v22, s[60:63], s13 offen offset:512 sc1
    v_lshlrev_b32 v152, 16, v156
    v_and_b32 v153, 0xffff0000, v156
    v_lshlrev_b32 v154, 16, v157
    v_and_b32 v155, 0xffff0000, v157
    v_lshlrev_b32 v156, 16, v158
    v_and_b32 v157, 0xffff0000, v158
    v_lshlrev_b32 v158, 16, v159
    v_and_b32 v159, 0xffff0000, v159
    v_pk_add_f32 v[64:65], v[64:65], v[152:153]
    v_pk_add_f32 v[66:67], v[66:67], v[154:155]
    v_pk_add_f32 v[68:69], v[68:69], v[156:157]
    v_pk_add_f32 v[70:71], v[70:71], v[158:159]
    v_pk_fma_f32 v[72:73], v[152:153], v[152:153], v[72:73]
    v_pk_fma_f32 v[74:75], v[154:155], v[154:155], v[74:75]
    v_pk_fma_f32 v[76:77], v[156:157], v[156:157], v[76:77]
    v_pk_fma_f32 v[78:79], v[158:159], v[158:159], v[78:79]
    v_accvgpr_read_b32 v164, a112
    v_accvgpr_read_b32 v165, a113
    v_accvgpr_read_b32 v166, a114
    v_accvgpr_read_b32 v167, a115
    s_mov_b32 s13, 0x100000
    buffer_load_dwordx4 a[112:115], v22, s[60:63], s13 offen offset:512 sc1
    v_lshlrev_b32 v160, 16, v164
    v_and_b32 v161, 0xffff0000, v164
    v_lshlrev_b32 v162, 16, v165
    v_and_b32 v163, 0xffff0000, v165
    v_lshlrev_b32 v164, 16, v166
    v_and_b32 v165, 0xffff0000, v166
    v_lshlrev_b32 v166, 16, v167
    v_and_b32 v167, 0xffff0000, v167
    v_pk_add_f32 v[64:65], v[64:65], v[160:161]
    v_pk_add_f32 v[66:67], v[66:67], v[162:163]
    v_pk_add_f32 v[68:69], v[68:69], v[164:165]
    v_pk_add_f32 v[70:71], v[70:71], v[166:167]
    v_pk_fma_f32 v[72:73], v[160:161], v[160:161], v[72:73]
    v_pk_fma_f32 v[74:75], v[162:163], v[162:163], v[74:75]
    v_pk_fma_f32 v[76:77], v[164:165], v[164:165], v[76:77]
    v_pk_fma_f32 v[78:79], v[166:167], v[166:167], v[78:79]
    v_accvgpr_read_b32 v172, a116
    v_accvgpr_read_b32 v173, a117
    v_accvgpr_read_b32 v174, a118
    v_accvgpr_read_b32 v175, a119
    s_mov_b32 s13, 0x140000
    buffer_load_dwordx4 a[116:119], v22, s[60:63], s13 offen offset:512 sc1
    v_lshlrev_b32 v168, 16, v172
    v_and_b32 v169, 0xffff0000, v172
    v_lshlrev_b32 v170, 16, v173
    v_and_b32 v171, 0xffff0000, v173
    v_lshlrev_b32 v172, 16, v174
    v_and_b32 v173, 0xffff0000, v174
    v_lshlrev_b32 v174, 16, v175
    v_and_b32 v175, 0xffff0000, v175
    v_pk_add_f32 v[64:65], v[64:65], v[168:169]
    v_pk_add_f32 v[66:67], v[66:67], v[170:171]
    v_pk_add_f32 v[68:69], v[68:69], v[172:173]
    v_pk_add_f32 v[70:71], v[70:71], v[174:175]
    v_pk_fma_f32 v[72:73], v[168:169], v[168:169], v[72:73]
    v_pk_fma_f32 v[74:75], v[170:171], v[170:171], v[74:75]
    v_pk_fma_f32 v[76:77], v[172:173], v[172:173], v[76:77]
    v_pk_fma_f32 v[78:79], v[174:175], v[174:175], v[78:79]
    v_accvgpr_read_b32 v180, a120
    v_accvgpr_read_b32 v181, a121
    v_accvgpr_read_b32 v182, a122
    v_accvgpr_read_b32 v183, a123
    s_mov_b32 s13, 0x180000
    buffer_load_dwordx4 a[120:123], v22, s[60:63], s13 offen offset:512 sc1
    v_lshlrev_b32 v176, 16, v180
    v_and_b32 v177, 0xffff0000, v180
    v_lshlrev_b32 v178, 16, v181
    v_and_b32 v179, 0xffff0000, v181
    v_lshlrev_b32 v180, 16, v182
    v_and_b32 v181, 0xffff0000, v182
    v_lshlrev_b32 v182, 16, v183
    v_and_b32 v183, 0xffff0000, v183
    v_pk_add_f32 v[64:65], v[64:65], v[176:177]
    v_pk_add_f32 v[66:67], v[66:67], v[178:179]
    v_pk_add_f32 v[68:69], v[68:69], v[180:181]
    v_pk_add_f32 v[70:71], v[70:71], v[182:183]
    v_pk_fma_f32 v[72:73], v[176:177], v[176:177], v[72:73]
    v_pk_fma_f32 v[74:75], v[178:179], v[178:179], v[74:75]
    v_pk_fma_f32 v[76:77], v[180:181], v[180:181], v[76:77]
    v_pk_fma_f32 v[78:79], v[182:183], v[182:183], v[78:79]
    v_accvgpr_read_b32 v188, a124
    v_accvgpr_read_b32 v189, a125
    v_accvgpr_read_b32 v190, a126
    v_accvgpr_read_b32 v191, a127
    s_mov_b32 s13, 0x1c0000
    buffer_load_dwordx4 a[124:127], v22, s[60:63], s13 offen offset:512 sc1
    v_lshlrev_b32 v184, 16, v188
    v_and_b32 v185, 0xffff0000, v188
    v_lshlrev_b32 v186, 16, v189
    v_and_b32 v187, 0xffff0000, v189
    v_lshlrev_b32 v188, 16, v190
    v_and_b32 v189, 0xffff0000, v190
    v_lshlrev_b32 v190, 16, v191
    v_and_b32 v191, 0xffff0000, v191
    v_pk_add_f32 v[64:65], v[64:65], v[184:185]
    v_pk_add_f32 v[66:67], v[66:67], v[186:187]
    v_pk_add_f32 v[68:69], v[68:69], v[188:189]
    v_pk_add_f32 v[70:71], v[70:71], v[190:191]
    v_pk_fma_f32 v[72:73], v[184:185], v[184:185], v[72:73]
    v_pk_fma_f32 v[74:75], v[186:187], v[186:187], v[74:75]
    v_pk_fma_f32 v[76:77], v[188:189], v[188:189], v[76:77]
    v_pk_fma_f32 v[78:79], v[190:191], v[190:191], v[78:79]
    v_accvgpr_read_b32 v196, a128
    v_accvgpr_read_b32 v197, a129
    v_accvgpr_read_b32 v198, a130
    v_accvgpr_read_b32 v199, a131
    s_mov_b32 s13, 0x200000
    buffer_load_dwordx4 a[128:131], v22, s[60:63], s13 offen offset:512 sc1
    v_lshlrev_b32 v192, 16, v196
    v_and_b32 v193, 0xffff0000, v196
    v_lshlrev_b32 v194, 16, v197
    v_and_b32 v195, 0xffff0000, v197
    v_lshlrev_b32 v196, 16, v198
    v_and_b32 v197, 0xffff0000, v198
    v_lshlrev_b32 v198, 16, v199
    v_and_b32 v199, 0xffff0000, v199
    v_pk_add_f32 v[64:65], v[64:65], v[192:193]
    v_pk_add_f32 v[66:67], v[66:67], v[194:195]
    v_pk_add_f32 v[68:69], v[68:69], v[196:197]
    v_pk_add_f32 v[70:71], v[70:71], v[198:199]
    v_pk_fma_f32 v[72:73], v[192:193], v[192:193], v[72:73]
    v_pk_fma_f32 v[74:75], v[194:195], v[194:195], v[74:75]
    v_pk_fma_f32 v[76:77], v[196:197], v[196:197], v[76:77]
    v_pk_fma_f32 v[78:79], v[198:199], v[198:199], v[78:79]
    v_accvgpr_read_b32 v204, a132
    v_accvgpr_read_b32 v205, a133
    v_accvgpr_read_b32 v206, a134
    v_accvgpr_read_b32 v207, a135
    s_mov_b32 s13, 0x240000
    buffer_load_dwordx4 a[132:135], v22, s[60:63], s13 offen offset:512 sc1
    v_lshlrev_b32 v200, 16, v204
    v_and_b32 v201, 0xffff0000, v204
    v_lshlrev_b32 v202, 16, v205
    v_and_b32 v203, 0xffff0000, v205
    v_lshlrev_b32 v204, 16, v206
    v_and_b32 v205, 0xffff0000, v206
    v_lshlrev_b32 v206, 16, v207
    v_and_b32 v207, 0xffff0000, v207
    v_pk_add_f32 v[64:65], v[64:65], v[200:201]
    v_pk_add_f32 v[66:67], v[66:67], v[202:203]
    v_pk_add_f32 v[68:69], v[68:69], v[204:205]
    v_pk_add_f32 v[70:71], v[70:71], v[206:207]
    v_pk_fma_f32 v[72:73], v[200:201], v[200:201], v[72:73]
    v_pk_fma_f32 v[74:75], v[202:203], v[202:203], v[74:75]
    v_pk_fma_f32 v[76:77], v[204:205], v[204:205], v[76:77]
    v_pk_fma_f32 v[78:79], v[206:207], v[206:207], v[78:79]
    v_accvgpr_read_b32 v212, a136
    v_accvgpr_read_b32 v213, a137
    v_accvgpr_read_b32 v214, a138
    v_accvgpr_read_b32 v215, a139
    s_mov_b32 s13, 0x280000
    buffer_load_dwordx4 a[136:139], v22, s[60:63], s13 offen offset:512 sc1
    v_lshlrev_b32 v208, 16, v212
    v_and_b32 v209, 0xffff0000, v212
    v_lshlrev_b32 v210, 16, v213
    v_and_b32 v211, 0xffff0000, v213
    v_lshlrev_b32 v212, 16, v214
    v_and_b32 v213, 0xffff0000, v214
    v_lshlrev_b32 v214, 16, v215
    v_and_b32 v215, 0xffff0000, v215
    v_pk_add_f32 v[64:65], v[64:65], v[208:209]
    v_pk_add_f32 v[66:67], v[66:67], v[210:211]
    v_pk_add_f32 v[68:69], v[68:69], v[212:213]
    v_pk_add_f32 v[70:71], v[70:71], v[214:215]
    v_pk_fma_f32 v[72:73], v[208:209], v[208:209], v[72:73]
    v_pk_fma_f32 v[74:75], v[210:211], v[210:211], v[74:75]
    v_pk_fma_f32 v[76:77], v[212:213], v[212:213], v[76:77]
    v_pk_fma_f32 v[78:79], v[214:215], v[214:215], v[78:79]
    v_accvgpr_read_b32 v220, a140
    v_accvgpr_read_b32 v221, a141
    v_accvgpr_read_b32 v222, a142
    v_accvgpr_read_b32 v223, a143
    s_mov_b32 s13, 0x2c0000
    buffer_load_dwordx4 a[140:143], v22, s[60:63], s13 offen offset:512 sc1
    v_lshlrev_b32 v216, 16, v220
    v_and_b32 v217, 0xffff0000, v220
    v_lshlrev_b32 v218, 16, v221
    v_and_b32 v219, 0xffff0000, v221
    v_lshlrev_b32 v220, 16, v222
    v_and_b32 v221, 0xffff0000, v222
    v_lshlrev_b32 v222, 16, v223
    v_and_b32 v223, 0xffff0000, v223
    v_pk_add_f32 v[64:65], v[64:65], v[216:217]
    v_pk_add_f32 v[66:67], v[66:67], v[218:219]
    v_pk_add_f32 v[68:69], v[68:69], v[220:221]
    v_pk_add_f32 v[70:71], v[70:71], v[222:223]
    v_pk_fma_f32 v[72:73], v[216:217], v[216:217], v[72:73]
    v_pk_fma_f32 v[74:75], v[218:219], v[218:219], v[74:75]
    v_pk_fma_f32 v[76:77], v[220:221], v[220:221], v[76:77]
    v_pk_fma_f32 v[78:79], v[222:223], v[222:223], v[78:79]
    v_accvgpr_read_b32 v228, a144
    v_accvgpr_read_b32 v229, a145
    v_accvgpr_read_b32 v230, a146
    v_accvgpr_read_b32 v231, a147
    s_mov_b32 s13, 0x300000
    buffer_load_dwordx4 a[144:147], v22, s[60:63], s13 offen offset:512 sc1
    v_lshlrev_b32 v224, 16, v228
    v_and_b32 v225, 0xffff0000, v228
    v_lshlrev_b32 v226, 16, v229
    v_and_b32 v227, 0xffff0000, v229
    v_lshlrev_b32 v228, 16, v230
    v_and_b32 v229, 0xffff0000, v230
    v_lshlrev_b32 v230, 16, v231
    v_and_b32 v231, 0xffff0000, v231
    v_pk_add_f32 v[64:65], v[64:65], v[224:225]
    v_pk_add_f32 v[66:67], v[66:67], v[226:227]
    v_pk_add_f32 v[68:69], v[68:69], v[228:229]
    v_pk_add_f32 v[70:71], v[70:71], v[230:231]
    v_pk_fma_f32 v[72:73], v[224:225], v[224:225], v[72:73]
    v_pk_fma_f32 v[74:75], v[226:227], v[226:227], v[74:75]
    v_pk_fma_f32 v[76:77], v[228:229], v[228:229], v[76:77]
    v_pk_fma_f32 v[78:79], v[230:231], v[230:231], v[78:79]
    v_accvgpr_read_b32 v236, a148
    v_accvgpr_read_b32 v237, a149
    v_accvgpr_read_b32 v238, a150
    v_accvgpr_read_b32 v239, a151
    s_mov_b32 s13, 0x340000
    buffer_load_dwordx4 a[148:151], v22, s[60:63], s13 offen offset:512 sc1
    v_lshlrev_b32 v232, 16, v236
    v_and_b32 v233, 0xffff0000, v236
    v_lshlrev_b32 v234, 16, v237
    v_and_b32 v235, 0xffff0000, v237
    v_lshlrev_b32 v236, 16, v238
    v_and_b32 v237, 0xffff0000, v238
    v_lshlrev_b32 v238, 16, v239
    v_and_b32 v239, 0xffff0000, v239
    v_pk_add_f32 v[64:65], v[64:65], v[232:233]
    v_pk_add_f32 v[66:67], v[66:67], v[234:235]
    v_pk_add_f32 v[68:69], v[68:69], v[236:237]
    v_pk_add_f32 v[70:71], v[70:71], v[238:239]
    v_pk_fma_f32 v[72:73], v[232:233], v[232:233], v[72:73]
    v_pk_fma_f32 v[74:75], v[234:235], v[234:235], v[74:75]
    v_pk_fma_f32 v[76:77], v[236:237], v[236:237], v[76:77]
    v_pk_fma_f32 v[78:79], v[238:239], v[238:239], v[78:79]
    v_permlane32_swap_b32 v64, v68
    v_permlane32_swap_b32 v65, v69
    v_permlane32_swap_b32 v66, v70
    v_permlane32_swap_b32 v67, v71
    v_permlane32_swap_b32 v72, v76
    v_permlane32_swap_b32 v73, v77
    v_permlane32_swap_b32 v74, v78
    v_permlane32_swap_b32 v75, v79
    v_add_f32 v64, v64, v68
    v_add_f32 v65, v65, v69
    v_add_f32 v66, v66, v70
    v_add_f32 v67, v67, v71
    v_add_f32 v72, v72, v76
    v_add_f32 v73, v73, v77
    v_add_f32 v74, v74, v78
    v_add_f32 v75, v75, v79
    v_permlane16_swap_b32 v64, v66
    v_permlane16_swap_b32 v65, v67
    v_permlane16_swap_b32 v72, v74
    v_permlane16_swap_b32 v73, v75
    v_add_f32 v64, v64, v66
    v_add_f32 v65, v65, v67
    v_add_f32 v72, v72, v74
    v_add_f32 v73, v73, v75
    v_add_f32_dpp v64, v64, v64 quad_perm:[1,0,3,2] row_mask:0xf bank_mask:0xf
    v_add_f32_dpp v65, v65, v65 quad_perm:[1,0,3,2] row_mask:0xf bank_mask:0xf
    v_add_f32_dpp v72, v72, v72 quad_perm:[1,0,3,2] row_mask:0xf bank_mask:0xf
    v_add_f32_dpp v73, v73, v73 quad_perm:[1,0,3,2] row_mask:0xf bank_mask:0xf
    v_add_f32_dpp v64, v64, v64 quad_perm:[2,3,0,1] row_mask:0xf bank_mask:0xf
    v_add_f32_dpp v65, v65, v65 quad_perm:[2,3,0,1] row_mask:0xf bank_mask:0xf
    v_add_f32_dpp v72, v72, v72 quad_perm:[2,3,0,1] row_mask:0xf bank_mask:0xf
    v_add_f32_dpp v73, v73, v73 quad_perm:[2,3,0,1] row_mask:0xf bank_mask:0xf
    v_add_f32_dpp v64, v64, v64 row_half_mirror row_mask:0xf bank_mask:0xf
    v_add_f32_dpp v65, v65, v65 row_half_mirror row_mask:0xf bank_mask:0xf
    v_add_f32_dpp v72, v72, v72 row_half_mirror row_mask:0xf bank_mask:0xf
    v_add_f32_dpp v73, v73, v73 row_half_mirror row_mask:0xf bank_mask:0xf
    v_add_f32_dpp v64, v64, v64 row_mirror row_mask:0xf bank_mask:0xf
    v_add_f32_dpp v65, v65, v65 row_mirror row_mask:0xf bank_mask:0xf
    v_add_f32_dpp v72, v72, v72 row_mirror row_mask:0xf bank_mask:0xf
    v_add_f32_dpp v73, v73, v73 row_mirror row_mask:0xf bank_mask:0xf
    v_mul_f32 v64, 0xba97b426, v64
    v_mul_f32 v65, 0xba97b426, v65
    v_mul_f32 v72, 0x3a97b426, v72
    v_mul_f32 v73, 0x3a97b426, v73
    v_fma_f32 v72, -v64, v64, v72
    v_fma_f32 v73, -v65, v65, v73
    v_max_f32 v72, 0, v72
    v_max_f32 v73, 0, v73
    v_cvt_pk_bf16_f32 v72, v72, v72
    v_cvt_pk_bf16_f32 v73, v73, v73
    v_lshlrev_b32 v72, 16, v72
    v_lshlrev_b32 v73, 16, v73
    v_add_f32 v72, 0x3727c5ac, v72
    v_add_f32 v73, 0x3727c5ac, v73
    v_cvt_pk_bf16_f32 v72, v72, v72
    v_cvt_pk_bf16_f32 v73, v73, v73
    v_lshlrev_b32 v72, 16, v72
    v_lshlrev_b32 v73, 16, v73
    v_sqrt_f32 v72, v72
    v_sqrt_f32 v73, v73
    v_cvt_pk_bf16_f32 v72, v72, v72
    v_cvt_pk_bf16_f32 v73, v73, v73
    v_lshlrev_b32 v72, 16, v72
    v_lshlrev_b32 v73, 16, v73
    v_rcp_f32 v72, v72
    v_rcp_f32 v73, v73
    v_cvt_pk_bf16_f32 v64, v64, v64
    v_cvt_pk_bf16_f32 v65, v65, v65
    v_lshlrev_b32 v64, 16, v64
    v_lshlrev_b32 v65, 16, v65
    v_mul_f32 v64, v64, v72
    v_mul_f32 v65, v65, v73
    v_readlane_b32 s80, v72, 0
    v_readlane_b32 s81, v73, 0
    v_readlane_b32 s82, v72, 16
    v_readlane_b32 s83, v73, 16
    v_readlane_b32 s84, v72, 32
    v_readlane_b32 s85, v73, 32
    v_readlane_b32 s86, v72, 48
    v_readlane_b32 s87, v73, 48
    v_readlane_b32 s44, v64, 0
    v_readlane_b32 s45, v65, 0
    v_readlane_b32 s46, v64, 16
    v_readlane_b32 s47, v65, 16
    v_readlane_b32 s48, v64, 32
    v_readlane_b32 s49, v65, 32
    v_readlane_b32 s50, v64, 48
    v_readlane_b32 s51, v65, 48
    v_mov_b32 v64, s44
    v_mov_b32 v65, s45
    v_mov_b32 v66, s46
    v_mov_b32 v67, s47
    v_mov_b32 v68, s48
    v_mov_b32 v69, s49
    v_mov_b32 v70, s50
    v_mov_b32 v71, s51
    v_pk_fma_f32 v[128:129], v[128:129], s[80:81], v[64:65]
    v_pk_fma_f32 v[130:131], v[130:131], s[82:83], v[66:67]
    v_pk_fma_f32 v[132:133], v[132:133], s[84:85], v[68:69]
    v_pk_fma_f32 v[134:135], v[134:135], s[86:87], v[70:71]
    v_cvt_pk_bf16_f32 v240, v128, v129
    v_cvt_pk_bf16_f32 v241, v130, v131
    v_cvt_pk_bf16_f32 v242, v132, v133
    v_cvt_pk_bf16_f32 v243, v134, v135
    s_mov_b32 s13, 0x0
    buffer_store_dwordx4 v[240:243], v22, s[72:75], s13 offen sc1
    v_pk_fma_f32 v[136:137], v[136:137], s[80:81], v[64:65]
    v_pk_fma_f32 v[138:139], v[138:139], s[82:83], v[66:67]
    v_pk_fma_f32 v[140:141], v[140:141], s[84:85], v[68:69]
    v_pk_fma_f32 v[142:143], v[142:143], s[86:87], v[70:71]
    v_cvt_pk_bf16_f32 v244, v136, v137
    v_cvt_pk_bf16_f32 v245, v138, v139
    v_cvt_pk_bf16_f32 v246, v140, v141
    v_cvt_pk_bf16_f32 v247, v142, v143
    s_mov_b32 s13, 0x40000
    buffer_store_dwordx4 v[244:247], v22, s[72:75], s13 offen sc1
    v_pk_fma_f32 v[144:145], v[144:145], s[80:81], v[64:65]
    v_pk_fma_f32 v[146:147], v[146:147], s[82:83], v[66:67]
    v_pk_fma_f32 v[148:149], v[148:149], s[84:85], v[68:69]
    v_pk_fma_f32 v[150:151], v[150:151], s[86:87], v[70:71]
    v_cvt_pk_bf16_f32 v248, v144, v145
    v_cvt_pk_bf16_f32 v249, v146, v147
    v_cvt_pk_bf16_f32 v250, v148, v149
    v_cvt_pk_bf16_f32 v251, v150, v151
    s_mov_b32 s13, 0x80000
    buffer_store_dwordx4 v[248:251], v22, s[72:75], s13 offen sc1
    v_pk_fma_f32 v[152:153], v[152:153], s[80:81], v[64:65]
    v_pk_fma_f32 v[154:155], v[154:155], s[82:83], v[66:67]
    v_pk_fma_f32 v[156:157], v[156:157], s[84:85], v[68:69]
    v_pk_fma_f32 v[158:159], v[158:159], s[86:87], v[70:71]
    v_cvt_pk_bf16_f32 v252, v152, v153
    v_cvt_pk_bf16_f32 v253, v154, v155
    v_cvt_pk_bf16_f32 v254, v156, v157
    v_cvt_pk_bf16_f32 v255, v158, v159
    s_mov_b32 s13, 0xc0000
    buffer_store_dwordx4 v[252:255], v22, s[72:75], s13 offen sc1
    v_pk_fma_f32 v[160:161], v[160:161], s[80:81], v[64:65]
    v_pk_fma_f32 v[162:163], v[162:163], s[82:83], v[66:67]
    v_pk_fma_f32 v[164:165], v[164:165], s[84:85], v[68:69]
    v_pk_fma_f32 v[166:167], v[166:167], s[86:87], v[70:71]
    v_cvt_pk_bf16_f32 v240, v160, v161
    v_cvt_pk_bf16_f32 v241, v162, v163
    v_cvt_pk_bf16_f32 v242, v164, v165
    v_cvt_pk_bf16_f32 v243, v166, v167
    s_mov_b32 s13, 0x100000
    buffer_store_dwordx4 v[240:243], v22, s[72:75], s13 offen sc1
    v_pk_fma_f32 v[168:169], v[168:169], s[80:81], v[64:65]
    v_pk_fma_f32 v[170:171], v[170:171], s[82:83], v[66:67]
    v_pk_fma_f32 v[172:173], v[172:173], s[84:85], v[68:69]
    v_pk_fma_f32 v[174:175], v[174:175], s[86:87], v[70:71]
    v_cvt_pk_bf16_f32 v244, v168, v169
    v_cvt_pk_bf16_f32 v245, v170, v171
    v_cvt_pk_bf16_f32 v246, v172, v173
    v_cvt_pk_bf16_f32 v247, v174, v175
    s_mov_b32 s13, 0x140000
    buffer_store_dwordx4 v[244:247], v22, s[72:75], s13 offen sc1
    v_pk_fma_f32 v[176:177], v[176:177], s[80:81], v[64:65]
    v_pk_fma_f32 v[178:179], v[178:179], s[82:83], v[66:67]
    v_pk_fma_f32 v[180:181], v[180:181], s[84:85], v[68:69]
    v_pk_fma_f32 v[182:183], v[182:183], s[86:87], v[70:71]
    v_cvt_pk_bf16_f32 v248, v176, v177
    v_cvt_pk_bf16_f32 v249, v178, v179
    v_cvt_pk_bf16_f32 v250, v180, v181
    v_cvt_pk_bf16_f32 v251, v182, v183
    s_mov_b32 s13, 0x180000
    buffer_store_dwordx4 v[248:251], v22, s[72:75], s13 offen sc1
    v_pk_fma_f32 v[184:185], v[184:185], s[80:81], v[64:65]
    v_pk_fma_f32 v[186:187], v[186:187], s[82:83], v[66:67]
    v_pk_fma_f32 v[188:189], v[188:189], s[84:85], v[68:69]
    v_pk_fma_f32 v[190:191], v[190:191], s[86:87], v[70:71]
    v_cvt_pk_bf16_f32 v252, v184, v185
    v_cvt_pk_bf16_f32 v253, v186, v187
    v_cvt_pk_bf16_f32 v254, v188, v189
    v_cvt_pk_bf16_f32 v255, v190, v191
    s_mov_b32 s13, 0x1c0000
    buffer_store_dwordx4 v[252:255], v22, s[72:75], s13 offen sc1
    v_pk_fma_f32 v[192:193], v[192:193], s[80:81], v[64:65]
    v_pk_fma_f32 v[194:195], v[194:195], s[82:83], v[66:67]
    v_pk_fma_f32 v[196:197], v[196:197], s[84:85], v[68:69]
    v_pk_fma_f32 v[198:199], v[198:199], s[86:87], v[70:71]
    v_cvt_pk_bf16_f32 v240, v192, v193
    v_cvt_pk_bf16_f32 v241, v194, v195
    v_cvt_pk_bf16_f32 v242, v196, v197
    v_cvt_pk_bf16_f32 v243, v198, v199
    s_mov_b32 s13, 0x200000
    buffer_store_dwordx4 v[240:243], v22, s[72:75], s13 offen sc1
    v_pk_fma_f32 v[200:201], v[200:201], s[80:81], v[64:65]
    v_pk_fma_f32 v[202:203], v[202:203], s[82:83], v[66:67]
    v_pk_fma_f32 v[204:205], v[204:205], s[84:85], v[68:69]
    v_pk_fma_f32 v[206:207], v[206:207], s[86:87], v[70:71]
    v_cvt_pk_bf16_f32 v244, v200, v201
    v_cvt_pk_bf16_f32 v245, v202, v203
    v_cvt_pk_bf16_f32 v246, v204, v205
    v_cvt_pk_bf16_f32 v247, v206, v207
    s_mov_b32 s13, 0x240000
    buffer_store_dwordx4 v[244:247], v22, s[72:75], s13 offen sc1
    v_pk_fma_f32 v[208:209], v[208:209], s[80:81], v[64:65]
    v_pk_fma_f32 v[210:211], v[210:211], s[82:83], v[66:67]
    v_pk_fma_f32 v[212:213], v[212:213], s[84:85], v[68:69]
    v_pk_fma_f32 v[214:215], v[214:215], s[86:87], v[70:71]
    v_cvt_pk_bf16_f32 v248, v208, v209
    v_cvt_pk_bf16_f32 v249, v210, v211
    v_cvt_pk_bf16_f32 v250, v212, v213
    v_cvt_pk_bf16_f32 v251, v214, v215
    s_mov_b32 s13, 0x280000
    buffer_store_dwordx4 v[248:251], v22, s[72:75], s13 offen sc1
    v_pk_fma_f32 v[216:217], v[216:217], s[80:81], v[64:65]
    v_pk_fma_f32 v[218:219], v[218:219], s[82:83], v[66:67]
    v_pk_fma_f32 v[220:221], v[220:221], s[84:85], v[68:69]
    v_pk_fma_f32 v[222:223], v[222:223], s[86:87], v[70:71]
    v_cvt_pk_bf16_f32 v252, v216, v217
    v_cvt_pk_bf16_f32 v253, v218, v219
    v_cvt_pk_bf16_f32 v254, v220, v221
    v_cvt_pk_bf16_f32 v255, v222, v223
    s_mov_b32 s13, 0x2c0000
    buffer_store_dwordx4 v[252:255], v22, s[72:75], s13 offen sc1
    v_pk_fma_f32 v[224:225], v[224:225], s[80:81], v[64:65]
    v_pk_fma_f32 v[226:227], v[226:227], s[82:83], v[66:67]
    v_pk_fma_f32 v[228:229], v[228:229], s[84:85], v[68:69]
    v_pk_fma_f32 v[230:231], v[230:231], s[86:87], v[70:71]
    v_cvt_pk_bf16_f32 v240, v224, v225
    v_cvt_pk_bf16_f32 v241, v226, v227
    v_cvt_pk_bf16_f32 v242, v228, v229
    v_cvt_pk_bf16_f32 v243, v230, v231
    s_mov_b32 s13, 0x300000
    buffer_store_dwordx4 v[240:243], v22, s[72:75], s13 offen sc1
    v_pk_fma_f32 v[232:233], v[232:233], s[80:81], v[64:65]
    v_pk_fma_f32 v[234:235], v[234:235], s[82:83], v[66:67]
    v_pk_fma_f32 v[236:237], v[236:237], s[84:85], v[68:69]
    v_pk_fma_f32 v[238:239], v[238:239], s[86:87], v[70:71]
    v_cvt_pk_bf16_f32 v244, v232, v233
    v_cvt_pk_bf16_f32 v245, v234, v235
    v_cvt_pk_bf16_f32 v246, v236, v237
    v_cvt_pk_bf16_f32 v247, v238, v239
    s_mov_b32 s13, 0x340000
    buffer_store_dwordx4 v[244:247], v22, s[72:75], s13 offen sc1
    s_cmp_lg_u32 s62, 0
    s_cbranch_scc1 fk_ln2
    s_waitcnt vmcnt(28)
    s_mov_b32 s74, 0
    s_lshl_b32 s11, s6, 4
    s_add_u32 s11, s11, s7
    s_lshl_b32 s11, s11, 15
    s_add_u32 s11, s11, 0x340000
    s_mov_b32 s12, 0x1008000
    s_add_u32 s84, s42, s11
    s_addc_u32 s85, s43, 0
    s_mov_b32 s86, s12
    s_mov_b32 s87, 0x20000
    s_waitcnt vmcnt(0)
    s_barrier
    s_cmp_lg_u32 s3, 0
    s_cbranch_scc1 fk_p3
    v_mov_b32 v30, 1
    s_mov_b64 exec, 1
    buffer_store_dword v30, off, s[68:71], s100 sc1
    s_mov_b64 exec, -1
fk_p3:
    s_branch kX
fk_os:
    s_sub_u32 s11, 15, s7
    s_bitcmp1_b32 s4, 0
    s_cselect_b32 s96, s11, s7
    s_and_b32 s100, s5, 3
    s_mul_i32 s97, s100, 320
    s_mul_i32 s11, s88, 0x140000
    s_add_u32 s11, s11, s97
    s_sub_u32 s12, 0x500000, s11
    s_add_u32 s44, s26, s11
    s_addc_u32 s45, s27, 0
    s_mov_b32 s46, s12
    s_mov_b32 s47, 0x20000
    s_mul_i32 s11, s88, 0x46000
    s_add_u32 s11, s11, s97
    s_sub_u32 s12, 0x10e000, s11
    s_add_u32 s48, s36, s11
    s_addc_u32 s49, s37, 0
    s_mov_b32 s50, s12
    s_mov_b32 s51, 0x20000
    s_mul_i32 s95, s3, 5120
    s_mul_i32 s11, s3, 0x5000
    v_add_u32 v8, 0, v1
    v_mul_u32_u24 v29, 0x199a, v8
    v_lshrrev_b32 v29, 16, v29
    v_bfe_u32 v30, v29, 3, 1
    v_xor_b32 v30, v30, v29
    v_sub_u32 v30, v30, v29
    v_lshrrev_b32 v29, 1, v29
    v_mad_i32_i24 v29, v29, 6, v30
    v_mad_i32_i24 v8, v29, 10, v8
    s_sub_u32 s12, s11, 0
    v_lshl_add_u32 v8, v8, 4, s12
    v_add_u32 v9, 64, v1
    v_mul_u32_u24 v29, 0x199a, v9
    v_lshrrev_b32 v29, 16, v29
    v_bfe_u32 v30, v29, 3, 1
    v_xor_b32 v30, v30, v29
    v_sub_u32 v30, v30, v29
    v_lshrrev_b32 v29, 1, v29
    v_mad_i32_i24 v29, v29, 6, v30
    v_mad_i32_i24 v9, v29, 10, v9
    s_sub_u32 s12, s11, 1024
    v_lshl_add_u32 v9, v9, 4, s12
    v_add_u32 v10, 128, v1
    v_mul_u32_u24 v29, 0x199a, v10
    v_lshrrev_b32 v29, 16, v29
    v_bfe_u32 v30, v29, 3, 1
    v_xor_b32 v30, v30, v29
    v_sub_u32 v30, v30, v29
    v_lshrrev_b32 v29, 1, v29
    v_mad_i32_i24 v29, v29, 6, v30
    v_mad_i32_i24 v10, v29, 10, v10
    s_sub_u32 s12, s11, 2048
    v_lshl_add_u32 v10, v10, 4, s12
    v_add_u32 v11, 192, v1
    v_mul_u32_u24 v29, 0x199a, v11
    v_lshrrev_b32 v29, 16, v29
    v_bfe_u32 v30, v29, 3, 1
    v_xor_b32 v30, v30, v29
    v_sub_u32 v30, v30, v29
    v_lshrrev_b32 v29, 1, v29
    v_mad_i32_i24 v29, v29, 6, v30
    v_mad_i32_i24 v11, v29, 10, v11
    s_sub_u32 s12, s11, 3072
    v_lshl_add_u32 v11, v11, 4, s12
    v_add_u32 v12, 256, v1
    v_mul_u32_u24 v29, 0x199a, v12
    v_lshrrev_b32 v29, 16, v29
    v_bfe_u32 v30, v29, 3, 1
    v_xor_b32 v30, v30, v29
    v_sub_u32 v30, v30, v29
    v_lshrrev_b32 v29, 1, v29
    v_mad_i32_i24 v29, v29, 6, v30
    v_mad_i32_i24 v12, v29, 10, v12
    s_sub_u32 s12, s11, 0
    v_lshl_add_u32 v12, v12, 4, s12
    s_lshl_b32 s11, s96, 2
    s_add_u32 s100, s100, s11
    s_add_u32 s92, s11, s3
    s_mul_i32 s11, s92, 0xa000
    s_add_u32 s11, s11, s97
    s_lshr_b32 s99, s88, 1
    s_mul_i32 s12, s99, 160
    s_add_u32 s11, s11, s12
    s_and_b32 s12, s88, 1
    s_lshl_b32 s12, s12, 8
    v_xor_b32 v18, s12, v0
    v_xor_b32 v19, 0x100, v18
    v_and_b32 v29, 0x1f0, v18
    v_mul_u32_u24 v29, 80, v29
    v_lshrrev_b32 v30, 4, v1
    v_mul_u32_u24 v25, 40, v30
    v_add3_u32 v25, v29, v25, s11
    v_xor_b32 v30, s99, v30
    v_and_b32 v30, 1, v30
    v_and_b32 v29, 60, v1
    v_add_u32 v29, v29, v1
    v_lshl_add_u32 v29, v30, 2, v29
    v_xor_b32 v30, 4, v29
    s_mov_b32 s12, 0x19000
    v_mad_u32_u24 v13, v29, 40, s12
    v_mad_u32_u24 v14, v30, 40, s12
    s_lshr_b32 s101, s92, 1
    s_lshl_b32 s101, s101, 8
    s_mul_i32 s11, s92, 0x4d800
    s_lshl_b32 s12, s88, 16
    s_add_u32 s92, s11, s12
    s_mul_i32 s12, s88, 28
    s_add_u32 s101, s101, s12
    s_add_u32 s101, s101, 0xe000
    s_lshl_b32 s12, s12, 9
    s_add_u32 s97, s11, s12
    s_add_u32 s97, s97, 0x40000
    s_add_u32 s60, s16, 0x0
    s_addc_u32 s61, s17, 0
    s_mov_b32 s62, 0x280000
    s_mov_b32 s63, 0x20000
    s_add_u32 s64, s38, 0x0
    s_addc_u32 s65, s39, 0
    s_mov_b32 s66, 0x280000
    s_mov_b32 s67, 0x20000
    s_add_u32 s52, s42, 0x5100000
    s_addc_u32 s53, s43, 0
    s_mov_b32 s54, 0x780000
    s_mov_b32 s55, 0x20000
    s_lshl_b32 s100, s100, 8
    s_add_u32 s100, s100, 0xa000
    s_add_u32 s84, s42, 0x5c00000
    s_addc_u32 s85, s43, 0
    s_mov_b32 s86, 0x0
    s_mov_b32 s87, 0x20000
    s_mov_b32 s94, 0x7f000000
    s_mov_b32 s91, 0
    s_mov_b32 s93, 0
    s_waitcnt lgkmcnt(0)
    s_waitcnt vmcnt(0)
    s_barrier
    s_mov_b64 exec, 1
    buffer_store_dword v3, off, s[68:71], s90 sc1
    s_mov_b64 exec, -1
    s_add_u32 m0, s95, 0x23000
    s_mov_b32 s10, 0x0
    buffer_load_dwordx4 v8, s[44:47], s10 offen offset:0 lds
    buffer_load_dwordx4 v9, s[44:47], s10 offen offset:1024 lds
    buffer_load_dwordx4 v10, s[44:47], s10 offen offset:2048 lds
    buffer_load_dwordx4 v11, s[44:47], s10 offen offset:3072 lds
    s_add_u32 m0, s95, 0x24000
    s_nop 0
    buffer_load_dwordx4 v12, s[44:47], s10 offen offset:0 lds
    s_add_u32 m0, s95, 0x1e000
    s_mov_b32 s10, 0x14000
    buffer_load_dwordx4 v8, s[44:47], s10 offen offset:0 lds
    buffer_load_dwordx4 v9, s[44:47], s10 offen offset:1024 lds
    buffer_load_dwordx4 v10, s[44:47], s10 offen offset:2048 lds
    buffer_load_dwordx4 v11, s[44:47], s10 offen offset:3072 lds
    s_add_u32 m0, s95, 0x1f000
    s_nop 0
    buffer_load_dwordx4 v12, s[44:47], s10 offen offset:0 lds
    s_add_u32 m0, s95, 0x19000
    s_mov_b32 s10, 0x28000
    buffer_load_dwordx4 v8, s[44:47], s10 offen offset:0 lds
    buffer_load_dwordx4 v9, s[44:47], s10 offen offset:1024 lds
    buffer_load_dwordx4 v10, s[44:47], s10 offen offset:2048 lds
    buffer_load_dwordx4 v11, s[44:47], s10 offen offset:3072 lds
    s_add_u32 m0, s95, 0x1a000
    s_nop 0
    buffer_load_dwordx4 v12, s[44:47], s10 offen offset:0 lds
    s_add_u32 m0, s95, 0x0
    s_mov_b32 s10, 0x3c000
    buffer_load_dwordx4 v8, s[44:47], s10 offen offset:0 lds
    buffer_load_dwordx4 v9, s[44:47], s10 offen offset:1024 lds
    buffer_load_dwordx4 v10, s[44:47], s10 offen offset:2048 lds
    buffer_load_dwordx4 v11, s[44:47], s10 offen offset:3072 lds
    s_add_u32 m0, s95, 0x1000
    s_nop 0
    buffer_load_dwordx4 v12, s[44:47], s10 offen offset:0 lds
    s_add_u32 m0, s95, 0x5000
    s_mov_b32 s10, 0x50000
    buffer_load_dwordx4 v8, s[44:47], s10 offen offset:0 lds
    buffer_load_dwordx4 v9, s[44:47], s10 offen offset:1024 lds
    buffer_load_dwordx4 v10, s[44:47], s10 offen offset:2048 lds
    buffer_load_dwordx4 v11, s[44:47], s10 offen offset:3072 lds
    s_add_u32 m0, s95, 0x6000
    s_nop 0
    buffer_load_dwordx4 v12, s[44:47], s10 offen offset:0 lds
    buffer_load_dword v27, v28, s[68:71], s89 offen sc1
    s_add_u32 m0, s95, 0xa000
    s_mov_b32 s10, 0x64000
    buffer_load_dwordx4 v8, s[44:47], s10 offen offset:0 lds
    buffer_load_dwordx4 v9, s[44:47], s10 offen offset:1024 lds
    buffer_load_dwordx4 v10, s[44:47], s10 offen offset:2048 lds
    buffer_load_dwordx4 v11, s[44:47], s10 offen offset:3072 lds
    s_add_u32 m0, s95, 0xb000
    s_nop 0
    buffer_load_dwordx4 v12, s[44:47], s10 offen offset:0 lds
    s_waitcnt vmcnt(5)
    v_cmp_eq_u32 vcc, 1, v27
    s_nop 0
    s_bfe_u32 s11, vcc_lo, 0x80000
    s_cmp_ge_u32 s11, 255
    s_cbranch_scc0 fk_w5_slow
fk_w5_ok:
    s_add_u32 s13, s92, 0x0
    buffer_load_dwordx4 a[160:163], v18, s[56:59], s13 offen sc1
    buffer_load_dwordx4 a[164:167], v19, s[56:59], s13 offen sc1
    s_add_u32 s13, s92, 0x800
    buffer_load_dwordx4 a[168:171], v18, s[56:59], s13 offen sc1
    buffer_load_dwordx4 a[172:175], v19, s[56:59], s13 offen sc1
    s_add_u32 s13, s92, 0x1000
    buffer_load_dwordx4 a[176:179], v18, s[56:59], s13 offen sc1
    buffer_load_dwordx4 a[180:183], v19, s[56:59], s13 offen sc1
    s_add_u32 s13, s92, 0x1800
    buffer_load_dwordx4 a[184:187], v18, s[56:59], s13 offen sc1
    buffer_load_dwordx4 a[188:191], v19, s[56:59], s13 offen sc1
    s_barrier
    ds_read_b64_tr_b16 a[0:1], v13 offset:40960
    ds_read_b64_tr_b16 a[2:3], v13 offset:46080
    ds_read_b64_tr_b16 a[4:5], v13 offset:51200
    ds_read_b64_tr_b16 a[6:7], v13 offset:56320
    ds_read_b64_tr_b16 a[8:9], v13 offset:40968
    ds_read_b64_tr_b16 a[10:11], v13 offset:46088
    ds_read_b64_tr_b16 a[12:13], v13 offset:51208
    ds_read_b64_tr_b16 a[14:15], v13 offset:56328
    ds_read_b64_tr_b16 a[16:17], v13 offset:40976
    ds_read_b64_tr_b16 a[18:19], v13 offset:46096
    ds_read_b64_tr_b16 a[20:21], v13 offset:51216
    ds_read_b64_tr_b16 a[22:23], v13 offset:56336
    ds_read_b64_tr_b16 a[24:25], v13 offset:40984
    ds_read_b64_tr_b16 a[26:27], v13 offset:46104
    ds_read_b64_tr_b16 a[28:29], v13 offset:51224
    ds_read_b64_tr_b16 a[30:31], v13 offset:56344
    ds_read_b64_tr_b16 a[32:33], v13 offset:40992
    ds_read_b64_tr_b16 a[34:35], v13 offset:46112
    ds_read_b64_tr_b16 a[36:37], v13 offset:51232
    ds_read_b64_tr_b16 a[38:39], v13 offset:56352
    s_add_u32 s13, s92, 0x2000
    buffer_load_dwordx4 a[192:195], v18, s[56:59], s13 offen sc1
    buffer_load_dwordx4 a[196:199], v19, s[56:59], s13 offen sc1
    s_add_u32 s13, s92, 0x2800
    buffer_load_dwordx4 a[200:203], v18, s[56:59], s13 offen sc1
    buffer_load_dwordx4 a[204:207], v19, s[56:59], s13 offen sc1
    s_add_u32 s13, s92, 0x3000
    buffer_load_dwordx4 a[208:211], v18, s[56:59], s13 offen sc1
    buffer_load_dwordx4 a[212:215], v19, s[56:59], s13 offen sc1
    s_add_u32 s13, s92, 0x3800
    buffer_load_dwordx4 a[216:219], v18, s[56:59], s13 offen sc1
    buffer_load_dwordx4 a[220:223], v19, s[56:59], s13 offen sc1
    s_add_u32 s13, s92, 0x4000
    buffer_load_dwordx4 a[224:227], v18, s[56:59], s13 offen sc1
    buffer_load_dwordx4 a[228:231], v19, s[56:59], s13 offen sc1
    s_add_u32 s13, s92, 0x4800
    buffer_load_dwordx4 a[232:235], v18, s[56:59], s13 offen sc1
    buffer_load_dwordx4 a[236:239], v19, s[56:59], s13 offen sc1
    s_add_u32 s13, s92, 0x5000
    buffer_load_dwordx4 a[240:243], v18, s[56:59], s13 offen sc1
    buffer_load_dwordx4 a[244:247], v19, s[56:59], s13 offen sc1
    s_add_u32 s13, s92, 0x5800
    buffer_load_dwordx4 a[248:251], v18, s[56:59], s13 offen sc1
    buffer_load_dwordx4 a[252:255], v19, s[56:59], s13 offen sc1
    s_add_u32 s13, s92, 0x6000
    buffer_load_dwordx4 a[128:131], v18, s[56:59], s13 offen sc1
    buffer_load_dwordx4 a[132:135], v19, s[56:59], s13 offen sc1
    s_add_u32 s13, s92, 0x6800
    buffer_load_dwordx4 a[136:139], v18, s[56:59], s13 offen sc1
    buffer_load_dwordx4 a[140:143], v19, s[56:59], s13 offen sc1
    s_add_u32 s13, s92, 0x7000
    buffer_load_dwordx4 a[144:147], v18, s[56:59], s13 offen sc1
    buffer_load_dwordx4 a[148:151], v19, s[56:59], s13 offen sc1
    s_branch fk_o
fk_g:
    s_lshr_b32 s88, s4, 1
    s_lshl_b32 s89, s7, 2
    s_add_u32 s89, s89, s88
    s_lshl_b32 s89, s89, 3
    s_add_u32 s89, s89, s3
    s_lshl_b32 s89, s89, 5
    s_add_u32 s89, s89, 0x4000
    s_and_b32 s90, s6, 7
    s_lshl_b32 s90, s90, 2
    s_add_u32 s90, s90, s89
    v_mov_b32 v3, 1
    s_cmp_ge_u32 s5, 28
    s_cbranch_scc1 fk_os
    v_mov_b32 v4, v24
    v_xor_b32 v5, 64, v24
    ds_read_b128 a[64:67], v4 offset:0
    ds_read_b128 a[68:71], v5 offset:0
    ds_read_b128 a[72:75], v4 offset:2048
    ds_read_b128 a[76:79], v5 offset:2048
    ds_read_b128 a[80:83], v4 offset:4096
    ds_read_b128 a[84:87], v5 offset:4096
    ds_read_b128 a[88:91], v4 offset:6144
    ds_read_b128 a[92:95], v5 offset:6144
    ds_read_b128 a[96:99], v4 offset:8192
    ds_read_b128 a[100:103], v5 offset:8192
    ds_read_b128 a[104:107], v4 offset:10240
    ds_read_b128 a[108:111], v5 offset:10240
    s_waitcnt lgkmcnt(6)
    v_mfma_f32_16x16x32_bf16 v[128:131], a[0:3], a[64:67], 0
    s_add_u32 s80, s42, 0x2300000
    s_addc_u32 s81, s43, 0
    s_mov_b32 s82, 0x360000
    v_mfma_f32_16x16x32_bf16 v[128:131], a[8:11], a[68:71], v[128:131]
    s_mov_b32 s13, 0xa000
    s_mov_b32 s83, 0x20000
    v_mfma_f32_16x16x32_bf16 v[132:135], a[4:7], a[64:67], 0
    buffer_load_dwordx4 a[32:35], v0, s[72:75], s13 offen sc1
    v_mfma_f32_16x16x32_bf16 v[132:135], a[12:15], a[68:71], v[132:135]
    ds_read_b128 a[112:115], v4 offset:12288
    ds_read_b128 a[116:119], v5 offset:12288
    v_mfma_f32_16x16x32_bf16 v[136:139], a[0:3], a[72:75], 0
    s_add_u32 s52, s34, 0x0
    s_addc_u32 s53, s35, 0
    s_mov_b32 s54, 0x1000
    v_mfma_f32_16x16x32_bf16 v[136:139], a[8:11], a[76:79], v[136:139]
    s_mov_b32 s55, 0x20000
    s_and_b32 s93, s4, 1
    s_lshl_b32 s11, s93, 1
    v_mfma_f32_16x16x32_bf16 v[140:143], a[4:7], a[72:75], 0
    buffer_load_dwordx4 a[36:39], v0, s[72:75], s13 offen offset:256 sc1
    v_mfma_f32_16x16x32_bf16 v[140:143], a[12:15], a[76:79], v[140:143]
    s_add_u32 s91, s8, s11
    ds_read_b128 a[120:123], v4 offset:14336
    ds_read_b128 a[124:127], v5 offset:14336
    v_mfma_f32_16x16x32_bf16 v[144:147], a[0:3], a[80:83], 0
    s_lshl_b32 s98, s9, 2
    s_add_u32 s98, s98, s3
    s_mul_i32 s11, s91, 27
    v_mfma_f32_16x16x32_bf16 v[144:147], a[8:11], a[84:87], v[144:147]
    s_add_u32 s11, s11, s98
    s_lshl_b32 s11, s11, 11
    s_add_u32 s12, s11, 0xd800
    v_mfma_f32_16x16x32_bf16 v[148:151], a[4:7], a[80:83], 0
    buffer_load_dwordx4 a[40:43], v0, s[72:75], s13 offen offset:2048 sc1
    v_mfma_f32_16x16x32_bf16 v[148:151], a[12:15], a[84:87], v[148:151]
    s_waitcnt lgkmcnt(4)
    ds_read_b128 a[64:67], v4 offset:16384
    ds_read_b128 a[68:71], v5 offset:16384
    v_mfma_f32_16x16x32_bf16 v[152:155], a[0:3], a[88:91], 0
    v_and_b32 v30, 0xe30, v0
    v_and_b32 v29, 4, v1
    v_mfma_f32_16x16x32_bf16 v[152:155], a[8:11], a[92:95], v[152:155]
    v_lshl_add_u32 v30, v29, 6, v30
    v_and_b32 v29, 8, v1
    v_mfma_f32_16x16x32_bf16 v[156:159], a[4:7], a[88:91], 0
    buffer_load_dwordx4 a[44:47], v0, s[72:75], s13 offen offset:2304 sc1
    v_mfma_f32_16x16x32_bf16 v[156:159], a[12:15], a[92:95], v[156:159]
    ds_read_b128 a[72:75], v4 offset:18432
    ds_read_b128 a[76:79], v5 offset:18432
    v_mfma_f32_16x16x32_bf16 v[160:163], a[0:3], a[96:99], 0
    v_lshl_add_u32 v30, v29, 3, v30
    v_mfma_f32_16x16x32_bf16 v[160:163], a[8:11], a[100:103], v[160:163]
    s_mov_b32 s13, 0xb000
    v_mfma_f32_16x16x32_bf16 v[164:167], a[4:7], a[96:99], 0
    buffer_load_dwordx4 a[48:51], v0, s[72:75], s13 offen sc1
    v_mfma_f32_16x16x32_bf16 v[164:167], a[12:15], a[100:103], v[164:167]
    ds_read_b128 a[80:83], v4 offset:20480
    ds_read_b128 a[84:87], v5 offset:20480
    v_mfma_f32_16x16x32_bf16 v[168:171], a[0:3], a[104:107], 0
    buffer_load_dwordx4 v[112:115], v30, s[80:83], s11 offen sc1
    v_mfma_f32_16x16x32_bf16 v[168:171], a[8:11], a[108:111], v[168:171]
    buffer_load_dwordx4 v[116:119], v30, s[80:83], s11 offen offset:128 sc1
    v_mfma_f32_16x16x32_bf16 v[172:175], a[4:7], a[104:107], 0
    buffer_load_dwordx4 a[52:55], v0, s[72:75], s13 offen offset:256 sc1
    v_mfma_f32_16x16x32_bf16 v[172:175], a[12:15], a[108:111], v[172:175]
    s_waitcnt lgkmcnt(4)
    ds_read_b128 a[88:91], v4 offset:22528
    ds_read_b128 a[92:95], v5 offset:22528
    v_mfma_f32_16x16x32_bf16 v[176:179], a[0:3], a[112:115], 0
    buffer_load_dwordx4 v[120:123], v30, s[80:83], s12 offen sc1
    v_mfma_f32_16x16x32_bf16 v[176:179], a[8:11], a[116:119], v[176:179]
    buffer_load_dwordx4 v[124:127], v30, s[80:83], s12 offen offset:128 sc1
    v_mfma_f32_16x16x32_bf16 v[180:183], a[4:7], a[112:115], 0
    buffer_load_dwordx4 a[56:59], v0, s[72:75], s13 offen offset:2048 sc1
    v_mfma_f32_16x16x32_bf16 v[180:183], a[12:15], a[116:119], v[180:183]
    s_lshl_b32 s11, s91, 6
    ds_read_b128 a[96:99], v4 offset:24576
    ds_read_b128 a[100:103], v5 offset:24576
    v_mfma_f32_16x16x32_bf16 v[184:187], a[0:3], a[120:123], 0
    v_and_b32 v29, 15, v1
    v_lshlrev_b32 v29, 1, v29
    v_mfma_f32_16x16x32_bf16 v[184:187], a[8:11], a[124:127], v[184:187]
    buffer_load_ushort v96, v29, s[52:55], s11 offen offset:0
    v_mfma_f32_16x16x32_bf16 v[188:191], a[4:7], a[120:123], 0
    buffer_load_dwordx4 a[60:63], v0, s[72:75], s13 offen offset:2304 sc1
    v_mfma_f32_16x16x32_bf16 v[188:191], a[12:15], a[124:127], v[188:191]
    ds_read_b128 a[104:107], v4 offset:26624
    ds_read_b128 a[108:111], v5 offset:26624
    v_mfma_f32_16x16x32_bf16 v[128:131], a[16:19], a[64:67], v[128:131]
    buffer_load_ushort v97, v29, s[52:55], s11 offen offset:32
    v_mfma_f32_16x16x32_bf16 v[128:131], a[24:27], a[68:71], v[128:131]
    s_mov_b32 s13, 0xc000
    v_mfma_f32_16x16x32_bf16 v[132:135], a[20:23], a[64:67], v[132:135]
    buffer_load_dwordx4 v[32:35], v0, s[72:75], s13 offen sc1
    v_mfma_f32_16x16x32_bf16 v[132:135], a[28:31], a[68:71], v[132:135]
    s_waitcnt lgkmcnt(8)
    ds_read_b128 a[112:115], v4 offset:28672
    ds_read_b128 a[116:119], v5 offset:28672
    v_mfma_f32_16x16x32_bf16 v[136:139], a[16:19], a[72:75], v[136:139]
    buffer_load_ushort v98, v29, s[52:55], s11 offen offset:64
    v_mfma_f32_16x16x32_bf16 v[136:139], a[24:27], a[76:79], v[136:139]
    buffer_load_ushort v99, v29, s[52:55], s11 offen offset:96
    v_mfma_f32_16x16x32_bf16 v[140:143], a[20:23], a[72:75], v[140:143]
    buffer_load_dwordx4 v[36:39], v0, s[72:75], s13 offen offset:256 sc1
    v_mfma_f32_16x16x32_bf16 v[140:143], a[28:31], a[76:79], v[140:143]
    s_waitcnt vmcnt(46)
    s_barrier
    ds_read_b128 a[120:123], v4 offset:30720
    ds_read_b128 a[124:127], v5 offset:30720
    s_waitcnt lgkmcnt(6)
    v_mfma_f32_16x16x32_bf16 v[144:147], a[16:19], a[80:83], v[144:147]
    buffer_load_dword v26, v2, s[28:31], 0 offen sc1
    v_mfma_f32_16x16x32_bf16 v[144:147], a[24:27], a[84:87], v[144:147]
    s_sub_u32 s11, 15, s7
    ds_read_b128 a[64:67], v4 offset:32768
    v_mfma_f32_16x16x32_bf16 v[148:151], a[20:23], a[80:83], v[148:151]
    buffer_load_dwordx4 v[40:43], v0, s[72:75], s13 offen offset:2048 sc1
    v_mfma_f32_16x16x32_bf16 v[148:151], a[28:31], a[84:87], v[148:151]
    s_bitcmp1_b32 s4, 0
    s_cselect_b32 s96, s11, s7
    ds_read_b128 a[68:71], v5 offset:32768
    v_mfma_f32_16x16x32_bf16 v[152:155], a[16:19], a[88:91], v[152:155]
    s_and_b32 s100, s5, 3
    s_mul_i32 s97, s100, 320
    s_mul_i32 s11, s88, 0x140000
    v_mfma_f32_16x16x32_bf16 v[152:155], a[24:27], a[92:95], v[152:155]
    s_add_u32 s11, s11, s97
    s_sub_u32 s12, 0x500000, s11
    v_mfma_f32_16x16x32_bf16 v[156:159], a[20:23], a[88:91], v[156:159]
    buffer_load_dwordx4 v[44:47], v0, s[72:75], s13 offen offset:2304 sc1
    v_mfma_f32_16x16x32_bf16 v[156:159], a[28:31], a[92:95], v[156:159]
    ds_read_b128 a[72:75], v4 offset:34816
    ds_read_b128 a[76:79], v5 offset:34816
    v_mfma_f32_16x16x32_bf16 v[160:163], a[16:19], a[96:99], v[160:163]
    s_add_u32 s44, s26, s11
    s_addc_u32 s45, s27, 0
    s_mov_b32 s46, s12
    v_mfma_f32_16x16x32_bf16 v[160:163], a[24:27], a[100:103], v[160:163]
    s_movk_i32 s10, 0x300
    s_add_u32 m0, s14, 0x24000
    s_mov_b32 s47, 0x20000
    v_mfma_f32_16x16x32_bf16 v[164:167], a[20:23], a[96:99], v[164:167]
    s_waitcnt lgkmcnt(4)
    buffer_load_dwordx4 v20, s[76:79], s10 offen offset:0 lds
    v_mfma_f32_16x16x32_bf16 v[164:167], a[28:31], a[100:103], v[164:167]
    s_mul_i32 s11, s88, 0x46000
    ds_read_b128 a[80:83], v4 offset:36864
    ds_read_b128 a[84:87], v5 offset:36864
    v_mfma_f32_16x16x32_bf16 v[168:171], a[16:19], a[104:107], v[168:171]
    s_add_u32 s11, s11, s97
    s_sub_u32 s12, 0x10e000, s11
    v_mfma_f32_16x16x32_bf16 v[168:171], a[24:27], a[108:111], v[168:171]
    s_add_u32 s48, s36, s11
    s_addc_u32 s49, s37, 0
    s_mov_b32 s50, s12
    v_mfma_f32_16x16x32_bf16 v[172:175], a[20:23], a[104:107], v[172:175]
    buffer_load_dwordx4 v21, s[76:79], s10 offen offset:1024 lds
    v_mfma_f32_16x16x32_bf16 v[172:175], a[28:31], a[108:111], v[172:175]
    s_mov_b32 s51, 0x20000
    ds_read_b128 a[88:91], v4 offset:38912
    ds_read_b128 a[92:95], v5 offset:38912
    v_mfma_f32_16x16x32_bf16 v[176:179], a[16:19], a[112:115], v[176:179]
    s_mul_i32 s95, s3, 5120
    s_mul_i32 s11, s3, 0x5000
    v_add_u32 v8, 0, v1
    v_mfma_f32_16x16x32_bf16 v[176:179], a[24:27], a[116:119], v[176:179]
    v_mul_u32_u24 v29, 0x199a, v8
    v_lshrrev_b32 v29, 16, v29
    v_mfma_f32_16x16x32_bf16 v[180:183], a[20:23], a[112:115], v[180:183]
    buffer_load_dwordx4 v22, s[76:79], s10 offen offset:2048 lds
    v_mfma_f32_16x16x32_bf16 v[180:183], a[28:31], a[116:119], v[180:183]
    ds_read_b128 a[96:99], v4 offset:40960
    ds_read_b128 a[100:103], v5 offset:40960
    v_mfma_f32_16x16x32_bf16 v[184:187], a[16:19], a[120:123], v[184:187]
    v_bfe_u32 v30, v29, 3, 1
    v_xor_b32 v30, v30, v29
    v_mfma_f32_16x16x32_bf16 v[184:187], a[24:27], a[124:127], v[184:187]
    v_sub_u32 v30, v30, v29
    v_lshrrev_b32 v29, 1, v29
    v_mfma_f32_16x16x32_bf16 v[188:191], a[20:23], a[120:123], v[188:191]
    buffer_load_dwordx4 v23, s[76:79], s10 offen offset:3072 lds
    v_mfma_f32_16x16x32_bf16 v[188:191], a[28:31], a[124:127], v[188:191]
    s_waitcnt lgkmcnt(6)
    ds_read_b128 a[104:107], v4 offset:43008
    ds_read_b128 a[108:111], v5 offset:43008
    v_mfma_f32_16x16x32_bf16 v[128:131], a[160:163], a[64:67], v[128:131]
    v_mad_i32_i24 v29, v29, 6, v30
    v_mad_i32_i24 v8, v29, 10, v8
    v_mfma_f32_16x16x32_bf16 v[128:131], a[168:171], a[68:71], v[128:131]
    s_movk_i32 s10, 0x380
    s_add_u32 m0, s14, 0x20000
    s_sub_u32 s12, s11, 0
    v_mfma_f32_16x16x32_bf16 v[132:135], a[164:167], a[64:67], v[132:135]
    buffer_load_dwordx4 v20, s[76:79], s10 offen offset:0 lds
    v_mfma_f32_16x16x32_bf16 v[132:135], a[172:175], a[68:71], v[132:135]
    ds_read_b128 a[112:115], v4 offset:45056
    ds_read_b128 a[116:119], v5 offset:45056
    v_mfma_f32_16x16x32_bf16 v[136:139], a[160:163], a[72:75], v[136:139]
    v_lshl_add_u32 v8, v8, 4, s12
    v_add_u32 v9, 64, v1
    v_mfma_f32_16x16x32_bf16 v[136:139], a[168:171], a[76:79], v[136:139]
    v_mul_u32_u24 v29, 0x199a, v9
    v_lshrrev_b32 v29, 16, v29
    v_mfma_f32_16x16x32_bf16 v[140:143], a[164:167], a[72:75], v[140:143]
    buffer_load_dwordx4 v21, s[76:79], s10 offen offset:1024 lds
    v_mfma_f32_16x16x32_bf16 v[140:143], a[172:175], a[76:79], v[140:143]
    s_waitcnt vmcnt(27)
    s_barrier
    ds_read_b128 a[120:123], v4 offset:47104
    ds_read_b128 a[124:127], v5 offset:47104
    s_waitcnt lgkmcnt(6)
    v_mfma_f32_16x16x32_bf16 v[144:147], a[160:163], a[80:83], v[144:147]
    v_bfe_u32 v30, v29, 3, 1
    v_xor_b32 v30, v30, v29
    v_mfma_f32_16x16x32_bf16 v[144:147], a[168:171], a[84:87], v[144:147]
    v_sub_u32 v30, v30, v29
    v_lshrrev_b32 v29, 1, v29
    v_mfma_f32_16x16x32_bf16 v[148:151], a[164:167], a[80:83], v[148:151]
    buffer_load_dwordx4 v22, s[76:79], s10 offen offset:2048 lds
    v_mfma_f32_16x16x32_bf16 v[148:151], a[172:175], a[84:87], v[148:151]
    ds_read_b128 a[64:67], v4 offset:49152
    ds_read_b128 a[68:71], v5 offset:49152
    v_mfma_f32_16x16x32_bf16 v[152:155], a[160:163], a[88:91], v[152:155]
    v_mad_i32_i24 v29, v29, 6, v30
    v_mad_i32_i24 v9, v29, 10, v9
    v_mfma_f32_16x16x32_bf16 v[152:155], a[168:171], a[92:95], v[152:155]
    s_sub_u32 s12, s11, 1024
    v_lshl_add_u32 v9, v9, 4, s12
    v_add_u32 v10, 128, v1
    v_mfma_f32_16x16x32_bf16 v[156:159], a[164:167], a[88:91], v[156:159]
    buffer_load_dwordx4 v23, s[76:79], s10 offen offset:3072 lds
    v_mfma_f32_16x16x32_bf16 v[156:159], a[172:175], a[92:95], v[156:159]
    ds_read_b128 a[72:75], v4 offset:51200
    ds_read_b128 a[76:79], v5 offset:51200
    v_mfma_f32_16x16x32_bf16 v[160:163], a[160:163], a[96:99], v[160:163]
    v_mul_u32_u24 v29, 0x199a, v10
    v_lshrrev_b32 v29, 16, v29
    v_mfma_f32_16x16x32_bf16 v[160:163], a[168:171], a[100:103], v[160:163]
    s_movk_i32 s10, 0x400
    s_add_u32 m0, s14, 0x1c000
    v_bfe_u32 v30, v29, 3, 1
    v_mfma_f32_16x16x32_bf16 v[164:167], a[164:167], a[96:99], v[164:167]
    buffer_load_dwordx4 v20, s[76:79], s10 offen offset:0 lds
    v_mfma_f32_16x16x32_bf16 v[164:167], a[172:175], a[100:103], v[164:167]
    s_waitcnt lgkmcnt(4)
    ds_read_b128 a[80:83], v4 offset:53248
    ds_read_b128 a[84:87], v5 offset:53248
    v_mfma_f32_16x16x32_bf16 v[168:171], a[160:163], a[104:107], v[168:171]
    s_mov_b64 exec, 1
    buffer_store_dword v3, off, s[68:71], s90 sc1
    s_mov_b64 exec, -1
    v_mfma_f32_16x16x32_bf16 v[168:171], a[168:171], a[108:111], v[168:171]
    v_xor_b32 v30, v30, v29
    v_sub_u32 v30, v30, v29
    v_mfma_f32_16x16x32_bf16 v[172:175], a[164:167], a[104:107], v[172:175]
    buffer_load_dwordx4 v21, s[76:79], s10 offen offset:1024 lds
    v_mfma_f32_16x16x32_bf16 v[172:175], a[172:175], a[108:111], v[172:175]
    ds_read_b128 a[88:91], v4 offset:55296
    ds_read_b128 a[92:95], v5 offset:55296
    v_mfma_f32_16x16x32_bf16 v[176:179], a[160:163], a[112:115], v[176:179]
    v_lshrrev_b32 v29, 1, v29
    v_mad_i32_i24 v29, v29, 6, v30
    v_mfma_f32_16x16x32_bf16 v[176:179], a[168:171], a[116:119], v[176:179]
    v_mad_i32_i24 v10, v29, 10, v10
    v_mfma_f32_16x16x32_bf16 v[180:183], a[164:167], a[112:115], v[180:183]
    buffer_load_dwordx4 v22, s[76:79], s10 offen offset:2048 lds
    v_mfma_f32_16x16x32_bf16 v[180:183], a[172:175], a[116:119], v[180:183]
    s_sub_u32 s12, s11, 2048
    ds_read_b128 a[96:99], v4 offset:57344
    ds_read_b128 a[100:103], v5 offset:57344
    v_mfma_f32_16x16x32_bf16 v[184:187], a[160:163], a[120:123], v[184:187]
    v_lshl_add_u32 v10, v10, 4, s12
    v_add_u32 v11, 192, v1
    v_mfma_f32_16x16x32_bf16 v[184:187], a[168:171], a[124:127], v[184:187]
    v_mul_u32_u24 v29, 0x199a, v11
    v_lshrrev_b32 v29, 16, v29
    v_mfma_f32_16x16x32_bf16 v[188:191], a[164:167], a[120:123], v[188:191]
    buffer_load_dwordx4 v23, s[76:79], s10 offen offset:3072 lds
    v_mfma_f32_16x16x32_bf16 v[188:191], a[172:175], a[124:127], v[188:191]
    s_waitcnt lgkmcnt(6)
    ds_read_b128 a[104:107], v4 offset:59392
    ds_read_b128 a[108:111], v5 offset:59392
    v_mfma_f32_16x16x32_bf16 v[128:131], a[176:179], a[64:67], v[128:131]
    v_bfe_u32 v30, v29, 3, 1
    v_xor_b32 v30, v30, v29
    v_mfma_f32_16x16x32_bf16 v[128:131], a[184:187], a[68:71], v[128:131]
    s_movk_i32 s10, 0x480
    s_add_u32 m0, s14, 0x18000
    v_sub_u32 v30, v30, v29
    v_mfma_f32_16x16x32_bf16 v[132:135], a[180:183], a[64:67], v[132:135]
    buffer_load_dwordx4 v20, s[76:79], s10 offen offset:0 lds
    v_mfma_f32_16x16x32_bf16 v[132:135], a[188:191], a[68:71], v[132:135]
    ds_read_b128 a[112:115], v4 offset:61440
    ds_read_b128 a[116:119], v5 offset:61440
    v_mfma_f32_16x16x32_bf16 v[136:139], a[176:179], a[72:75], v[136:139]
    v_lshrrev_b32 v29, 1, v29
    v_mad_i32_i24 v29, v29, 6, v30
    v_mfma_f32_16x16x32_bf16 v[136:139], a[184:187], a[76:79], v[136:139]
    v_mad_i32_i24 v11, v29, 10, v11
    v_mfma_f32_16x16x32_bf16 v[140:143], a[180:183], a[72:75], v[140:143]
    buffer_load_dwordx4 v21, s[76:79], s10 offen offset:1024 lds
    v_mfma_f32_16x16x32_bf16 v[140:143], a[188:191], a[76:79], v[140:143]
    s_barrier
    ds_read_b128 a[120:123], v4 offset:63488
    ds_read_b128 a[124:127], v5 offset:63488
    s_waitcnt lgkmcnt(6)
    v_mfma_f32_16x16x32_bf16 v[144:147], a[176:179], a[80:83], v[144:147]
    s_sub_u32 s12, s11, 3072
    v_add_u32 v4, 0x10000, v4
    v_add_u32 v5, 0x10000, v5
    v_mfma_f32_16x16x32_bf16 v[144:147], a[184:187], a[84:87], v[144:147]
    v_lshl_add_u32 v11, v11, 4, s12
    v_add_u32 v12, 256, v1
    v_mfma_f32_16x16x32_bf16 v[148:151], a[180:183], a[80:83], v[148:151]
    buffer_load_dwordx4 v22, s[76:79], s10 offen offset:2048 lds
    v_mfma_f32_16x16x32_bf16 v[148:151], a[188:191], a[84:87], v[148:151]
    ds_read_b128 a[64:67], v4 offset:0
    ds_read_b128 a[68:71], v5 offset:0
    v_mfma_f32_16x16x32_bf16 v[152:155], a[176:179], a[88:91], v[152:155]
    v_mul_u32_u24 v29, 0x199a, v12
    v_lshrrev_b32 v29, 16, v29
    v_mfma_f32_16x16x32_bf16 v[152:155], a[184:187], a[92:95], v[152:155]
    v_bfe_u32 v30, v29, 3, 1
    v_xor_b32 v30, v30, v29
    v_mfma_f32_16x16x32_bf16 v[156:159], a[180:183], a[88:91], v[156:159]
    buffer_load_dwordx4 v23, s[76:79], s10 offen offset:3072 lds
    v_mfma_f32_16x16x32_bf16 v[156:159], a[188:191], a[92:95], v[156:159]
    ds_read_b128 a[72:75], v4 offset:2048
    ds_read_b128 a[76:79], v5 offset:2048
    v_mfma_f32_16x16x32_bf16 v[160:163], a[176:179], a[96:99], v[160:163]
    v_sub_u32 v30, v30, v29
    v_lshrrev_b32 v29, 1, v29
    v_mfma_f32_16x16x32_bf16 v[160:163], a[184:187], a[100:103], v[160:163]
    s_movk_i32 s10, 0x500
    s_add_u32 m0, s14, 0x0
    v_mad_i32_i24 v29, v29, 6, v30
    v_mfma_f32_16x16x32_bf16 v[164:167], a[180:183], a[96:99], v[164:167]
    buffer_load_dwordx4 v20, s[76:79], s10 offen offset:0 lds
    v_mfma_f32_16x16x32_bf16 v[164:167], a[188:191], a[100:103], v[164:167]
    s_waitcnt lgkmcnt(4)
    ds_read_b128 a[80:83], v4 offset:4096
    ds_read_b128 a[84:87], v5 offset:4096
    v_mfma_f32_16x16x32_bf16 v[168:171], a[176:179], a[104:107], v[168:171]
    v_mad_i32_i24 v12, v29, 10, v12
    v_mfma_f32_16x16x32_bf16 v[168:171], a[184:187], a[108:111], v[168:171]
    s_sub_u32 s12, s11, 0
    v_lshl_add_u32 v12, v12, 4, s12
    v_mfma_f32_16x16x32_bf16 v[172:175], a[180:183], a[104:107], v[172:175]
    buffer_load_dwordx4 v21, s[76:79], s10 offen offset:1024 lds
    v_mfma_f32_16x16x32_bf16 v[172:175], a[188:191], a[108:111], v[172:175]
    s_lshr_b32 s11, s91, 1
    ds_read_b128 a[88:91], v4 offset:6144
    ds_read_b128 a[92:95], v5 offset:6144
    v_mfma_f32_16x16x32_bf16 v[176:179], a[176:179], a[112:115], v[176:179]
    s_mul_i32 s12, s91, 155
    s_add_u32 s12, s12, s98
    s_add_u32 s12, s12, 128
    v_mfma_f32_16x16x32_bf16 v[176:179], a[184:187], a[116:119], v[176:179]
    s_lshl_b32 s12, s12, 11
    s_cmp_lt_u32 s98, 27
    s_cselect_b32 s94, s12, 0x7f000000
    v_mfma_f32_16x16x32_bf16 v[180:183], a[180:183], a[112:115], v[180:183]
    buffer_load_dwordx4 v22, s[76:79], s10 offen offset:2048 lds
    v_mfma_f32_16x16x32_bf16 v[180:183], a[188:191], a[116:119], v[180:183]
    s_lshl_b32 s11, s11, 6
    ds_read_b128 a[96:99], v4 offset:8192
    ds_read_b128 a[100:103], v5 offset:8192
    v_mfma_f32_16x16x32_bf16 v[184:187], a[176:179], a[120:123], v[184:187]
    s_add_u32 s11, s11, s98
    s_lshl_b32 s11, s11, 2
    s_add_u32 s9, s11, 0xe000
    v_mfma_f32_16x16x32_bf16 v[184:187], a[184:187], a[124:127], v[184:187]
    s_add_u32 s84, s42, 0x5c00000
    s_addc_u32 s85, s43, 0
    s_mov_b32 s86, 0x400000
    v_mfma_f32_16x16x32_bf16 v[188:191], a[180:183], a[120:123], v[188:191]
    s_waitcnt lgkmcnt(6)
    buffer_load_dwordx4 v23, s[76:79], s10 offen offset:3072 lds
    v_mfma_f32_16x16x32_bf16 v[188:191], a[188:191], a[124:127], v[188:191]
    s_mov_b32 s87, 0x20000
    ds_read_b128 a[104:107], v4 offset:10240
    ds_read_b128 a[108:111], v5 offset:10240
    v_mfma_f32_16x16x32_bf16 v[128:131], a[192:195], a[64:67], v[128:131]
    s_lshl_b32 s11, s2, 2
    s_add_u32 s11, s11, s3
    s_lshl_b32 s93, s11, 12
    v_mfma_f32_16x16x32_bf16 v[128:131], a[200:203], a[68:71], v[128:131]
    s_movk_i32 s10, 0x580
    s_add_u32 m0, s14, 0x4000
    s_xor_b32 s91, s93, 0x4000
    v_mfma_f32_16x16x32_bf16 v[132:135], a[196:199], a[64:67], v[132:135]
    buffer_load_dwordx4 v20, s[76:79], s10 offen offset:0 lds
    v_mfma_f32_16x16x32_bf16 v[132:135], a[204:207], a[68:71], v[132:135]
    s_lshl_b32 s12, s2, 4
    ds_read_b128 a[112:115], v4 offset:12288
    ds_read_b128 a[116:119], v5 offset:12288
    s_waitcnt vmcnt(31)
    v_lshlrev_b32 v96, 16, v96
    v_mfma_f32_16x16x32_bf16 v[136:139], a[192:195], a[72:75], v[136:139]
    s_lshl_b32 s11, s11, 2
    s_add_u32 s11, s11, s12
    s_add_u32 s98, s11, 0x6000
    s_waitcnt vmcnt(29)
    v_lshlrev_b32 v97, 16, v97
    v_mfma_f32_16x16x32_bf16 v[136:139], a[200:203], a[76:79], v[136:139]
    s_lshl_b32 s11, s96, 2
    s_add_u32 s100, s100, s11
    s_add_u32 s92, s11, s3
    s_waitcnt vmcnt(27)
    v_lshlrev_b32 v98, 16, v98
    v_mfma_f32_16x16x32_bf16 v[140:143], a[196:199], a[72:75], v[140:143]
    buffer_load_dwordx4 v21, s[76:79], s10 offen offset:1024 lds
    v_mfma_f32_16x16x32_bf16 v[140:143], a[204:207], a[76:79], v[140:143]
    s_barrier
    ds_read_b128 a[120:123], v4 offset:14336
    ds_read_b128 a[124:127], v5 offset:14336
    s_waitcnt vmcnt(27)
    v_lshlrev_b32 v99, 16, v99
    s_waitcnt lgkmcnt(6)
    v_mfma_f32_16x16x32_bf16 v[144:147], a[192:195], a[80:83], v[144:147]
    s_mul_i32 s11, s92, 0xa000
    s_add_u32 s11, s11, s97
    s_lshr_b32 s99, s88, 1
    s_mov_b32 s80, 0xbdd2d3e8
    v_mfma_f32_16x16x32_bf16 v[144:147], a[200:203], a[84:87], v[144:147]
    s_mul_i32 s12, s99, 160
    s_add_u32 s11, s11, s12
    s_and_b32 s12, s88, 1
    v_mov_b32 v24, 0xc0135761
    v_lshlrev_b32 v192, 16, v112
    v_mfma_f32_16x16x32_bf16 v[148:151], a[196:199], a[80:83], v[148:151]
    buffer_load_dwordx4 v22, s[76:79], s10 offen offset:2048 lds
    v_mfma_f32_16x16x32_bf16 v[148:151], a[204:207], a[84:87], v[148:151]
    s_lshl_b32 s12, s12, 8
    ds_read_b128 a[64:67], v4 offset:16384
    ds_read_b128 a[68:71], v5 offset:16384
    v_mfma_f32_16x16x32_bf16 v[152:155], a[192:195], a[88:91], v[152:155]
    v_xor_b32 v18, s12, v0
    v_xor_b32 v19, 0x100, v18
    v_and_b32 v193, 0xffff0000, v112
    v_mfma_f32_16x16x32_bf16 v[152:155], a[200:203], a[92:95], v[152:155]
    v_and_b32 v29, 0x1f0, v18
    v_mul_u32_u24 v29, 80, v29
    v_lshlrev_b32 v194, 16, v113
    v_and_b32 v195, 0xffff0000, v113
    v_mfma_f32_16x16x32_bf16 v[156:159], a[196:199], a[88:91], v[156:159]
    buffer_load_dwordx4 v23, s[76:79], s10 offen offset:3072 lds
    v_mfma_f32_16x16x32_bf16 v[156:159], a[204:207], a[92:95], v[156:159]
    ds_read_b128 a[72:75], v4 offset:18432
    ds_read_b128 a[76:79], v5 offset:18432
    v_mfma_f32_16x16x32_bf16 v[160:163], a[192:195], a[96:99], v[160:163]
    v_lshrrev_b32 v30, 4, v1
    v_mul_u32_u24 v25, 40, v30
    v_lshlrev_b32 v196, 16, v114
    v_mfma_f32_16x16x32_bf16 v[160:163], a[200:203], a[100:103], v[160:163]
    s_movk_i32 s10, 0x600
    s_add_u32 m0, s14, 0x8000
    v_add3_u32 v25, v29, v25, s11
    v_and_b32 v197, 0xffff0000, v114
    v_lshlrev_b32 v198, 16, v115
    v_mfma_f32_16x16x32_bf16 v[164:167], a[196:199], a[96:99], v[164:167]
    buffer_load_dwordx4 v20, s[76:79], s10 offen offset:0 lds
    v_mfma_f32_16x16x32_bf16 v[164:167], a[204:207], a[100:103], v[164:167]
    s_waitcnt lgkmcnt(4)
    ds_read_b128 a[80:83], v4 offset:20480
    ds_read_b128 a[84:87], v5 offset:20480
    v_and_b32 v199, 0xffff0000, v115
    v_mfma_f32_16x16x32_bf16 v[168:171], a[192:195], a[104:107], v[168:171]
    v_xor_b32 v30, s99, v30
    v_and_b32 v30, 1, v30
    v_mfma_f32_16x16x32_bf16 v[168:171], a[200:203], a[108:111], v[168:171]
    v_and_b32 v29, 60, v1
    v_add_u32 v29, v29, v1
    v_lshlrev_b32 v200, 16, v116
    v_and_b32 v201, 0xffff0000, v116
    v_mfma_f32_16x16x32_bf16 v[172:175], a[196:199], a[104:107], v[172:175]
    buffer_load_dwordx4 v21, s[76:79], s10 offen offset:1024 lds
    v_mfma_f32_16x16x32_bf16 v[172:175], a[204:207], a[108:111], v[172:175]
    ds_read_b128 a[88:91], v4 offset:22528
    ds_read_b128 a[92:95], v5 offset:22528
    v_lshlrev_b32 v202, 16, v117
    v_mfma_f32_16x16x32_bf16 v[176:179], a[192:195], a[112:115], v[176:179]
    v_lshl_add_u32 v29, v30, 2, v29
    v_xor_b32 v30, 4, v29
    v_and_b32 v203, 0xffff0000, v117
    v_mfma_f32_16x16x32_bf16 v[176:179], a[200:203], a[116:119], v[176:179]
    s_mov_b32 s12, 0x19000
    v_mad_u32_u24 v13, v29, 40, s12
    v_mad_u32_u24 v14, v30, 40, s12
    v_lshlrev_b32 v204, 16, v118
    v_mfma_f32_16x16x32_bf16 v[180:183], a[196:199], a[112:115], v[180:183]
    buffer_load_dwordx4 v22, s[76:79], s10 offen offset:2048 lds
    v_mfma_f32_16x16x32_bf16 v[180:183], a[204:207], a[116:119], v[180:183]
    s_lshr_b32 s101, s92, 1
    ds_read_b128 a[96:99], v4 offset:24576
    ds_read_b128 a[100:103], v5 offset:24576
    v_and_b32 v205, 0xffff0000, v118
    v_mfma_f32_16x16x32_bf16 v[184:187], a[192:195], a[120:123], v[184:187]
    s_lshl_b32 s101, s101, 8
    s_mul_i32 s11, s92, 0x4d800
    s_lshl_b32 s12, s88, 16
    v_lshlrev_b32 v206, 16, v119
    v_mfma_f32_16x16x32_bf16 v[184:187], a[200:203], a[124:127], v[184:187]
    s_add_u32 s92, s11, s12
    s_mul_i32 s12, s88, 28
    s_add_u32 s101, s101, s12
    v_and_b32 v207, 0xffff0000, v119
    v_mfma_f32_16x16x32_bf16 v[188:191], a[196:199], a[120:123], v[188:191]
    s_waitcnt lgkmcnt(6)
    buffer_load_dwordx4 v23, s[76:79], s10 offen offset:3072 lds
    v_mfma_f32_16x16x32_bf16 v[188:191], a[204:207], a[124:127], v[188:191]
    s_add_u32 s101, s101, 0xe000
    ds_read_b128 a[104:107], v4 offset:26624
    ds_read_b128 a[108:111], v5 offset:26624
    v_lshlrev_b32 v208, 16, v120
    v_mfma_f32_16x16x32_bf16 v[128:131], a[208:211], a[64:67], v[128:131]
    s_lshl_b32 s12, s12, 9
    s_add_u32 s97, s11, s12
    s_add_u32 s97, s97, 0x40000
    v_and_b32 v209, 0xffff0000, v120
    v_mfma_f32_16x16x32_bf16 v[128:131], a[216:219], a[68:71], v[128:131]
    s_movk_i32 s10, 0x680
    s_add_u32 m0, s14, 0xc000
    v_lshlrev_b32 v210, 16, v121
    v_mfma_f32_16x16x32_bf16 v[132:135], a[212:215], a[64:67], v[132:135]
    buffer_load_dwordx4 v20, s[76:79], s10 offen offset:0 lds
    v_mfma_f32_16x16x32_bf16 v[132:135], a[220:223], a[68:71], v[132:135]
    ds_read_b128 a[112:115], v4 offset:28672
    ds_read_b128 a[116:119], v5 offset:28672
    v_and_b32 v211, 0xffff0000, v121
    v_mfma_f32_16x16x32_bf16 v[136:139], a[208:211], a[72:75], v[136:139]
    s_add_u32 s60, s16, 0x0
    s_addc_u32 s61, s17, 0
    s_mov_b32 s62, 0x280000
    v_lshlrev_b32 v212, 16, v122
    v_mfma_f32_16x16x32_bf16 v[136:139], a[216:219], a[76:79], v[136:139]
    s_mov_b32 s63, 0x20000
    s_add_u32 s64, s38, 0x0
    s_addc_u32 s65, s39, 0
    v_and_b32 v213, 0xffff0000, v122
    v_lshlrev_b32 v214, 16, v123
    v_mfma_f32_16x16x32_bf16 v[140:143], a[212:215], a[72:75], v[140:143]
    buffer_load_dwordx4 v21, s[76:79], s10 offen offset:1024 lds
    v_mfma_f32_16x16x32_bf16 v[140:143], a[220:223], a[76:79], v[140:143]
    s_waitcnt vmcnt(27)
    s_barrier
    ds_read_b128 a[120:123], v4 offset:30720
    ds_read_b128 a[124:127], v5 offset:30720
    s_waitcnt lgkmcnt(6)
    v_mfma_f32_16x16x32_bf16 v[144:147], a[208:211], a[80:83], v[144:147]
    s_mov_b32 s66, 0x280000
    v_add_u32 v4, 0x10000, v4
    v_add_u32 v5, 0x10000, v5
    v_and_b32 v215, 0xffff0000, v123
    v_mfma_f32_16x16x32_bf16 v[144:147], a[216:219], a[84:87], v[144:147]
    s_mov_b32 s67, 0x20000
    s_add_u32 s52, s42, 0x5100000
    s_addc_u32 s53, s43, 0
    v_lshlrev_b32 v216, 16, v124
    v_and_b32 v217, 0xffff0000, v124
    v_mfma_f32_16x16x32_bf16 v[148:151], a[212:215], a[80:83], v[148:151]
    buffer_load_dwordx4 v22, s[76:79], s10 offen offset:2048 lds
    v_mfma_f32_16x16x32_bf16 v[148:151], a[220:223], a[84:87], v[148:151]
    s_mov_b32 s54, 0x780000
    ds_read_b128 a[64:67], v4 offset:16384
    ds_read_b128 a[68:71], v5 offset:16384
    v_mfma_f32_16x16x32_bf16 v[152:155], a[208:211], a[88:91], v[152:155]
    s_mov_b32 s55, 0x20000
    s_lshl_b32 s100, s100, 8
    s_add_u32 s100, s100, 0xa000
    v_lshlrev_b32 v218, 16, v125
    v_mfma_f32_16x16x32_bf16 v[152:155], a[216:219], a[92:95], v[152:155]
    v_and_b32 v219, 0xffff0000, v125
    v_lshlrev_b32 v220, 16, v126
    v_mfma_f32_16x16x32_bf16 v[156:159], a[212:215], a[88:91], v[156:159]
    buffer_load_dwordx4 v23, s[76:79], s10 offen offset:3072 lds
    v_mfma_f32_16x16x32_bf16 v[156:159], a[220:223], a[92:95], v[156:159]
    ds_read_b128 a[72:75], v4 offset:18432
    ds_read_b128 a[76:79], v5 offset:18432
    v_and_b32 v221, 0xffff0000, v126
    v_mfma_f32_16x16x32_bf16 v[160:163], a[208:211], a[96:99], v[160:163]
    v_lshlrev_b32 v222, 16, v127
    v_and_b32 v223, 0xffff0000, v127
    v_mfma_f32_16x16x32_bf16 v[160:163], a[216:219], a[100:103], v[160:163]
    s_movk_i32 s10, 0x700
    s_add_u32 m0, s14, 0x10000
    v_mul_f32 v112, v192, v192
    v_mfma_f32_16x16x32_bf16 v[164:167], a[212:215], a[96:99], v[164:167]
    buffer_load_dwordx4 v20, s[76:79], s10 offen offset:0 lds
    v_mfma_f32_16x16x32_bf16 v[164:167], a[220:223], a[100:103], v[164:167]
    s_waitcnt lgkmcnt(4)
    ds_read_b128 a[80:83], v4 offset:20480
    ds_read_b128 a[84:87], v5 offset:20480
    v_mfma_f32_16x16x32_bf16 v[168:171], a[208:211], a[104:107], v[168:171]
    v_mul_f32 v113, v193, v193
    v_mul_f32 v114, v194, v194
    v_mfma_f32_16x16x32_bf16 v[168:171], a[216:219], a[108:111], v[168:171]
    v_mul_f32 v115, v195, v195
    v_mul_f32 v116, v196, v196
    v_mfma_f32_16x16x32_bf16 v[172:175], a[212:215], a[104:107], v[172:175]
    buffer_load_dwordx4 v21, s[76:79], s10 offen offset:1024 lds
    v_mfma_f32_16x16x32_bf16 v[172:175], a[220:223], a[108:111], v[172:175]
    ds_read_b128 a[88:91], v4 offset:22528
    ds_read_b128 a[92:95], v5 offset:22528
    v_mfma_f32_16x16x32_bf16 v[176:179], a[208:211], a[112:115], v[176:179]
    v_mul_f32 v117, v197, v197
    v_mul_f32 v118, v198, v198
    v_mfma_f32_16x16x32_bf16 v[176:179], a[216:219], a[116:119], v[176:179]
    v_mul_f32 v119, v199, v199
    v_fma_f32 v112, v112, s80, v24
    v_mfma_f32_16x16x32_bf16 v[180:183], a[212:215], a[112:115], v[180:183]
    buffer_load_dwordx4 v22, s[76:79], s10 offen offset:2048 lds
    v_mfma_f32_16x16x32_bf16 v[180:183], a[220:223], a[116:119], v[180:183]
    ds_read_b128 a[96:99], v4 offset:24576
    ds_read_b128 a[100:103], v5 offset:24576
    v_mfma_f32_16x16x32_bf16 v[184:187], a[208:211], a[120:123], v[184:187]
    v_fma_f32 v113, v113, s80, v24
    v_fma_f32 v114, v114, s80, v24
    v_mfma_f32_16x16x32_bf16 v[184:187], a[216:219], a[124:127], v[184:187]
    v_fma_f32 v115, v115, s80, v24
    v_fma_f32 v116, v116, s80, v24
    v_mfma_f32_16x16x32_bf16 v[188:191], a[212:215], a[120:123], v[188:191]
    buffer_load_dwordx4 v23, s[76:79], s10 offen offset:3072 lds
    v_mfma_f32_16x16x32_bf16 v[188:191], a[220:223], a[124:127], v[188:191]
    s_waitcnt lgkmcnt(6)
    ds_read_b128 a[104:107], v4 offset:26624
    ds_read_b128 a[108:111], v5 offset:26624
    v_mfma_f32_16x16x32_bf16 v[128:131], a[224:227], a[64:67], v[128:131]
    v_fma_f32 v117, v117, s80, v24
    v_fma_f32 v118, v118, s80, v24
    v_mfma_f32_16x16x32_bf16 v[128:131], a[232:235], a[68:71], v[128:131]
    s_mov_b32 s13, 0xd000
    v_fma_f32 v119, v119, s80, v24
    v_mul_f32 v112, v112, v192
    v_mfma_f32_16x16x32_bf16 v[132:135], a[228:231], a[64:67], v[132:135]
    buffer_load_dwordx4 v[48:51], v0, s[72:75], s13 offen sc1
    v_mfma_f32_16x16x32_bf16 v[132:135], a[236:239], a[68:71], v[132:135]
    ds_read_b128 a[112:115], v4 offset:28672
    ds_read_b128 a[116:119], v5 offset:28672
    v_mfma_f32_16x16x32_bf16 v[136:139], a[224:227], a[72:75], v[136:139]
    v_mul_f32 v113, v113, v193
    v_mul_f32 v114, v114, v194
    v_mfma_f32_16x16x32_bf16 v[136:139], a[232:235], a[76:79], v[136:139]
    v_mul_f32 v115, v115, v195
    v_mul_f32 v116, v116, v196
    v_mfma_f32_16x16x32_bf16 v[140:143], a[228:231], a[72:75], v[140:143]
    buffer_load_dwordx4 v[52:55], v0, s[72:75], s13 offen offset:256 sc1
    v_mfma_f32_16x16x32_bf16 v[140:143], a[236:239], a[76:79], v[140:143]
    s_waitcnt vmcnt(31)
    s_barrier
    ds_read_b128 a[120:123], v4 offset:30720
    ds_read_b128 a[124:127], v5 offset:30720
    s_waitcnt lgkmcnt(6)
    v_mfma_f32_16x16x32_bf16 v[144:147], a[224:227], a[80:83], v[144:147]
    v_mul_f32 v117, v117, v197
    v_mul_f32 v118, v118, v198
    v_mfma_f32_16x16x32_bf16 v[144:147], a[232:235], a[84:87], v[144:147]
    v_mul_f32 v119, v119, v199
    v_mfma_f32_16x16x32_bf16 v[148:151], a[228:231], a[80:83], v[148:151]
    buffer_load_dwordx4 v[56:59], v0, s[72:75], s13 offen offset:2048 sc1
    v_mfma_f32_16x16x32_bf16 v[148:151], a[236:239], a[84:87], v[148:151]
    ds_read_b128 a[64:67], v4 offset:0
    ds_read_b128 a[68:71], v5 offset:0
    v_mfma_f32_16x16x32_bf16 v[152:155], a[224:227], a[88:91], v[152:155]
    v_exp_f32 v112, v112
    v_mfma_f32_16x16x32_bf16 v[152:155], a[232:235], a[92:95], v[152:155]
    v_mul_f32 v120, v200, v200
    v_mfma_f32_16x16x32_bf16 v[156:159], a[228:231], a[88:91], v[156:159]
    buffer_load_dwordx4 v[60:63], v0, s[72:75], s13 offen offset:2304 sc1
    v_mfma_f32_16x16x32_bf16 v[156:159], a[236:239], a[92:95], v[156:159]
    ds_read_b128 a[72:75], v4 offset:2048
    ds_read_b128 a[76:79], v5 offset:2048
    v_mfma_f32_16x16x32_bf16 v[160:163], a[224:227], a[96:99], v[160:163]
    v_exp_f32 v113, v113
    v_mfma_f32_16x16x32_bf16 v[160:163], a[232:235], a[100:103], v[160:163]
    s_movk_i32 s10, 0x780
    s_add_u32 m0, s14, 0x14000
    v_mul_f32 v121, v201, v201
    v_mfma_f32_16x16x32_bf16 v[164:167], a[228:231], a[96:99], v[164:167]
    buffer_load_dwordx4 v20, s[76:79], s10 offen offset:0 lds
    v_mfma_f32_16x16x32_bf16 v[164:167], a[236:239], a[100:103], v[164:167]
    s_waitcnt lgkmcnt(4)
    ds_read_b128 a[80:83], v4 offset:4096
    ds_read_b128 a[84:87], v5 offset:4096
    v_mfma_f32_16x16x32_bf16 v[168:171], a[224:227], a[104:107], v[168:171]
    buffer_load_dword v27, v28, s[68:71], s89 offen sc1
    v_mfma_f32_16x16x32_bf16 v[168:171], a[232:235], a[108:111], v[168:171]
    ds_read_b128 a[88:91], v4 offset:6144
    v_mfma_f32_16x16x32_bf16 v[172:175], a[228:231], a[104:107], v[172:175]
    buffer_load_dwordx4 v21, s[76:79], s10 offen offset:1024 lds
    v_mfma_f32_16x16x32_bf16 v[172:175], a[236:239], a[108:111], v[172:175]
    ds_read_b128 a[92:95], v5 offset:6144
    v_exp_f32 v114, v114
    v_mfma_f32_16x16x32_bf16 v[176:179], a[224:227], a[112:115], v[176:179]
    v_exp_f32 v115, v115
    v_mfma_f32_16x16x32_bf16 v[176:179], a[232:235], a[116:119], v[176:179]
    v_mul_f32 v122, v202, v202
    v_exp_f32 v116, v116
    v_mfma_f32_16x16x32_bf16 v[180:183], a[228:231], a[112:115], v[180:183]
    buffer_load_dwordx4 v22, s[76:79], s10 offen offset:2048 lds
    v_mfma_f32_16x16x32_bf16 v[180:183], a[236:239], a[116:119], v[180:183]
    ds_read_b128 a[96:99], v4 offset:8192
    ds_read_b128 a[100:103], v5 offset:8192
    v_mfma_f32_16x16x32_bf16 v[184:187], a[224:227], a[120:123], v[184:187]
    v_exp_f32 v117, v117
    v_mfma_f32_16x16x32_bf16 v[184:187], a[232:235], a[124:127], v[184:187]
    v_mul_f32 v123, v203, v203
    v_exp_f32 v118, v118
    v_mfma_f32_16x16x32_bf16 v[188:191], a[228:231], a[120:123], v[188:191]
    buffer_load_dwordx4 v23, s[76:79], s10 offen offset:3072 lds
    v_mfma_f32_16x16x32_bf16 v[188:191], a[236:239], a[124:127], v[188:191]
    s_waitcnt lgkmcnt(6)
    ds_read_b128 a[104:107], v4 offset:10240
    ds_read_b128 a[108:111], v5 offset:10240
    v_mfma_f32_16x16x32_bf16 v[128:131], a[240:243], a[64:67], v[128:131]
    v_mul_f32 v124, v204, v204
    v_mfma_f32_16x16x32_bf16 v[128:131], a[248:251], a[68:71], v[128:131]
    s_mov_b32 s13, 0xe000
    v_exp_f32 v119, v119
    v_add_f32 v112, 1.0, v112
    v_mfma_f32_16x16x32_bf16 v[132:135], a[244:247], a[64:67], v[132:135]
    buffer_load_dwordx4 v[64:67], v0, s[72:75], s13 offen sc1
    v_mfma_f32_16x16x32_bf16 v[132:135], a[252:255], a[68:71], v[132:135]
    ds_read_b128 a[112:115], v4 offset:12288
    ds_read_b128 a[116:119], v5 offset:12288
    v_mfma_f32_16x16x32_bf16 v[136:139], a[240:243], a[72:75], v[136:139]
    v_mul_f32 v125, v205, v205
    v_add_f32 v113, 1.0, v113
    v_mfma_f32_16x16x32_bf16 v[136:139], a[248:251], a[76:79], v[136:139]
    v_add_f32 v114, 1.0, v114
    v_mul_f32 v126, v206, v206
    v_mfma_f32_16x16x32_bf16 v[140:143], a[244:247], a[72:75], v[140:143]
    buffer_load_dwordx4 v[68:71], v0, s[72:75], s13 offen offset:256 sc1
    v_mfma_f32_16x16x32_bf16 v[140:143], a[252:255], a[76:79], v[140:143]
    s_waitcnt vmcnt(35)
    s_barrier
    ds_read_b128 a[120:123], v4 offset:14336
    ds_read_b128 a[124:127], v5 offset:14336
    s_waitcnt lgkmcnt(6)
    v_mfma_f32_16x16x32_bf16 v[144:147], a[240:243], a[80:83], v[144:147]
    v_add_u32 v4, 0xffff0000, v4
    v_add_u32 v5, 0xffff0000, v5
    v_mfma_f32_16x16x32_bf16 v[144:147], a[248:251], a[84:87], v[144:147]
    v_add_f32 v115, 1.0, v115
    v_mul_f32 v127, v207, v207
    v_mfma_f32_16x16x32_bf16 v[148:151], a[244:247], a[80:83], v[148:151]
    buffer_load_dwordx4 v[72:75], v0, s[72:75], s13 offen offset:2048 sc1
    v_mfma_f32_16x16x32_bf16 v[148:151], a[252:255], a[84:87], v[148:151]
    ds_read_b128 a[64:67], v4 offset:49152
    ds_read_b128 a[68:71], v5 offset:49152
    v_add_f32 v116, 1.0, v116
    v_mfma_f32_16x16x32_bf16 v[152:155], a[240:243], a[88:91], v[152:155]
    v_add_f32 v117, 1.0, v117
    v_fma_f32 v120, v120, s80, v24
    v_mfma_f32_16x16x32_bf16 v[152:155], a[248:251], a[92:95], v[152:155]
    v_add_f32 v118, 1.0, v118
    v_add_f32 v119, 1.0, v119
    v_mfma_f32_16x16x32_bf16 v[156:159], a[244:247], a[88:91], v[156:159]
    buffer_load_dwordx4 v[76:79], v0, s[72:75], s13 offen offset:2304 sc1
    v_mfma_f32_16x16x32_bf16 v[156:159], a[252:255], a[92:95], v[156:159]
    ds_read_b128 a[72:75], v4 offset:51200
    ds_read_b128 a[76:79], v5 offset:51200
    v_mfma_f32_16x16x32_bf16 v[160:163], a[240:243], a[96:99], v[160:163]
    v_fma_f32 v121, v121, s80, v24
    v_mfma_f32_16x16x32_bf16 v[160:163], a[248:251], a[100:103], v[160:163]
    s_mov_b32 s13, 0xf000
    v_rcp_f32 v112, v112
    v_mfma_f32_16x16x32_bf16 v[164:167], a[244:247], a[96:99], v[164:167]
    buffer_load_dwordx4 v[80:83], v0, s[72:75], s13 offen sc1
    v_mfma_f32_16x16x32_bf16 v[164:167], a[252:255], a[100:103], v[164:167]
    s_waitcnt lgkmcnt(4)
    ds_read_b128 a[80:83], v4 offset:53248
    ds_read_b128 a[84:87], v5 offset:53248
    v_mfma_f32_16x16x32_bf16 v[168:171], a[240:243], a[104:107], v[168:171]
    v_fma_f32 v122, v122, s80, v24
    v_mfma_f32_16x16x32_bf16 v[168:171], a[248:251], a[108:111], v[168:171]
    v_rcp_f32 v113, v113
    v_mfma_f32_16x16x32_bf16 v[172:175], a[244:247], a[104:107], v[172:175]
    buffer_load_dwordx4 v[84:87], v0, s[72:75], s13 offen offset:256 sc1
    v_mfma_f32_16x16x32_bf16 v[172:175], a[252:255], a[108:111], v[172:175]
    ds_read_b128 a[88:91], v4 offset:55296
    ds_read_b128 a[92:95], v5 offset:55296
    v_rcp_f32 v114, v114
    v_mfma_f32_16x16x32_bf16 v[176:179], a[240:243], a[112:115], v[176:179]
    v_fma_f32 v123, v123, s80, v24
    v_mfma_f32_16x16x32_bf16 v[176:179], a[248:251], a[116:119], v[176:179]
    v_rcp_f32 v115, v115
    v_mfma_f32_16x16x32_bf16 v[180:183], a[244:247], a[112:115], v[180:183]
    buffer_load_dwordx4 v[88:91], v0, s[72:75], s13 offen offset:2048 sc1
    v_mfma_f32_16x16x32_bf16 v[180:183], a[252:255], a[116:119], v[180:183]
    ds_read_b128 a[96:99], v4 offset:57344
    ds_read_b128 a[100:103], v5 offset:57344
    v_rcp_f32 v116, v116
    v_mfma_f32_16x16x32_bf16 v[184:187], a[240:243], a[120:123], v[184:187]
    v_fma_f32 v124, v124, s80, v24
    v_mfma_f32_16x16x32_bf16 v[184:187], a[248:251], a[124:127], v[184:187]
    v_rcp_f32 v117, v117
    v_mfma_f32_16x16x32_bf16 v[188:191], a[244:247], a[120:123], v[188:191]
    buffer_load_dwordx4 v[92:95], v0, s[72:75], s13 offen offset:2304 sc1
    v_mfma_f32_16x16x32_bf16 v[188:191], a[252:255], a[124:127], v[188:191]
    s_waitcnt lgkmcnt(6)
    ds_read_b128 a[104:107], v4 offset:59392
    ds_read_b128 a[108:111], v5 offset:59392
    v_fma_f32 v125, v125, s80, v24
    v_mfma_f32_16x16x32_bf16 v[128:131], a[128:131], a[64:67], v[128:131]
    ds_read_b128 a[112:115], v4 offset:61440
    v_rcp_f32 v118, v118
    v_mfma_f32_16x16x32_bf16 v[128:131], a[136:139], a[68:71], v[128:131]
    v_rcp_f32 v119, v119
    v_mfma_f32_16x16x32_bf16 v[132:135], a[132:135], a[64:67], v[132:135]
    ds_read_b128 a[116:119], v5 offset:61440
    v_fma_f32 v126, v126, s80, v24
    v_mfma_f32_16x16x32_bf16 v[132:135], a[140:143], a[68:71], v[132:135]
    v_mul_f32 v192, v112, v192
    v_mul_f32 v193, v113, v193
    v_mfma_f32_16x16x32_bf16 v[136:139], a[128:131], a[72:75], v[136:139]
    ds_read_b128 a[120:123], v4 offset:63488
    v_fma_f32 v127, v127, s80, v24
    v_mfma_f32_16x16x32_bf16 v[136:139], a[136:139], a[76:79], v[136:139]
    v_mul_f32 v194, v114, v194
    v_mul_f32 v120, v120, v200
    v_mfma_f32_16x16x32_bf16 v[140:143], a[132:135], a[72:75], v[140:143]
    ds_read_b128 a[124:127], v5 offset:63488
    v_mul_f32 v195, v115, v195
    v_mfma_f32_16x16x32_bf16 v[140:143], a[140:143], a[76:79], v[140:143]
    s_waitcnt vmcnt(37)
    s_barrier
    v_mul_f32 v196, v116, v196
    v_mul_f32 v121, v121, v201
    s_waitcnt lgkmcnt(6)
    v_mfma_f32_16x16x32_bf16 v[144:147], a[128:131], a[80:83], v[144:147]
    v_mul_f32 v197, v117, v197
    v_mul_f32 v198, v118, v198
    v_mfma_f32_16x16x32_bf16 v[144:147], a[136:139], a[84:87], v[144:147]
    s_mov_b32 s10, 0x0
    s_add_u32 m0, s95, 0x23000
    v_mul_f32 v122, v122, v202
    v_mfma_f32_16x16x32_bf16 v[148:151], a[132:135], a[80:83], v[148:151]
    buffer_load_dwordx4 v8, s[44:47], s10 offen offset:0 lds
    v_mfma_f32_16x16x32_bf16 v[148:151], a[140:143], a[84:87], v[148:151]
    ds_read_b128 a[64:67], v4 offset:32768
    ds_read_b128 a[68:71], v5 offset:32768
    v_mfma_f32_16x16x32_bf16 v[152:155], a[128:131], a[88:91], v[152:155]
    v_mul_f32 v199, v119, v199
    v_mul_f32 v123, v123, v203
    v_mfma_f32_16x16x32_bf16 v[152:155], a[136:139], a[92:95], v[152:155]
    v_mul_f32 v224, v192, v96
    v_mul_f32 v225, v193, v96
    v_mfma_f32_16x16x32_bf16 v[156:159], a[132:135], a[88:91], v[156:159]
    buffer_load_dwordx4 v9, s[44:47], s10 offen offset:1024 lds
    v_mfma_f32_16x16x32_bf16 v[156:159], a[140:143], a[92:95], v[156:159]
    ds_read_b128 a[72:75], v4 offset:34816
    ds_read_b128 a[76:79], v5 offset:34816
    v_mfma_f32_16x16x32_bf16 v[160:163], a[128:131], a[96:99], v[160:163]
    v_mul_f32 v124, v124, v204
    v_mul_f32 v226, v194, v96
    v_mfma_f32_16x16x32_bf16 v[160:163], a[136:139], a[100:103], v[160:163]
    v_mul_f32 v227, v195, v96
    v_mul_f32 v125, v125, v205
    v_mfma_f32_16x16x32_bf16 v[164:167], a[132:135], a[96:99], v[164:167]
    buffer_load_dwordx4 v10, s[44:47], s10 offen offset:2048 lds
    v_mfma_f32_16x16x32_bf16 v[164:167], a[140:143], a[100:103], v[164:167]
    s_waitcnt lgkmcnt(9)
    ds_read_b128 a[80:83], v4 offset:36864
    ds_read_b128 a[84:87], v5 offset:36864
    v_mfma_f32_16x16x32_bf16 v[168:171], a[128:131], a[104:107], v[168:171]
    s_waitcnt vmcnt(14)
    v_cmp_eq_u32 vcc, 1, v27
    s_nop 0
    s_bfe_u32 s11, vcc_lo, 0x80000
    s_cmp_ge_u32 s11, 255
    s_cbranch_scc0 fk_w4_slow
fk_w4_ok:
    s_waitcnt lgkmcnt(6)
    v_mfma_f32_16x16x32_bf16 v[168:171], a[136:139], a[108:111], v[168:171]
    v_mul_f32 v228, v196, v96
    v_mul_f32 v126, v126, v206
    v_mfma_f32_16x16x32_bf16 v[172:175], a[132:135], a[104:107], v[172:175]
    buffer_load_dwordx4 v11, s[44:47], s10 offen offset:3072 lds
    v_mfma_f32_16x16x32_bf16 v[172:175], a[140:143], a[108:111], v[172:175]
    ds_read_b128 a[88:91], v4 offset:38912
    ds_read_b128 a[92:95], v5 offset:38912
    v_mfma_f32_16x16x32_bf16 v[176:179], a[128:131], a[112:115], v[176:179]
    v_mul_f32 v229, v197, v96
    v_mul_f32 v230, v198, v96
    v_mfma_f32_16x16x32_bf16 v[176:179], a[136:139], a[116:119], v[176:179]
    s_add_u32 m0, s95, 0x24000
    v_mul_f32 v127, v127, v207
    v_mul_f32 v231, v199, v96
    v_mfma_f32_16x16x32_bf16 v[180:183], a[132:135], a[112:115], v[180:183]
    buffer_load_dwordx4 v12, s[44:47], s10 offen offset:0 lds
    v_mfma_f32_16x16x32_bf16 v[180:183], a[140:143], a[116:119], v[180:183]
    ds_read_b128 a[96:99], v4 offset:40960
    ds_read_b128 a[100:103], v5 offset:40960
    v_mfma_f32_16x16x32_bf16 v[184:187], a[128:131], a[120:123], v[184:187]
    v_exp_f32 v120, v120
    v_mfma_f32_16x16x32_bf16 v[184:187], a[136:139], a[124:127], v[184:187]
    s_add_u32 s13, s92, 0x0
    v_mul_f32 v112, v208, v208
    v_mfma_f32_16x16x32_bf16 v[188:191], a[132:135], a[120:123], v[188:191]
    buffer_load_dwordx4 a[160:163], v18, s[56:59], s13 offen sc1
    v_mfma_f32_16x16x32_bf16 v[188:191], a[140:143], a[124:127], v[188:191]
    s_waitcnt lgkmcnt(6)
    ds_read_b128 a[104:107], v4 offset:43008
    ds_read_b128 a[108:111], v5 offset:43008
    v_mfma_f32_16x16x32_bf16 v[128:131], a[144:147], a[64:67], v[128:131]
    v_exp_f32 v121, v121
    v_mfma_f32_16x16x32_bf16 v[128:131], a[152:155], a[68:71], v[128:131]
    v_mul_f32 v113, v209, v209
    v_mfma_f32_16x16x32_bf16 v[132:135], a[148:151], a[64:67], v[132:135]
    buffer_load_dwordx4 a[164:167], v19, s[56:59], s13 offen sc1
    v_mfma_f32_16x16x32_bf16 v[132:135], a[156:159], a[68:71], v[132:135]
    ds_read_b128 a[112:115], v4 offset:45056
    ds_read_b128 a[116:119], v5 offset:45056
    v_mfma_f32_16x16x32_bf16 v[136:139], a[144:147], a[72:75], v[136:139]
    v_exp_f32 v122, v122
    v_mfma_f32_16x16x32_bf16 v[136:139], a[152:155], a[76:79], v[136:139]
    s_add_u32 s13, s92, 0x800
    v_exp_f32 v123, v123
    v_mfma_f32_16x16x32_bf16 v[140:143], a[148:151], a[72:75], v[140:143]
    buffer_load_dwordx4 a[168:171], v18, s[56:59], s13 offen sc1
    v_mfma_f32_16x16x32_bf16 v[140:143], a[156:159], a[76:79], v[140:143]
    s_barrier
    ds_read_b128 a[120:123], v4 offset:47104
    ds_read_b128 a[124:127], v5 offset:47104
    s_waitcnt lgkmcnt(6)
    v_mfma_f32_16x16x32_bf16 v[144:147], a[144:147], a[80:83], v[144:147]
    v_add_u32 v4, 0xffff0000, v4
    v_add_u32 v5, 0xffff0000, v5
    v_mfma_f32_16x16x32_bf16 v[144:147], a[152:155], a[84:87], v[144:147]
    v_mul_f32 v114, v210, v210
    v_exp_f32 v124, v124
    v_mfma_f32_16x16x32_bf16 v[148:151], a[148:151], a[80:83], v[148:151]
    buffer_load_dwordx4 a[172:175], v19, s[56:59], s13 offen sc1
    v_mfma_f32_16x16x32_bf16 v[148:151], a[156:159], a[84:87], v[148:151]
    ds_read_b128 a[64:67], v4 offset:8192
    ds_read_b128 a[68:71], v5 offset:8192
    v_mfma_f32_16x16x32_bf16 v[152:155], a[144:147], a[88:91], v[152:155]
    buffer_load_dword v26, v2, s[28:31], 0 offen sc1
    v_mfma_f32_16x16x32_bf16 v[152:155], a[152:155], a[92:95], v[152:155]
    s_mov_b32 s10, 0x14000
    s_add_u32 m0, s95, 0x1e000
    ds_read_b128 a[72:75], v4 offset:10240
    v_mfma_f32_16x16x32_bf16 v[156:159], a[148:151], a[88:91], v[156:159]
    buffer_load_dwordx4 v8, s[44:47], s10 offen offset:0 lds
    v_exp_f32 v125, v125
    v_mfma_f32_16x16x32_bf16 v[156:159], a[156:159], a[92:95], v[156:159]
    ds_read_b128 a[76:79], v5 offset:10240
    v_mul_f32 v115, v211, v211
    v_mfma_f32_16x16x32_bf16 v[160:163], a[144:147], a[96:99], v[160:163]
    v_exp_f32 v126, v126
    v_mfma_f32_16x16x32_bf16 v[160:163], a[152:155], a[100:103], v[160:163]
    v_mul_f32 v116, v212, v212
    v_exp_f32 v127, v127
    v_mfma_f32_16x16x32_bf16 v[164:167], a[148:151], a[96:99], v[164:167]
    buffer_load_dwordx4 v9, s[44:47], s10 offen offset:1024 lds
    v_mfma_f32_16x16x32_bf16 v[164:167], a[156:159], a[100:103], v[164:167]
    s_waitcnt lgkmcnt(4)
    ds_read_b128 a[80:83], v4 offset:12288
    ds_read_b128 a[84:87], v5 offset:12288
    v_mfma_f32_16x16x32_bf16 v[168:171], a[144:147], a[104:107], v[168:171]
    v_add_f32 v120, 1.0, v120
    v_mul_f32 v117, v213, v213
    v_mfma_f32_16x16x32_bf16 v[168:171], a[152:155], a[108:111], v[168:171]
    v_add_f32 v121, 1.0, v121
    v_add_f32 v122, 1.0, v122
    v_mfma_f32_16x16x32_bf16 v[172:175], a[148:151], a[104:107], v[172:175]
    buffer_load_dwordx4 v10, s[44:47], s10 offen offset:2048 lds
    v_mfma_f32_16x16x32_bf16 v[172:175], a[156:159], a[108:111], v[172:175]
    ds_read_b128 a[88:91], v4 offset:14336
    ds_read_b128 a[92:95], v5 offset:14336
    v_mfma_f32_16x16x32_bf16 v[176:179], a[144:147], a[112:115], v[176:179]
    v_mul_f32 v118, v214, v214
    v_add_f32 v123, 1.0, v123
    v_mfma_f32_16x16x32_bf16 v[176:179], a[152:155], a[116:119], v[176:179]
    v_mul_f32 v119, v215, v215
    v_add_f32 v124, 1.0, v124
    v_mfma_f32_16x16x32_bf16 v[180:183], a[148:151], a[112:115], v[180:183]
    buffer_load_dwordx4 v11, s[44:47], s10 offen offset:3072 lds
    v_mfma_f32_16x16x32_bf16 v[180:183], a[156:159], a[116:119], v[180:183]
    ds_read_b128 a[96:99], v4 offset:24576
    ds_read_b128 a[100:103], v5 offset:24576
    v_mfma_f32_16x16x32_bf16 v[184:187], a[144:147], a[120:123], v[184:187]
    v_add_f32 v125, 1.0, v125
    v_fma_f32 v112, v112, s80, v24
    v_mfma_f32_16x16x32_bf16 v[184:187], a[152:155], a[124:127], v[184:187]
    s_add_u32 m0, s95, 0x1f000
    v_add_f32 v126, 1.0, v126
    v_add_f32 v127, 1.0, v127
    v_mfma_f32_16x16x32_bf16 v[188:191], a[148:151], a[120:123], v[188:191]
    buffer_load_dwordx4 v12, s[44:47], s10 offen offset:0 lds
    v_mfma_f32_16x16x32_bf16 v[188:191], a[156:159], a[124:127], v[188:191]
    s_waitcnt lgkmcnt(6)
    ds_read_b128 a[104:107], v4 offset:26624
    ds_read_b128 a[108:111], v5 offset:26624
    v_mfma_f32_16x16x32_bf16 v[160:163], a[32:35], a[64:67], v[160:163]
    v_fma_f32 v113, v113, s80, v24
    v_mfma_f32_16x16x32_bf16 v[160:163], a[40:43], a[68:71], v[160:163]
    s_add_u32 s13, s92, 0x1000
    v_rcp_f32 v120, v120
    v_mfma_f32_16x16x32_bf16 v[164:167], a[36:39], a[64:67], v[164:167]
    buffer_load_dwordx4 a[176:179], v18, s[56:59], s13 offen sc1
    v_mfma_f32_16x16x32_bf16 v[164:167], a[44:47], a[68:71], v[164:167]
    ds_read_b128 a[112:115], v4 offset:28672
    ds_read_b128 a[116:119], v5 offset:28672
    v_mfma_f32_16x16x32_bf16 v[168:171], a[32:35], a[72:75], v[168:171]
    v_fma_f32 v114, v114, s80, v24
    v_mfma_f32_16x16x32_bf16 v[168:171], a[40:43], a[76:79], v[168:171]
    v_rcp_f32 v121, v121
    v_mfma_f32_16x16x32_bf16 v[172:175], a[36:39], a[72:75], v[172:175]
    buffer_load_dwordx4 a[180:183], v19, s[56:59], s13 offen sc1
    v_mfma_f32_16x16x32_bf16 v[172:175], a[44:47], a[76:79], v[172:175]
    s_barrier
    ds_read_b128 a[120:123], v4 offset:30720
    ds_read_b128 a[124:127], v5 offset:30720
    s_waitcnt lgkmcnt(6)
    v_mfma_f32_16x16x32_bf16 v[176:179], a[32:35], a[80:83], v[176:179]
    v_rcp_f32 v122, v122
    v_mfma_f32_16x16x32_bf16 v[176:179], a[40:43], a[84:87], v[176:179]
    s_mov_b32 s10, 0x28000
    s_add_u32 m0, s95, 0x19000
    v_fma_f32 v115, v115, s80, v24
    v_mfma_f32_16x16x32_bf16 v[180:183], a[36:39], a[80:83], v[180:183]
    buffer_load_dwordx4 v8, s[44:47], s10 offen offset:0 lds
    v_mfma_f32_16x16x32_bf16 v[180:183], a[44:47], a[84:87], v[180:183]
    ds_read_b128 a[64:67], v4 offset:40960
    ds_read_b128 a[68:71], v5 offset:40960
    v_rcp_f32 v123, v123
    v_mfma_f32_16x16x32_bf16 v[184:187], a[32:35], a[88:91], v[184:187]
    v_rcp_f32 v124, v124
    v_mfma_f32_16x16x32_bf16 v[184:187], a[40:43], a[92:95], v[184:187]
    v_fma_f32 v116, v116, s80, v24
    v_rcp_f32 v125, v125
    v_mfma_f32_16x16x32_bf16 v[188:191], a[36:39], a[88:91], v[188:191]
    buffer_load_dwordx4 v9, s[44:47], s10 offen offset:1024 lds
    v_mfma_f32_16x16x32_bf16 v[188:191], a[44:47], a[92:95], v[188:191]
    ds_read_b128 a[72:75], v4 offset:43008
    ds_read_b128 a[76:79], v5 offset:43008
    v_mfma_f32_16x16x32_bf16 v[160:163], a[48:51], a[96:99], v[160:163]
    v_fma_f32 v117, v117, s80, v24
    v_mfma_f32_16x16x32_bf16 v[160:163], a[56:59], a[100:103], v[160:163]
    v_rcp_f32 v126, v126
    v_mfma_f32_16x16x32_bf16 v[164:167], a[52:55], a[96:99], v[164:167]
    buffer_load_dwordx4 v10, s[44:47], s10 offen offset:2048 lds
    v_mfma_f32_16x16x32_bf16 v[164:167], a[60:63], a[100:103], v[164:167]
    s_waitcnt lgkmcnt(4)
    ds_read_b128 a[80:83], v4 offset:45056
    ds_read_b128 a[84:87], v5 offset:45056
    v_rcp_f32 v127, v127
    v_mfma_f32_16x16x32_bf16 v[168:171], a[48:51], a[104:107], v[168:171]
    v_fma_f32 v118, v118, s80, v24
    v_mul_f32 v200, v120, v200
    v_mfma_f32_16x16x32_bf16 v[168:171], a[56:59], a[108:111], v[168:171]
    v_mul_f32 v201, v121, v201
    v_fma_f32 v119, v119, s80, v24
    v_mfma_f32_16x16x32_bf16 v[172:175], a[52:55], a[104:107], v[172:175]
    buffer_load_dwordx4 v11, s[44:47], s10 offen offset:3072 lds
    v_mfma_f32_16x16x32_bf16 v[172:175], a[60:63], a[108:111], v[172:175]
    ds_read_b128 a[88:91], v4 offset:47104
    ds_read_b128 a[92:95], v5 offset:47104
    v_mfma_f32_16x16x32_bf16 v[176:179], a[48:51], a[112:115], v[176:179]
    v_mul_f32 v202, v122, v202
    v_mul_f32 v112, v112, v208
    v_mfma_f32_16x16x32_bf16 v[176:179], a[56:59], a[116:119], v[176:179]
    s_add_u32 m0, s95, 0x1a000
    v_mul_f32 v203, v123, v203
    v_mul_f32 v204, v124, v204
    v_mfma_f32_16x16x32_bf16 v[180:183], a[52:55], a[112:115], v[180:183]
    buffer_load_dwordx4 v12, s[44:47], s10 offen offset:0 lds
    v_mfma_f32_16x16x32_bf16 v[180:183], a[60:63], a[116:119], v[180:183]
    ds_read_b128 a[96:99], v4 offset:57344
    ds_read_b128 a[100:103], v5 offset:57344
    v_mfma_f32_16x16x32_bf16 v[184:187], a[48:51], a[120:123], v[184:187]
    v_mul_f32 v113, v113, v209
    v_mul_f32 v205, v125, v205
    v_mfma_f32_16x16x32_bf16 v[184:187], a[56:59], a[124:127], v[184:187]
    s_add_u32 s13, s92, 0x1800
    v_mul_f32 v206, v126, v206
    v_mul_f32 v114, v114, v210
    v_mfma_f32_16x16x32_bf16 v[188:191], a[52:55], a[120:123], v[188:191]
    buffer_load_dwordx4 a[184:187], v18, s[56:59], s13 offen sc1
    v_mfma_f32_16x16x32_bf16 v[188:191], a[60:63], a[124:127], v[188:191]
    s_waitcnt lgkmcnt(6)
    ds_read_b128 a[104:107], v4 offset:59392
    ds_read_b128 a[108:111], v5 offset:59392
    v_mfma_f32_16x16x32_bf16 v[160:163], v[32:35], a[64:67], v[160:163]
    v_mul_f32 v207, v127, v207
    v_mul_f32 v115, v115, v211
    v_mfma_f32_16x16x32_bf16 v[160:163], v[40:43], a[68:71], v[160:163]
    v_mul_f32 v232, v200, v97
    v_mul_f32 v233, v201, v97
    v_mfma_f32_16x16x32_bf16 v[164:167], v[36:39], a[64:67], v[164:167]
    buffer_load_dwordx4 a[188:191], v19, s[56:59], s13 offen sc1
    v_mfma_f32_16x16x32_bf16 v[164:167], v[44:47], a[68:71], v[164:167]
    ds_read_b128 a[112:115], v4 offset:61440
    ds_read_b128 a[116:119], v5 offset:61440
    v_mfma_f32_16x16x32_bf16 v[168:171], v[32:35], a[72:75], v[168:171]
    v_mul_f32 v116, v116, v212
    v_mul_f32 v234, v202, v97
    v_mfma_f32_16x16x32_bf16 v[168:171], v[40:43], a[76:79], v[168:171]
    s_add_u32 s13, s92, 0x2000
    v_mul_f32 v235, v203, v97
    v_mul_f32 v117, v117, v213
    v_mfma_f32_16x16x32_bf16 v[172:175], v[36:39], a[72:75], v[172:175]
    buffer_load_dwordx4 a[192:195], v18, s[56:59], s13 offen sc1
    v_mfma_f32_16x16x32_bf16 v[172:175], v[44:47], a[76:79], v[172:175]
    s_waitcnt vmcnt(33)
    s_barrier
    ds_read_b128 a[120:123], v4 offset:63488
    ds_read_b128 a[124:127], v5 offset:63488
    s_waitcnt lgkmcnt(6)
    v_mfma_f32_16x16x32_bf16 v[176:179], v[32:35], a[80:83], v[176:179]
    v_add_u32 v4, 0x10000, v4
    v_add_u32 v5, 0x10000, v5
    v_mfma_f32_16x16x32_bf16 v[176:179], v[40:43], a[84:87], v[176:179]
    v_mul_f32 v236, v204, v97
    v_mul_f32 v118, v118, v214
    v_mfma_f32_16x16x32_bf16 v[180:183], v[36:39], a[80:83], v[180:183]
    buffer_load_dwordx4 a[196:199], v19, s[56:59], s13 offen sc1
    v_mfma_f32_16x16x32_bf16 v[180:183], v[44:47], a[84:87], v[180:183]
    ds_read_b128 a[64:67], v4 offset:8192
    ds_read_b128 a[68:71], v5 offset:8192
    v_mfma_f32_16x16x32_bf16 v[184:187], v[32:35], a[88:91], v[184:187]
    v_mul_f32 v237, v205, v97
    v_mul_f32 v238, v206, v97
    v_mfma_f32_16x16x32_bf16 v[184:187], v[40:43], a[92:95], v[184:187]
    s_add_u32 s13, s92, 0x2800
    v_mul_f32 v119, v119, v215
    v_mul_f32 v239, v207, v97
    v_mfma_f32_16x16x32_bf16 v[188:191], v[36:39], a[88:91], v[188:191]
    buffer_load_dwordx4 a[200:203], v18, s[56:59], s13 offen sc1
    v_mfma_f32_16x16x32_bf16 v[188:191], v[44:47], a[92:95], v[188:191]
    ds_read_b128 a[72:75], v4 offset:10240
    ds_read_b128 a[76:79], v5 offset:10240
    v_mfma_f32_16x16x32_bf16 v[160:163], v[48:51], a[96:99], v[160:163]
    v_exp_f32 v112, v112
    v_mfma_f32_16x16x32_bf16 v[160:163], v[56:59], a[100:103], v[160:163]
    v_mul_f32 v120, v216, v216
    v_mfma_f32_16x16x32_bf16 v[164:167], v[52:55], a[96:99], v[164:167]
    buffer_load_dwordx4 a[204:207], v19, s[56:59], s13 offen sc1
    v_mfma_f32_16x16x32_bf16 v[164:167], v[60:63], a[100:103], v[164:167]
    s_waitcnt lgkmcnt(4)
    ds_read_b128 a[80:83], v4 offset:12288
    ds_read_b128 a[84:87], v5 offset:12288
    v_mfma_f32_16x16x32_bf16 v[168:171], v[48:51], a[104:107], v[168:171]
    v_exp_f32 v113, v113
    v_mfma_f32_16x16x32_bf16 v[168:171], v[56:59], a[108:111], v[168:171]
    s_add_u32 s13, s92, 0x3000
    v_mul_f32 v121, v217, v217
    v_mfma_f32_16x16x32_bf16 v[172:175], v[52:55], a[104:107], v[172:175]
    buffer_load_dwordx4 a[208:211], v18, s[56:59], s13 offen sc1
    v_mfma_f32_16x16x32_bf16 v[172:175], v[60:63], a[108:111], v[172:175]
    ds_read_b128 a[88:91], v4 offset:14336
    ds_read_b128 a[92:95], v5 offset:14336
    v_mfma_f32_16x16x32_bf16 v[176:179], v[48:51], a[112:115], v[176:179]
    v_exp_f32 v114, v114
    v_mfma_f32_16x16x32_bf16 v[176:179], v[56:59], a[116:119], v[176:179]
    v_exp_f32 v115, v115
    v_mfma_f32_16x16x32_bf16 v[180:183], v[52:55], a[112:115], v[180:183]
    buffer_load_dwordx4 a[212:215], v19, s[56:59], s13 offen sc1
    v_mfma_f32_16x16x32_bf16 v[180:183], v[60:63], a[116:119], v[180:183]
    ds_read_b128 a[96:99], v4 offset:24576
    ds_read_b128 a[100:103], v5 offset:24576
    v_mfma_f32_16x16x32_bf16 v[184:187], v[48:51], a[120:123], v[184:187]
    v_mul_f32 v122, v218, v218
    v_mfma_f32_16x16x32_bf16 v[184:187], v[56:59], a[124:127], v[184:187]
    s_add_u32 s13, s92, 0x3800
    v_exp_f32 v116, v116
    v_mfma_f32_16x16x32_bf16 v[188:191], v[52:55], a[120:123], v[188:191]
    buffer_load_dwordx4 a[216:219], v18, s[56:59], s13 offen sc1
    v_mfma_f32_16x16x32_bf16 v[188:191], v[60:63], a[124:127], v[188:191]
    ds_read_b128 a[104:107], v4 offset:26624
    ds_read_b128 a[108:111], v5 offset:26624
    v_exp_f32 v117, v117
    s_waitcnt vmcnt(38) lgkmcnt(6)
    v_mfma_f32_16x16x32_bf16 v[160:163], v[64:67], a[64:67], v[160:163]
    v_mul_f32 v123, v219, v219
    s_waitcnt vmcnt(36)
    v_mfma_f32_16x16x32_bf16 v[160:163], v[72:75], a[68:71], v[160:163]
    v_exp_f32 v118, v118
    v_mfma_f32_16x16x32_bf16 v[164:167], v[68:71], a[64:67], v[164:167]
    buffer_load_dwordx4 a[220:223], v19, s[56:59], s13 offen sc1
    s_waitcnt vmcnt(36)
    v_mfma_f32_16x16x32_bf16 v[164:167], v[76:79], a[68:71], v[164:167]
    ds_read_b128 a[112:115], v4 offset:28672
    ds_read_b128 a[116:119], v5 offset:28672
    v_mul_f32 v124, v220, v220
    v_mfma_f32_16x16x32_bf16 v[168:171], v[64:67], a[72:75], v[168:171]
    v_exp_f32 v119, v119
    v_mfma_f32_16x16x32_bf16 v[168:171], v[72:75], a[76:79], v[168:171]
    s_add_u32 s13, s92, 0x4000
    v_add_f32 v112, 1.0, v112
    v_mul_f32 v125, v221, v221
    v_mfma_f32_16x16x32_bf16 v[172:175], v[68:71], a[72:75], v[172:175]
    buffer_load_dwordx4 a[224:227], v18, s[56:59], s13 offen sc1
    v_mfma_f32_16x16x32_bf16 v[172:175], v[76:79], a[76:79], v[172:175]
    ds_read_b128 a[120:123], v4 offset:30720
    ds_read_b128 a[124:127], v5 offset:30720
    v_mfma_f32_16x16x32_bf16 v[176:179], v[64:67], a[80:83], v[176:179]
    v_add_u32 v4, 0xffff0000, v4
    v_add_u32 v5, 0xffff0000, v5
    v_add_f32 v113, 1.0, v113
    v_mfma_f32_16x16x32_bf16 v[176:179], v[72:75], a[84:87], v[176:179]
    v_add_f32 v114, 1.0, v114
    v_mul_f32 v126, v222, v222
    v_mfma_f32_16x16x32_bf16 v[180:183], v[68:71], a[80:83], v[180:183]
    buffer_load_dwordx4 a[228:231], v19, s[56:59], s13 offen sc1
    v_mfma_f32_16x16x32_bf16 v[180:183], v[76:79], a[84:87], v[180:183]
    s_waitcnt lgkmcnt(4)
    ds_read_b128 a[64:67], v4 offset:0
    ds_read_b128 a[68:71], v5 offset:0
    v_mfma_f32_16x16x32_bf16 v[184:187], v[64:67], a[88:91], v[184:187]
    v_add_f32 v115, 1.0, v115
    v_mul_f32 v127, v223, v223
    v_mfma_f32_16x16x32_bf16 v[184:187], v[72:75], a[92:95], v[184:187]
    s_add_u32 s13, s92, 0x4800
    v_add_f32 v116, 1.0, v116
    v_add_f32 v117, 1.0, v117
    v_mfma_f32_16x16x32_bf16 v[188:191], v[68:71], a[88:91], v[188:191]
    buffer_load_dwordx4 a[232:235], v18, s[56:59], s13 offen sc1
    v_mfma_f32_16x16x32_bf16 v[188:191], v[76:79], a[92:95], v[188:191]
    ds_read_b128 a[72:75], v4 offset:2048
    ds_read_b128 a[76:79], v5 offset:2048
    s_waitcnt vmcnt(38)
    v_mfma_f32_16x16x32_bf16 v[160:163], v[80:83], a[96:99], v[160:163]
    v_fma_f32 v120, v120, s80, v24
    v_add_f32 v118, 1.0, v118
    s_waitcnt vmcnt(36)
    v_mfma_f32_16x16x32_bf16 v[160:163], v[88:91], a[100:103], v[160:163]
    v_add_f32 v119, 1.0, v119
    v_fma_f32 v121, v121, s80, v24
    v_mfma_f32_16x16x32_bf16 v[164:167], v[84:87], a[96:99], v[164:167]
    buffer_load_dwordx4 a[236:239], v19, s[56:59], s13 offen sc1
    s_waitcnt vmcnt(36)
    v_mfma_f32_16x16x32_bf16 v[164:167], v[92:95], a[100:103], v[164:167]
    ds_read_b128 a[80:83], v4 offset:4096
    ds_read_b128 a[84:87], v5 offset:4096
    v_mfma_f32_16x16x32_bf16 v[168:171], v[80:83], a[104:107], v[168:171]
    v_rcp_f32 v112, v112
    v_mfma_f32_16x16x32_bf16 v[168:171], v[88:91], a[108:111], v[168:171]
    s_add_u32 s13, s92, 0x5000
    v_fma_f32 v122, v122, s80, v24
    v_rcp_f32 v113, v113
    v_mfma_f32_16x16x32_bf16 v[172:175], v[84:87], a[104:107], v[172:175]
    buffer_load_dwordx4 a[240:243], v18, s[56:59], s13 offen sc1
    v_mfma_f32_16x16x32_bf16 v[172:175], v[92:95], a[108:111], v[172:175]
    s_waitcnt lgkmcnt(4)
    ds_read_b128 a[88:91], v4 offset:6144
    ds_read_b128 a[92:95], v5 offset:6144
    v_mfma_f32_16x16x32_bf16 v[176:179], v[80:83], a[112:115], v[176:179]
    v_cvt_pk_bf16_f32 v160, v160, v161
    v_cvt_pk_bf16_f32 v161, v162, v163
    v_mfma_f32_16x16x32_bf16 v[176:179], v[88:91], a[116:119], v[176:179]
    v_cvt_pk_bf16_f32 v162, v164, v165
    v_cvt_pk_bf16_f32 v163, v166, v167
    v_mfma_f32_16x16x32_bf16 v[180:183], v[84:87], a[112:115], v[180:183]
    buffer_load_dwordx4 a[244:247], v19, s[56:59], s13 offen sc1
    v_rcp_f32 v114, v114
    v_mfma_f32_16x16x32_bf16 v[180:183], v[92:95], a[116:119], v[180:183]
    buffer_store_dwordx4 v[160:163], v2, s[84:87], s91 offen sc1
    ds_read_b128 a[96:99], v4 offset:16384
    ds_read_b128 a[100:103], v5 offset:16384
    v_fma_f32 v123, v123, s80, v24
    v_mfma_f32_16x16x32_bf16 v[184:187], v[80:83], a[120:123], v[184:187]
    v_rcp_f32 v115, v115
    v_mfma_f32_16x16x32_bf16 v[184:187], v[88:91], a[124:127], v[184:187]
    s_add_u32 s13, s92, 0x5800
    v_rcp_f32 v116, v116
    v_mfma_f32_16x16x32_bf16 v[188:191], v[84:87], a[120:123], v[188:191]
    buffer_load_dwordx4 a[248:251], v18, s[56:59], s13 offen sc1
    v_mfma_f32_16x16x32_bf16 v[188:191], v[92:95], a[124:127], v[188:191]
    ds_read_b128 a[104:107], v4 offset:18432
    ds_read_b128 a[108:111], v5 offset:18432
    v_fma_f32 v124, v124, s80, v24
    v_mfma_f32_16x16x32_bf16 v[128:131], a[32:35], a[64:67], v[128:131]
    v_cvt_pk_bf16_f32 v168, v168, v169
    v_cvt_pk_bf16_f32 v169, v170, v171
    v_rcp_f32 v117, v117
    v_mfma_f32_16x16x32_bf16 v[128:131], a[40:43], a[68:71], v[128:131]
    v_cvt_pk_bf16_f32 v170, v172, v173
    v_cvt_pk_bf16_f32 v171, v174, v175
    v_mfma_f32_16x16x32_bf16 v[132:135], a[36:39], a[64:67], v[132:135]
    buffer_load_dwordx4 a[252:255], v19, s[56:59], s13 offen sc1
    v_fma_f32 v125, v125, s80, v24
    v_mfma_f32_16x16x32_bf16 v[132:135], a[44:47], a[68:71], v[132:135]
    s_waitcnt lgkmcnt(4)
    buffer_store_dwordx4 v[168:171], v2, s[84:87], s91 offen offset:1024 sc1
    ds_read_b128 a[112:115], v4 offset:20480
    ds_read_b128 a[116:119], v5 offset:20480
    v_rcp_f32 v118, v118
    v_mfma_f32_16x16x32_bf16 v[136:139], a[32:35], a[72:75], v[136:139]
    v_rcp_f32 v119, v119
    v_mfma_f32_16x16x32_bf16 v[136:139], a[40:43], a[76:79], v[136:139]
    s_add_u32 s13, s92, 0x6000
    v_fma_f32 v126, v126, s80, v24
    v_mul_f32 v208, v112, v208
    v_mfma_f32_16x16x32_bf16 v[140:143], a[36:39], a[72:75], v[140:143]
    buffer_load_dwordx4 a[128:131], v18, s[56:59], s13 offen sc1
    v_mfma_f32_16x16x32_bf16 v[140:143], a[44:47], a[76:79], v[140:143]
    ds_read_b128 a[120:123], v4 offset:22528
    ds_read_b128 a[124:127], v5 offset:22528
    v_mfma_f32_16x16x32_bf16 v[144:147], a[32:35], a[80:83], v[144:147]
    v_cvt_pk_bf16_f32 v176, v176, v177
    v_cvt_pk_bf16_f32 v177, v178, v179
    v_mul_f32 v209, v113, v209
    v_mfma_f32_16x16x32_bf16 v[144:147], a[40:43], a[84:87], v[144:147]
    v_cvt_pk_bf16_f32 v178, v180, v181
    v_cvt_pk_bf16_f32 v179, v182, v183
    v_fma_f32 v127, v127, s80, v24
    v_mfma_f32_16x16x32_bf16 v[148:151], a[36:39], a[80:83], v[148:151]
    buffer_load_dwordx4 a[132:135], v19, s[56:59], s13 offen sc1
    v_mfma_f32_16x16x32_bf16 v[148:151], a[44:47], a[84:87], v[148:151]
    buffer_store_dwordx4 v[176:179], v2, s[84:87], s91 offen offset:2048 sc1
    ds_read_b128 a[64:67], v4 offset:32768
    ds_read_b128 a[68:71], v5 offset:32768
    v_mul_f32 v210, v114, v210
    v_mfma_f32_16x16x32_bf16 v[152:155], a[32:35], a[88:91], v[152:155]
    v_mul_f32 v120, v120, v216
    v_mul_f32 v211, v115, v211
    v_mfma_f32_16x16x32_bf16 v[152:155], a[40:43], a[92:95], v[152:155]
    s_add_u32 s13, s92, 0x6800
    v_mul_f32 v212, v116, v212
    v_mul_f32 v121, v121, v217
    v_mfma_f32_16x16x32_bf16 v[156:159], a[36:39], a[88:91], v[156:159]
    buffer_load_dwordx4 a[136:139], v18, s[56:59], s13 offen sc1
    v_mfma_f32_16x16x32_bf16 v[156:159], a[44:47], a[92:95], v[156:159]
    s_waitcnt lgkmcnt(4)
    ds_read_b128 a[72:75], v4 offset:34816
    ds_read_b128 a[76:79], v5 offset:34816
    v_mfma_f32_16x16x32_bf16 v[128:131], a[48:51], a[96:99], v[128:131]
    v_cvt_pk_bf16_f32 v184, v184, v185
    v_cvt_pk_bf16_f32 v185, v186, v187
    v_mfma_f32_16x16x32_bf16 v[128:131], a[56:59], a[100:103], v[128:131]
    v_cvt_pk_bf16_f32 v186, v188, v189
    v_cvt_pk_bf16_f32 v187, v190, v191
    v_mul_f32 v213, v117, v213
    v_mfma_f32_16x16x32_bf16 v[132:135], a[52:55], a[96:99], v[132:135]
    buffer_load_dwordx4 a[140:143], v19, s[56:59], s13 offen sc1
    v_mul_f32 v214, v118, v214
    v_mfma_f32_16x16x32_bf16 v[132:135], a[60:63], a[100:103], v[132:135]
    buffer_store_dwordx4 v[184:187], v2, s[84:87], s91 offen offset:3072 sc1
    ds_read_b128 a[80:83], v4 offset:36864
    ds_read_b128 a[84:87], v5 offset:36864
    v_mfma_f32_16x16x32_bf16 v[136:139], a[48:51], a[104:107], v[136:139]
    v_mul_f32 v122, v122, v218
    v_mul_f32 v215, v119, v215
    v_mfma_f32_16x16x32_bf16 v[136:139], a[56:59], a[108:111], v[136:139]
    s_add_u32 s13, s92, 0x7000
    v_mul_f32 v123, v123, v219
    v_mul_f32 v240, v208, v98
    v_mfma_f32_16x16x32_bf16 v[140:143], a[52:55], a[104:107], v[140:143]
    buffer_load_dwordx4 a[144:147], v18, s[56:59], s13 offen sc1
    v_mfma_f32_16x16x32_bf16 v[140:143], a[60:63], a[108:111], v[140:143]
    ds_read_b128 a[88:91], v4 offset:38912
    ds_read_b128 a[92:95], v5 offset:38912
    v_mfma_f32_16x16x32_bf16 v[144:147], a[48:51], a[112:115], v[144:147]
    v_mul_f32 v241, v209, v98
    v_mul_f32 v124, v124, v220
    v_mfma_f32_16x16x32_bf16 v[144:147], a[56:59], a[116:119], v[144:147]
    v_mul_f32 v242, v210, v98
    v_mul_f32 v243, v211, v98
    v_mfma_f32_16x16x32_bf16 v[148:151], a[52:55], a[112:115], v[148:151]
    buffer_load_dwordx4 a[148:151], v19, s[56:59], s13 offen sc1
    v_mfma_f32_16x16x32_bf16 v[148:151], a[60:63], a[116:119], v[148:151]
    s_waitcnt lgkmcnt(8)
    ds_read_b128 a[96:99], v4 offset:49152
    ds_read_b128 a[100:103], v5 offset:49152
    v_mfma_f32_16x16x32_bf16 v[152:155], a[48:51], a[120:123], v[152:155]
    ds_read_b128 a[104:107], v4 offset:51200
    v_mul_f32 v125, v125, v221
    v_mfma_f32_16x16x32_bf16 v[152:155], a[56:59], a[124:127], v[152:155]
    v_mul_f32 v244, v212, v98
    v_mul_f32 v126, v126, v222
    v_mfma_f32_16x16x32_bf16 v[156:159], a[52:55], a[120:123], v[156:159]
    ds_read_b128 a[108:111], v5 offset:51200
    v_mul_f32 v245, v213, v98
    v_mfma_f32_16x16x32_bf16 v[156:159], a[60:63], a[124:127], v[156:159]
    s_barrier
    v_mul_f32 v246, v214, v98
    v_mul_f32 v127, v127, v223
    s_waitcnt lgkmcnt(6)
    v_mfma_f32_16x16x32_bf16 v[128:131], v[32:35], a[64:67], v[128:131]
    v_mul_f32 v247, v215, v98
    v_mfma_f32_16x16x32_bf16 v[128:131], v[40:43], a[68:71], v[128:131]
    s_mov_b32 s10, 0x3c000
    s_add_u32 m0, s95, 0x0
    v_mfma_f32_16x16x32_bf16 v[132:135], v[36:39], a[64:67], v[132:135]
    buffer_load_dwordx4 v8, s[44:47], s10 offen offset:0 lds
    v_mfma_f32_16x16x32_bf16 v[132:135], v[44:47], a[68:71], v[132:135]
    ds_read_b128 a[112:115], v4 offset:53248
    ds_read_b128 a[116:119], v5 offset:53248
    v_mfma_f32_16x16x32_bf16 v[136:139], v[32:35], a[72:75], v[136:139]
    v_exp_f32 v120, v120
    v_mfma_f32_16x16x32_bf16 v[136:139], v[40:43], a[76:79], v[136:139]
    v_exp_f32 v121, v121
    v_mfma_f32_16x16x32_bf16 v[140:143], v[36:39], a[72:75], v[140:143]
    buffer_load_dwordx4 v9, s[44:47], s10 offen offset:1024 lds
    v_mfma_f32_16x16x32_bf16 v[140:143], v[44:47], a[76:79], v[140:143]
    ds_read_b128 a[120:123], v4 offset:55296
    ds_read_b128 a[124:127], v5 offset:55296
    v_mfma_f32_16x16x32_bf16 v[144:147], v[32:35], a[80:83], v[144:147]
    v_add_u32 v4, 0x10000, v4
    v_add_u32 v5, 0x10000, v5
    v_mfma_f32_16x16x32_bf16 v[144:147], v[40:43], a[84:87], v[144:147]
    v_exp_f32 v122, v122
    v_mfma_f32_16x16x32_bf16 v[148:151], v[36:39], a[80:83], v[148:151]
    buffer_load_dwordx4 v10, s[44:47], s10 offen offset:2048 lds
    v_mfma_f32_16x16x32_bf16 v[148:151], v[44:47], a[84:87], v[148:151]
    s_waitcnt lgkmcnt(8)
    ds_read_b128 a[64:67], v4 offset:0
    ds_read_b128 a[68:71], v5 offset:0
    v_exp_f32 v123, v123
    v_mfma_f32_16x16x32_bf16 v[152:155], v[32:35], a[88:91], v[152:155]
    v_exp_f32 v124, v124
    v_mfma_f32_16x16x32_bf16 v[152:155], v[40:43], a[92:95], v[152:155]
    v_exp_f32 v125, v125
    v_exp_f32 v126, v126
    v_mfma_f32_16x16x32_bf16 v[156:159], v[36:39], a[88:91], v[156:159]
    buffer_load_dwordx4 v11, s[44:47], s10 offen offset:3072 lds
    v_mfma_f32_16x16x32_bf16 v[156:159], v[44:47], a[92:95], v[156:159]
    s_barrier
    ds_read_b128 a[72:75], v4 offset:2048
    ds_read_b128 a[76:79], v5 offset:2048
    s_waitcnt lgkmcnt(6)
    v_mfma_f32_16x16x32_bf16 v[128:131], v[48:51], a[96:99], v[128:131]
    v_exp_f32 v127, v127
    v_mfma_f32_16x16x32_bf16 v[128:131], v[56:59], a[100:103], v[128:131]
    s_add_u32 m0, s95, 0x1000
    v_add_f32 v120, 1.0, v120
    v_add_f32 v121, 1.0, v121
    v_mfma_f32_16x16x32_bf16 v[132:135], v[52:55], a[96:99], v[132:135]
    buffer_load_dwordx4 v12, s[44:47], s10 offen offset:0 lds
    v_mfma_f32_16x16x32_bf16 v[132:135], v[60:63], a[100:103], v[132:135]
    ds_read_b128 a[80:83], v4 offset:4096
    ds_read_b128 a[84:87], v5 offset:4096
    v_mfma_f32_16x16x32_bf16 v[136:139], v[48:51], a[104:107], v[136:139]
    v_add_f32 v122, 1.0, v122
    v_add_f32 v123, 1.0, v123
    v_mfma_f32_16x16x32_bf16 v[136:139], v[56:59], a[108:111], v[136:139]
    s_mov_b32 s10, 0x50000
    s_add_u32 m0, s95, 0x5000
    v_add_f32 v124, 1.0, v124
    v_mfma_f32_16x16x32_bf16 v[140:143], v[52:55], a[104:107], v[140:143]
    buffer_load_dwordx4 v8, s[44:47], s10 offen offset:0 lds
    v_mfma_f32_16x16x32_bf16 v[140:143], v[60:63], a[108:111], v[140:143]
    ds_read_b128 a[88:91], v4 offset:6144
    ds_read_b128 a[92:95], v5 offset:6144
    v_add_f32 v125, 1.0, v125
    v_mfma_f32_16x16x32_bf16 v[144:147], v[48:51], a[112:115], v[144:147]
    v_add_f32 v126, 1.0, v126
    v_add_f32 v127, 1.0, v127
    v_mfma_f32_16x16x32_bf16 v[144:147], v[56:59], a[116:119], v[144:147]
    v_rcp_f32 v120, v120
    v_mfma_f32_16x16x32_bf16 v[148:151], v[52:55], a[112:115], v[148:151]
    buffer_load_dwordx4 v9, s[44:47], s10 offen offset:1024 lds
    v_mfma_f32_16x16x32_bf16 v[148:151], v[60:63], a[116:119], v[148:151]
    s_waitcnt lgkmcnt(8)
    ds_read_b128 a[96:99], v4 offset:16384
    ds_read_b128 a[100:103], v5 offset:16384
    v_mfma_f32_16x16x32_bf16 v[152:155], v[48:51], a[120:123], v[152:155]
    v_rcp_f32 v121, v121
    v_mfma_f32_16x16x32_bf16 v[152:155], v[56:59], a[124:127], v[152:155]
    v_rcp_f32 v122, v122
    v_mfma_f32_16x16x32_bf16 v[156:159], v[52:55], a[120:123], v[156:159]
    buffer_load_dwordx4 v10, s[44:47], s10 offen offset:2048 lds
    v_mfma_f32_16x16x32_bf16 v[156:159], v[60:63], a[124:127], v[156:159]
    s_waitcnt vmcnt(53)
    s_barrier
    ds_read_b128 a[104:107], v4 offset:18432
    ds_read_b128 a[108:111], v5 offset:18432
    v_rcp_f32 v123, v123
    s_waitcnt lgkmcnt(6)
    v_mfma_f32_16x16x32_bf16 v[128:131], v[64:67], a[64:67], v[128:131]
    v_rcp_f32 v124, v124
    v_mfma_f32_16x16x32_bf16 v[128:131], v[72:75], a[68:71], v[128:131]
    v_rcp_f32 v125, v125
    v_mfma_f32_16x16x32_bf16 v[132:135], v[68:71], a[64:67], v[132:135]
    buffer_load_dwordx4 v11, s[44:47], s10 offen offset:3072 lds
    v_mfma_f32_16x16x32_bf16 v[132:135], v[76:79], a[68:71], v[132:135]
    ds_read_b128 a[112:115], v4 offset:20480
    ds_read_b128 a[116:119], v5 offset:20480
    v_rcp_f32 v126, v126
    v_mfma_f32_16x16x32_bf16 v[136:139], v[64:67], a[72:75], v[136:139]
    v_rcp_f32 v127, v127
    v_mfma_f32_16x16x32_bf16 v[136:139], v[72:75], a[76:79], v[136:139]
    s_add_u32 m0, s95, 0x6000
    v_mul_f32 v216, v120, v216
    v_mul_f32 v217, v121, v217
    v_mfma_f32_16x16x32_bf16 v[140:143], v[68:71], a[72:75], v[140:143]
    buffer_load_dwordx4 v12, s[44:47], s10 offen offset:0 lds
    v_mfma_f32_16x16x32_bf16 v[140:143], v[76:79], a[76:79], v[140:143]
    ds_read_b128 a[120:123], v4 offset:22528
    ds_read_b128 a[124:127], v5 offset:22528
    v_mfma_f32_16x16x32_bf16 v[144:147], v[64:67], a[80:83], v[144:147]
    v_mul_f32 v218, v122, v218
    v_mul_f32 v219, v123, v219
    v_mfma_f32_16x16x32_bf16 v[144:147], v[72:75], a[84:87], v[144:147]
    s_mov_b32 s10, 0x64000
    s_add_u32 m0, s95, 0xa000
    v_mul_f32 v220, v124, v220
    v_mfma_f32_16x16x32_bf16 v[148:151], v[68:71], a[80:83], v[148:151]
    buffer_load_dwordx4 v8, s[44:47], s10 offen offset:0 lds
    v_mfma_f32_16x16x32_bf16 v[148:151], v[76:79], a[84:87], v[148:151]
    s_waitcnt lgkmcnt(4)
    ds_read_b64_tr_b16 a[0:1], v13 offset:40960
    ds_read_b64_tr_b16 a[2:3], v13 offset:46080
    v_mfma_f32_16x16x32_bf16 v[152:155], v[64:67], a[88:91], v[152:155]
    v_mul_f32 v221, v125, v221
    v_mul_f32 v222, v126, v222
    v_mfma_f32_16x16x32_bf16 v[152:155], v[72:75], a[92:95], v[152:155]
    v_mul_f32 v223, v127, v223
    v_mul_f32 v248, v216, v99
    v_mfma_f32_16x16x32_bf16 v[156:159], v[68:71], a[88:91], v[156:159]
    buffer_load_dwordx4 v9, s[44:47], s10 offen offset:1024 lds
    v_mfma_f32_16x16x32_bf16 v[156:159], v[76:79], a[92:95], v[156:159]
    ds_read_b64_tr_b16 a[4:5], v13 offset:51200
    ds_read_b64_tr_b16 a[6:7], v13 offset:56320
    v_mfma_f32_16x16x32_bf16 v[128:131], v[80:83], a[96:99], v[128:131]
    v_mul_f32 v249, v217, v99
    v_mul_f32 v250, v218, v99
    v_mfma_f32_16x16x32_bf16 v[128:131], v[88:91], a[100:103], v[128:131]
    v_mul_f32 v251, v219, v99
    v_mul_f32 v252, v220, v99
    v_mfma_f32_16x16x32_bf16 v[132:135], v[84:87], a[96:99], v[132:135]
    buffer_load_dwordx4 v10, s[44:47], s10 offen offset:2048 lds
    v_mfma_f32_16x16x32_bf16 v[132:135], v[92:95], a[100:103], v[132:135]
    ds_read_b64_tr_b16 a[8:9], v13 offset:40968
    ds_read_b64_tr_b16 a[10:11], v13 offset:46088
    v_mfma_f32_16x16x32_bf16 v[136:139], v[80:83], a[104:107], v[136:139]
    v_mul_f32 v253, v221, v99
    v_mul_f32 v254, v222, v99
    v_mfma_f32_16x16x32_bf16 v[136:139], v[88:91], a[108:111], v[136:139]
    v_mul_f32 v255, v223, v99
    v_mfma_f32_16x16x32_bf16 v[140:143], v[84:87], a[104:107], v[140:143]
    buffer_load_dwordx4 v11, s[44:47], s10 offen offset:3072 lds
    v_mfma_f32_16x16x32_bf16 v[140:143], v[92:95], a[108:111], v[140:143]
    s_waitcnt lgkmcnt(6)
    ds_read_b64_tr_b16 a[12:13], v13 offset:51208
    ds_read_b64_tr_b16 a[14:15], v13 offset:56328
    v_mfma_f32_16x16x32_bf16 v[144:147], v[80:83], a[112:115], v[144:147]
    v_mfma_f32_16x16x32_bf16 v[144:147], v[88:91], a[116:119], v[144:147]
    s_add_u32 m0, s95, 0xb000
    v_mfma_f32_16x16x32_bf16 v[148:151], v[84:87], a[112:115], v[148:151]
    buffer_load_dwordx4 v12, s[44:47], s10 offen offset:0 lds
    v_mfma_f32_16x16x32_bf16 v[148:151], v[92:95], a[116:119], v[148:151]
    ds_read_b64_tr_b16 a[16:17], v13 offset:40976
    ds_read_b64_tr_b16 a[18:19], v13 offset:46096
    v_mfma_f32_16x16x32_bf16 v[152:155], v[80:83], a[120:123], v[152:155]
    ds_read_b64_tr_b16 a[20:21], v13 offset:51216
    v_mfma_f32_16x16x32_bf16 v[152:155], v[88:91], a[124:127], v[152:155]
    ds_read_b64_tr_b16 a[22:23], v13 offset:56336
    v_mfma_f32_16x16x32_bf16 v[156:159], v[84:87], a[120:123], v[156:159]
    ds_read_b64_tr_b16 a[24:25], v13 offset:40984
    v_mfma_f32_16x16x32_bf16 v[156:159], v[92:95], a[124:127], v[156:159]
    ds_read_b64_tr_b16 a[26:27], v13 offset:46104
    ds_read_b64_tr_b16 a[28:29], v13 offset:51224
    ds_read_b64_tr_b16 a[30:31], v13 offset:56344
    ds_read_b64_tr_b16 a[32:33], v13 offset:40992
    ds_read_b64_tr_b16 a[34:35], v13 offset:46112
    ds_read_b64_tr_b16 a[36:37], v13 offset:51232
    ds_read_b64_tr_b16 a[38:39], v13 offset:56352
fk_o:
    s_waitcnt vmcnt(29) lgkmcnt(14)
    v_mfma_f32_16x16x32_bf16 v[32:35], a[0:3], a[160:163], 0
    ds_read_b64_tr_b16 a[40:41], v14 offset:40960
    s_waitcnt vmcnt(27)
    v_mfma_f32_16x16x32_bf16 v[32:35], a[4:7], a[168:171], v[32:35]
    s_add_u32 s13, s92, 0x7800
    ds_read_b64_tr_b16 a[42:43], v14 offset:46080
    v_mfma_f32_16x16x32_bf16 v[52:55], a[0:3], a[164:167], 0
    buffer_load_dwordx4 a[152:155], v18, s[56:59], s13 offen sc1
    s_waitcnt vmcnt(27)
    v_mfma_f32_16x16x32_bf16 v[52:55], a[4:7], a[172:175], v[52:55]
    ds_read_b64_tr_b16 a[44:45], v14 offset:51200
    ds_read_b64_tr_b16 a[46:47], v14 offset:56320
    v_mfma_f32_16x16x32_bf16 v[36:39], a[8:11], a[160:163], 0
    s_cmp_ge_u32 s5, 28
    s_cbranch_scc1 fk_p6
    s_xor_b32 s11, s98, 32
    s_waitcnt vmcnt(18)
    s_mov_b64 exec, 1
    buffer_store_dword v3, off, s[68:71], s11 sc1
    s_mov_b64 exec, -1
fk_p6:
    s_waitcnt lgkmcnt(12)
    v_mfma_f32_16x16x32_bf16 v[36:39], a[12:15], a[168:171], v[36:39]
    ds_read_b64_tr_b16 a[48:49], v14 offset:40968
    v_fma_f32 v128, v128, v192, v224
    v_mfma_f32_16x16x32_bf16 v[56:59], a[8:11], a[164:167], 0
    ds_read_b64_tr_b16 a[50:51], v14 offset:46088
    v_fma_f32 v129, v129, v193, v225
    v_mfma_f32_16x16x32_bf16 v[56:59], a[12:15], a[172:175], v[56:59]
    buffer_load_dwordx4 a[156:159], v19, s[56:59], s13 offen sc1
    v_mfma_f32_16x16x32_bf16 v[40:43], a[16:19], a[160:163], 0
    ds_read_b64_tr_b16 a[52:53], v14 offset:51208
    ds_read_b64_tr_b16 a[54:55], v14 offset:56328
    v_mfma_f32_16x16x32_bf16 v[40:43], a[20:23], a[168:171], v[40:43]
    ds_read_b64_tr_b16 a[56:57], v14 offset:40976
    v_fma_f32 v130, v130, v194, v226
    v_mfma_f32_16x16x32_bf16 v[60:63], a[16:19], a[164:167], 0
    s_barrier
    ds_read_b64_tr_b16 a[58:59], v14 offset:46096
    v_fma_f32 v131, v131, v195, v227
    v_mfma_f32_16x16x32_bf16 v[60:63], a[20:23], a[172:175], v[60:63]
    s_waitcnt lgkmcnt(6)
    ds_read_b64_tr_b16 a[60:61], v14 offset:51216
    v_fma_f32 v132, v132, v196, v228
    v_mfma_f32_16x16x32_bf16 v[44:47], a[24:27], a[160:163], 0
    s_mov_b32 s10, 0x78000
    s_add_u32 m0, s95, 0xf000
    ds_read_b64_tr_b16 a[62:63], v14 offset:56336
    v_mfma_f32_16x16x32_bf16 v[44:47], a[28:31], a[168:171], v[44:47]
    buffer_load_dwordx4 v8, s[44:47], s10 offen offset:0 lds
    v_mfma_f32_16x16x32_bf16 v[64:67], a[24:27], a[164:167], 0
    ds_read_b64_tr_b16 a[64:65], v14 offset:40984
    ds_read_b64_tr_b16 a[66:67], v14 offset:46104
    v_mfma_f32_16x16x32_bf16 v[64:67], a[28:31], a[172:175], v[64:67]
    ds_read_b64_tr_b16 a[68:69], v14 offset:51224
    v_fma_f32 v133, v133, v197, v229
    v_mfma_f32_16x16x32_bf16 v[48:51], a[32:35], a[160:163], 0
    ds_read_b64_tr_b16 a[70:71], v14 offset:56344
    v_fma_f32 v134, v134, v198, v230
    v_mfma_f32_16x16x32_bf16 v[48:51], a[36:39], a[168:171], v[48:51]
    ds_read_b64_tr_b16 a[72:73], v14 offset:40992
    v_fma_f32 v135, v135, v199, v231
    v_mfma_f32_16x16x32_bf16 v[68:71], a[32:35], a[164:167], 0
    buffer_load_dwordx4 v9, s[44:47], s10 offen offset:1024 lds
    v_mfma_f32_16x16x32_bf16 v[68:71], a[36:39], a[172:175], v[68:71]
    ds_read_b64_tr_b16 a[74:75], v14 offset:46112
    ds_read_b64_tr_b16 a[76:77], v14 offset:51232
    v_mfma_f32_16x16x32_bf16 v[72:75], a[40:43], a[160:163], 0
    ds_read_b64_tr_b16 a[78:79], v14 offset:56352
    v_fma_f32 v136, v136, v200, v232
    v_mfma_f32_16x16x32_bf16 v[72:75], a[44:47], a[168:171], v[72:75]
    ds_read_b64_tr_b16 a[0:1], v13 offset:20480
    v_fma_f32 v137, v137, v201, v233
    v_mfma_f32_16x16x32_bf16 v[92:95], a[40:43], a[164:167], 0
    ds_read_b64_tr_b16 a[2:3], v13 offset:25600
    v_mfma_f32_16x16x32_bf16 v[92:95], a[44:47], a[172:175], v[92:95]
    s_waitcnt lgkmcnt(7)
    buffer_load_dwordx4 v10, s[44:47], s10 offen offset:2048 lds
    v_mfma_f32_16x16x32_bf16 v[76:79], a[48:51], a[160:163], 0
    ds_read_b64_tr_b16 a[4:5], v13 offset:30720
    ds_read_b64_tr_b16 a[6:7], v13 offset:35840
    v_mfma_f32_16x16x32_bf16 v[76:79], a[52:55], a[168:171], v[76:79]
    ds_read_b64_tr_b16 a[8:9], v13 offset:20488
    v_fma_f32 v138, v138, v202, v234
    v_mfma_f32_16x16x32_bf16 v[96:99], a[48:51], a[164:167], 0
    ds_read_b64_tr_b16 a[10:11], v13 offset:25608
    v_fma_f32 v139, v139, v203, v235
    v_mfma_f32_16x16x32_bf16 v[96:99], a[52:55], a[172:175], v[96:99]
    ds_read_b64_tr_b16 a[12:13], v13 offset:30728
    v_mfma_f32_16x16x32_bf16 v[80:83], a[56:59], a[160:163], 0
    buffer_load_dwordx4 v11, s[44:47], s10 offen offset:3072 lds
    v_mfma_f32_16x16x32_bf16 v[80:83], a[60:63], a[168:171], v[80:83]
    ds_read_b64_tr_b16 a[14:15], v13 offset:35848
    ds_read_b64_tr_b16 a[16:17], v13 offset:20496
    v_mfma_f32_16x16x32_bf16 v[100:103], a[56:59], a[164:167], 0
    ds_read_b64_tr_b16 a[18:19], v13 offset:25616
    v_fma_f32 v140, v140, v204, v236
    v_mfma_f32_16x16x32_bf16 v[100:103], a[60:63], a[172:175], v[100:103]
    s_waitcnt lgkmcnt(6)
    ds_read_b64_tr_b16 a[20:21], v13 offset:30736
    v_fma_f32 v141, v141, v205, v237
    v_mfma_f32_16x16x32_bf16 v[84:87], a[64:67], a[160:163], 0
    s_add_u32 m0, s95, 0x10000
    ds_read_b64_tr_b16 a[22:23], v13 offset:35856
    v_fma_f32 v142, v142, v206, v238
    v_mfma_f32_16x16x32_bf16 v[84:87], a[68:71], a[168:171], v[84:87]
    buffer_load_dwordx4 v12, s[44:47], s10 offen offset:0 lds
    v_mfma_f32_16x16x32_bf16 v[104:107], a[64:67], a[164:167], 0
    ds_read_b64_tr_b16 a[24:25], v13 offset:20504
    ds_read_b64_tr_b16 a[26:27], v13 offset:25624
    v_mfma_f32_16x16x32_bf16 v[104:107], a[68:71], a[172:175], v[104:107]
    ds_read_b64_tr_b16 a[28:29], v13 offset:30744
    v_fma_f32 v143, v143, v207, v239
    v_mfma_f32_16x16x32_bf16 v[88:91], a[72:75], a[160:163], 0
    ds_read_b64_tr_b16 a[30:31], v13 offset:35864
    v_fma_f32 v144, v144, v208, v240
    v_mfma_f32_16x16x32_bf16 v[88:91], a[76:79], a[168:171], v[88:91]
    s_mov_b32 s10, 0x8c000
    s_add_u32 m0, s95, 0x14000
    ds_read_b64_tr_b16 a[32:33], v13 offset:20512
    v_mfma_f32_16x16x32_bf16 v[108:111], a[72:75], a[164:167], 0
    buffer_load_dwordx4 v8, s[44:47], s10 offen offset:0 lds
    v_mfma_f32_16x16x32_bf16 v[108:111], a[76:79], a[172:175], v[108:111]
    ds_read_b64_tr_b16 a[34:35], v13 offset:25632
    ds_read_b64_tr_b16 a[36:37], v13 offset:30752
    s_waitcnt vmcnt(33)
    v_mfma_f32_16x16x32_bf16 v[32:35], a[0:3], a[176:179], v[32:35]
    ds_read_b64_tr_b16 a[38:39], v13 offset:35872
    v_fma_f32 v145, v145, v209, v241
    s_waitcnt vmcnt(31)
    v_mfma_f32_16x16x32_bf16 v[32:35], a[4:7], a[184:187], v[32:35]
    ds_read_b64_tr_b16 a[40:41], v14 offset:20480
    v_fma_f32 v146, v146, v210, v242
    v_mfma_f32_16x16x32_bf16 v[52:55], a[0:3], a[180:183], v[52:55]
    ds_read_b64_tr_b16 a[42:43], v14 offset:25600
    v_fma_f32 v147, v147, v211, v243
    s_waitcnt vmcnt(30)
    v_mfma_f32_16x16x32_bf16 v[52:55], a[4:7], a[188:191], v[52:55]
    s_waitcnt lgkmcnt(10)
    buffer_load_dwordx4 v9, s[44:47], s10 offen offset:1024 lds
    v_mfma_f32_16x16x32_bf16 v[36:39], a[8:11], a[176:179], v[36:39]
    ds_read_b64_tr_b16 a[44:45], v14 offset:30720
    ds_read_b64_tr_b16 a[46:47], v14 offset:35840
    v_mfma_f32_16x16x32_bf16 v[36:39], a[12:15], a[184:187], v[36:39]
    ds_read_b64_tr_b16 a[48:49], v14 offset:20488
    v_fma_f32 v148, v148, v212, v244
    v_mfma_f32_16x16x32_bf16 v[56:59], a[8:11], a[180:183], v[56:59]
    ds_read_b64_tr_b16 a[50:51], v14 offset:25608
    v_fma_f32 v149, v149, v213, v245
    v_mfma_f32_16x16x32_bf16 v[56:59], a[12:15], a[188:191], v[56:59]
    ds_read_b64_tr_b16 a[52:53], v14 offset:30728
    v_mfma_f32_16x16x32_bf16 v[40:43], a[16:19], a[176:179], v[40:43]
    buffer_load_dwordx4 v10, s[44:47], s10 offen offset:2048 lds
    v_mfma_f32_16x16x32_bf16 v[40:43], a[20:23], a[184:187], v[40:43]
    ds_read_b64_tr_b16 a[54:55], v14 offset:35848
    ds_read_b64_tr_b16 a[56:57], v14 offset:20496
    v_mfma_f32_16x16x32_bf16 v[60:63], a[16:19], a[180:183], v[60:63]
    s_barrier
    ds_read_b64_tr_b16 a[58:59], v14 offset:25616
    v_fma_f32 v150, v150, v214, v246
    v_mfma_f32_16x16x32_bf16 v[60:63], a[20:23], a[188:191], v[60:63]
    s_waitcnt lgkmcnt(8)
    ds_read_b64_tr_b16 a[60:61], v14 offset:30736
    v_fma_f32 v151, v151, v215, v247
    v_mfma_f32_16x16x32_bf16 v[44:47], a[24:27], a[176:179], v[44:47]
    ds_read_b64_tr_b16 a[62:63], v14 offset:35856
    v_mfma_f32_16x16x32_bf16 v[44:47], a[28:31], a[184:187], v[44:47]
    buffer_load_dwordx4 v11, s[44:47], s10 offen offset:3072 lds
    v_mfma_f32_16x16x32_bf16 v[64:67], a[24:27], a[180:183], v[64:67]
    ds_read_b64_tr_b16 a[64:65], v14 offset:20504
    ds_read_b64_tr_b16 a[66:67], v14 offset:25624
    v_mfma_f32_16x16x32_bf16 v[64:67], a[28:31], a[188:191], v[64:67]
    ds_read_b64_tr_b16 a[68:69], v14 offset:30744
    v_fma_f32 v152, v152, v216, v248
    v_mfma_f32_16x16x32_bf16 v[48:51], a[32:35], a[176:179], v[48:51]
    s_lshl_b32 s11, s88, 2
    s_add_u32 s11, s11, s3
    s_lshl_b32 s11, s11, 2
    s_add_u32 s11, s11, s100
    s_xor_b32 s12, s11, 0x1c00
    s_cmp_ge_u32 s7, 3
    s_cselect_b32 s11, s11, 0x7f000000
    s_cmp_ge_u32 s7, 5
    s_cselect_b32 s12, s12, 0x7f000000
    s_mov_b64 exec, 1
    buffer_store_dword v3, off, s[68:71], s11 sc1
    buffer_store_dword v3, off, s[68:71], s12 sc1
    s_mov_b64 exec, -1
    v_mfma_f32_16x16x32_bf16 v[48:51], a[36:39], a[184:187], v[48:51]
    s_add_u32 m0, s95, 0x15000
    ds_read_b64_tr_b16 a[70:71], v14 offset:35864
    v_fma_f32 v153, v153, v217, v249
    v_mfma_f32_16x16x32_bf16 v[68:71], a[32:35], a[180:183], v[68:71]
    buffer_load_dwordx4 v12, s[44:47], s10 offen offset:0 lds
    v_mfma_f32_16x16x32_bf16 v[68:71], a[36:39], a[188:191], v[68:71]
    ds_read_b64_tr_b16 a[72:73], v14 offset:20512
    ds_read_b64_tr_b16 a[74:75], v14 offset:25632
    v_mfma_f32_16x16x32_bf16 v[72:75], a[40:43], a[176:179], v[72:75]
    s_waitcnt lgkmcnt(6)
    ds_read_b64_tr_b16 a[76:77], v14 offset:30752
    v_fma_f32 v154, v154, v218, v250
    v_mfma_f32_16x16x32_bf16 v[72:75], a[44:47], a[184:187], v[72:75]
    ds_read_b64_tr_b16 a[78:79], v14 offset:35872
    v_fma_f32 v155, v155, v219, v251
    v_mfma_f32_16x16x32_bf16 v[92:95], a[40:43], a[180:183], v[92:95]
    s_mov_b32 s10, 0xa0000
    s_add_u32 m0, s95, 0x23000
    ds_read_b64_tr_b16 a[0:1], v13 offset:0
    v_mfma_f32_16x16x32_bf16 v[92:95], a[44:47], a[188:191], v[92:95]
    buffer_load_dwordx4 v8, s[44:47], s10 offen offset:0 lds
    v_mfma_f32_16x16x32_bf16 v[76:79], a[48:51], a[176:179], v[76:79]
    ds_read_b64_tr_b16 a[2:3], v13 offset:5120
    ds_read_b64_tr_b16 a[4:5], v13 offset:10240
    v_mfma_f32_16x16x32_bf16 v[76:79], a[52:55], a[184:187], v[76:79]
    ds_read_b64_tr_b16 a[6:7], v13 offset:15360
    v_fma_f32 v156, v156, v220, v252
    v_mfma_f32_16x16x32_bf16 v[96:99], a[48:51], a[180:183], v[96:99]
    ds_read_b64_tr_b16 a[8:9], v13 offset:8
    v_fma_f32 v157, v157, v221, v253
    v_mfma_f32_16x16x32_bf16 v[96:99], a[52:55], a[188:191], v[96:99]
    ds_read_b64_tr_b16 a[10:11], v13 offset:5128
    v_fma_f32 v158, v158, v222, v254
    v_mfma_f32_16x16x32_bf16 v[80:83], a[56:59], a[176:179], v[80:83]
    buffer_load_dwordx4 v9, s[44:47], s10 offen offset:1024 lds
    v_mfma_f32_16x16x32_bf16 v[80:83], a[60:63], a[184:187], v[80:83]
    ds_read_b64_tr_b16 a[12:13], v13 offset:10248
    ds_read_b64_tr_b16 a[14:15], v13 offset:15368
    v_mfma_f32_16x16x32_bf16 v[100:103], a[56:59], a[180:183], v[100:103]
    ds_read_b64_tr_b16 a[16:17], v13 offset:16
    v_fma_f32 v159, v159, v223, v255
    v_mfma_f32_16x16x32_bf16 v[100:103], a[60:63], a[188:191], v[100:103]
    ds_read_b64_tr_b16 a[18:19], v13 offset:5136
    s_waitcnt lgkmcnt(9)
    v_mfma_f32_16x16x32_bf16 v[84:87], a[64:67], a[176:179], v[84:87]
    ds_read_b64_tr_b16 a[20:21], v13 offset:10256
    v_mfma_f32_16x16x32_bf16 v[84:87], a[68:71], a[184:187], v[84:87]
    buffer_load_dwordx4 v10, s[44:47], s10 offen offset:2048 lds
    v_mfma_f32_16x16x32_bf16 v[104:107], a[64:67], a[180:183], v[104:107]
    ds_read_b64_tr_b16 a[22:23], v13 offset:15376
    ds_read_b64_tr_b16 a[24:25], v13 offset:24
    v_mfma_f32_16x16x32_bf16 v[104:107], a[68:71], a[188:191], v[104:107]
    ds_read_b64_tr_b16 a[26:27], v13 offset:5144
    v_mfma_f32_16x16x32_bf16 v[88:91], a[72:75], a[176:179], v[88:91]
    ds_read_b64_tr_b16 a[28:29], v13 offset:10264
    v_mfma_f32_16x16x32_bf16 v[88:91], a[76:79], a[184:187], v[88:91]
    ds_read_b64_tr_b16 a[30:31], v13 offset:15384
    v_mfma_f32_16x16x32_bf16 v[108:111], a[72:75], a[180:183], v[108:111]
    buffer_load_dwordx4 v11, s[44:47], s10 offen offset:3072 lds
    v_mfma_f32_16x16x32_bf16 v[108:111], a[76:79], a[188:191], v[108:111]
    ds_read_b64_tr_b16 a[32:33], v13 offset:32
    ds_read_b64_tr_b16 a[34:35], v13 offset:5152
    s_waitcnt vmcnt(39) lgkmcnt(8)
    v_mfma_f32_16x16x32_bf16 v[32:35], a[0:3], a[192:195], v[32:35]
    ds_read_b64_tr_b16 a[36:37], v13 offset:10272
    s_waitcnt vmcnt(37)
    v_mfma_f32_16x16x32_bf16 v[32:35], a[4:7], a[200:203], v[32:35]
    ds_read_b64_tr_b16 a[38:39], v13 offset:15392
    v_mfma_f32_16x16x32_bf16 v[52:55], a[0:3], a[196:199], v[52:55]
    s_add_u32 m0, s95, 0x24000
    ds_read_b64_tr_b16 a[40:41], v14 offset:0
    s_waitcnt vmcnt(36)
    v_mfma_f32_16x16x32_bf16 v[52:55], a[4:7], a[204:207], v[52:55]
    buffer_load_dwordx4 v12, s[44:47], s10 offen offset:0 lds
    v_mfma_f32_16x16x32_bf16 v[36:39], a[8:11], a[192:195], v[36:39]
    ds_read_b64_tr_b16 a[42:43], v14 offset:5120
    ds_read_b64_tr_b16 a[44:45], v14 offset:10240
    v_mfma_f32_16x16x32_bf16 v[36:39], a[12:15], a[200:203], v[36:39]
    ds_read_b64_tr_b16 a[46:47], v14 offset:15360
    v_mfma_f32_16x16x32_bf16 v[56:59], a[8:11], a[196:199], v[56:59]
    ds_read_b64_tr_b16 a[48:49], v14 offset:8
    v_mfma_f32_16x16x32_bf16 v[56:59], a[12:15], a[204:207], v[56:59]
    s_add_u32 s13, s92, 0x8000
    ds_read_b64_tr_b16 a[50:51], v14 offset:5128
    v_mfma_f32_16x16x32_bf16 v[40:43], a[16:19], a[192:195], v[40:43]
    s_waitcnt lgkmcnt(14)
    buffer_load_dwordx4 a[160:163], v18, s[56:59], s13 offen sc1
    v_mfma_f32_16x16x32_bf16 v[40:43], a[20:23], a[200:203], v[40:43]
    ds_read_b64_tr_b16 a[52:53], v14 offset:10248
    ds_read_b64_tr_b16 a[54:55], v14 offset:15368
    v_mfma_f32_16x16x32_bf16 v[60:63], a[16:19], a[196:199], v[60:63]
    s_waitcnt vmcnt(30)
    s_barrier
    ds_read_b64_tr_b16 a[56:57], v14 offset:16
    v_mfma_f32_16x16x32_bf16 v[60:63], a[20:23], a[204:207], v[60:63]
    ds_read_b64_tr_b16 a[58:59], v14 offset:5136
    s_waitcnt lgkmcnt(9)
    v_mfma_f32_16x16x32_bf16 v[44:47], a[24:27], a[192:195], v[44:47]
    ds_read_b64_tr_b16 a[60:61], v14 offset:10256
    v_mfma_f32_16x16x32_bf16 v[44:47], a[28:31], a[200:203], v[44:47]
    buffer_load_dwordx4 a[164:167], v19, s[56:59], s13 offen sc1
    v_mfma_f32_16x16x32_bf16 v[64:67], a[24:27], a[196:199], v[64:67]
    buffer_load_dword v27, v28, s[68:71], s98 offen sc1
    v_mfma_f32_16x16x32_bf16 v[64:67], a[28:31], a[204:207], v[64:67]
    ds_read_b64_tr_b16 a[62:63], v14 offset:15376
    ds_read_b64_tr_b16 a[64:65], v14 offset:24
    v_mfma_f32_16x16x32_bf16 v[48:51], a[32:35], a[192:195], v[48:51]
    ds_read_b64_tr_b16 a[66:67], v14 offset:5144
    v_mfma_f32_16x16x32_bf16 v[48:51], a[36:39], a[200:203], v[48:51]
    s_mov_b32 s10, 0xb4000
    s_add_u32 m0, s95, 0x1e000
    ds_read_b64_tr_b16 a[68:69], v14 offset:10264
    v_mfma_f32_16x16x32_bf16 v[68:71], a[32:35], a[196:199], v[68:71]
    buffer_load_dwordx4 v8, s[44:47], s10 offen offset:0 lds
    v_mfma_f32_16x16x32_bf16 v[68:71], a[36:39], a[204:207], v[68:71]
    s_waitcnt lgkmcnt(5)
    ds_read_b64_tr_b16 a[70:71], v14 offset:15384
    ds_read_b64_tr_b16 a[72:73], v14 offset:32
    ds_read_b64_tr_b16 a[74:75], v14 offset:5152
    ds_read_b64_tr_b16 a[76:77], v14 offset:10272
    ds_read_b64_tr_b16 a[78:79], v14 offset:15392
    v_add_u32 v13, 0xfffe7000, v13
    v_add_u32 v14, 0xfffe7000, v14
    v_mfma_f32_16x16x32_bf16 v[72:75], a[40:43], a[192:195], v[72:75]
    buffer_load_dword v26, v2, s[28:31], 0 offen sc1
    v_mfma_f32_16x16x32_bf16 v[72:75], a[44:47], a[200:203], v[72:75]
    ds_read_b64_tr_b16 a[0:1], v13 offset:0
    ds_read_b64_tr_b16 a[2:3], v13 offset:5120
    v_mfma_f32_16x16x32_bf16 v[92:95], a[40:43], a[196:199], v[92:95]
    ds_read_b64_tr_b16 a[4:5], v13 offset:10240
    v_mfma_f32_16x16x32_bf16 v[92:95], a[44:47], a[204:207], v[92:95]
    buffer_load_dwordx4 v9, s[44:47], s10 offen offset:1024 lds
    v_mfma_f32_16x16x32_bf16 v[76:79], a[48:51], a[192:195], v[76:79]
    ds_read_b64_tr_b16 a[6:7], v13 offset:15360
    ds_read_b64_tr_b16 a[8:9], v13 offset:8
    v_mfma_f32_16x16x32_bf16 v[76:79], a[52:55], a[200:203], v[76:79]
    ds_read_b64_tr_b16 a[10:11], v13 offset:5128
    v_mfma_f32_16x16x32_bf16 v[96:99], a[48:51], a[196:199], v[96:99]
    ds_read_b64_tr_b16 a[12:13], v13 offset:10248
    v_mfma_f32_16x16x32_bf16 v[96:99], a[52:55], a[204:207], v[96:99]
    ds_read_b64_tr_b16 a[14:15], v13 offset:15368
    v_mfma_f32_16x16x32_bf16 v[80:83], a[56:59], a[192:195], v[80:83]
    s_waitcnt lgkmcnt(8)
    buffer_load_dwordx4 v10, s[44:47], s10 offen offset:2048 lds
    v_mfma_f32_16x16x32_bf16 v[80:83], a[60:63], a[200:203], v[80:83]
    ds_read_b64_tr_b16 a[16:17], v13 offset:16
    ds_read_b64_tr_b16 a[18:19], v13 offset:5136
    v_mfma_f32_16x16x32_bf16 v[100:103], a[56:59], a[196:199], v[100:103]
    ds_read_b64_tr_b16 a[20:21], v13 offset:10256
    v_mfma_f32_16x16x32_bf16 v[100:103], a[60:63], a[204:207], v[100:103]
    ds_read_b64_tr_b16 a[22:23], v13 offset:15376
    v_mfma_f32_16x16x32_bf16 v[84:87], a[64:67], a[192:195], v[84:87]
    ds_read_b64_tr_b16 a[24:25], v13 offset:24
    v_mfma_f32_16x16x32_bf16 v[84:87], a[68:71], a[200:203], v[84:87]
    buffer_load_dwordx4 v11, s[44:47], s10 offen offset:3072 lds
    v_mfma_f32_16x16x32_bf16 v[104:107], a[64:67], a[196:199], v[104:107]
    ds_read_b64_tr_b16 a[26:27], v13 offset:5144
    ds_read_b64_tr_b16 a[28:29], v13 offset:10264
    v_mfma_f32_16x16x32_bf16 v[104:107], a[68:71], a[204:207], v[104:107]
    ds_read_b64_tr_b16 a[30:31], v13 offset:15384
    v_mfma_f32_16x16x32_bf16 v[88:91], a[72:75], a[192:195], v[88:91]
    ds_read_b64_tr_b16 a[32:33], v13 offset:32
    v_mfma_f32_16x16x32_bf16 v[88:91], a[76:79], a[200:203], v[88:91]
    s_add_u32 m0, s95, 0x1f000
    ds_read_b64_tr_b16 a[34:35], v13 offset:5152
    v_mfma_f32_16x16x32_bf16 v[108:111], a[72:75], a[196:199], v[108:111]
    buffer_load_dwordx4 v12, s[44:47], s10 offen offset:0 lds
    v_mfma_f32_16x16x32_bf16 v[108:111], a[76:79], a[204:207], v[108:111]
    s_waitcnt lgkmcnt(6)
    ds_read_b64_tr_b16 a[36:37], v13 offset:10272
    ds_read_b64_tr_b16 a[38:39], v13 offset:15392
    v_mfma_f32_16x16x32_bf16 v[32:35], a[0:3], a[208:211], v[32:35]
    ds_read_b64_tr_b16 a[40:41], v14 offset:0
    v_mfma_f32_16x16x32_bf16 v[32:35], a[4:7], a[216:219], v[32:35]
    ds_read_b64_tr_b16 a[42:43], v14 offset:5120
    v_mfma_f32_16x16x32_bf16 v[52:55], a[0:3], a[212:215], v[52:55]
    s_add_u32 s13, s92, 0x8800
    ds_read_b64_tr_b16 a[44:45], v14 offset:10240
    v_mfma_f32_16x16x32_bf16 v[52:55], a[4:7], a[220:223], v[52:55]
    buffer_load_dwordx4 a[168:171], v18, s[56:59], s13 offen sc1
    v_mfma_f32_16x16x32_bf16 v[36:39], a[8:11], a[208:211], v[36:39]
    ds_read_b64_tr_b16 a[46:47], v14 offset:15360
    ds_read_b64_tr_b16 a[48:49], v14 offset:8
    v_mfma_f32_16x16x32_bf16 v[36:39], a[12:15], a[216:219], v[36:39]
    ds_read_b64_tr_b16 a[50:51], v14 offset:5128
    v_mfma_f32_16x16x32_bf16 v[56:59], a[8:11], a[212:215], v[56:59]
    ds_read_b64_tr_b16 a[52:53], v14 offset:10248
    v_mfma_f32_16x16x32_bf16 v[56:59], a[12:15], a[220:223], v[56:59]
    ds_read_b64_tr_b16 a[54:55], v14 offset:15368
    v_mfma_f32_16x16x32_bf16 v[40:43], a[16:19], a[208:211], v[40:43]
    buffer_load_dwordx4 a[172:175], v19, s[56:59], s13 offen sc1
    v_mfma_f32_16x16x32_bf16 v[40:43], a[20:23], a[216:219], v[40:43]
    ds_read_b64_tr_b16 a[56:57], v14 offset:16
    ds_read_b64_tr_b16 a[58:59], v14 offset:5136
    v_mfma_f32_16x16x32_bf16 v[60:63], a[16:19], a[212:215], v[60:63]
    s_waitcnt vmcnt(35)
    s_barrier
    ds_read_b64_tr_b16 a[60:61], v14 offset:10256
    v_mfma_f32_16x16x32_bf16 v[60:63], a[20:23], a[220:223], v[60:63]
    ds_read_b64_tr_b16 a[62:63], v14 offset:15376
    s_waitcnt lgkmcnt(15)
    v_mfma_f32_16x16x32_bf16 v[44:47], a[24:27], a[208:211], v[44:47]
    s_add_u32 s13, s92, 0x9000
    ds_read_b64_tr_b16 a[64:65], v14 offset:24
    v_mfma_f32_16x16x32_bf16 v[44:47], a[28:31], a[216:219], v[44:47]
    buffer_load_dwordx4 a[176:179], v18, s[56:59], s13 offen sc1
    v_mfma_f32_16x16x32_bf16 v[64:67], a[24:27], a[212:215], v[64:67]
    s_cmp_ge_u32 s5, 28
    s_cbranch_scc1 fk_c6
    s_waitcnt vmcnt(9)
    v_cmp_eq_u32 vcc, 1, v27
    s_nop 0
    s_bfe_u32 s11, vcc_lo, 0x10000
    s_cmp_ge_u32 s11, 1
    s_cbranch_scc0 fk_w6_slow
fk_w6_ok:
fk_c6:
    v_mfma_f32_16x16x32_bf16 v[64:67], a[28:31], a[220:223], v[64:67]
    ds_read_b64_tr_b16 a[66:67], v14 offset:5144
    s_waitcnt lgkmcnt(6)
    v_mfma_f32_16x16x32_bf16 v[48:51], a[32:35], a[208:211], v[48:51]
    buffer_load_dwordx4 v[112:115], v2, s[84:87], s93 offen sc1
    v_mfma_f32_16x16x32_bf16 v[48:51], a[36:39], a[216:219], v[48:51]
    ds_read_b64_tr_b16 a[68:69], v14 offset:10264
    ds_read_b64_tr_b16 a[70:71], v14 offset:15384
    v_mfma_f32_16x16x32_bf16 v[68:71], a[32:35], a[212:215], v[68:71]
    buffer_load_dwordx4 a[180:183], v19, s[56:59], s13 offen sc1
    v_mfma_f32_16x16x32_bf16 v[68:71], a[36:39], a[220:223], v[68:71]
    ds_read_b64_tr_b16 a[72:73], v14 offset:32
    ds_read_b64_tr_b16 a[74:75], v14 offset:5152
    v_mfma_f32_16x16x32_bf16 v[72:75], a[40:43], a[208:211], v[72:75]
    buffer_load_dwordx4 v[116:119], v2, s[84:87], s93 offen offset:1024 sc1
    v_mfma_f32_16x16x32_bf16 v[72:75], a[44:47], a[216:219], v[72:75]
    ds_read_b64_tr_b16 a[76:77], v14 offset:10272
    ds_read_b64_tr_b16 a[78:79], v14 offset:15392
    v_mfma_f32_16x16x32_bf16 v[92:95], a[40:43], a[212:215], v[92:95]
    s_mov_b32 s10, 0xc8000
    s_add_u32 m0, s95, 0x19000
    ds_read_b64_tr_b16 a[0:1], v13 offset:20480
    v_mfma_f32_16x16x32_bf16 v[92:95], a[44:47], a[220:223], v[92:95]
    buffer_load_dwordx4 v8, s[44:47], s10 offen offset:0 lds
    v_mfma_f32_16x16x32_bf16 v[76:79], a[48:51], a[208:211], v[76:79]
    buffer_load_dwordx4 v[120:123], v2, s[84:87], s93 offen offset:2048 sc1
    v_mfma_f32_16x16x32_bf16 v[76:79], a[52:55], a[216:219], v[76:79]
    ds_read_b64_tr_b16 a[2:3], v13 offset:25600
    ds_read_b64_tr_b16 a[4:5], v13 offset:30720
    v_mfma_f32_16x16x32_bf16 v[96:99], a[48:51], a[212:215], v[96:99]
    ds_read_b64_tr_b16 a[6:7], v13 offset:35840
    v_mfma_f32_16x16x32_bf16 v[96:99], a[52:55], a[220:223], v[96:99]
    ds_read_b64_tr_b16 a[8:9], v13 offset:20488
    s_waitcnt lgkmcnt(7)
    v_mfma_f32_16x16x32_bf16 v[80:83], a[56:59], a[208:211], v[80:83]
    buffer_load_dwordx4 v[124:127], v2, s[84:87], s93 offen offset:3072 sc1
    v_mfma_f32_16x16x32_bf16 v[80:83], a[60:63], a[216:219], v[80:83]
    buffer_load_dwordx4 v9, s[44:47], s10 offen offset:1024 lds
    v_mfma_f32_16x16x32_bf16 v[100:103], a[56:59], a[212:215], v[100:103]
    ds_read_b64_tr_b16 a[10:11], v13 offset:25608
    ds_read_b64_tr_b16 a[12:13], v13 offset:30728
    v_mfma_f32_16x16x32_bf16 v[100:103], a[60:63], a[220:223], v[100:103]
    ds_read_b64_tr_b16 a[14:15], v13 offset:35848
    v_mfma_f32_16x16x32_bf16 v[84:87], a[64:67], a[208:211], v[84:87]
    ds_read_b64_tr_b16 a[16:17], v13 offset:20496
    v_mfma_f32_16x16x32_bf16 v[84:87], a[68:71], a[216:219], v[84:87]
    buffer_load_dwordx4 v10, s[44:47], s10 offen offset:2048 lds
    v_mfma_f32_16x16x32_bf16 v[104:107], a[64:67], a[212:215], v[104:107]
    ds_read_b64_tr_b16 a[18:19], v13 offset:25616
    ds_read_b64_tr_b16 a[20:21], v13 offset:30736
    v_mfma_f32_16x16x32_bf16 v[104:107], a[68:71], a[220:223], v[104:107]
    ds_read_b64_tr_b16 a[22:23], v13 offset:35856
    v_mfma_f32_16x16x32_bf16 v[88:91], a[72:75], a[208:211], v[88:91]
    ds_read_b64_tr_b16 a[24:25], v13 offset:20504
    s_waitcnt lgkmcnt(8)
    v_mfma_f32_16x16x32_bf16 v[88:91], a[76:79], a[216:219], v[88:91]
    ds_read_b64_tr_b16 a[26:27], v13 offset:25624
    v_mfma_f32_16x16x32_bf16 v[108:111], a[72:75], a[212:215], v[108:111]
    buffer_load_dwordx4 v11, s[44:47], s10 offen offset:3072 lds
    v_mfma_f32_16x16x32_bf16 v[108:111], a[76:79], a[220:223], v[108:111]
    ds_read_b64_tr_b16 a[28:29], v13 offset:30744
    ds_read_b64_tr_b16 a[30:31], v13 offset:35864
    v_mfma_f32_16x16x32_bf16 v[32:35], a[0:3], a[224:227], v[32:35]
    ds_read_b64_tr_b16 a[32:33], v13 offset:20512
    v_mfma_f32_16x16x32_bf16 v[32:35], a[4:7], a[232:235], v[32:35]
    ds_read_b64_tr_b16 a[34:35], v13 offset:25632
    v_mfma_f32_16x16x32_bf16 v[52:55], a[0:3], a[228:231], v[52:55]
    s_add_u32 m0, s95, 0x1a000
    ds_read_b64_tr_b16 a[36:37], v13 offset:30752
    v_mfma_f32_16x16x32_bf16 v[52:55], a[4:7], a[236:239], v[52:55]
    s_waitcnt lgkmcnt(7)
    buffer_load_dwordx4 v12, s[44:47], s10 offen offset:0 lds
    v_mfma_f32_16x16x32_bf16 v[36:39], a[8:11], a[224:227], v[36:39]
    ds_read_b64_tr_b16 a[38:39], v13 offset:35872
    ds_read_b64_tr_b16 a[40:41], v14 offset:20480
    v_mfma_f32_16x16x32_bf16 v[36:39], a[12:15], a[232:235], v[36:39]
    ds_read_b64_tr_b16 a[42:43], v14 offset:25600
    v_mfma_f32_16x16x32_bf16 v[56:59], a[8:11], a[228:231], v[56:59]
    ds_read_b64_tr_b16 a[44:45], v14 offset:30720
    v_mfma_f32_16x16x32_bf16 v[56:59], a[12:15], a[236:239], v[56:59]
    s_add_u32 s13, s92, 0x9800
    ds_read_b64_tr_b16 a[46:47], v14 offset:35840
    v_mfma_f32_16x16x32_bf16 v[40:43], a[16:19], a[224:227], v[40:43]
    buffer_load_dwordx4 a[184:187], v18, s[56:59], s13 offen sc1
    v_mfma_f32_16x16x32_bf16 v[40:43], a[20:23], a[232:235], v[40:43]
    ds_read_b64_tr_b16 a[48:49], v14 offset:20488
    ds_read_b64_tr_b16 a[50:51], v14 offset:25608
    v_mfma_f32_16x16x32_bf16 v[60:63], a[16:19], a[228:231], v[60:63]
    s_waitcnt vmcnt(42)
    s_barrier
    ds_read_b64_tr_b16 a[52:53], v14 offset:30728
    v_mfma_f32_16x16x32_bf16 v[60:63], a[20:23], a[236:239], v[60:63]
    ds_read_b64_tr_b16 a[54:55], v14 offset:35848
    s_waitcnt lgkmcnt(9)
    v_mfma_f32_16x16x32_bf16 v[44:47], a[24:27], a[224:227], v[44:47]
    ds_read_b64_tr_b16 a[56:57], v14 offset:20496
    v_mfma_f32_16x16x32_bf16 v[44:47], a[28:31], a[232:235], v[44:47]
    buffer_load_dwordx4 a[188:191], v19, s[56:59], s13 offen sc1
    v_mfma_f32_16x16x32_bf16 v[64:67], a[24:27], a[228:231], v[64:67]
    ds_read_b64_tr_b16 a[58:59], v14 offset:25616
    ds_read_b64_tr_b16 a[60:61], v14 offset:30736
    v_mfma_f32_16x16x32_bf16 v[64:67], a[28:31], a[236:239], v[64:67]
    ds_read_b64_tr_b16 a[62:63], v14 offset:35856
    v_mfma_f32_16x16x32_bf16 v[48:51], a[32:35], a[224:227], v[48:51]
    ds_read_b64_tr_b16 a[64:65], v14 offset:20504
    s_waitcnt lgkmcnt(9)
    v_mfma_f32_16x16x32_bf16 v[48:51], a[36:39], a[232:235], v[48:51]
    s_add_u32 s13, s92, 0xa000
    ds_read_b64_tr_b16 a[66:67], v14 offset:25624
    v_mfma_f32_16x16x32_bf16 v[68:71], a[32:35], a[228:231], v[68:71]
    buffer_load_dwordx4 a[192:195], v18, s[56:59], s13 offen sc1
    v_mfma_f32_16x16x32_bf16 v[68:71], a[36:39], a[236:239], v[68:71]
    ds_read_b64_tr_b16 a[68:69], v14 offset:30744
    ds_read_b64_tr_b16 a[70:71], v14 offset:35864
    v_mfma_f32_16x16x32_bf16 v[72:75], a[40:43], a[224:227], v[72:75]
    ds_read_b64_tr_b16 a[72:73], v14 offset:20512
    v_mfma_f32_16x16x32_bf16 v[72:75], a[44:47], a[232:235], v[72:75]
    ds_read_b64_tr_b16 a[74:75], v14 offset:25632
    v_mfma_f32_16x16x32_bf16 v[92:95], a[40:43], a[228:231], v[92:95]
    ds_read_b64_tr_b16 a[76:77], v14 offset:30752
    v_mfma_f32_16x16x32_bf16 v[92:95], a[44:47], a[236:239], v[92:95]
    s_waitcnt lgkmcnt(7)
    buffer_load_dwordx4 a[196:199], v19, s[56:59], s13 offen sc1
    v_mfma_f32_16x16x32_bf16 v[76:79], a[48:51], a[224:227], v[76:79]
    ds_read_b64_tr_b16 a[78:79], v14 offset:35872
    ds_read_b64_tr_b16 a[0:1], v13 offset:40960
    v_mfma_f32_16x16x32_bf16 v[76:79], a[52:55], a[232:235], v[76:79]
    ds_read_b64_tr_b16 a[2:3], v13 offset:46080
    v_mfma_f32_16x16x32_bf16 v[96:99], a[48:51], a[228:231], v[96:99]
    ds_read_b64_tr_b16 a[4:5], v13 offset:51200
    v_mfma_f32_16x16x32_bf16 v[96:99], a[52:55], a[236:239], v[96:99]
    s_mov_b32 s10, 0xdc000
    s_add_u32 m0, s95, 0x0
    ds_read_b64_tr_b16 a[6:7], v13 offset:56320
    v_mfma_f32_16x16x32_bf16 v[80:83], a[56:59], a[224:227], v[80:83]
    buffer_load_dwordx4 v8, s[44:47], s10 offen offset:0 lds
    v_mfma_f32_16x16x32_bf16 v[80:83], a[60:63], a[232:235], v[80:83]
    ds_read_b64_tr_b16 a[8:9], v13 offset:40968
    ds_read_b64_tr_b16 a[10:11], v13 offset:46088
    v_mfma_f32_16x16x32_bf16 v[100:103], a[56:59], a[228:231], v[100:103]
    ds_read_b64_tr_b16 a[12:13], v13 offset:51208
    v_mfma_f32_16x16x32_bf16 v[100:103], a[60:63], a[236:239], v[100:103]
    ds_read_b64_tr_b16 a[14:15], v13 offset:56328
    s_waitcnt lgkmcnt(9)
    v_mfma_f32_16x16x32_bf16 v[84:87], a[64:67], a[224:227], v[84:87]
    ds_read_b64_tr_b16 a[16:17], v13 offset:40976
    v_mfma_f32_16x16x32_bf16 v[84:87], a[68:71], a[232:235], v[84:87]
    buffer_load_dwordx4 v9, s[44:47], s10 offen offset:1024 lds
    v_mfma_f32_16x16x32_bf16 v[104:107], a[64:67], a[228:231], v[104:107]
    ds_read_b64_tr_b16 a[18:19], v13 offset:46096
    ds_read_b64_tr_b16 a[20:21], v13 offset:51216
    v_mfma_f32_16x16x32_bf16 v[104:107], a[68:71], a[236:239], v[104:107]
    ds_read_b64_tr_b16 a[22:23], v13 offset:56336
    v_mfma_f32_16x16x32_bf16 v[88:91], a[72:75], a[224:227], v[88:91]
    ds_read_b64_tr_b16 a[24:25], v13 offset:40984
    s_waitcnt lgkmcnt(9)
    v_mfma_f32_16x16x32_bf16 v[88:91], a[76:79], a[232:235], v[88:91]
    ds_read_b64_tr_b16 a[26:27], v13 offset:46104
    v_mfma_f32_16x16x32_bf16 v[108:111], a[72:75], a[228:231], v[108:111]
    buffer_load_dwordx4 v10, s[44:47], s10 offen offset:2048 lds
    v_mfma_f32_16x16x32_bf16 v[108:111], a[76:79], a[236:239], v[108:111]
    ds_read_b64_tr_b16 a[28:29], v13 offset:51224
    ds_read_b64_tr_b16 a[30:31], v13 offset:56344
    v_mfma_f32_16x16x32_bf16 v[32:35], a[0:3], a[240:243], v[32:35]
    ds_read_b64_tr_b16 a[32:33], v13 offset:40992
    s_waitcnt vmcnt(16)
    v_lshlrev_b32 v160, 16, v112
    v_mfma_f32_16x16x32_bf16 v[32:35], a[4:7], a[248:251], v[32:35]
    ds_read_b64_tr_b16 a[34:35], v13 offset:46112
    v_and_b32 v161, 0xffff0000, v112
    v_mfma_f32_16x16x32_bf16 v[52:55], a[0:3], a[244:247], v[52:55]
    ds_read_b64_tr_b16 a[36:37], v13 offset:51232
    v_lshlrev_b32 v162, 16, v113
    v_mfma_f32_16x16x32_bf16 v[52:55], a[4:7], a[252:255], v[52:55]
    s_waitcnt lgkmcnt(7)
    buffer_load_dwordx4 v11, s[44:47], s10 offen offset:3072 lds
    v_mfma_f32_16x16x32_bf16 v[36:39], a[8:11], a[240:243], v[36:39]
    ds_read_b64_tr_b16 a[38:39], v13 offset:56352
    ds_read_b64_tr_b16 a[40:41], v14 offset:40960
    v_mfma_f32_16x16x32_bf16 v[36:39], a[12:15], a[248:251], v[36:39]
    ds_read_b64_tr_b16 a[42:43], v14 offset:46080
    v_and_b32 v163, 0xffff0000, v113
    v_mfma_f32_16x16x32_bf16 v[56:59], a[8:11], a[244:247], v[56:59]
    ds_read_b64_tr_b16 a[44:45], v14 offset:51200
    v_lshlrev_b32 v164, 16, v114
    v_mfma_f32_16x16x32_bf16 v[56:59], a[12:15], a[252:255], v[56:59]
    s_add_u32 m0, s95, 0x1000
    ds_read_b64_tr_b16 a[46:47], v14 offset:56320
    v_and_b32 v165, 0xffff0000, v114
    v_mfma_f32_16x16x32_bf16 v[40:43], a[16:19], a[240:243], v[40:43]
    buffer_load_dwordx4 v12, s[44:47], s10 offen offset:0 lds
    v_mfma_f32_16x16x32_bf16 v[40:43], a[20:23], a[248:251], v[40:43]
    ds_read_b64_tr_b16 a[48:49], v14 offset:40968
    ds_read_b64_tr_b16 a[50:51], v14 offset:46088
    v_mfma_f32_16x16x32_bf16 v[60:63], a[16:19], a[244:247], v[60:63]
    s_barrier
    ds_read_b64_tr_b16 a[52:53], v14 offset:51208
    v_lshlrev_b32 v166, 16, v115
    v_mfma_f32_16x16x32_bf16 v[60:63], a[20:23], a[252:255], v[60:63]
    s_waitcnt lgkmcnt(8)
    ds_read_b64_tr_b16 a[54:55], v14 offset:56328
    v_and_b32 v167, 0xffff0000, v115
    v_mfma_f32_16x16x32_bf16 v[44:47], a[24:27], a[240:243], v[44:47]
    s_add_u32 s13, s92, 0xa800
    ds_read_b64_tr_b16 a[56:57], v14 offset:40976
    v_fmac_f32 v128, v160, v192
    v_mfma_f32_16x16x32_bf16 v[44:47], a[28:31], a[248:251], v[44:47]
    buffer_load_dwordx4 a[200:203], v18, s[56:59], s13 offen sc1
    v_mfma_f32_16x16x32_bf16 v[64:67], a[24:27], a[244:247], v[64:67]
    ds_read_b64_tr_b16 a[58:59], v14 offset:46096
    ds_read_b64_tr_b16 a[60:61], v14 offset:51216
    v_mfma_f32_16x16x32_bf16 v[64:67], a[28:31], a[252:255], v[64:67]
    ds_read_b64_tr_b16 a[62:63], v14 offset:56336
    v_fmac_f32 v129, v161, v193
    v_mfma_f32_16x16x32_bf16 v[48:51], a[32:35], a[240:243], v[48:51]
    s_waitcnt lgkmcnt(8)
    ds_read_b64_tr_b16 a[64:65], v14 offset:40984
    v_fmac_f32 v130, v162, v194
    v_mfma_f32_16x16x32_bf16 v[48:51], a[36:39], a[248:251], v[48:51]
    ds_read_b64_tr_b16 a[66:67], v14 offset:46104
    v_fmac_f32 v131, v163, v195
    v_mfma_f32_16x16x32_bf16 v[68:71], a[32:35], a[244:247], v[68:71]
    buffer_load_dwordx4 a[204:207], v19, s[56:59], s13 offen sc1
    v_mfma_f32_16x16x32_bf16 v[68:71], a[36:39], a[252:255], v[68:71]
    ds_read_b64_tr_b16 a[68:69], v14 offset:51224
    ds_read_b64_tr_b16 a[70:71], v14 offset:56344
    ds_read_b64_tr_b16 a[72:73], v14 offset:40992
    ds_read_b64_tr_b16 a[74:75], v14 offset:46112
    ds_read_b64_tr_b16 a[76:77], v14 offset:51232
    ds_read_b64_tr_b16 a[78:79], v14 offset:56352
    v_add_u32 v13, 0xf000, v13
    v_add_u32 v14, 0xf000, v14
    v_mfma_f32_16x16x32_bf16 v[72:75], a[40:43], a[240:243], v[72:75]
    ds_read_b64_tr_b16 a[0:1], v13 offset:0
    v_fmac_f32 v132, v164, v196
    v_mfma_f32_16x16x32_bf16 v[72:75], a[44:47], a[248:251], v[72:75]
    ds_read_b64_tr_b16 a[2:3], v13 offset:5120
    v_fmac_f32 v133, v165, v197
    v_mfma_f32_16x16x32_bf16 v[92:95], a[40:43], a[244:247], v[92:95]
    s_add_u32 s13, s92, 0xb000
    ds_read_b64_tr_b16 a[4:5], v13 offset:10240
    v_fmac_f32 v134, v166, v198
    v_mfma_f32_16x16x32_bf16 v[92:95], a[44:47], a[252:255], v[92:95]
    s_waitcnt lgkmcnt(11)
    buffer_load_dwordx4 a[208:211], v18, s[56:59], s13 offen sc1
    v_mfma_f32_16x16x32_bf16 v[76:79], a[48:51], a[240:243], v[76:79]
    ds_read_b64_tr_b16 a[6:7], v13 offset:15360
    ds_read_b64_tr_b16 a[8:9], v13 offset:8
    v_mfma_f32_16x16x32_bf16 v[76:79], a[52:55], a[248:251], v[76:79]
    ds_read_b64_tr_b16 a[10:11], v13 offset:5128
    v_fmac_f32 v135, v167, v199
    v_mfma_f32_16x16x32_bf16 v[96:99], a[48:51], a[244:247], v[96:99]
    ds_read_b64_tr_b16 a[12:13], v13 offset:10248
    v_cvt_pk_bf16_f32 v160, v128, v129
    v_mfma_f32_16x16x32_bf16 v[96:99], a[52:55], a[252:255], v[96:99]
    ds_read_b64_tr_b16 a[14:15], v13 offset:15368
    v_cvt_pk_bf16_f32 v161, v130, v131
    v_mfma_f32_16x16x32_bf16 v[80:83], a[56:59], a[240:243], v[80:83]
    buffer_load_dwordx4 a[212:215], v19, s[56:59], s13 offen sc1
    v_mfma_f32_16x16x32_bf16 v[80:83], a[60:63], a[248:251], v[80:83]
    ds_read_b64_tr_b16 a[16:17], v13 offset:16
    ds_read_b64_tr_b16 a[18:19], v13 offset:5136
    v_mfma_f32_16x16x32_bf16 v[100:103], a[56:59], a[244:247], v[100:103]
    ds_read_b64_tr_b16 a[20:21], v13 offset:10256
    v_cvt_pk_bf16_f32 v162, v132, v133
    v_mfma_f32_16x16x32_bf16 v[100:103], a[60:63], a[252:255], v[100:103]
    s_waitcnt lgkmcnt(8)
    ds_read_b64_tr_b16 a[22:23], v13 offset:15376
    v_cvt_pk_bf16_f32 v163, v134, v135
    v_mfma_f32_16x16x32_bf16 v[84:87], a[64:67], a[240:243], v[84:87]
    s_mov_b32 s10, 0xf0000
    s_add_u32 m0, s95, 0x5000
    ds_read_b64_tr_b16 a[24:25], v13 offset:24
    v_mfma_f32_16x16x32_bf16 v[84:87], a[68:71], a[248:251], v[84:87]
    buffer_load_dwordx4 v8, s[44:47], s10 offen offset:0 lds
    v_mfma_f32_16x16x32_bf16 v[104:107], a[64:67], a[244:247], v[104:107]
    buffer_store_dwordx4 v[160:163], v0, s[56:59], s94 offen sc1
    ds_read_b64_tr_b16 a[26:27], v13 offset:5144
    ds_read_b64_tr_b16 a[28:29], v13 offset:10264
    s_waitcnt vmcnt(22)
    v_lshlrev_b32 v168, 16, v116
    v_mfma_f32_16x16x32_bf16 v[104:107], a[68:71], a[252:255], v[104:107]
    ds_read_b64_tr_b16 a[30:31], v13 offset:15384
    v_and_b32 v169, 0xffff0000, v116
    v_mfma_f32_16x16x32_bf16 v[88:91], a[72:75], a[240:243], v[88:91]
    ds_read_b64_tr_b16 a[32:33], v13 offset:32
    v_lshlrev_b32 v170, 16, v117
    v_mfma_f32_16x16x32_bf16 v[88:91], a[76:79], a[248:251], v[88:91]
    ds_read_b64_tr_b16 a[34:35], v13 offset:5152
    v_and_b32 v171, 0xffff0000, v117
    v_mfma_f32_16x16x32_bf16 v[108:111], a[72:75], a[244:247], v[108:111]
    buffer_load_dwordx4 v9, s[44:47], s10 offen offset:1024 lds
    v_mfma_f32_16x16x32_bf16 v[108:111], a[76:79], a[252:255], v[108:111]
    ds_read_b64_tr_b16 a[36:37], v13 offset:10272
    ds_read_b64_tr_b16 a[38:39], v13 offset:15392
    v_mfma_f32_16x16x32_bf16 v[32:35], a[0:3], a[128:131], v[32:35]
    s_waitcnt lgkmcnt(8)
    ds_read_b64_tr_b16 a[40:41], v14 offset:0
    v_lshlrev_b32 v172, 16, v118
    v_mfma_f32_16x16x32_bf16 v[32:35], a[4:7], a[136:139], v[32:35]
    ds_read_b64_tr_b16 a[42:43], v14 offset:5120
    v_and_b32 v173, 0xffff0000, v118
    v_mfma_f32_16x16x32_bf16 v[52:55], a[0:3], a[132:135], v[52:55]
    ds_read_b64_tr_b16 a[44:45], v14 offset:10240
    v_lshlrev_b32 v174, 16, v119
    v_mfma_f32_16x16x32_bf16 v[52:55], a[4:7], a[140:143], v[52:55]
    buffer_load_dwordx4 v10, s[44:47], s10 offen offset:2048 lds
    v_mfma_f32_16x16x32_bf16 v[36:39], a[8:11], a[128:131], v[36:39]
    ds_read_b64_tr_b16 a[46:47], v14 offset:15360
    ds_read_b64_tr_b16 a[48:49], v14 offset:8
    v_mfma_f32_16x16x32_bf16 v[36:39], a[12:15], a[136:139], v[36:39]
    ds_read_b64_tr_b16 a[50:51], v14 offset:5128
    v_and_b32 v175, 0xffff0000, v119
    v_mfma_f32_16x16x32_bf16 v[56:59], a[8:11], a[132:135], v[56:59]
    ds_read_b64_tr_b16 a[52:53], v14 offset:10248
    v_fmac_f32 v136, v168, v200
    v_mfma_f32_16x16x32_bf16 v[56:59], a[12:15], a[140:143], v[56:59]
    ds_read_b64_tr_b16 a[54:55], v14 offset:15368
    v_fmac_f32 v137, v169, v201
    v_mfma_f32_16x16x32_bf16 v[40:43], a[16:19], a[128:131], v[40:43]
    buffer_load_dwordx4 v11, s[44:47], s10 offen offset:3072 lds
    v_mfma_f32_16x16x32_bf16 v[40:43], a[20:23], a[136:139], v[40:43]
    ds_read_b64_tr_b16 a[56:57], v14 offset:16
    ds_read_b64_tr_b16 a[58:59], v14 offset:5136
    v_mfma_f32_16x16x32_bf16 v[60:63], a[16:19], a[132:135], v[60:63]
    s_barrier
    ds_read_b64_tr_b16 a[60:61], v14 offset:10256
    v_fmac_f32 v138, v170, v202
    v_mfma_f32_16x16x32_bf16 v[60:63], a[20:23], a[140:143], v[60:63]
    s_waitcnt lgkmcnt(8)
    ds_read_b64_tr_b16 a[62:63], v14 offset:15376
    v_fmac_f32 v139, v171, v203
    v_mfma_f32_16x16x32_bf16 v[44:47], a[24:27], a[128:131], v[44:47]
    s_add_u32 m0, s95, 0x6000
    ds_read_b64_tr_b16 a[64:65], v14 offset:24
    v_fmac_f32 v140, v172, v204
    v_mfma_f32_16x16x32_bf16 v[44:47], a[28:31], a[136:139], v[44:47]
    buffer_load_dwordx4 v12, s[44:47], s10 offen offset:0 lds
    v_mfma_f32_16x16x32_bf16 v[64:67], a[24:27], a[132:135], v[64:67]
    ds_read_b64_tr_b16 a[66:67], v14 offset:5144
    ds_read_b64_tr_b16 a[68:69], v14 offset:10264
    v_mfma_f32_16x16x32_bf16 v[64:67], a[28:31], a[140:143], v[64:67]
    ds_read_b64_tr_b16 a[70:71], v14 offset:15384
    v_fmac_f32 v141, v173, v205
    v_mfma_f32_16x16x32_bf16 v[48:51], a[32:35], a[128:131], v[48:51]
    ds_read_b64_tr_b16 a[72:73], v14 offset:32
    v_fmac_f32 v142, v174, v206
    v_mfma_f32_16x16x32_bf16 v[48:51], a[36:39], a[136:139], v[48:51]
    s_add_u32 s13, s92, 0xb800
    ds_read_b64_tr_b16 a[74:75], v14 offset:5152
    v_fmac_f32 v143, v175, v207
    v_mfma_f32_16x16x32_bf16 v[68:71], a[32:35], a[132:135], v[68:71]
    buffer_load_dwordx4 a[216:219], v18, s[56:59], s13 offen sc1
    v_mfma_f32_16x16x32_bf16 v[68:71], a[36:39], a[140:143], v[68:71]
    ds_read_b64_tr_b16 a[76:77], v14 offset:10272
    ds_read_b64_tr_b16 a[78:79], v14 offset:15392
    v_mfma_f32_16x16x32_bf16 v[72:75], a[40:43], a[128:131], v[72:75]
    s_waitcnt lgkmcnt(8)
    ds_read_b64_tr_b16 a[0:1], v13 offset:20480
    v_cvt_pk_bf16_f32 v168, v136, v137
    v_mfma_f32_16x16x32_bf16 v[72:75], a[44:47], a[136:139], v[72:75]
    ds_read_b64_tr_b16 a[2:3], v13 offset:25600
    v_cvt_pk_bf16_f32 v169, v138, v139
    v_mfma_f32_16x16x32_bf16 v[92:95], a[40:43], a[132:135], v[92:95]
    ds_read_b64_tr_b16 a[4:5], v13 offset:30720
    v_cvt_pk_bf16_f32 v170, v140, v141
    v_mfma_f32_16x16x32_bf16 v[92:95], a[44:47], a[140:143], v[92:95]
    buffer_load_dwordx4 a[220:223], v19, s[56:59], s13 offen sc1
    v_mfma_f32_16x16x32_bf16 v[76:79], a[48:51], a[128:131], v[76:79]
    ds_read_b64_tr_b16 a[6:7], v13 offset:35840
    ds_read_b64_tr_b16 a[8:9], v13 offset:20488
    v_mfma_f32_16x16x32_bf16 v[76:79], a[52:55], a[136:139], v[76:79]
    ds_read_b64_tr_b16 a[10:11], v13 offset:25608
    v_cvt_pk_bf16_f32 v171, v142, v143
    v_mfma_f32_16x16x32_bf16 v[96:99], a[48:51], a[132:135], v[96:99]
    buffer_store_dwordx4 v[168:171], v0, s[56:59], s94 offen offset:256 sc1
    ds_read_b64_tr_b16 a[12:13], v13 offset:30728
    s_waitcnt vmcnt(27)
    v_lshlrev_b32 v176, 16, v120
    v_and_b32 v177, 0xffff0000, v120
    v_mfma_f32_16x16x32_bf16 v[96:99], a[52:55], a[140:143], v[96:99]
    s_add_u32 s13, s92, 0xc000
    ds_read_b64_tr_b16 a[14:15], v13 offset:35848
    v_lshlrev_b32 v178, 16, v121
    v_mfma_f32_16x16x32_bf16 v[80:83], a[56:59], a[128:131], v[80:83]
    buffer_load_dwordx4 a[224:227], v18, s[56:59], s13 offen sc1
    v_mfma_f32_16x16x32_bf16 v[80:83], a[60:63], a[136:139], v[80:83]
    ds_read_b64_tr_b16 a[16:17], v13 offset:20496
    ds_read_b64_tr_b16 a[18:19], v13 offset:25616
    v_mfma_f32_16x16x32_bf16 v[100:103], a[56:59], a[132:135], v[100:103]
    ds_read_b64_tr_b16 a[20:21], v13 offset:30736
    v_and_b32 v179, 0xffff0000, v121
    v_mfma_f32_16x16x32_bf16 v[100:103], a[60:63], a[140:143], v[100:103]
    s_waitcnt lgkmcnt(8)
    ds_read_b64_tr_b16 a[22:23], v13 offset:35856
    v_lshlrev_b32 v180, 16, v122
    v_mfma_f32_16x16x32_bf16 v[84:87], a[64:67], a[128:131], v[84:87]
    ds_read_b64_tr_b16 a[24:25], v13 offset:20504
    v_and_b32 v181, 0xffff0000, v122
    v_mfma_f32_16x16x32_bf16 v[84:87], a[68:71], a[136:139], v[84:87]
    buffer_load_dwordx4 a[228:231], v19, s[56:59], s13 offen sc1
    v_mfma_f32_16x16x32_bf16 v[104:107], a[64:67], a[132:135], v[104:107]
    ds_read_b64_tr_b16 a[26:27], v13 offset:25624
    ds_read_b64_tr_b16 a[28:29], v13 offset:30744
    v_mfma_f32_16x16x32_bf16 v[104:107], a[68:71], a[140:143], v[104:107]
    ds_read_b64_tr_b16 a[30:31], v13 offset:35864
    v_lshlrev_b32 v182, 16, v123
    v_mfma_f32_16x16x32_bf16 v[88:91], a[72:75], a[128:131], v[88:91]
    ds_read_b64_tr_b16 a[32:33], v13 offset:20512
    v_and_b32 v183, 0xffff0000, v123
    v_mfma_f32_16x16x32_bf16 v[88:91], a[76:79], a[136:139], v[88:91]
    s_mov_b32 s10, 0x104000
    s_add_u32 m0, s95, 0xa000
    ds_read_b64_tr_b16 a[34:35], v13 offset:25632
    v_mfma_f32_16x16x32_bf16 v[108:111], a[72:75], a[132:135], v[108:111]
    buffer_load_dwordx4 v8, s[44:47], s10 offen offset:0 lds
    v_mfma_f32_16x16x32_bf16 v[108:111], a[76:79], a[140:143], v[108:111]
    ds_read_b64_tr_b16 a[36:37], v13 offset:30752
    ds_read_b64_tr_b16 a[38:39], v13 offset:35872
    v_mfma_f32_16x16x32_bf16 v[32:35], a[0:3], a[144:147], v[32:35]
    s_waitcnt lgkmcnt(8)
    ds_read_b64_tr_b16 a[40:41], v14 offset:20480
    v_fmac_f32 v144, v176, v208
    v_mfma_f32_16x16x32_bf16 v[32:35], a[4:7], a[152:155], v[32:35]
    ds_read_b64_tr_b16 a[42:43], v14 offset:25600
    v_fmac_f32 v145, v177, v209
    v_mfma_f32_16x16x32_bf16 v[52:55], a[0:3], a[148:151], v[52:55]
    ds_read_b64_tr_b16 a[44:45], v14 offset:30720
    v_fmac_f32 v146, v178, v210
    v_mfma_f32_16x16x32_bf16 v[52:55], a[4:7], a[156:159], v[52:55]
    buffer_load_dwordx4 v9, s[44:47], s10 offen offset:1024 lds
    v_mfma_f32_16x16x32_bf16 v[36:39], a[8:11], a[144:147], v[36:39]
    ds_read_b64_tr_b16 a[46:47], v14 offset:35840
    ds_read_b64_tr_b16 a[48:49], v14 offset:20488
    v_mfma_f32_16x16x32_bf16 v[36:39], a[12:15], a[152:155], v[36:39]
    ds_read_b64_tr_b16 a[50:51], v14 offset:25608
    v_fmac_f32 v147, v179, v211
    v_mfma_f32_16x16x32_bf16 v[56:59], a[8:11], a[148:151], v[56:59]
    ds_read_b64_tr_b16 a[52:53], v14 offset:30728
    v_fmac_f32 v148, v180, v212
    v_mfma_f32_16x16x32_bf16 v[56:59], a[12:15], a[156:159], v[56:59]
    ds_read_b64_tr_b16 a[54:55], v14 offset:35848
    v_fmac_f32 v149, v181, v213
    v_mfma_f32_16x16x32_bf16 v[40:43], a[16:19], a[144:147], v[40:43]
    buffer_load_dwordx4 v10, s[44:47], s10 offen offset:2048 lds
    v_mfma_f32_16x16x32_bf16 v[40:43], a[20:23], a[152:155], v[40:43]
    ds_read_b64_tr_b16 a[56:57], v14 offset:20496
    ds_read_b64_tr_b16 a[58:59], v14 offset:25616
    v_mfma_f32_16x16x32_bf16 v[60:63], a[16:19], a[148:151], v[60:63]
    s_barrier
    ds_read_b64_tr_b16 a[60:61], v14 offset:30736
    v_fmac_f32 v150, v182, v214
    v_mfma_f32_16x16x32_bf16 v[60:63], a[20:23], a[156:159], v[60:63]
    s_waitcnt lgkmcnt(8)
    ds_read_b64_tr_b16 a[62:63], v14 offset:35856
    v_fmac_f32 v151, v183, v215
    v_mfma_f32_16x16x32_bf16 v[44:47], a[24:27], a[144:147], v[44:47]
    ds_read_b64_tr_b16 a[64:65], v14 offset:20504
    v_cvt_pk_bf16_f32 v176, v144, v145
    v_mfma_f32_16x16x32_bf16 v[44:47], a[28:31], a[152:155], v[44:47]
    buffer_load_dwordx4 v11, s[44:47], s10 offen offset:3072 lds
    v_mfma_f32_16x16x32_bf16 v[64:67], a[24:27], a[148:151], v[64:67]
    ds_read_b64_tr_b16 a[66:67], v14 offset:25624
    ds_read_b64_tr_b16 a[68:69], v14 offset:30744
    v_mfma_f32_16x16x32_bf16 v[64:67], a[28:31], a[156:159], v[64:67]
    ds_read_b64_tr_b16 a[70:71], v14 offset:35864
    v_cvt_pk_bf16_f32 v177, v146, v147
    v_mfma_f32_16x16x32_bf16 v[48:51], a[32:35], a[144:147], v[48:51]
    ds_read_b64_tr_b16 a[72:73], v14 offset:20512
    v_cvt_pk_bf16_f32 v178, v148, v149
    v_mfma_f32_16x16x32_bf16 v[48:51], a[36:39], a[152:155], v[48:51]
    s_add_u32 m0, s95, 0xb000
    ds_read_b64_tr_b16 a[74:75], v14 offset:25632
    v_cvt_pk_bf16_f32 v179, v150, v151
    v_mfma_f32_16x16x32_bf16 v[68:71], a[32:35], a[148:151], v[68:71]
    s_add_u32 s94, s94, 0x4d800
    buffer_load_dwordx4 v12, s[44:47], s10 offen offset:0 lds
    v_mfma_f32_16x16x32_bf16 v[68:71], a[36:39], a[156:159], v[68:71]
    buffer_store_dwordx4 v[176:179], v0, s[56:59], s94 offen sc1
    ds_read_b64_tr_b16 a[76:77], v14 offset:30752
    ds_read_b64_tr_b16 a[78:79], v14 offset:35872
    v_add_u32 v13, 0xa000, v13
    v_add_u32 v14, 0xa000, v14
    s_waitcnt vmcnt(34)
    v_lshlrev_b32 v184, 16, v124
    v_and_b32 v185, 0xffff0000, v124
    v_lshlrev_b32 v186, 16, v125
    v_and_b32 v187, 0xffff0000, v125
    v_lshlrev_b32 v188, 16, v126
    v_and_b32 v189, 0xffff0000, v126
    v_lshlrev_b32 v190, 16, v127
    v_and_b32 v191, 0xffff0000, v127
    v_fmac_f32 v152, v184, v216
    v_fmac_f32 v153, v185, v217
    v_fmac_f32 v154, v186, v218
    v_fmac_f32 v155, v187, v219
    v_fmac_f32 v156, v188, v220
    v_fmac_f32 v157, v189, v221
    v_fmac_f32 v158, v190, v222
    v_fmac_f32 v159, v191, v223
    v_cvt_pk_bf16_f32 v184, v152, v153
    v_cvt_pk_bf16_f32 v185, v154, v155
    v_cvt_pk_bf16_f32 v186, v156, v157
    v_cvt_pk_bf16_f32 v187, v158, v159
    v_mfma_f32_16x16x32_bf16 v[72:75], a[40:43], a[144:147], v[72:75]
    buffer_store_dwordx4 v[184:187], v0, s[56:59], s94 offen offset:256 sc1
    ds_read_b64_tr_b16 a[0:1], v13 offset:40960
    s_waitcnt lgkmcnt(9)
    v_mfma_f32_16x16x32_bf16 v[72:75], a[44:47], a[152:155], v[72:75]
    ds_read_b64_tr_b16 a[2:3], v13 offset:46080
    v_mfma_f32_16x16x32_bf16 v[92:95], a[40:43], a[148:151], v[92:95]
    s_add_u32 s13, s92, 0xc800
    ds_read_b64_tr_b16 a[4:5], v13 offset:51200
    v_mfma_f32_16x16x32_bf16 v[92:95], a[44:47], a[156:159], v[92:95]
    buffer_load_dwordx4 a[232:235], v18, s[56:59], s13 offen sc1
    v_mfma_f32_16x16x32_bf16 v[76:79], a[48:51], a[144:147], v[76:79]
    ds_read_b64_tr_b16 a[6:7], v13 offset:56320
    ds_read_b64_tr_b16 a[8:9], v13 offset:40968
    v_mfma_f32_16x16x32_bf16 v[76:79], a[52:55], a[152:155], v[76:79]
    ds_read_b64_tr_b16 a[10:11], v13 offset:46088
    v_mfma_f32_16x16x32_bf16 v[96:99], a[48:51], a[148:151], v[96:99]
    ds_read_b64_tr_b16 a[12:13], v13 offset:51208
    v_mfma_f32_16x16x32_bf16 v[96:99], a[52:55], a[156:159], v[96:99]
    ds_read_b64_tr_b16 a[14:15], v13 offset:56328
    v_mfma_f32_16x16x32_bf16 v[80:83], a[56:59], a[144:147], v[80:83]
    buffer_load_dwordx4 a[236:239], v19, s[56:59], s13 offen sc1
    v_mfma_f32_16x16x32_bf16 v[80:83], a[60:63], a[152:155], v[80:83]
    ds_read_b64_tr_b16 a[16:17], v13 offset:40976
    ds_read_b64_tr_b16 a[18:19], v13 offset:46096
    v_mfma_f32_16x16x32_bf16 v[100:103], a[56:59], a[148:151], v[100:103]
    ds_read_b64_tr_b16 a[20:21], v13 offset:51216
    v_mfma_f32_16x16x32_bf16 v[100:103], a[60:63], a[156:159], v[100:103]
    ds_read_b64_tr_b16 a[22:23], v13 offset:56336
    s_waitcnt lgkmcnt(9)
    v_mfma_f32_16x16x32_bf16 v[84:87], a[64:67], a[144:147], v[84:87]
    s_add_u32 s13, s92, 0xd000
    ds_read_b64_tr_b16 a[24:25], v13 offset:40984
    v_mfma_f32_16x16x32_bf16 v[84:87], a[68:71], a[152:155], v[84:87]
    buffer_load_dwordx4 a[240:243], v18, s[56:59], s13 offen sc1
    v_mfma_f32_16x16x32_bf16 v[104:107], a[64:67], a[148:151], v[104:107]
    ds_read_b64_tr_b16 a[26:27], v13 offset:46104
    ds_read_b64_tr_b16 a[28:29], v13 offset:51224
    v_mfma_f32_16x16x32_bf16 v[104:107], a[68:71], a[156:159], v[104:107]
    ds_read_b64_tr_b16 a[30:31], v13 offset:56344
    v_mfma_f32_16x16x32_bf16 v[88:91], a[72:75], a[144:147], v[88:91]
    ds_read_b64_tr_b16 a[32:33], v13 offset:40992
    v_mfma_f32_16x16x32_bf16 v[88:91], a[76:79], a[152:155], v[88:91]
    ds_read_b64_tr_b16 a[34:35], v13 offset:46112
    v_mfma_f32_16x16x32_bf16 v[108:111], a[72:75], a[148:151], v[108:111]
    buffer_load_dwordx4 a[244:247], v19, s[56:59], s13 offen sc1
    v_mfma_f32_16x16x32_bf16 v[108:111], a[76:79], a[156:159], v[108:111]
    ds_read_b64_tr_b16 a[36:37], v13 offset:51232
    ds_read_b64_tr_b16 a[38:39], v13 offset:56352
    v_mfma_f32_16x16x32_bf16 v[32:35], a[0:3], a[160:163], v[32:35]
    ds_read_b64_tr_b16 a[40:41], v14 offset:40960
    s_waitcnt lgkmcnt(9)
    v_mfma_f32_16x16x32_bf16 v[32:35], a[4:7], a[168:171], v[32:35]
    ds_read_b64_tr_b16 a[42:43], v14 offset:46080
    v_mfma_f32_16x16x32_bf16 v[52:55], a[0:3], a[164:167], v[52:55]
    s_mov_b32 s10, 0x118000
    s_add_u32 m0, s95, 0xf000
    ds_read_b64_tr_b16 a[44:45], v14 offset:51200
    v_mfma_f32_16x16x32_bf16 v[52:55], a[4:7], a[172:175], v[52:55]
    buffer_load_dwordx4 v8, s[44:47], s10 offen offset:0 lds
    v_mfma_f32_16x16x32_bf16 v[36:39], a[8:11], a[160:163], v[36:39]
    ds_read_b64_tr_b16 a[46:47], v14 offset:56320
    ds_read_b64_tr_b16 a[48:49], v14 offset:40968
    v_mfma_f32_16x16x32_bf16 v[36:39], a[12:15], a[168:171], v[36:39]
    ds_read_b64_tr_b16 a[50:51], v14 offset:46088
    v_mfma_f32_16x16x32_bf16 v[56:59], a[8:11], a[164:167], v[56:59]
    ds_read_b64_tr_b16 a[52:53], v14 offset:51208
    v_mfma_f32_16x16x32_bf16 v[56:59], a[12:15], a[172:175], v[56:59]
    ds_read_b64_tr_b16 a[54:55], v14 offset:56328
    v_mfma_f32_16x16x32_bf16 v[40:43], a[16:19], a[160:163], v[40:43]
    buffer_load_dwordx4 v9, s[44:47], s10 offen offset:1024 lds
    v_mfma_f32_16x16x32_bf16 v[40:43], a[20:23], a[168:171], v[40:43]
    ds_read_b64_tr_b16 a[56:57], v14 offset:40976
    ds_read_b64_tr_b16 a[58:59], v14 offset:46096
    v_mfma_f32_16x16x32_bf16 v[60:63], a[16:19], a[164:167], v[60:63]
    s_barrier
    ds_read_b64_tr_b16 a[60:61], v14 offset:51216
    v_mfma_f32_16x16x32_bf16 v[60:63], a[20:23], a[172:175], v[60:63]
    ds_read_b64_tr_b16 a[62:63], v14 offset:56336
    s_waitcnt lgkmcnt(9)
    v_mfma_f32_16x16x32_bf16 v[44:47], a[24:27], a[160:163], v[44:47]
    ds_read_b64_tr_b16 a[64:65], v14 offset:40984
    v_mfma_f32_16x16x32_bf16 v[44:47], a[28:31], a[168:171], v[44:47]
    buffer_load_dwordx4 v10, s[44:47], s10 offen offset:2048 lds
    v_mfma_f32_16x16x32_bf16 v[64:67], a[24:27], a[164:167], v[64:67]
    ds_read_b64_tr_b16 a[66:67], v14 offset:46104
    ds_read_b64_tr_b16 a[68:69], v14 offset:51224
    v_mfma_f32_16x16x32_bf16 v[64:67], a[28:31], a[172:175], v[64:67]
    ds_read_b64_tr_b16 a[70:71], v14 offset:56344
    v_mfma_f32_16x16x32_bf16 v[48:51], a[32:35], a[160:163], v[48:51]
    ds_read_b64_tr_b16 a[72:73], v14 offset:40992
    v_mfma_f32_16x16x32_bf16 v[48:51], a[36:39], a[168:171], v[48:51]
    ds_read_b64_tr_b16 a[74:75], v14 offset:46112
    v_mfma_f32_16x16x32_bf16 v[68:71], a[32:35], a[164:167], v[68:71]
    buffer_load_dwordx4 v11, s[44:47], s10 offen offset:3072 lds
    v_mfma_f32_16x16x32_bf16 v[68:71], a[36:39], a[172:175], v[68:71]
    ds_read_b64_tr_b16 a[76:77], v14 offset:51232
    ds_read_b64_tr_b16 a[78:79], v14 offset:56352
    v_mfma_f32_16x16x32_bf16 v[72:75], a[40:43], a[160:163], v[72:75]
    ds_read_b64_tr_b16 a[0:1], v13 offset:20480
    s_waitcnt lgkmcnt(9)
    v_mfma_f32_16x16x32_bf16 v[72:75], a[44:47], a[168:171], v[72:75]
    ds_read_b64_tr_b16 a[2:3], v13 offset:25600
    v_mfma_f32_16x16x32_bf16 v[92:95], a[40:43], a[164:167], v[92:95]
    s_add_u32 m0, s95, 0x10000
    ds_read_b64_tr_b16 a[4:5], v13 offset:30720
    v_mfma_f32_16x16x32_bf16 v[92:95], a[44:47], a[172:175], v[92:95]
    buffer_load_dwordx4 v12, s[44:47], s10 offen offset:0 lds
    v_mfma_f32_16x16x32_bf16 v[76:79], a[48:51], a[160:163], v[76:79]
    ds_read_b64_tr_b16 a[6:7], v13 offset:35840
    ds_read_b64_tr_b16 a[8:9], v13 offset:20488
    v_mfma_f32_16x16x32_bf16 v[76:79], a[52:55], a[168:171], v[76:79]
    ds_read_b64_tr_b16 a[10:11], v13 offset:25608
    v_mfma_f32_16x16x32_bf16 v[96:99], a[48:51], a[164:167], v[96:99]
    ds_read_b64_tr_b16 a[12:13], v13 offset:30728
    v_mfma_f32_16x16x32_bf16 v[96:99], a[52:55], a[172:175], v[96:99]
    s_add_u32 s13, s92, 0xd800
    ds_read_b64_tr_b16 a[14:15], v13 offset:35848
    v_mfma_f32_16x16x32_bf16 v[80:83], a[56:59], a[160:163], v[80:83]
    buffer_load_dwordx4 a[248:251], v18, s[56:59], s13 offen sc1
    v_mfma_f32_16x16x32_bf16 v[80:83], a[60:63], a[168:171], v[80:83]
    ds_read_b64_tr_b16 a[16:17], v13 offset:20496
    ds_read_b64_tr_b16 a[18:19], v13 offset:25616
    v_mfma_f32_16x16x32_bf16 v[100:103], a[56:59], a[164:167], v[100:103]
    ds_read_b64_tr_b16 a[20:21], v13 offset:30736
    v_mfma_f32_16x16x32_bf16 v[100:103], a[60:63], a[172:175], v[100:103]
    ds_read_b64_tr_b16 a[22:23], v13 offset:35856
    s_waitcnt lgkmcnt(15)
    v_mfma_f32_16x16x32_bf16 v[84:87], a[64:67], a[160:163], v[84:87]
    ds_read_b64_tr_b16 a[24:25], v13 offset:20504
    v_mfma_f32_16x16x32_bf16 v[84:87], a[68:71], a[168:171], v[84:87]
    buffer_load_dwordx4 a[252:255], v19, s[56:59], s13 offen sc1
    v_mfma_f32_16x16x32_bf16 v[104:107], a[64:67], a[164:167], v[104:107]
    s_cmp_ge_u32 s5, 28
    s_cbranch_scc1 fk_p7
    s_waitcnt vmcnt(11)
    s_mov_b64 exec, 1
    buffer_store_dword v3, off, s[68:71], s9 sc1
    s_mov_b64 exec, -1
fk_p7:
    v_mfma_f32_16x16x32_bf16 v[104:107], a[68:71], a[172:175], v[104:107]
    ds_read_b64_tr_b16 a[26:27], v13 offset:25624
    s_waitcnt lgkmcnt(6)
    v_mfma_f32_16x16x32_bf16 v[88:91], a[72:75], a[160:163], v[88:91]
    ds_read_b64_tr_b16 a[28:29], v13 offset:30744
    v_mfma_f32_16x16x32_bf16 v[88:91], a[76:79], a[168:171], v[88:91]
    s_add_u32 s13, s92, 0xe000
    ds_read_b64_tr_b16 a[30:31], v13 offset:35864
    v_mfma_f32_16x16x32_bf16 v[108:111], a[72:75], a[164:167], v[108:111]
    buffer_load_dwordx4 a[128:131], v18, s[56:59], s13 offen sc1
    v_mfma_f32_16x16x32_bf16 v[108:111], a[76:79], a[172:175], v[108:111]
    ds_read_b64_tr_b16 a[32:33], v13 offset:20512
    ds_read_b64_tr_b16 a[34:35], v13 offset:25632
    v_mfma_f32_16x16x32_bf16 v[32:35], a[0:3], a[176:179], v[32:35]
    ds_read_b64_tr_b16 a[36:37], v13 offset:30752
    s_waitcnt vmcnt(42)
    v_mfma_f32_16x16x32_bf16 v[32:35], a[4:7], a[184:187], v[32:35]
    ds_read_b64_tr_b16 a[38:39], v13 offset:35872
    v_mfma_f32_16x16x32_bf16 v[52:55], a[0:3], a[180:183], v[52:55]
    ds_read_b64_tr_b16 a[40:41], v14 offset:20480
    s_waitcnt vmcnt(41)
    v_mfma_f32_16x16x32_bf16 v[52:55], a[4:7], a[188:191], v[52:55]
    buffer_load_dwordx4 a[132:135], v19, s[56:59], s13 offen sc1
    v_mfma_f32_16x16x32_bf16 v[36:39], a[8:11], a[176:179], v[36:39]
    ds_read_b64_tr_b16 a[42:43], v14 offset:25600
    ds_read_b64_tr_b16 a[44:45], v14 offset:30720
    v_mfma_f32_16x16x32_bf16 v[36:39], a[12:15], a[184:187], v[36:39]
    ds_read_b64_tr_b16 a[46:47], v14 offset:35840
    v_mfma_f32_16x16x32_bf16 v[56:59], a[8:11], a[180:183], v[56:59]
    s_waitcnt lgkmcnt(12)
    ds_read_b64_tr_b16 a[48:49], v14 offset:20488
    v_mfma_f32_16x16x32_bf16 v[56:59], a[12:15], a[188:191], v[56:59]
    s_mov_b32 s10, 0x12c000
    s_add_u32 m0, s95, 0x14000
    ds_read_b64_tr_b16 a[50:51], v14 offset:25608
    v_mfma_f32_16x16x32_bf16 v[40:43], a[16:19], a[176:179], v[40:43]
    buffer_load_dwordx4 v8, s[44:47], s10 offen offset:0 lds
    v_mfma_f32_16x16x32_bf16 v[40:43], a[20:23], a[184:187], v[40:43]
    ds_read_b64_tr_b16 a[52:53], v14 offset:30728
    ds_read_b64_tr_b16 a[54:55], v14 offset:35848
    v_mfma_f32_16x16x32_bf16 v[60:63], a[16:19], a[180:183], v[60:63]
    s_barrier
    ds_read_b64_tr_b16 a[56:57], v14 offset:20496
    v_mfma_f32_16x16x32_bf16 v[60:63], a[20:23], a[188:191], v[60:63]
    ds_read_b64_tr_b16 a[58:59], v14 offset:25616
    s_waitcnt lgkmcnt(9)
    v_mfma_f32_16x16x32_bf16 v[44:47], a[24:27], a[176:179], v[44:47]
    ds_read_b64_tr_b16 a[60:61], v14 offset:30736
    v_mfma_f32_16x16x32_bf16 v[44:47], a[28:31], a[184:187], v[44:47]
    buffer_load_dwordx4 v9, s[44:47], s10 offen offset:1024 lds
    v_mfma_f32_16x16x32_bf16 v[64:67], a[24:27], a[180:183], v[64:67]
    ds_read_b64_tr_b16 a[62:63], v14 offset:35856
    ds_read_b64_tr_b16 a[64:65], v14 offset:20504
    v_mfma_f32_16x16x32_bf16 v[64:67], a[28:31], a[188:191], v[64:67]
    ds_read_b64_tr_b16 a[66:67], v14 offset:25624
    v_mfma_f32_16x16x32_bf16 v[48:51], a[32:35], a[176:179], v[48:51]
    ds_read_b64_tr_b16 a[68:69], v14 offset:30744
    v_mfma_f32_16x16x32_bf16 v[48:51], a[36:39], a[184:187], v[48:51]
    ds_read_b64_tr_b16 a[70:71], v14 offset:35864
    v_mfma_f32_16x16x32_bf16 v[68:71], a[32:35], a[180:183], v[68:71]
    buffer_load_dwordx4 v10, s[44:47], s10 offen offset:2048 lds
    v_mfma_f32_16x16x32_bf16 v[68:71], a[36:39], a[188:191], v[68:71]
    s_waitcnt lgkmcnt(6)
    ds_read_b64_tr_b16 a[72:73], v14 offset:20512
    ds_read_b64_tr_b16 a[74:75], v14 offset:25632
    v_mfma_f32_16x16x32_bf16 v[72:75], a[40:43], a[176:179], v[72:75]
    ds_read_b64_tr_b16 a[76:77], v14 offset:30752
    v_mfma_f32_16x16x32_bf16 v[72:75], a[44:47], a[184:187], v[72:75]
    ds_read_b64_tr_b16 a[78:79], v14 offset:35872
    v_mfma_f32_16x16x32_bf16 v[92:95], a[40:43], a[180:183], v[92:95]
    ds_read_b64_tr_b16 a[0:1], v13 offset:0
    v_mfma_f32_16x16x32_bf16 v[92:95], a[44:47], a[188:191], v[92:95]
    buffer_load_dwordx4 v11, s[44:47], s10 offen offset:3072 lds
    v_mfma_f32_16x16x32_bf16 v[76:79], a[48:51], a[176:179], v[76:79]
    ds_read_b64_tr_b16 a[2:3], v13 offset:5120
    ds_read_b64_tr_b16 a[4:5], v13 offset:10240
    v_mfma_f32_16x16x32_bf16 v[76:79], a[52:55], a[184:187], v[76:79]
    ds_read_b64_tr_b16 a[6:7], v13 offset:15360
    v_mfma_f32_16x16x32_bf16 v[96:99], a[48:51], a[180:183], v[96:99]
    ds_read_b64_tr_b16 a[8:9], v13 offset:8
    v_mfma_f32_16x16x32_bf16 v[96:99], a[52:55], a[188:191], v[96:99]
    s_add_u32 m0, s95, 0x15000
    ds_read_b64_tr_b16 a[10:11], v13 offset:5128
    v_mfma_f32_16x16x32_bf16 v[80:83], a[56:59], a[176:179], v[80:83]
    s_waitcnt lgkmcnt(7)
    buffer_load_dwordx4 v12, s[44:47], s10 offen offset:0 lds
    v_mfma_f32_16x16x32_bf16 v[80:83], a[60:63], a[184:187], v[80:83]
    ds_read_b64_tr_b16 a[12:13], v13 offset:10248
    ds_read_b64_tr_b16 a[14:15], v13 offset:15368
    v_mfma_f32_16x16x32_bf16 v[100:103], a[56:59], a[180:183], v[100:103]
    ds_read_b64_tr_b16 a[16:17], v13 offset:16
    v_mfma_f32_16x16x32_bf16 v[100:103], a[60:63], a[188:191], v[100:103]
    ds_read_b64_tr_b16 a[18:19], v13 offset:5136
    v_mfma_f32_16x16x32_bf16 v[84:87], a[64:67], a[176:179], v[84:87]
    s_add_u32 s13, s92, 0xe800
    ds_read_b64_tr_b16 a[20:21], v13 offset:10256
    v_mfma_f32_16x16x32_bf16 v[84:87], a[68:71], a[184:187], v[84:87]
    buffer_load_dwordx4 a[136:139], v18, s[56:59], s13 offen sc1
    v_mfma_f32_16x16x32_bf16 v[104:107], a[64:67], a[180:183], v[104:107]
    ds_read_b64_tr_b16 a[22:23], v13 offset:15376
    ds_read_b64_tr_b16 a[24:25], v13 offset:24
    v_mfma_f32_16x16x32_bf16 v[104:107], a[68:71], a[188:191], v[104:107]
    ds_read_b64_tr_b16 a[26:27], v13 offset:5144
    v_mfma_f32_16x16x32_bf16 v[88:91], a[72:75], a[176:179], v[88:91]
    ds_read_b64_tr_b16 a[28:29], v13 offset:10264
    s_waitcnt lgkmcnt(9)
    v_mfma_f32_16x16x32_bf16 v[88:91], a[76:79], a[184:187], v[88:91]
    ds_read_b64_tr_b16 a[30:31], v13 offset:15384
    v_mfma_f32_16x16x32_bf16 v[108:111], a[72:75], a[180:183], v[108:111]
    buffer_load_dwordx4 a[140:143], v19, s[56:59], s13 offen sc1
    v_mfma_f32_16x16x32_bf16 v[108:111], a[76:79], a[188:191], v[108:111]
    ds_read_b64_tr_b16 a[32:33], v13 offset:32
    ds_read_b64_tr_b16 a[34:35], v13 offset:5152
    s_waitcnt vmcnt(48)
    v_mfma_f32_16x16x32_bf16 v[32:35], a[0:3], a[192:195], v[32:35]
    buffer_load_dword v26, v2, s[28:31], 0 offen sc1
    s_waitcnt vmcnt(42)
    v_mfma_f32_16x16x32_bf16 v[32:35], a[4:7], a[200:203], v[32:35]
    ds_read_b64_tr_b16 a[36:37], v13 offset:10272
    ds_read_b64_tr_b16 a[38:39], v13 offset:15392
    v_mfma_f32_16x16x32_bf16 v[52:55], a[0:3], a[196:199], v[52:55]
    s_add_u32 s13, s92, 0xf000
    ds_read_b64_tr_b16 a[40:41], v14 offset:0
    s_waitcnt vmcnt(41)
    v_mfma_f32_16x16x32_bf16 v[52:55], a[4:7], a[204:207], v[52:55]
    buffer_load_dwordx4 a[144:147], v18, s[56:59], s13 offen sc1
    v_mfma_f32_16x16x32_bf16 v[36:39], a[8:11], a[192:195], v[36:39]
    s_waitcnt lgkmcnt(9)
    ds_read_b64_tr_b16 a[42:43], v14 offset:5120
    ds_read_b64_tr_b16 a[44:45], v14 offset:10240
    v_mfma_f32_16x16x32_bf16 v[36:39], a[12:15], a[200:203], v[36:39]
    ds_read_b64_tr_b16 a[46:47], v14 offset:15360
    v_mfma_f32_16x16x32_bf16 v[56:59], a[8:11], a[196:199], v[56:59]
    ds_read_b64_tr_b16 a[48:49], v14 offset:8
    v_mfma_f32_16x16x32_bf16 v[56:59], a[12:15], a[204:207], v[56:59]
    ds_read_b64_tr_b16 a[50:51], v14 offset:5128
    v_mfma_f32_16x16x32_bf16 v[40:43], a[16:19], a[192:195], v[40:43]
    buffer_load_dwordx4 a[148:151], v19, s[56:59], s13 offen sc1
    v_mfma_f32_16x16x32_bf16 v[40:43], a[20:23], a[200:203], v[40:43]
    ds_read_b64_tr_b16 a[52:53], v14 offset:10248
    ds_read_b64_tr_b16 a[54:55], v14 offset:15368
    v_mfma_f32_16x16x32_bf16 v[60:63], a[16:19], a[196:199], v[60:63]
    s_barrier
    ds_read_b64_tr_b16 a[56:57], v14 offset:16
    v_mfma_f32_16x16x32_bf16 v[60:63], a[20:23], a[204:207], v[60:63]
    ds_read_b64_tr_b16 a[58:59], v14 offset:5136
    s_waitcnt lgkmcnt(9)
    v_mfma_f32_16x16x32_bf16 v[44:47], a[24:27], a[192:195], v[44:47]
    s_mov_b32 s10, 0x0
    s_add_u32 m0, s95, 0x23000
    ds_read_b64_tr_b16 a[60:61], v14 offset:10256
    v_mfma_f32_16x16x32_bf16 v[44:47], a[28:31], a[200:203], v[44:47]
    buffer_load_dwordx4 v8, s[48:51], s10 offen offset:0 lds
    v_mfma_f32_16x16x32_bf16 v[64:67], a[24:27], a[196:199], v[64:67]
    ds_read_b64_tr_b16 a[62:63], v14 offset:15376
    ds_read_b64_tr_b16 a[64:65], v14 offset:24
    v_mfma_f32_16x16x32_bf16 v[64:67], a[28:31], a[204:207], v[64:67]
    ds_read_b64_tr_b16 a[66:67], v14 offset:5144
    v_mfma_f32_16x16x32_bf16 v[48:51], a[32:35], a[192:195], v[48:51]
    ds_read_b64_tr_b16 a[68:69], v14 offset:10264
    v_mfma_f32_16x16x32_bf16 v[48:51], a[36:39], a[200:203], v[48:51]
    ds_read_b64_tr_b16 a[70:71], v14 offset:15384
    v_mfma_f32_16x16x32_bf16 v[68:71], a[32:35], a[196:199], v[68:71]
    buffer_load_dwordx4 v9, s[48:51], s10 offen offset:1024 lds
    v_mfma_f32_16x16x32_bf16 v[68:71], a[36:39], a[204:207], v[68:71]
    s_waitcnt lgkmcnt(6)
    ds_read_b64_tr_b16 a[72:73], v14 offset:32
    ds_read_b64_tr_b16 a[74:75], v14 offset:5152
    ds_read_b64_tr_b16 a[76:77], v14 offset:10272
    ds_read_b64_tr_b16 a[78:79], v14 offset:15392
    v_add_u32 v13, 0xfffe7000, v13
    v_add_u32 v14, 0xfffe7000, v14
    v_mfma_f32_16x16x32_bf16 v[72:75], a[40:43], a[192:195], v[72:75]
    ds_read_b64_tr_b16 a[0:1], v13 offset:0
    v_mfma_f32_16x16x32_bf16 v[72:75], a[44:47], a[200:203], v[72:75]
    ds_read_b64_tr_b16 a[2:3], v13 offset:5120
    v_mfma_f32_16x16x32_bf16 v[92:95], a[40:43], a[196:199], v[92:95]
    ds_read_b64_tr_b16 a[4:5], v13 offset:10240
    v_mfma_f32_16x16x32_bf16 v[92:95], a[44:47], a[204:207], v[92:95]
    buffer_load_dwordx4 v10, s[48:51], s10 offen offset:2048 lds
    v_mfma_f32_16x16x32_bf16 v[76:79], a[48:51], a[192:195], v[76:79]
    ds_read_b64_tr_b16 a[6:7], v13 offset:15360
    ds_read_b64_tr_b16 a[8:9], v13 offset:8
    v_mfma_f32_16x16x32_bf16 v[76:79], a[52:55], a[200:203], v[76:79]
    ds_read_b64_tr_b16 a[10:11], v13 offset:5128
    v_mfma_f32_16x16x32_bf16 v[96:99], a[48:51], a[196:199], v[96:99]
    ds_read_b64_tr_b16 a[12:13], v13 offset:10248
    v_mfma_f32_16x16x32_bf16 v[96:99], a[52:55], a[204:207], v[96:99]
    ds_read_b64_tr_b16 a[14:15], v13 offset:15368
    v_mfma_f32_16x16x32_bf16 v[80:83], a[56:59], a[192:195], v[80:83]
    s_waitcnt lgkmcnt(8)
    buffer_load_dwordx4 v11, s[48:51], s10 offen offset:3072 lds
    v_mfma_f32_16x16x32_bf16 v[80:83], a[60:63], a[200:203], v[80:83]
    ds_read_b64_tr_b16 a[16:17], v13 offset:16
    ds_read_b64_tr_b16 a[18:19], v13 offset:5136
    v_mfma_f32_16x16x32_bf16 v[100:103], a[56:59], a[196:199], v[100:103]
    ds_read_b64_tr_b16 a[20:21], v13 offset:10256
    v_mfma_f32_16x16x32_bf16 v[100:103], a[60:63], a[204:207], v[100:103]
    ds_read_b64_tr_b16 a[22:23], v13 offset:15376
    v_mfma_f32_16x16x32_bf16 v[84:87], a[64:67], a[192:195], v[84:87]
    s_add_u32 m0, s95, 0x24000
    ds_read_b64_tr_b16 a[24:25], v13 offset:24
    v_mfma_f32_16x16x32_bf16 v[84:87], a[68:71], a[200:203], v[84:87]
    buffer_load_dwordx4 v12, s[48:51], s10 offen offset:0 lds
    v_mfma_f32_16x16x32_bf16 v[104:107], a[64:67], a[196:199], v[104:107]
    buffer_load_dword v27, v28, s[68:71], s101 offen sc1
    v_mfma_f32_16x16x32_bf16 v[104:107], a[68:71], a[204:207], v[104:107]
    ds_read_b64_tr_b16 a[26:27], v13 offset:5144
    ds_read_b64_tr_b16 a[28:29], v13 offset:10264
    v_mfma_f32_16x16x32_bf16 v[88:91], a[72:75], a[192:195], v[88:91]
    ds_read_b64_tr_b16 a[30:31], v13 offset:15384
    v_mfma_f32_16x16x32_bf16 v[88:91], a[76:79], a[200:203], v[88:91]
    s_add_u32 s13, s92, 0xf800
    ds_read_b64_tr_b16 a[32:33], v13 offset:32
    v_mfma_f32_16x16x32_bf16 v[108:111], a[72:75], a[196:199], v[108:111]
    buffer_load_dwordx4 a[152:155], v18, s[56:59], s13 offen sc1
    v_mfma_f32_16x16x32_bf16 v[108:111], a[76:79], a[204:207], v[108:111]
    ds_read_b64_tr_b16 a[34:35], v13 offset:5152
    ds_read_b64_tr_b16 a[36:37], v13 offset:10272
    s_waitcnt vmcnt(49) lgkmcnt(7)
    v_mfma_f32_16x16x32_bf16 v[32:35], a[0:3], a[208:211], v[32:35]
    ds_read_b64_tr_b16 a[38:39], v13 offset:15392
    s_waitcnt vmcnt(41)
    v_mfma_f32_16x16x32_bf16 v[32:35], a[4:7], a[216:219], v[32:35]
    ds_read_b64_tr_b16 a[40:41], v14 offset:0
    v_mfma_f32_16x16x32_bf16 v[52:55], a[0:3], a[212:215], v[52:55]
    ds_read_b64_tr_b16 a[42:43], v14 offset:5120
    s_waitcnt vmcnt(40)
    v_mfma_f32_16x16x32_bf16 v[52:55], a[4:7], a[220:223], v[52:55]
    buffer_load_dwordx4 a[156:159], v19, s[56:59], s13 offen sc1
    v_mfma_f32_16x16x32_bf16 v[36:39], a[8:11], a[208:211], v[36:39]
    ds_read_b64_tr_b16 a[44:45], v14 offset:10240
    ds_read_b64_tr_b16 a[46:47], v14 offset:15360
    v_mfma_f32_16x16x32_bf16 v[36:39], a[12:15], a[216:219], v[36:39]
    ds_read_b64_tr_b16 a[48:49], v14 offset:8
    v_mfma_f32_16x16x32_bf16 v[56:59], a[8:11], a[212:215], v[56:59]
    ds_read_b64_tr_b16 a[50:51], v14 offset:5128
    v_mfma_f32_16x16x32_bf16 v[56:59], a[12:15], a[220:223], v[56:59]
    s_mov_b32 s10, 0x14000
    s_add_u32 m0, s95, 0x1e000
    ds_read_b64_tr_b16 a[52:53], v14 offset:10248
    v_mfma_f32_16x16x32_bf16 v[40:43], a[16:19], a[208:211], v[40:43]
    buffer_load_dwordx4 v8, s[48:51], s10 offen offset:0 lds
    v_mfma_f32_16x16x32_bf16 v[40:43], a[20:23], a[216:219], v[40:43]
    ds_read_b64_tr_b16 a[54:55], v14 offset:15368
    ds_read_b64_tr_b16 a[56:57], v14 offset:16
    v_mfma_f32_16x16x32_bf16 v[60:63], a[16:19], a[212:215], v[60:63]
    s_barrier
    ds_read_b64_tr_b16 a[58:59], v14 offset:5136
    v_mfma_f32_16x16x32_bf16 v[60:63], a[20:23], a[220:223], v[60:63]
    ds_read_b64_tr_b16 a[60:61], v14 offset:10256
    s_waitcnt lgkmcnt(9)
    v_mfma_f32_16x16x32_bf16 v[44:47], a[24:27], a[208:211], v[44:47]
    ds_read_b64_tr_b16 a[62:63], v14 offset:15376
    v_mfma_f32_16x16x32_bf16 v[44:47], a[28:31], a[216:219], v[44:47]
    buffer_load_dwordx4 v9, s[48:51], s10 offen offset:1024 lds
    v_mfma_f32_16x16x32_bf16 v[64:67], a[24:27], a[212:215], v[64:67]
    ds_read_b64_tr_b16 a[64:65], v14 offset:24
    ds_read_b64_tr_b16 a[66:67], v14 offset:5144
    v_mfma_f32_16x16x32_bf16 v[64:67], a[28:31], a[220:223], v[64:67]
    ds_read_b64_tr_b16 a[68:69], v14 offset:10264
    v_mfma_f32_16x16x32_bf16 v[48:51], a[32:35], a[208:211], v[48:51]
    ds_read_b64_tr_b16 a[70:71], v14 offset:15384
    v_mfma_f32_16x16x32_bf16 v[48:51], a[36:39], a[216:219], v[48:51]
    ds_read_b64_tr_b16 a[72:73], v14 offset:32
    v_mfma_f32_16x16x32_bf16 v[68:71], a[32:35], a[212:215], v[68:71]
    buffer_load_dwordx4 v10, s[48:51], s10 offen offset:2048 lds
    v_mfma_f32_16x16x32_bf16 v[68:71], a[36:39], a[220:223], v[68:71]
    ds_read_b64_tr_b16 a[74:75], v14 offset:5152
    ds_read_b64_tr_b16 a[76:77], v14 offset:10272
    v_mfma_f32_16x16x32_bf16 v[72:75], a[40:43], a[208:211], v[72:75]
    ds_read_b64_tr_b16 a[78:79], v14 offset:15392
    s_waitcnt lgkmcnt(8)
    v_mfma_f32_16x16x32_bf16 v[72:75], a[44:47], a[216:219], v[72:75]
    ds_read_b64_tr_b16 a[0:1], v13 offset:20480
    v_mfma_f32_16x16x32_bf16 v[92:95], a[40:43], a[212:215], v[92:95]
    ds_read_b64_tr_b16 a[2:3], v13 offset:25600
    v_mfma_f32_16x16x32_bf16 v[92:95], a[44:47], a[220:223], v[92:95]
    buffer_load_dwordx4 v11, s[48:51], s10 offen offset:3072 lds
    v_mfma_f32_16x16x32_bf16 v[76:79], a[48:51], a[208:211], v[76:79]
    ds_read_b64_tr_b16 a[4:5], v13 offset:30720
    ds_read_b64_tr_b16 a[6:7], v13 offset:35840
    v_mfma_f32_16x16x32_bf16 v[76:79], a[52:55], a[216:219], v[76:79]
    ds_read_b64_tr_b16 a[8:9], v13 offset:20488
    v_mfma_f32_16x16x32_bf16 v[96:99], a[48:51], a[212:215], v[96:99]
    ds_read_b64_tr_b16 a[10:11], v13 offset:25608
    v_mfma_f32_16x16x32_bf16 v[96:99], a[52:55], a[220:223], v[96:99]
    s_add_u32 m0, s95, 0x1f000
    ds_read_b64_tr_b16 a[12:13], v13 offset:30728
    v_mfma_f32_16x16x32_bf16 v[80:83], a[56:59], a[208:211], v[80:83]
    buffer_load_dwordx4 v12, s[48:51], s10 offen offset:0 lds
    v_mfma_f32_16x16x32_bf16 v[80:83], a[60:63], a[216:219], v[80:83]
    ds_read_b64_tr_b16 a[14:15], v13 offset:35848
    ds_read_b64_tr_b16 a[16:17], v13 offset:20496
    v_mfma_f32_16x16x32_bf16 v[100:103], a[56:59], a[212:215], v[100:103]
    ds_read_b64_tr_b16 a[18:19], v13 offset:25616
    v_mfma_f32_16x16x32_bf16 v[100:103], a[60:63], a[220:223], v[100:103]
    ds_read_b64_tr_b16 a[20:21], v13 offset:30736
    s_waitcnt lgkmcnt(9)
    v_mfma_f32_16x16x32_bf16 v[84:87], a[64:67], a[208:211], v[84:87]
    s_mov_b32 s10, 0x28000
    s_add_u32 m0, s95, 0x19000
    ds_read_b64_tr_b16 a[22:23], v13 offset:35856
    v_mfma_f32_16x16x32_bf16 v[84:87], a[68:71], a[216:219], v[84:87]
    buffer_load_dwordx4 v8, s[48:51], s10 offen offset:0 lds
    v_mfma_f32_16x16x32_bf16 v[104:107], a[64:67], a[212:215], v[104:107]
    ds_read_b64_tr_b16 a[24:25], v13 offset:20504
    ds_read_b64_tr_b16 a[26:27], v13 offset:25624
    v_mfma_f32_16x16x32_bf16 v[104:107], a[68:71], a[220:223], v[104:107]
    ds_read_b64_tr_b16 a[28:29], v13 offset:30744
    v_mfma_f32_16x16x32_bf16 v[88:91], a[72:75], a[208:211], v[88:91]
    ds_read_b64_tr_b16 a[30:31], v13 offset:35864
    v_mfma_f32_16x16x32_bf16 v[88:91], a[76:79], a[216:219], v[88:91]
    ds_read_b64_tr_b16 a[32:33], v13 offset:20512
    v_mfma_f32_16x16x32_bf16 v[108:111], a[72:75], a[212:215], v[108:111]
    buffer_load_dwordx4 v9, s[48:51], s10 offen offset:1024 lds
    v_mfma_f32_16x16x32_bf16 v[108:111], a[76:79], a[220:223], v[108:111]
    ds_read_b64_tr_b16 a[34:35], v13 offset:25632
    ds_read_b64_tr_b16 a[36:37], v13 offset:30752
    s_waitcnt vmcnt(46)
    v_mfma_f32_16x16x32_bf16 v[32:35], a[0:3], a[224:227], v[32:35]
    ds_read_b64_tr_b16 a[38:39], v13 offset:35872
    s_waitcnt vmcnt(37) lgkmcnt(8)
    v_mfma_f32_16x16x32_bf16 v[32:35], a[4:7], a[232:235], v[32:35]
    ds_read_b64_tr_b16 a[40:41], v14 offset:20480
    v_mfma_f32_16x16x32_bf16 v[52:55], a[0:3], a[228:231], v[52:55]
    ds_read_b64_tr_b16 a[42:43], v14 offset:25600
    s_waitcnt vmcnt(36)
    v_mfma_f32_16x16x32_bf16 v[52:55], a[4:7], a[236:239], v[52:55]
    buffer_load_dwordx4 v10, s[48:51], s10 offen offset:2048 lds
    v_mfma_f32_16x16x32_bf16 v[36:39], a[8:11], a[224:227], v[36:39]
    ds_read_b64_tr_b16 a[44:45], v14 offset:30720
    ds_read_b64_tr_b16 a[46:47], v14 offset:35840
    v_mfma_f32_16x16x32_bf16 v[36:39], a[12:15], a[232:235], v[36:39]
    ds_read_b64_tr_b16 a[48:49], v14 offset:20488
    v_mfma_f32_16x16x32_bf16 v[56:59], a[8:11], a[228:231], v[56:59]
    ds_read_b64_tr_b16 a[50:51], v14 offset:25608
    v_mfma_f32_16x16x32_bf16 v[56:59], a[12:15], a[236:239], v[56:59]
    ds_read_b64_tr_b16 a[52:53], v14 offset:30728
    v_mfma_f32_16x16x32_bf16 v[40:43], a[16:19], a[224:227], v[40:43]
    buffer_load_dwordx4 v11, s[48:51], s10 offen offset:3072 lds
    v_mfma_f32_16x16x32_bf16 v[40:43], a[20:23], a[232:235], v[40:43]
    ds_read_b64_tr_b16 a[54:55], v14 offset:35848
    ds_read_b64_tr_b16 a[56:57], v14 offset:20496
    v_mfma_f32_16x16x32_bf16 v[60:63], a[16:19], a[228:231], v[60:63]
    s_barrier
    ds_read_b64_tr_b16 a[58:59], v14 offset:25616
    v_mfma_f32_16x16x32_bf16 v[60:63], a[20:23], a[236:239], v[60:63]
    ds_read_b64_tr_b16 a[60:61], v14 offset:30736
    s_waitcnt lgkmcnt(15)
    v_mfma_f32_16x16x32_bf16 v[44:47], a[24:27], a[224:227], v[44:47]
    s_add_u32 m0, s95, 0x1a000
    ds_read_b64_tr_b16 a[62:63], v14 offset:35856
    v_mfma_f32_16x16x32_bf16 v[44:47], a[28:31], a[232:235], v[44:47]
    buffer_load_dwordx4 v12, s[48:51], s10 offen offset:0 lds
    v_mfma_f32_16x16x32_bf16 v[64:67], a[24:27], a[228:231], v[64:67]
    s_waitcnt vmcnt(12)
    v_cmp_eq_u32 vcc, 1, v27
    s_nop 0
    s_bfe_u32 s11, vcc_lo, 0x70000
    s_cmp_ge_u32 s11, 127
    s_cbranch_scc0 fk_w8_slow
fk_w8_ok:
    v_mfma_f32_16x16x32_bf16 v[64:67], a[28:31], a[236:239], v[64:67]
    ds_read_b64_tr_b16 a[64:65], v14 offset:20504
    s_waitcnt lgkmcnt(6)
    v_mfma_f32_16x16x32_bf16 v[48:51], a[32:35], a[224:227], v[48:51]
    ds_read_b64_tr_b16 a[66:67], v14 offset:25624
    v_mfma_f32_16x16x32_bf16 v[48:51], a[36:39], a[232:235], v[48:51]
    s_add_u32 s13, s97, 0x0
    ds_read_b64_tr_b16 a[68:69], v14 offset:30744
    v_mfma_f32_16x16x32_bf16 v[68:71], a[32:35], a[228:231], v[68:71]
    buffer_load_dwordx4 a[160:163], v18, s[56:59], s13 offen sc1
    v_mfma_f32_16x16x32_bf16 v[68:71], a[36:39], a[236:239], v[68:71]
    ds_read_b64_tr_b16 a[70:71], v14 offset:35864
    ds_read_b64_tr_b16 a[72:73], v14 offset:20512
    v_mfma_f32_16x16x32_bf16 v[72:75], a[40:43], a[224:227], v[72:75]
    ds_read_b64_tr_b16 a[74:75], v14 offset:25632
    v_mfma_f32_16x16x32_bf16 v[72:75], a[44:47], a[232:235], v[72:75]
    ds_read_b64_tr_b16 a[76:77], v14 offset:30752
    v_mfma_f32_16x16x32_bf16 v[92:95], a[40:43], a[228:231], v[92:95]
    ds_read_b64_tr_b16 a[78:79], v14 offset:35872
    v_mfma_f32_16x16x32_bf16 v[92:95], a[44:47], a[236:239], v[92:95]
    buffer_load_dwordx4 a[164:167], v19, s[56:59], s13 offen sc1
    v_mfma_f32_16x16x32_bf16 v[76:79], a[48:51], a[224:227], v[76:79]
    s_waitcnt lgkmcnt(6)
    ds_read_b64_tr_b16 a[0:1], v13 offset:40960
    ds_read_b64_tr_b16 a[2:3], v13 offset:46080
    v_mfma_f32_16x16x32_bf16 v[76:79], a[52:55], a[232:235], v[76:79]
    ds_read_b64_tr_b16 a[4:5], v13 offset:51200
    v_mfma_f32_16x16x32_bf16 v[96:99], a[48:51], a[228:231], v[96:99]
    ds_read_b64_tr_b16 a[6:7], v13 offset:56320
    v_mfma_f32_16x16x32_bf16 v[96:99], a[52:55], a[236:239], v[96:99]
    s_add_u32 s13, s97, 0x800
    ds_read_b64_tr_b16 a[8:9], v13 offset:40968
    v_mfma_f32_16x16x32_bf16 v[80:83], a[56:59], a[224:227], v[80:83]
    buffer_load_dwordx4 a[168:171], v18, s[56:59], s13 offen sc1
    v_mfma_f32_16x16x32_bf16 v[80:83], a[60:63], a[232:235], v[80:83]
    ds_read_b64_tr_b16 a[10:11], v13 offset:46088
    ds_read_b64_tr_b16 a[12:13], v13 offset:51208
    v_mfma_f32_16x16x32_bf16 v[100:103], a[56:59], a[228:231], v[100:103]
    ds_read_b64_tr_b16 a[14:15], v13 offset:56328
    v_mfma_f32_16x16x32_bf16 v[100:103], a[60:63], a[236:239], v[100:103]
    ds_read_b64_tr_b16 a[16:17], v13 offset:40976
    v_mfma_f32_16x16x32_bf16 v[84:87], a[64:67], a[224:227], v[84:87]
    ds_read_b64_tr_b16 a[18:19], v13 offset:46096
    s_waitcnt lgkmcnt(8)
    v_mfma_f32_16x16x32_bf16 v[84:87], a[68:71], a[232:235], v[84:87]
    buffer_load_dwordx4 a[172:175], v19, s[56:59], s13 offen sc1
    v_mfma_f32_16x16x32_bf16 v[104:107], a[64:67], a[228:231], v[104:107]
    ds_read_b64_tr_b16 a[20:21], v13 offset:51216
    ds_read_b64_tr_b16 a[22:23], v13 offset:56336
    v_mfma_f32_16x16x32_bf16 v[104:107], a[68:71], a[236:239], v[104:107]
    ds_read_b64_tr_b16 a[24:25], v13 offset:40984
    v_mfma_f32_16x16x32_bf16 v[88:91], a[72:75], a[224:227], v[88:91]
    s_mov_b32 s10, 0x3c000
    ds_read_b64_tr_b16 a[26:27], v13 offset:46104
    v_mfma_f32_16x16x32_bf16 v[88:91], a[76:79], a[232:235], v[88:91]
    s_cmp_ge_u32 s3, 2
    s_cselect_b32 s10, 0x7f000000, s10
    s_add_u32 m0, s95, 0x0
    v_mfma_f32_16x16x32_bf16 v[108:111], a[72:75], a[228:231], v[108:111]
    buffer_load_dwordx4 v8, s[48:51], s10 offen offset:0 lds
    v_mfma_f32_16x16x32_bf16 v[108:111], a[76:79], a[236:239], v[108:111]
    ds_read_b64_tr_b16 a[28:29], v13 offset:51224
    ds_read_b64_tr_b16 a[30:31], v13 offset:56344
    v_mfma_f32_16x16x32_bf16 v[32:35], a[0:3], a[240:243], v[32:35]
    s_waitcnt lgkmcnt(6)
    ds_read_b64_tr_b16 a[32:33], v13 offset:40992
    v_lshlrev_b32 v224, 3, v1
    v_mfma_f32_16x16x32_bf16 v[32:35], a[4:7], a[248:251], v[32:35]
    ds_read_b64_tr_b16 a[34:35], v13 offset:46112
    v_mfma_f32_16x16x32_bf16 v[52:55], a[0:3], a[244:247], v[52:55]
    ds_read_b64_tr_b16 a[36:37], v13 offset:51232
    v_mfma_f32_16x16x32_bf16 v[52:55], a[4:7], a[252:255], v[52:55]
    buffer_load_dwordx4 v9, s[48:51], s10 offen offset:1024 lds
    v_mfma_f32_16x16x32_bf16 v[36:39], a[8:11], a[240:243], v[36:39]
    ds_read_b64_tr_b16 a[38:39], v13 offset:56352
    ds_read_b64_tr_b16 a[40:41], v14 offset:40960
    v_mfma_f32_16x16x32_bf16 v[36:39], a[12:15], a[248:251], v[36:39]
    ds_read_b64_tr_b16 a[42:43], v14 offset:46080
    v_mfma_f32_16x16x32_bf16 v[56:59], a[8:11], a[244:247], v[56:59]
    ds_read_b64_tr_b16 a[44:45], v14 offset:51200
    v_mfma_f32_16x16x32_bf16 v[56:59], a[12:15], a[252:255], v[56:59]
    ds_read_b64_tr_b16 a[46:47], v14 offset:56320
    v_mfma_f32_16x16x32_bf16 v[40:43], a[16:19], a[240:243], v[40:43]
    s_waitcnt lgkmcnt(12)
    buffer_load_dwordx4 v10, s[48:51], s10 offen offset:2048 lds
    v_mfma_f32_16x16x32_bf16 v[40:43], a[20:23], a[248:251], v[40:43]
    ds_read_b64_tr_b16 a[48:49], v14 offset:40968
    ds_read_b64_tr_b16 a[50:51], v14 offset:46088
    v_mfma_f32_16x16x32_bf16 v[60:63], a[16:19], a[244:247], v[60:63]
    s_barrier
    ds_read_b64_tr_b16 a[52:53], v14 offset:51208
    v_mfma_f32_16x16x32_bf16 v[60:63], a[20:23], a[252:255], v[60:63]
    ds_read_b64_tr_b16 a[54:55], v14 offset:56328
    s_waitcnt lgkmcnt(9)
    v_mfma_f32_16x16x32_bf16 v[44:47], a[24:27], a[240:243], v[44:47]
    ds_read_b64_tr_b16 a[56:57], v14 offset:40976
    v_mfma_f32_16x16x32_bf16 v[44:47], a[28:31], a[248:251], v[44:47]
    buffer_load_dwordx4 v11, s[48:51], s10 offen offset:3072 lds
    v_mfma_f32_16x16x32_bf16 v[64:67], a[24:27], a[244:247], v[64:67]
    ds_read_b64_tr_b16 a[58:59], v14 offset:46096
    ds_read_b64_tr_b16 a[60:61], v14 offset:51216
    v_mfma_f32_16x16x32_bf16 v[64:67], a[28:31], a[252:255], v[64:67]
    ds_read_b64_tr_b16 a[62:63], v14 offset:56336
    v_mfma_f32_16x16x32_bf16 v[48:51], a[32:35], a[240:243], v[48:51]
    ds_read_b64_tr_b16 a[64:65], v14 offset:40984
    s_waitcnt lgkmcnt(9)
    v_mfma_f32_16x16x32_bf16 v[48:51], a[36:39], a[248:251], v[48:51]
    s_add_u32 m0, s95, 0x1000
    ds_read_b64_tr_b16 a[66:67], v14 offset:46104
    v_mfma_f32_16x16x32_bf16 v[68:71], a[32:35], a[244:247], v[68:71]
    buffer_load_dwordx4 v12, s[48:51], s10 offen offset:0 lds
    v_mfma_f32_16x16x32_bf16 v[68:71], a[36:39], a[252:255], v[68:71]
    ds_read_b64_tr_b16 a[68:69], v14 offset:51224
    ds_read_b64_tr_b16 a[70:71], v14 offset:56344
    ds_read_b64_tr_b16 a[72:73], v14 offset:40992
    ds_read_b64_tr_b16 a[74:75], v14 offset:46112
    ds_read_b64_tr_b16 a[76:77], v14 offset:51232
    ds_read_b64_tr_b16 a[78:79], v14 offset:56352
    v_add_u32 v13, 0xf000, v13
    v_add_u32 v14, 0xf000, v14
    v_mfma_f32_16x16x32_bf16 v[72:75], a[40:43], a[240:243], v[72:75]
    ds_read_b64_tr_b16 a[0:1], v13 offset:0
    v_mfma_f32_16x16x32_bf16 v[72:75], a[44:47], a[248:251], v[72:75]
    ds_read_b64_tr_b16 a[2:3], v13 offset:5120
    v_mfma_f32_16x16x32_bf16 v[92:95], a[40:43], a[244:247], v[92:95]
    s_add_u32 s13, s97, 0x1000
    ds_read_b64_tr_b16 a[4:5], v13 offset:10240
    v_mfma_f32_16x16x32_bf16 v[92:95], a[44:47], a[252:255], v[92:95]
    s_waitcnt lgkmcnt(11)
    buffer_load_dwordx4 a[176:179], v18, s[56:59], s13 offen sc1
    v_mfma_f32_16x16x32_bf16 v[76:79], a[48:51], a[240:243], v[76:79]
    ds_read_b64_tr_b16 a[6:7], v13 offset:15360
    ds_read_b64_tr_b16 a[8:9], v13 offset:8
    v_mfma_f32_16x16x32_bf16 v[76:79], a[52:55], a[248:251], v[76:79]
    ds_read_b64_tr_b16 a[10:11], v13 offset:5128
    v_mfma_f32_16x16x32_bf16 v[96:99], a[48:51], a[244:247], v[96:99]
    ds_read_b64_tr_b16 a[12:13], v13 offset:10248
    v_mfma_f32_16x16x32_bf16 v[96:99], a[52:55], a[252:255], v[96:99]
    ds_read_b64_tr_b16 a[14:15], v13 offset:15368
    v_mfma_f32_16x16x32_bf16 v[80:83], a[56:59], a[240:243], v[80:83]
    buffer_load_dwordx4 a[180:183], v19, s[56:59], s13 offen sc1
    v_mfma_f32_16x16x32_bf16 v[80:83], a[60:63], a[248:251], v[80:83]
    ds_read_b64_tr_b16 a[16:17], v13 offset:16
    ds_read_b64_tr_b16 a[18:19], v13 offset:5136
    v_mfma_f32_16x16x32_bf16 v[100:103], a[56:59], a[244:247], v[100:103]
    ds_read_b64_tr_b16 a[20:21], v13 offset:10256
    v_mfma_f32_16x16x32_bf16 v[100:103], a[60:63], a[252:255], v[100:103]
    ds_read_b64_tr_b16 a[22:23], v13 offset:15376
    s_waitcnt lgkmcnt(9)
    v_mfma_f32_16x16x32_bf16 v[84:87], a[64:67], a[240:243], v[84:87]
    s_add_u32 s13, s97, 0x1800
    ds_read_b64_tr_b16 a[24:25], v13 offset:24
    v_mfma_f32_16x16x32_bf16 v[84:87], a[68:71], a[248:251], v[84:87]
    buffer_load_dwordx4 a[184:187], v18, s[56:59], s13 offen sc1
    v_mfma_f32_16x16x32_bf16 v[104:107], a[64:67], a[244:247], v[104:107]
    ds_read_b64_tr_b16 a[26:27], v13 offset:5144
    ds_read_b64_tr_b16 a[28:29], v13 offset:10264
    v_mfma_f32_16x16x32_bf16 v[104:107], a[68:71], a[252:255], v[104:107]
    ds_read_b64_tr_b16 a[30:31], v13 offset:15384
    v_mfma_f32_16x16x32_bf16 v[88:91], a[72:75], a[240:243], v[88:91]
    ds_read_b64_tr_b16 a[32:33], v13 offset:32
    v_mfma_f32_16x16x32_bf16 v[88:91], a[76:79], a[248:251], v[88:91]
    ds_read_b64_tr_b16 a[34:35], v13 offset:5152
    v_mfma_f32_16x16x32_bf16 v[108:111], a[72:75], a[244:247], v[108:111]
    buffer_load_dwordx4 a[188:191], v19, s[56:59], s13 offen sc1
    v_mfma_f32_16x16x32_bf16 v[108:111], a[76:79], a[252:255], v[108:111]
    ds_read_b64_tr_b16 a[36:37], v13 offset:10272
    ds_read_b64_tr_b16 a[38:39], v13 offset:15392
    v_mfma_f32_16x16x32_bf16 v[32:35], a[0:3], a[128:131], v[32:35]
    ds_read_b64_tr_b16 a[40:41], v14 offset:0
    s_waitcnt lgkmcnt(9)
    v_mfma_f32_16x16x32_bf16 v[32:35], a[4:7], a[136:139], v[32:35]
    ds_read_b64_tr_b16 a[42:43], v14 offset:5120
    v_mfma_f32_16x16x32_bf16 v[52:55], a[0:3], a[132:135], v[52:55]
    s_add_u32 s13, s97, 0x2000
    ds_read_b64_tr_b16 a[44:45], v14 offset:10240
    v_mfma_f32_16x16x32_bf16 v[52:55], a[4:7], a[140:143], v[52:55]
    buffer_load_dwordx4 a[192:195], v18, s[56:59], s13 offen sc1
    v_mfma_f32_16x16x32_bf16 v[36:39], a[8:11], a[128:131], v[36:39]
    ds_read_b64_tr_b16 a[46:47], v14 offset:15360
    ds_read_b64_tr_b16 a[48:49], v14 offset:8
    v_mfma_f32_16x16x32_bf16 v[36:39], a[12:15], a[136:139], v[36:39]
    ds_read_b64_tr_b16 a[50:51], v14 offset:5128
    v_mfma_f32_16x16x32_bf16 v[56:59], a[8:11], a[132:135], v[56:59]
    ds_read_b64_tr_b16 a[52:53], v14 offset:10248
    v_mfma_f32_16x16x32_bf16 v[56:59], a[12:15], a[140:143], v[56:59]
    ds_read_b64_tr_b16 a[54:55], v14 offset:15368
    v_mfma_f32_16x16x32_bf16 v[40:43], a[16:19], a[128:131], v[40:43]
    buffer_load_dwordx4 a[196:199], v19, s[56:59], s13 offen sc1
    v_mfma_f32_16x16x32_bf16 v[40:43], a[20:23], a[136:139], v[40:43]
    ds_read_b64_tr_b16 a[56:57], v14 offset:16
    ds_read_b64_tr_b16 a[58:59], v14 offset:5136
    v_mfma_f32_16x16x32_bf16 v[60:63], a[16:19], a[132:135], v[60:63]
    s_barrier
    ds_read_b64_tr_b16 a[60:61], v14 offset:10256
    v_mfma_f32_16x16x32_bf16 v[60:63], a[20:23], a[140:143], v[60:63]
    ds_read_b64_tr_b16 a[62:63], v14 offset:15376
    s_waitcnt lgkmcnt(9)
    v_mfma_f32_16x16x32_bf16 v[44:47], a[24:27], a[128:131], v[44:47]
    s_add_u32 s13, s97, 0x2800
    ds_read_b64_tr_b16 a[64:65], v14 offset:24
    v_mfma_f32_16x16x32_bf16 v[44:47], a[28:31], a[136:139], v[44:47]
    buffer_load_dwordx4 a[200:203], v18, s[56:59], s13 offen sc1
    v_mfma_f32_16x16x32_bf16 v[64:67], a[24:27], a[132:135], v[64:67]
    ds_read_b64_tr_b16 a[66:67], v14 offset:5144
    ds_read_b64_tr_b16 a[68:69], v14 offset:10264
    v_mfma_f32_16x16x32_bf16 v[64:67], a[28:31], a[140:143], v[64:67]
    ds_read_b64_tr_b16 a[70:71], v14 offset:15384
    v_mfma_f32_16x16x32_bf16 v[48:51], a[32:35], a[128:131], v[48:51]
    ds_read_b64_tr_b16 a[72:73], v14 offset:32
    v_mfma_f32_16x16x32_bf16 v[48:51], a[36:39], a[136:139], v[48:51]
    ds_read_b64_tr_b16 a[74:75], v14 offset:5152
    v_mfma_f32_16x16x32_bf16 v[68:71], a[32:35], a[132:135], v[68:71]
    buffer_load_dwordx4 a[204:207], v19, s[56:59], s13 offen sc1
    v_mfma_f32_16x16x32_bf16 v[68:71], a[36:39], a[140:143], v[68:71]
    ds_read_b64_tr_b16 a[76:77], v14 offset:10272
    ds_read_b64_tr_b16 a[78:79], v14 offset:15392
    v_mfma_f32_16x16x32_bf16 v[72:75], a[40:43], a[128:131], v[72:75]
    ds_read_b64_tr_b16 a[0:1], v13 offset:20480
    s_waitcnt lgkmcnt(9)
    v_mfma_f32_16x16x32_bf16 v[72:75], a[44:47], a[136:139], v[72:75]
    ds_read_b64_tr_b16 a[2:3], v13 offset:25600
    v_mfma_f32_16x16x32_bf16 v[92:95], a[40:43], a[132:135], v[92:95]
    s_add_u32 s13, s97, 0x3000
    s_cmp_eq_u32 s88, 3
    s_cselect_b32 s13, 0x7f000000, s13
    v_mfma_f32_16x16x32_bf16 v[92:95], a[44:47], a[140:143], v[92:95]
    buffer_load_dwordx4 a[208:211], v18, s[56:59], s13 offen sc1
    v_mfma_f32_16x16x32_bf16 v[76:79], a[48:51], a[128:131], v[76:79]
    ds_read_b64_tr_b16 a[4:5], v13 offset:30720
    ds_read_b64_tr_b16 a[6:7], v13 offset:35840
    v_mfma_f32_16x16x32_bf16 v[76:79], a[52:55], a[136:139], v[76:79]
    ds_read_b64_tr_b16 a[8:9], v13 offset:20488
    v_mfma_f32_16x16x32_bf16 v[96:99], a[48:51], a[132:135], v[96:99]
    buffer_load_dwordx4 v[192:195], v25, s[60:63], 0 offen
    v_mfma_f32_16x16x32_bf16 v[96:99], a[52:55], a[140:143], v[96:99]
    ds_read_b64_tr_b16 a[10:11], v13 offset:25608
    ds_read_b64_tr_b16 a[12:13], v13 offset:30728
    v_mfma_f32_16x16x32_bf16 v[80:83], a[56:59], a[128:131], v[80:83]
    buffer_load_dwordx4 a[212:215], v19, s[56:59], s13 offen sc1
    v_mfma_f32_16x16x32_bf16 v[80:83], a[60:63], a[136:139], v[80:83]
    ds_read_b64_tr_b16 a[14:15], v13 offset:35848
    ds_read_b64_tr_b16 a[16:17], v13 offset:20496
    v_mfma_f32_16x16x32_bf16 v[100:103], a[56:59], a[132:135], v[100:103]
    ds_read_b64_tr_b16 a[18:19], v13 offset:25616
    v_mfma_f32_16x16x32_bf16 v[100:103], a[60:63], a[140:143], v[100:103]
    ds_read_b64_tr_b16 a[20:21], v13 offset:30736
    s_waitcnt lgkmcnt(9)
    v_mfma_f32_16x16x32_bf16 v[84:87], a[64:67], a[128:131], v[84:87]
    ds_read_b64_tr_b16 a[22:23], v13 offset:35856
    v_mfma_f32_16x16x32_bf16 v[84:87], a[68:71], a[136:139], v[84:87]
    ds_read_b64_tr_b16 a[24:25], v13 offset:20504
    v_mfma_f32_16x16x32_bf16 v[104:107], a[64:67], a[132:135], v[104:107]
    ds_read_b64_tr_b16 a[26:27], v13 offset:25624
    v_mfma_f32_16x16x32_bf16 v[104:107], a[68:71], a[140:143], v[104:107]
    ds_read_b64_tr_b16 a[28:29], v13 offset:30744
    v_mfma_f32_16x16x32_bf16 v[88:91], a[72:75], a[128:131], v[88:91]
    buffer_load_dwordx4 v[196:199], v25, s[60:63], 0 offen offset:16
    v_mfma_f32_16x16x32_bf16 v[88:91], a[76:79], a[136:139], v[88:91]
    ds_read_b64_tr_b16 a[30:31], v13 offset:35864
    ds_read_b64_tr_b16 a[32:33], v13 offset:20512
    v_mfma_f32_16x16x32_bf16 v[108:111], a[72:75], a[132:135], v[108:111]
    ds_read_b64_tr_b16 a[34:35], v13 offset:25632
    v_mfma_f32_16x16x32_bf16 v[108:111], a[76:79], a[140:143], v[108:111]
    ds_read_b64_tr_b16 a[36:37], v13 offset:30752
    v_mfma_f32_16x16x32_bf16 v[32:35], a[0:3], a[144:147], v[32:35]
    ds_read_b64_tr_b16 a[38:39], v13 offset:35872
    s_waitcnt vmcnt(32) lgkmcnt(8)
    v_mfma_f32_16x16x32_bf16 v[32:35], a[4:7], a[152:155], v[32:35]
    ds_read_b64_tr_b16 a[40:41], v14 offset:20480
    v_mfma_f32_16x16x32_bf16 v[52:55], a[0:3], a[148:151], v[52:55]
    ds_read_b64_tr_b16 a[42:43], v14 offset:25600
    s_waitcnt vmcnt(31)
    v_mfma_f32_16x16x32_bf16 v[52:55], a[4:7], a[156:159], v[52:55]
    ds_read_b64_tr_b16 a[44:45], v14 offset:30720
    v_mfma_f32_16x16x32_bf16 v[36:39], a[8:11], a[144:147], v[36:39]
    buffer_load_dword v27, v28, s[68:71], s100 offen sc1
    v_mfma_f32_16x16x32_bf16 v[36:39], a[12:15], a[152:155], v[36:39]
    ds_read_b64_tr_b16 a[46:47], v14 offset:35840
    ds_read_b64_tr_b16 a[48:49], v14 offset:20488
    v_mfma_f32_16x16x32_bf16 v[56:59], a[8:11], a[148:151], v[56:59]
    buffer_load_dwordx2 v[200:201], v25, s[60:63], 0 offen offset:32
    v_mfma_f32_16x16x32_bf16 v[56:59], a[12:15], a[156:159], v[56:59]
    ds_read_b64_tr_b16 a[50:51], v14 offset:25608
    ds_read_b64_tr_b16 a[52:53], v14 offset:30728
    v_mfma_f32_16x16x32_bf16 v[40:43], a[16:19], a[144:147], v[40:43]
    ds_read_b64_tr_b16 a[54:55], v14 offset:35848
    v_mfma_f32_16x16x32_bf16 v[40:43], a[20:23], a[152:155], v[40:43]
    ds_read_b64_tr_b16 a[56:57], v14 offset:20496
    v_mfma_f32_16x16x32_bf16 v[60:63], a[16:19], a[148:151], v[60:63]
    s_barrier
    ds_read_b64_tr_b16 a[58:59], v14 offset:25616
    v_mfma_f32_16x16x32_bf16 v[60:63], a[20:23], a[156:159], v[60:63]
    ds_read_b64_tr_b16 a[60:61], v14 offset:30736
    s_waitcnt lgkmcnt(8)
    v_mfma_f32_16x16x32_bf16 v[44:47], a[24:27], a[144:147], v[44:47]
    ds_read_b64_tr_b16 a[62:63], v14 offset:35856
    v_mfma_f32_16x16x32_bf16 v[44:47], a[28:31], a[152:155], v[44:47]
    ds_read_b64_tr_b16 a[64:65], v14 offset:20504
    v_mfma_f32_16x16x32_bf16 v[64:67], a[24:27], a[148:151], v[64:67]
    ds_read_b64_tr_b16 a[66:67], v14 offset:25624
    v_mfma_f32_16x16x32_bf16 v[64:67], a[28:31], a[156:159], v[64:67]
    ds_read_b64_tr_b16 a[68:69], v14 offset:30744
    v_mfma_f32_16x16x32_bf16 v[48:51], a[32:35], a[144:147], v[48:51]
    ds_read_b64_tr_b16 a[70:71], v14 offset:35864
    v_mfma_f32_16x16x32_bf16 v[48:51], a[36:39], a[152:155], v[48:51]
    ds_read_b64_tr_b16 a[72:73], v14 offset:20512
    v_mfma_f32_16x16x32_bf16 v[68:71], a[32:35], a[148:151], v[68:71]
    ds_read_b64_tr_b16 a[74:75], v14 offset:25632
    v_mfma_f32_16x16x32_bf16 v[68:71], a[36:39], a[156:159], v[68:71]
    ds_read_b64_tr_b16 a[76:77], v14 offset:30752
    ds_read_b64_tr_b16 a[78:79], v14 offset:35872
    v_add_u32 v13, 0xa000, v13
    v_add_u32 v14, 0xa000, v14
    v_mfma_f32_16x16x32_bf16 v[72:75], a[40:43], a[144:147], v[72:75]
    ds_read_b64_tr_b16 a[0:1], v13 offset:40960
    s_waitcnt lgkmcnt(9)
    v_mfma_f32_16x16x32_bf16 v[72:75], a[44:47], a[152:155], v[72:75]
    ds_read_b64_tr_b16 a[2:3], v13 offset:46080
    v_mfma_f32_16x16x32_bf16 v[92:95], a[40:43], a[148:151], v[92:95]
    ds_read_b64_tr_b16 a[4:5], v13 offset:51200
    v_mfma_f32_16x16x32_bf16 v[92:95], a[44:47], a[156:159], v[92:95]
    ds_read_b64_tr_b16 a[6:7], v13 offset:56320
    v_mfma_f32_16x16x32_bf16 v[76:79], a[48:51], a[144:147], v[76:79]
    ds_read_b64_tr_b16 a[8:9], v13 offset:40968
    v_mfma_f32_16x16x32_bf16 v[76:79], a[52:55], a[152:155], v[76:79]
    ds_read_b64_tr_b16 a[10:11], v13 offset:46088
    v_mfma_f32_16x16x32_bf16 v[96:99], a[48:51], a[148:151], v[96:99]
    ds_read_b64_tr_b16 a[12:13], v13 offset:51208
    v_mfma_f32_16x16x32_bf16 v[96:99], a[52:55], a[156:159], v[96:99]
    ds_read_b64_tr_b16 a[14:15], v13 offset:56328
    v_mfma_f32_16x16x32_bf16 v[80:83], a[56:59], a[144:147], v[80:83]
    ds_read_b64_tr_b16 a[16:17], v13 offset:40976
    v_mfma_f32_16x16x32_bf16 v[80:83], a[60:63], a[152:155], v[80:83]
    ds_read_b64_tr_b16 a[18:19], v13 offset:46096
    v_mfma_f32_16x16x32_bf16 v[100:103], a[56:59], a[148:151], v[100:103]
    s_cmp_ge_u32 s7, 4
    s_cselect_b32 s93, 0xe0, 0
    s_cselect_b32 s91, 0, 7680
    s_xor_b32 s93, s93, s2
    s_lshl2_add_u32 s93, s93, s3
    s_mul_i32 s93, s93, 15360
    s_add_u32 s93, s93, s91
    s_add_u32 s91, s93, 2560
    s_add_u32 s98, s93, 5120
    s_xor_b32 s89, s4, 2
    s_sub_i32 s89, s89, s4
    s_mul_i32 s89, s89, 0xf000
    s_add_u32 s89, s89, s93
    s_xor_b32 s90, s4, 4
    s_sub_i32 s90, s90, s4
    s_mul_i32 s90, s90, 0xf000
    s_add_u32 s90, s90, s93
    s_add_u32 s90, s90, 2560
    ds_read_b64_tr_b16 a[20:21], v13 offset:51216
    v_mfma_f32_16x16x32_bf16 v[100:103], a[60:63], a[156:159], v[100:103]
    ds_read_b64_tr_b16 a[22:23], v13 offset:56336
    s_waitcnt lgkmcnt(8)
    v_mfma_f32_16x16x32_bf16 v[84:87], a[64:67], a[144:147], v[84:87]
    ds_read_b64_tr_b16 a[24:25], v13 offset:40984
    v_mfma_f32_16x16x32_bf16 v[84:87], a[68:71], a[152:155], v[84:87]
    ds_read_b64_tr_b16 a[26:27], v13 offset:46104
    v_mfma_f32_16x16x32_bf16 v[104:107], a[64:67], a[148:151], v[104:107]
    ds_read_b64_tr_b16 a[28:29], v13 offset:51224
    v_mfma_f32_16x16x32_bf16 v[104:107], a[68:71], a[156:159], v[104:107]
    ds_read_b64_tr_b16 a[30:31], v13 offset:56344
    v_mfma_f32_16x16x32_bf16 v[88:91], a[72:75], a[144:147], v[88:91]
    ds_read_b64_tr_b16 a[32:33], v13 offset:40992
    v_mfma_f32_16x16x32_bf16 v[88:91], a[76:79], a[152:155], v[88:91]
    ds_read_b64_tr_b16 a[34:35], v13 offset:46112
    v_mfma_f32_16x16x32_bf16 v[108:111], a[72:75], a[148:151], v[108:111]
    ds_read_b64_tr_b16 a[36:37], v13 offset:51232
    v_mfma_f32_16x16x32_bf16 v[108:111], a[76:79], a[156:159], v[108:111]
    ds_read_b64_tr_b16 a[38:39], v13 offset:56352
    s_waitcnt vmcnt(22)
    v_mfma_f32_16x16x32_bf16 v[32:35], a[0:3], a[160:163], v[32:35]
    ds_read_b64_tr_b16 a[40:41], v14 offset:40960
    s_waitcnt vmcnt(4)
    v_lshlrev_b32 v204, 16, v192
    v_mfma_f32_16x16x32_bf16 v[32:35], a[4:7], a[168:171], v[32:35]
    ds_read_b64_tr_b16 a[42:43], v14 offset:46080
    v_mfma_f32_16x16x32_bf16 v[52:55], a[0:3], a[164:167], v[52:55]
    ds_read_b64_tr_b16 a[44:45], v14 offset:51200
    v_mfma_f32_16x16x32_bf16 v[52:55], a[4:7], a[172:175], v[52:55]
    s_waitcnt lgkmcnt(7)
    ds_read_b64_tr_b16 a[46:47], v14 offset:56320
    v_and_b32 v205, 0xffff0000, v192
    v_mfma_f32_16x16x32_bf16 v[36:39], a[8:11], a[160:163], v[36:39]
    ds_read_b64_tr_b16 a[48:49], v14 offset:40968
    v_mfma_f32_16x16x32_bf16 v[36:39], a[12:15], a[168:171], v[36:39]
    ds_read_b64_tr_b16 a[50:51], v14 offset:46088
    v_mfma_f32_16x16x32_bf16 v[56:59], a[8:11], a[164:167], v[56:59]
    ds_read_b64_tr_b16 a[52:53], v14 offset:51208
    v_lshlrev_b32 v206, 16, v193
    v_mfma_f32_16x16x32_bf16 v[56:59], a[12:15], a[172:175], v[56:59]
    ds_read_b64_tr_b16 a[54:55], v14 offset:56328
    v_mfma_f32_16x16x32_bf16 v[40:43], a[16:19], a[160:163], v[40:43]
    ds_read_b64_tr_b16 a[56:57], v14 offset:40976
    v_mfma_f32_16x16x32_bf16 v[40:43], a[20:23], a[168:171], v[40:43]
    ds_read_b64_tr_b16 a[58:59], v14 offset:46096
    v_and_b32 v207, 0xffff0000, v193
    v_mfma_f32_16x16x32_bf16 v[60:63], a[16:19], a[164:167], v[60:63]
    ds_read_b64_tr_b16 a[60:61], v14 offset:51216
    v_mfma_f32_16x16x32_bf16 v[60:63], a[20:23], a[172:175], v[60:63]
    ds_read_b64_tr_b16 a[62:63], v14 offset:56336
    v_mfma_f32_16x16x32_bf16 v[44:47], a[24:27], a[160:163], v[44:47]
    ds_read_b64_tr_b16 a[64:65], v14 offset:40984
    v_lshlrev_b32 v208, 16, v194
    v_mfma_f32_16x16x32_bf16 v[44:47], a[28:31], a[168:171], v[44:47]
    ds_read_b64_tr_b16 a[66:67], v14 offset:46104
    v_mfma_f32_16x16x32_bf16 v[64:67], a[24:27], a[164:167], v[64:67]
    s_waitcnt vmcnt(1)
    v_cmp_eq_u32 vcc, 1, v27
    s_nop 0
    s_bcnt1_i32_b64 s11, vcc
    s_cmp_ge_u32 s11, 16
    s_cbranch_scc0 fk_w7_slow
fk_w7_ok:
    v_mfma_f32_16x16x32_bf16 v[64:67], a[28:31], a[172:175], v[64:67]
    s_waitcnt lgkmcnt(14)
    ds_read_b64_tr_b16 a[68:69], v14 offset:51224
    v_and_b32 v209, 0xffff0000, v194
    v_mfma_f32_16x16x32_bf16 v[48:51], a[32:35], a[160:163], v[48:51]
    s_barrier
    s_xor_b32 s100, s4, 6
    ds_read_b64_tr_b16 a[70:71], v14 offset:56344
    v_mfma_f32_16x16x32_bf16 v[48:51], a[36:39], a[168:171], v[48:51]
    ds_read_b64_tr_b16 a[72:73], v14 offset:40992
    v_mfma_f32_16x16x32_bf16 v[68:71], a[32:35], a[164:167], v[68:71]
    ds_read_b64_tr_b16 a[74:75], v14 offset:46112
    v_lshlrev_b32 v210, 16, v195
    v_mfma_f32_16x16x32_bf16 v[68:71], a[36:39], a[172:175], v[68:71]
    s_waitcnt lgkmcnt(6)
    ds_read_b64_tr_b16 a[76:77], v14 offset:51232
    ds_read_b64_tr_b16 a[78:79], v14 offset:56352
    v_add_u32 v15, 0xfffe7000, v13
    v_add_u32 v16, 0xfffe7000, v14
    v_mfma_f32_16x16x32_bf16 v[72:75], a[40:43], a[160:163], v[72:75]
    s_sub_i32 s100, s100, s4
    ds_read_b64_tr_b16 a[80:81], v14 offset:20480
    v_mfma_f32_16x16x32_bf16 v[72:75], a[44:47], a[168:171], v[72:75]
    ds_read_b64_tr_b16 a[82:83], v14 offset:25600
    v_and_b32 v211, 0xffff0000, v195
    v_mfma_f32_16x16x32_bf16 v[92:95], a[40:43], a[164:167], v[92:95]
    ds_read_b64_tr_b16 a[84:85], v14 offset:30720
    v_mfma_f32_16x16x32_bf16 v[92:95], a[44:47], a[172:175], v[92:95]
    ds_read_b64_tr_b16 a[86:87], v14 offset:35840
    v_mfma_f32_16x16x32_bf16 v[76:79], a[48:51], a[160:163], v[76:79]
    s_mul_i32 s100, s100, 0xf000
    ds_read_b64_tr_b16 a[88:89], v14 offset:0
    v_lshlrev_b32 v212, 16, v196
    v_mfma_f32_16x16x32_bf16 v[76:79], a[52:55], a[168:171], v[76:79]
    ds_read_b64_tr_b16 a[90:91], v14 offset:5120
    v_mfma_f32_16x16x32_bf16 v[96:99], a[48:51], a[164:167], v[96:99]
    ds_read_b64_tr_b16 a[92:93], v14 offset:10240
    v_mfma_f32_16x16x32_bf16 v[96:99], a[52:55], a[172:175], v[96:99]
    ds_read_b64_tr_b16 a[94:95], v14 offset:15360
    v_and_b32 v213, 0xffff0000, v196
    v_mfma_f32_16x16x32_bf16 v[80:83], a[56:59], a[160:163], v[80:83]
    s_add_u32 s100, s100, s93
    ds_read_b64_tr_b16 a[96:97], v16 offset:0
    v_mfma_f32_16x16x32_bf16 v[80:83], a[60:63], a[168:171], v[80:83]
    ds_read_b64_tr_b16 a[98:99], v16 offset:5120
    v_mfma_f32_16x16x32_bf16 v[100:103], a[56:59], a[164:167], v[100:103]
    ds_read_b64_tr_b16 a[100:101], v14 offset:20488
    v_lshlrev_b32 v214, 16, v197
    v_mfma_f32_16x16x32_bf16 v[100:103], a[60:63], a[172:175], v[100:103]
    ds_read_b64_tr_b16 a[102:103], v14 offset:25608
    s_waitcnt lgkmcnt(8)
    v_mfma_f32_16x16x32_bf16 v[84:87], a[64:67], a[160:163], v[84:87]
    s_add_u32 s100, s100, 5120
    ds_read_b64_tr_b16 a[104:105], v14 offset:30728
    v_mfma_f32_16x16x32_bf16 v[84:87], a[68:71], a[168:171], v[84:87]
    ds_read_b64_tr_b16 a[106:107], v14 offset:35848
    v_and_b32 v215, 0xffff0000, v197
    v_mfma_f32_16x16x32_bf16 v[104:107], a[64:67], a[164:167], v[104:107]
    ds_read_b64_tr_b16 a[108:109], v14 offset:8
    v_mfma_f32_16x16x32_bf16 v[104:107], a[68:71], a[172:175], v[104:107]
    ds_read_b64_tr_b16 a[110:111], v14 offset:5128
    v_mfma_f32_16x16x32_bf16 v[88:91], a[72:75], a[160:163], v[88:91]
    ds_read_b64_tr_b16 a[112:113], v14 offset:10248
    v_lshlrev_b32 v216, 16, v198
    v_mfma_f32_16x16x32_bf16 v[88:91], a[76:79], a[168:171], v[88:91]
    ds_read_b64_tr_b16 a[114:115], v14 offset:15368
    v_mfma_f32_16x16x32_bf16 v[108:111], a[72:75], a[164:167], v[108:111]
    ds_read_b64_tr_b16 a[116:117], v16 offset:8
    v_mfma_f32_16x16x32_bf16 v[108:111], a[76:79], a[172:175], v[108:111]
    ds_read_b64_tr_b16 a[118:119], v16 offset:5128
    v_and_b32 v217, 0xffff0000, v198
    v_mfma_f32_16x16x32_bf16 v[92:95], a[80:83], a[180:183], v[92:95]
    ds_read_b64_tr_b16 a[120:121], v14 offset:20496
    v_mfma_f32_16x16x32_bf16 v[92:95], a[84:87], a[188:191], v[92:95]
    ds_read_b64_tr_b16 a[122:123], v14 offset:25616
    s_waitcnt lgkmcnt(8)
    v_mfma_f32_16x16x32_bf16 v[92:95], a[88:91], a[196:199], v[92:95]
    ds_read_b64_tr_b16 a[124:125], v14 offset:30736
    v_lshlrev_b32 v218, 16, v199
    v_mfma_f32_16x16x32_bf16 v[92:95], a[92:95], a[204:207], v[92:95]
    ds_read_b64_tr_b16 a[126:127], v14 offset:35856
    v_mfma_f32_16x16x32_bf16 v[92:95], a[96:99], a[212:215], v[92:95]
    ds_read_b64_tr_b16 a[216:217], v14 offset:16
    v_mfma_f32_16x16x32_bf16 v[72:75], a[80:83], a[176:179], v[72:75]
    ds_read_b64_tr_b16 a[218:219], v14 offset:5136
    v_and_b32 v219, 0xffff0000, v199
    v_mfma_f32_16x16x32_bf16 v[72:75], a[84:87], a[184:187], v[72:75]
    ds_read_b64_tr_b16 a[220:221], v14 offset:10256
    v_mfma_f32_16x16x32_bf16 v[72:75], a[88:91], a[192:195], v[72:75]
    ds_read_b64_tr_b16 a[222:223], v14 offset:15376
    v_mfma_f32_16x16x32_bf16 v[72:75], a[92:95], a[200:203], v[72:75]
    ds_read_b64_tr_b16 a[224:225], v16 offset:16
    s_waitcnt vmcnt(0)
    v_lshlrev_b32 v220, 16, v200
    v_mfma_f32_16x16x32_bf16 v[72:75], a[96:99], a[208:211], v[72:75]
    ds_read_b64_tr_b16 a[226:227], v16 offset:5136
    v_mfma_f32_16x16x32_bf16 v[96:99], a[100:103], a[180:183], v[96:99]
    ds_read_b64_tr_b16 a[228:229], v14 offset:20504
    v_mfma_f32_16x16x32_bf16 v[96:99], a[104:107], a[188:191], v[96:99]
    s_waitcnt lgkmcnt(7)
    ds_read_b64_tr_b16 a[230:231], v14 offset:25624
    v_and_b32 v221, 0xffff0000, v200
    v_mfma_f32_16x16x32_bf16 v[96:99], a[108:111], a[196:199], v[96:99]
    ds_read_b64_tr_b16 a[232:233], v14 offset:30744
    v_mfma_f32_16x16x32_bf16 v[96:99], a[112:115], a[204:207], v[96:99]
    ds_read_b64_tr_b16 a[234:235], v14 offset:35864
    v_mfma_f32_16x16x32_bf16 v[96:99], a[116:119], a[212:215], v[96:99]
    ds_read_b64_tr_b16 a[236:237], v14 offset:24
    v_lshlrev_b32 v222, 16, v201
    v_mfma_f32_16x16x32_bf16 v[76:79], a[100:103], a[176:179], v[76:79]
    ds_read_b64_tr_b16 a[238:239], v14 offset:5144
    v_mfma_f32_16x16x32_bf16 v[76:79], a[104:107], a[184:187], v[76:79]
    ds_read_b64_tr_b16 a[240:241], v14 offset:10264
    v_mfma_f32_16x16x32_bf16 v[76:79], a[108:111], a[192:195], v[76:79]
    ds_read_b64_tr_b16 a[242:243], v14 offset:15384
    v_cvt_pk_bf16_f32 v136, v92, v93
    v_mfma_f32_16x16x32_bf16 v[76:79], a[112:115], a[200:203], v[76:79]
    ds_read_b64_tr_b16 a[244:245], v16 offset:24
    v_cvt_pk_bf16_f32 v137, v94, v95
    v_mfma_f32_16x16x32_bf16 v[76:79], a[116:119], a[208:211], v[76:79]
    ds_read_b64_tr_b16 a[246:247], v16 offset:5144
    v_cvt_pk_bf16_f32 v138, v96, v97
    v_mfma_f32_16x16x32_bf16 v[100:103], a[120:123], a[180:183], v[100:103]
    ds_read_b64_tr_b16 a[248:249], v14 offset:20512
    v_cvt_pk_bf16_f32 v139, v98, v99
    v_mfma_f32_16x16x32_bf16 v[100:103], a[124:127], a[188:191], v[100:103]
    buffer_store_dwordx4 v[136:139], v2, s[52:55], s100 offen sc1
    ds_read_b64_tr_b16 a[250:251], v14 offset:25632
    v_and_b32 v223, 0xffff0000, v201
    s_waitcnt lgkmcnt(8)
    v_mfma_f32_16x16x32_bf16 v[100:103], a[216:219], a[196:199], v[100:103]
    ds_read_b64_tr_b16 a[252:253], v14 offset:30752
    v_cvt_pk_bf16_f32 v124, v72, v73
    v_mfma_f32_16x16x32_bf16 v[100:103], a[220:223], a[204:207], v[100:103]
    ds_read_b64_tr_b16 a[254:255], v14 offset:35872
    v_cvt_pk_bf16_f32 v125, v74, v75
    v_mfma_f32_16x16x32_bf16 v[100:103], a[224:227], a[212:215], v[100:103]
    ds_read_b64_tr_b16 a[128:129], v14 offset:32
    v_cvt_pk_bf16_f32 v126, v76, v77
    v_mfma_f32_16x16x32_bf16 v[80:83], a[120:123], a[176:179], v[80:83]
    ds_read_b64_tr_b16 a[130:131], v14 offset:5152
    v_cvt_pk_bf16_f32 v127, v78, v79
    v_mfma_f32_16x16x32_bf16 v[80:83], a[124:127], a[184:187], v[80:83]
    buffer_store_dwordx4 v[124:127], v2, s[52:55], s90 offen sc1
    ds_read_b64_tr_b16 a[132:133], v14 offset:10272
    v_mfma_f32_16x16x32_bf16 v[80:83], a[216:219], a[192:195], v[80:83]
    ds_read_b64_tr_b16 a[134:135], v14 offset:15392
    v_mfma_f32_16x16x32_bf16 v[80:83], a[220:223], a[200:203], v[80:83]
    ds_read_b64_tr_b16 a[136:137], v16 offset:32
    v_mfma_f32_16x16x32_bf16 v[80:83], a[224:227], a[208:211], v[80:83]
    ds_read_b64_tr_b16 a[138:139], v16 offset:5152
    v_mfma_f32_16x16x32_bf16 v[104:107], a[228:231], a[180:183], v[104:107]
    ds_read_b64_tr_b16 a[140:141], v13 offset:20480
    v_mfma_f32_16x16x32_bf16 v[104:107], a[232:235], a[188:191], v[104:107]
    ds_read_b64_tr_b16 a[142:143], v13 offset:25600
    s_waitcnt lgkmcnt(8)
    v_mfma_f32_16x16x32_bf16 v[104:107], a[236:239], a[196:199], v[104:107]
    ds_read_b64_tr_b16 a[144:145], v13 offset:30720
    v_mfma_f32_16x16x32_bf16 v[104:107], a[240:243], a[204:207], v[104:107]
    ds_read_b64_tr_b16 a[146:147], v13 offset:35840
    v_mfma_f32_16x16x32_bf16 v[104:107], a[244:247], a[212:215], v[104:107]
    ds_read_b64_tr_b16 a[148:149], v13 offset:0
    v_mfma_f32_16x16x32_bf16 v[84:87], a[228:231], a[176:179], v[84:87]
    ds_read_b64_tr_b16 a[150:151], v13 offset:5120
    v_mfma_f32_16x16x32_bf16 v[84:87], a[232:235], a[184:187], v[84:87]
    ds_read_b64_tr_b16 a[152:153], v13 offset:10240
    v_mfma_f32_16x16x32_bf16 v[84:87], a[236:239], a[192:195], v[84:87]
    ds_read_b64_tr_b16 a[154:155], v13 offset:15360
    v_cvt_pk_bf16_f32 v140, v100, v101
    v_mfma_f32_16x16x32_bf16 v[84:87], a[240:243], a[200:203], v[84:87]
    ds_read_b64_tr_b16 a[156:157], v15 offset:0
    v_cvt_pk_bf16_f32 v141, v102, v103
    v_mfma_f32_16x16x32_bf16 v[84:87], a[244:247], a[208:211], v[84:87]
    ds_read_b64_tr_b16 a[158:159], v15 offset:5120
    v_cvt_pk_bf16_f32 v142, v104, v105
    v_mfma_f32_16x16x32_bf16 v[108:111], a[248:251], a[180:183], v[108:111]
    ds_read_b64_tr_b16 a[0:1], v13 offset:20488
    v_cvt_pk_bf16_f32 v143, v106, v107
    v_mfma_f32_16x16x32_bf16 v[108:111], a[252:255], a[188:191], v[108:111]
    buffer_store_dwordx4 v[140:143], v2, s[52:55], s100 offen offset:1024 sc1
    ds_read_b64_tr_b16 a[2:3], v13 offset:25608
    s_waitcnt lgkmcnt(8)
    v_mfma_f32_16x16x32_bf16 v[108:111], a[128:131], a[196:199], v[108:111]
    ds_read_b64_tr_b16 a[4:5], v13 offset:30728
    v_cvt_pk_bf16_f32 v128, v80, v81
    v_mfma_f32_16x16x32_bf16 v[108:111], a[132:135], a[204:207], v[108:111]
    ds_read_b64_tr_b16 a[6:7], v13 offset:35848
    v_cvt_pk_bf16_f32 v129, v82, v83
    v_mfma_f32_16x16x32_bf16 v[108:111], a[136:139], a[212:215], v[108:111]
    ds_read_b64_tr_b16 a[8:9], v13 offset:8
    v_cvt_pk_bf16_f32 v130, v84, v85
    v_mfma_f32_16x16x32_bf16 v[88:91], a[248:251], a[176:179], v[88:91]
    ds_read_b64_tr_b16 a[10:11], v13 offset:5128
    v_cvt_pk_bf16_f32 v131, v86, v87
    v_mfma_f32_16x16x32_bf16 v[88:91], a[252:255], a[184:187], v[88:91]
    buffer_store_dwordx4 v[128:131], v2, s[52:55], s90 offen offset:1024 sc1
    ds_read_b64_tr_b16 a[12:13], v13 offset:10248
    v_mfma_f32_16x16x32_bf16 v[88:91], a[128:131], a[192:195], v[88:91]
    ds_read_b64_tr_b16 a[14:15], v13 offset:15368
    v_cvt_pk_bf16_f32 v144, v108, v109
    v_mfma_f32_16x16x32_bf16 v[88:91], a[132:135], a[200:203], v[88:91]
    ds_read_b64_tr_b16 a[16:17], v15 offset:8
    v_cvt_pk_bf16_f32 v145, v110, v111
    v_mfma_f32_16x16x32_bf16 v[88:91], a[136:139], a[208:211], v[88:91]
    buffer_store_dwordx2 v[144:145], v224, s[52:55], s100 offen offset:2048 sc1
    ds_read_b64_tr_b16 a[18:19], v15 offset:5128
    v_mfma_f32_16x16x32_bf16 v[52:55], a[140:143], a[180:183], v[52:55]
    ds_read_b64_tr_b16 a[20:21], v13 offset:20496
    ds_read_b64_tr_b16 a[22:23], v13 offset:25616
    ds_read_b64_tr_b16 a[24:25], v13 offset:30736
    v_mfma_f32_16x16x32_bf16 v[52:55], a[144:147], a[188:191], v[52:55]
    ds_read_b64_tr_b16 a[26:27], v13 offset:35856
    s_waitcnt lgkmcnt(10)
    v_mfma_f32_16x16x32_bf16 v[52:55], a[148:151], a[196:199], v[52:55]
    ds_read_b64_tr_b16 a[28:29], v13 offset:16
    ds_read_b64_tr_b16 a[30:31], v13 offset:5136
    ds_read_b64_tr_b16 a[32:33], v13 offset:10256
    v_mfma_f32_16x16x32_bf16 v[52:55], a[152:155], a[204:207], v[52:55]
    ds_read_b64_tr_b16 a[34:35], v13 offset:15376
    v_cvt_pk_bf16_f32 v132, v88, v89
    v_mfma_f32_16x16x32_bf16 v[52:55], a[156:159], a[212:215], v[52:55]
    ds_read_b64_tr_b16 a[36:37], v15 offset:16
    ds_read_b64_tr_b16 a[38:39], v15 offset:5136
    ds_read_b64_tr_b16 a[40:41], v13 offset:20504
    v_mfma_f32_16x16x32_bf16 v[56:59], a[0:3], a[180:183], v[56:59]
    ds_read_b64_tr_b16 a[42:43], v13 offset:25624
    v_cvt_pk_bf16_f32 v133, v90, v91
    v_mfma_f32_16x16x32_bf16 v[56:59], a[4:7], a[188:191], v[56:59]
    s_waitcnt lgkmcnt(12)
    ds_read_b64_tr_b16 a[44:45], v13 offset:30744
    ds_read_b64_tr_b16 a[46:47], v13 offset:35864
    ds_read_b64_tr_b16 a[48:49], v13 offset:24
    v_mfma_f32_16x16x32_bf16 v[56:59], a[8:11], a[196:199], v[56:59]
    buffer_store_dwordx2 v[132:133], v224, s[52:55], s90 offen offset:2048 sc1
    ds_read_b64_tr_b16 a[50:51], v13 offset:5144
    v_mfma_f32_16x16x32_bf16 v[56:59], a[12:15], a[204:207], v[56:59]
    ds_read_b64_tr_b16 a[52:53], v13 offset:10264
    ds_read_b64_tr_b16 a[54:55], v13 offset:15384
    ds_read_b64_tr_b16 a[56:57], v15 offset:24
    v_mfma_f32_16x16x32_bf16 v[56:59], a[16:19], a[212:215], v[56:59]
    ds_read_b64_tr_b16 a[58:59], v15 offset:5144
    s_waitcnt lgkmcnt(15)
    v_mfma_f32_16x16x32_bf16 v[60:63], a[20:23], a[180:183], v[60:63]
    ds_read_b64_tr_b16 a[60:61], v13 offset:20512
    ds_read_b64_tr_b16 a[62:63], v13 offset:25632
    ds_read_b64_tr_b16 a[64:65], v13 offset:30752
    v_mfma_f32_16x16x32_bf16 v[60:63], a[24:27], a[188:191], v[60:63]
    ds_read_b64_tr_b16 a[66:67], v13 offset:35872
    s_waitcnt lgkmcnt(15)
    v_mfma_f32_16x16x32_bf16 v[60:63], a[28:31], a[196:199], v[60:63]
    ds_read_b64_tr_b16 a[68:69], v13 offset:32
    ds_read_b64_tr_b16 a[70:71], v13 offset:5152
    ds_read_b64_tr_b16 a[72:73], v13 offset:10272
    v_mfma_f32_16x16x32_bf16 v[60:63], a[32:35], a[204:207], v[60:63]
    s_waitcnt lgkmcnt(14)
    ds_read_b64_tr_b16 a[74:75], v13 offset:15392
    v_cvt_pk_bf16_f32 v112, v52, v53
    v_mfma_f32_16x16x32_bf16 v[60:63], a[36:39], a[212:215], v[60:63]
    ds_read_b64_tr_b16 a[76:77], v15 offset:32
    ds_read_b64_tr_b16 a[78:79], v15 offset:5152
    v_cvt_pk_bf16_f32 v113, v54, v55
    v_mfma_f32_16x16x32_bf16 v[64:67], a[40:43], a[180:183], v[64:67]
    s_waitcnt lgkmcnt(14)
    v_cvt_pk_bf16_f32 v114, v56, v57
    v_cvt_pk_bf16_f32 v115, v58, v59
    v_mfma_f32_16x16x32_bf16 v[64:67], a[44:47], a[188:191], v[64:67]
    buffer_store_dwordx4 v[112:115], v2, s[52:55], s89 offen sc1
    v_mfma_f32_16x16x32_bf16 v[64:67], a[48:51], a[196:199], v[64:67]
    s_waitcnt lgkmcnt(10)
    v_mfma_f32_16x16x32_bf16 v[64:67], a[52:55], a[204:207], v[64:67]
    v_mfma_f32_16x16x32_bf16 v[64:67], a[56:59], a[212:215], v[64:67]
    s_waitcnt lgkmcnt(6)
    v_mfma_f32_16x16x32_bf16 v[68:71], a[60:63], a[180:183], v[68:71]
    v_mfma_f32_16x16x32_bf16 v[68:71], a[64:67], a[188:191], v[68:71]
    s_waitcnt lgkmcnt(2)
    v_mfma_f32_16x16x32_bf16 v[68:71], a[68:71], a[196:199], v[68:71]
    v_cvt_pk_bf16_f32 v116, v60, v61
    v_cvt_pk_bf16_f32 v117, v62, v63
    v_mfma_f32_16x16x32_bf16 v[68:71], a[72:75], a[204:207], v[68:71]
    s_waitcnt lgkmcnt(0)
    v_cvt_pk_bf16_f32 v118, v64, v65
    v_cvt_pk_bf16_f32 v119, v66, v67
    v_mfma_f32_16x16x32_bf16 v[68:71], a[76:79], a[212:215], v[68:71]
    buffer_store_dwordx4 v[116:119], v2, s[52:55], s89 offen offset:1024 sc1
    v_mfma_f32_16x16x32_bf16 v[32:35], a[140:143], a[176:179], v[32:35]
    v_mfma_f32_16x16x32_bf16 v[32:35], a[144:147], a[184:187], v[32:35]
    v_mfma_f32_16x16x32_bf16 v[32:35], a[148:151], a[192:195], v[32:35]
    s_nop 3
    v_cvt_pk_bf16_f32 v120, v68, v69
    v_cvt_pk_bf16_f32 v121, v70, v71
    v_mfma_f32_16x16x32_bf16 v[32:35], a[152:155], a[200:203], v[32:35]
    buffer_store_dwordx2 v[120:121], v224, s[52:55], s89 offen offset:2048 sc1
    v_mfma_f32_16x16x32_bf16 v[32:35], a[156:159], a[208:211], v[32:35]
    v_mfma_f32_16x16x32_bf16 v[36:39], a[0:3], a[176:179], v[36:39]
    v_mfma_f32_16x16x32_bf16 v[36:39], a[4:7], a[184:187], v[36:39]
    v_mfma_f32_16x16x32_bf16 v[36:39], a[8:11], a[192:195], v[36:39]
    s_nop 4
    v_add_f32 v204, v32, v204
    v_add_f32 v205, v33, v205
    v_mfma_f32_16x16x32_bf16 v[36:39], a[12:15], a[200:203], v[36:39]
    v_add_f32 v206, v34, v206
    v_add_f32 v207, v35, v207
    v_mfma_f32_16x16x32_bf16 v[36:39], a[16:19], a[208:211], v[36:39]
    v_mfma_f32_16x16x32_bf16 v[40:43], a[20:23], a[176:179], v[40:43]
    v_mfma_f32_16x16x32_bf16 v[40:43], a[24:27], a[184:187], v[40:43]
    v_mfma_f32_16x16x32_bf16 v[40:43], a[28:31], a[192:195], v[40:43]
    s_nop 4
    v_add_f32 v208, v36, v208
    v_add_f32 v209, v37, v209
    v_mfma_f32_16x16x32_bf16 v[40:43], a[32:35], a[200:203], v[40:43]
    v_add_f32 v210, v38, v210
    v_add_f32 v211, v39, v211
    v_mfma_f32_16x16x32_bf16 v[40:43], a[36:39], a[208:211], v[40:43]
    v_mfma_f32_16x16x32_bf16 v[44:47], a[40:43], a[176:179], v[44:47]
    buffer_load_dwordx4 v[172:175], v2, s[52:55], s98 offen sc1
    v_mfma_f32_16x16x32_bf16 v[44:47], a[44:47], a[184:187], v[44:47]
    buffer_load_dwordx4 v[176:179], v2, s[52:55], s98 offen offset:1024 sc1
    v_mfma_f32_16x16x32_bf16 v[44:47], a[48:51], a[192:195], v[44:47]
    buffer_load_dwordx2 v[180:181], v224, s[52:55], s98 offen offset:2048 sc1
    v_mfma_f32_16x16x32_bf16 v[44:47], a[52:55], a[200:203], v[44:47]
    buffer_load_dwordx4 v[160:163], v2, s[52:55], s91 offen sc1
    v_mfma_f32_16x16x32_bf16 v[44:47], a[56:59], a[208:211], v[44:47]
    buffer_load_dwordx4 v[164:167], v2, s[52:55], s91 offen offset:1024 sc1
    v_mfma_f32_16x16x32_bf16 v[48:51], a[60:63], a[176:179], v[48:51]
    buffer_load_dwordx2 v[168:169], v224, s[52:55], s91 offen offset:2048 sc1
    v_mfma_f32_16x16x32_bf16 v[48:51], a[64:67], a[184:187], v[48:51]
    buffer_load_dwordx4 v[148:151], v2, s[52:55], s93 offen sc1
    v_mfma_f32_16x16x32_bf16 v[48:51], a[68:71], a[192:195], v[48:51]
    buffer_load_dwordx4 v[152:155], v2, s[52:55], s93 offen offset:1024 sc1
    v_mfma_f32_16x16x32_bf16 v[48:51], a[72:75], a[200:203], v[48:51]
    buffer_load_dwordx2 v[156:157], v224, s[52:55], s93 offen offset:2048 sc1
    v_mfma_f32_16x16x32_bf16 v[48:51], a[76:79], a[208:211], v[48:51]
    v_add_f32 v212, v40, v212
    v_add_f32 v213, v41, v213
    v_add_f32 v214, v42, v214
    v_add_f32 v215, v43, v215
    v_add_f32 v216, v44, v216
    v_add_f32 v217, v45, v217
    v_add_f32 v218, v46, v218
    v_add_f32 v219, v47, v219
    v_add_f32 v220, v48, v220
    v_add_f32 v221, v49, v221
    v_add_f32 v222, v50, v222
    v_add_f32 v223, v51, v223
    s_mov_b32 s11, 7
    s_movk_i32 s12, 0x2000
    s_waitcnt vmcnt(0)
fk_xl:
    s_bitcmp0_b32 s11, 2
    s_cbranch_scc1 fk_xn2
    v_max3_u32 v29, v172, v173, v174
    v_max3_u32 v30, v175, v176, v177
    v_max3_u32 v29, v29, v178, v179
    v_max3_u32 v30, v30, v180, v181
    v_max_u32 v29, v29, v30
    v_cmp_eq_u32 vcc, -1, v29
    s_cmp_eq_u32 s12, 0
    s_cbranch_scc1 fk_xo2
    s_cbranch_vccnz fk_xr2
fk_xo2:
    s_bitset0_b32 s11, 2
    v_lshlrev_b32 v92, 16, v172
    v_and_b32 v93, 0xffff0000, v172
    v_lshlrev_b32 v94, 16, v173
    v_and_b32 v95, 0xffff0000, v173
    v_lshlrev_b32 v96, 16, v174
    v_and_b32 v97, 0xffff0000, v174
    v_lshlrev_b32 v98, 16, v175
    v_and_b32 v99, 0xffff0000, v175
    v_lshlrev_b32 v100, 16, v176
    v_and_b32 v101, 0xffff0000, v176
    v_lshlrev_b32 v102, 16, v177
    v_and_b32 v103, 0xffff0000, v177
    v_lshlrev_b32 v104, 16, v178
    v_and_b32 v105, 0xffff0000, v178
    v_lshlrev_b32 v106, 16, v179
    v_and_b32 v107, 0xffff0000, v179
    v_lshlrev_b32 v108, 16, v180
    v_and_b32 v109, 0xffff0000, v180
    v_lshlrev_b32 v110, 16, v181
    v_and_b32 v111, 0xffff0000, v181
fk_xn2:
    s_bitcmp0_b32 s11, 1
    s_cbranch_scc1 fk_xn1
    v_max3_u32 v29, v160, v161, v162
    v_max3_u32 v30, v163, v164, v165
    v_max3_u32 v29, v29, v166, v167
    v_max3_u32 v30, v30, v168, v169
    v_max_u32 v29, v29, v30
    v_cmp_eq_u32 vcc, -1, v29
    s_cmp_eq_u32 s12, 0
    s_cbranch_scc1 fk_xo1
    s_cbranch_vccnz fk_xr1
fk_xo1:
    s_bitset0_b32 s11, 1
    v_lshlrev_b32 v72, 16, v160
    v_and_b32 v73, 0xffff0000, v160
    v_lshlrev_b32 v74, 16, v161
    v_and_b32 v75, 0xffff0000, v161
    v_lshlrev_b32 v76, 16, v162
    v_and_b32 v77, 0xffff0000, v162
    v_lshlrev_b32 v78, 16, v163
    v_and_b32 v79, 0xffff0000, v163
    v_lshlrev_b32 v80, 16, v164
    v_and_b32 v81, 0xffff0000, v164
    v_lshlrev_b32 v82, 16, v165
    v_and_b32 v83, 0xffff0000, v165
    v_lshlrev_b32 v84, 16, v166
    v_and_b32 v85, 0xffff0000, v166
    v_lshlrev_b32 v86, 16, v167
    v_and_b32 v87, 0xffff0000, v167
    v_lshlrev_b32 v88, 16, v168
    v_and_b32 v89, 0xffff0000, v168
    v_lshlrev_b32 v90, 16, v169
    v_and_b32 v91, 0xffff0000, v169
fk_xn1:
    s_bitcmp0_b32 s11, 0
    s_cbranch_scc1 fk_xn0
    v_max3_u32 v29, v148, v149, v150
    v_max3_u32 v30, v151, v152, v153
    v_max3_u32 v29, v29, v154, v155
    v_max3_u32 v30, v30, v156, v157
    v_max_u32 v29, v29, v30
    v_cmp_eq_u32 vcc, -1, v29
    s_cmp_eq_u32 s12, 0
    s_cbranch_scc1 fk_xo0
    s_cbranch_vccnz fk_xr0
fk_xo0:
    s_bitset0_b32 s11, 0
    v_lshlrev_b32 v52, 16, v148
    v_and_b32 v53, 0xffff0000, v148
    v_lshlrev_b32 v54, 16, v149
    v_and_b32 v55, 0xffff0000, v149
    v_lshlrev_b32 v56, 16, v150
    v_and_b32 v57, 0xffff0000, v150
    v_lshlrev_b32 v58, 16, v151
    v_and_b32 v59, 0xffff0000, v151
    v_lshlrev_b32 v60, 16, v152
    v_and_b32 v61, 0xffff0000, v152
    v_lshlrev_b32 v62, 16, v153
    v_and_b32 v63, 0xffff0000, v153
    v_lshlrev_b32 v64, 16, v154
    v_and_b32 v65, 0xffff0000, v154
    v_lshlrev_b32 v66, 16, v155
    v_and_b32 v67, 0xffff0000, v155
    v_lshlrev_b32 v68, 16, v156
    v_and_b32 v69, 0xffff0000, v156
    v_lshlrev_b32 v70, 16, v157
    v_and_b32 v71, 0xffff0000, v157
fk_xn0:
    s_cmp_lg_u32 s11, 0
    s_cbranch_scc1 fk_xs
    v_pk_add_f32 v[204:205], v[204:205], v[52:53]
    v_pk_add_f32 v[206:207], v[206:207], v[54:55]
    v_pk_add_f32 v[208:209], v[208:209], v[56:57]
    v_pk_add_f32 v[210:211], v[210:211], v[58:59]
    v_pk_add_f32 v[204:205], v[204:205], v[72:73]
    v_pk_add_f32 v[206:207], v[206:207], v[74:75]
    v_pk_add_f32 v[208:209], v[208:209], v[76:77]
    v_pk_add_f32 v[210:211], v[210:211], v[78:79]
    v_pk_add_f32 v[204:205], v[204:205], v[92:93]
    v_pk_add_f32 v[206:207], v[206:207], v[94:95]
    v_pk_add_f32 v[208:209], v[208:209], v[96:97]
    v_pk_add_f32 v[210:211], v[210:211], v[98:99]
    v_cvt_pk_bf16_f32 v192, v204, v205
    v_cvt_pk_bf16_f32 v193, v206, v207
    v_cvt_pk_bf16_f32 v194, v208, v209
    v_cvt_pk_bf16_f32 v195, v210, v211
    buffer_store_dwordx4 v[192:195], v25, s[64:67], 0 offen
    v_pk_add_f32 v[212:213], v[212:213], v[60:61]
    v_pk_add_f32 v[214:215], v[214:215], v[62:63]
    v_pk_add_f32 v[216:217], v[216:217], v[64:65]
    v_pk_add_f32 v[218:219], v[218:219], v[66:67]
    v_pk_add_f32 v[212:213], v[212:213], v[80:81]
    v_pk_add_f32 v[214:215], v[214:215], v[82:83]
    v_pk_add_f32 v[216:217], v[216:217], v[84:85]
    v_pk_add_f32 v[218:219], v[218:219], v[86:87]
    v_pk_add_f32 v[212:213], v[212:213], v[100:101]
    v_pk_add_f32 v[214:215], v[214:215], v[102:103]
    v_pk_add_f32 v[216:217], v[216:217], v[104:105]
    v_pk_add_f32 v[218:219], v[218:219], v[106:107]
    v_cvt_pk_bf16_f32 v196, v212, v213
    v_cvt_pk_bf16_f32 v197, v214, v215
    v_cvt_pk_bf16_f32 v198, v216, v217
    v_cvt_pk_bf16_f32 v199, v218, v219
    buffer_store_dwordx4 v[196:199], v25, s[64:67], 0 offen offset:16
    v_pk_add_f32 v[220:221], v[220:221], v[68:69]
    v_pk_add_f32 v[222:223], v[222:223], v[70:71]
    v_pk_add_f32 v[220:221], v[220:221], v[88:89]
    v_pk_add_f32 v[222:223], v[222:223], v[90:91]
    v_pk_add_f32 v[220:221], v[220:221], v[108:109]
    v_pk_add_f32 v[222:223], v[222:223], v[110:111]
    v_cvt_pk_bf16_f32 v200, v220, v221
    v_cvt_pk_bf16_f32 v201, v222, v223
    buffer_store_dwordx2 v[200:201], v25, s[64:67], 0 offen offset:32
    s_endpgm
fk_xr0:
    buffer_load_dwordx4 v[148:151], v2, s[52:55], s93 offen sc1
    buffer_load_dwordx4 v[152:155], v2, s[52:55], s93 offen offset:1024 sc1
    buffer_load_dwordx2 v[156:157], v224, s[52:55], s93 offen offset:2048 sc1
    s_branch fk_xn0
fk_xr1:
    buffer_load_dwordx4 v[160:163], v2, s[52:55], s91 offen sc1
    buffer_load_dwordx4 v[164:167], v2, s[52:55], s91 offen offset:1024 sc1
    buffer_load_dwordx2 v[168:169], v224, s[52:55], s91 offen offset:2048 sc1
    s_branch fk_xn1
fk_xr2:
    buffer_load_dwordx4 v[172:175], v2, s[52:55], s98 offen sc1
    buffer_load_dwordx4 v[176:179], v2, s[52:55], s98 offen offset:1024 sc1
    buffer_load_dwordx2 v[180:181], v224, s[52:55], s98 offen offset:2048 sc1
    s_branch fk_xn2
fk_xs:
    s_waitcnt vmcnt(0)
    s_sub_u32 s12, s12, 1
    s_branch fk_xl
fk_last:
.section .rodata,"a"
.p2align 6
.amdhsa_kernel fk_kernel
  .amdhsa_next_free_vgpr 512
  .amdhsa_next_free_sgpr 102
  .amdhsa_accum_offset 256
  .amdhsa_group_segment_fixed_size 0
  .amdhsa_kernarg_size 112
  .amdhsa_user_sgpr_count 2
  .amdhsa_user_sgpr_kernarg_segment_ptr 1
  .amdhsa_system_sgpr_workgroup_id_x 1
.end_amdhsa_kernel
```
